```python
import torch

def _softmax(x, axis=-1):
    return torch.softmax(x, dim=axis)
def _gelu(x):
    return torch.nn.functional.gelu(x, approximate="tanh")
def _silu(x):
    return torch.nn.functional.silu(x)
def _sigmoid(x):
    return torch.sigmoid(x)
def _layernorm(x, axis=-1, eps=1e-5):
    m = x.mean(dim=axis, keepdim=True)
    v = x.var(dim=axis, keepdim=True, unbiased=False)
    return (x - m) / torch.sqrt(v + eps)
def _scatter_add(tgt, idx, src, axis=0):
    return tgt.clone().index_add_(axis, idx, src)
def _segment_sum(src, seg, n):
    out = torch.zeros((n,) + src.shape[1:], dtype=src.dtype)
    return out.index_add_(0, seg, src)
def _pad(x, pw):
    flat = tuple(v for pair in reversed(pw) for v in pair)
    return torch.nn.functional.pad(x, flat)

kernel_name = 'recurrent_scan__mha_block__mixer_channel_mlp__prompt'

def setup_inputs():

    _w = (lambda a: (lambda t: t.to(torch.bfloat16) if t.is_floating_point() else t)(torch.as_tensor(a)))
    def _A_setup():
        B, S, D, H = 1, 2048, 1024, 32
        return {
            "x": _w((lambda *s: torch.randn(*s, dtype=torch.bfloat16) * 0.05)(B, S, D)),
            "wqkv": _w((lambda *s: torch.randn(*s, dtype=torch.bfloat16) * 0.05)(D, 3 * D)),
            "wo": _w((lambda *s: torch.randn(*s, dtype=torch.bfloat16) * 0.05)(D, D)),
        }
    _A_in = _A_setup()

    def _B_setup():
        B, S, D, F = 1, 2048, 1024, 3584
        return {
            "x": _w((lambda *s: torch.randn(*s, dtype=torch.bfloat16) * 0.05)(B, S, D)),
            "w1": _w((lambda *s: torch.randn(*s, dtype=torch.bfloat16) * 1.6)(D, F) * (D ** -0.5)),
            "b1": _w((lambda *s: torch.randn(*s, dtype=torch.bfloat16) * 0.8)(F)),
            "w2": _w((lambda *s: torch.randn(*s, dtype=torch.bfloat16) * 0.05)(F, D) * (F ** -0.5)),
            "b2": _w((lambda *s: torch.randn(*s, dtype=torch.bfloat16) * 0.05)(D)),
        }
    _B_in = _B_setup()

    return {
        "A_x": _A_in["x"],
        "A_wqkv": _A_in["wqkv"],
        "A_wo": _A_in["wo"],
        "B_x": _B_in["x"],
        "B_w1": _B_in["w1"],
        "B_b1": _B_in["b1"],
        "B_w2": _B_in["w2"],
        "B_b2": _B_in["b2"],
    }

def reference(A_x, A_wqkv, A_wo, B_x, B_w1, B_b1, B_w2, B_b2):
    def _A_ref(x, wqkv, wo):
        B, S, D = x.shape
        H = 32
        Dh = D // H
        qkv = (lambda x, *d: x.permute(*d))((x @ wqkv).reshape(B, S, 3, H, Dh), 2, 0, 3, 1, 4)
        q, k, v = qkv[0], qkv[1], qkv[2]
        scores = torch.einsum("bhqd,bhkd->bhqk", q, k) * (Dh ** -0.5)
        p = _softmax(scores, axis=-1)
        o = torch.einsum("bhqk,bhkd->bhqd", p, v)
        return (lambda x, *d: x.permute(*d))(o, 0, 2, 1, 3).reshape(B, S, D) @ wo

    def _B_ref(x, w1, b1, w2, b2):
        y = _layernorm(x, axis=-1)
        h = _gelu(torch.einsum("bsd,df->bsf", y, w1) + b1)
        return torch.einsum("bsf,fd->bsd", h, w2) + b2

    x = A_x
    xn = _layernorm(x, axis=-1)
    s = _A_ref(xn, A_wqkv, A_wo)
    g = _silu(_B_ref(xn, B_w1, B_b1, B_w2, B_b2))
    return x + s * g
```

```asm
; @launch kernel=gemm1_kernel grid=(256,1,1) block=(256,1,1) lds=131328
; @launch kernel=mid_kernel grid=(512,1,1) block=(256,1,1) lds=65792
.amdgcn_target "amdgcn-amd-amdhsa--gfx950"
.text
.globl gemm1_kernel
.p2align 8
.type gemm1_kernel,@function
gemm1_kernel:
s_cmp_ge_u32 s2, 256
s_cbranch_scc1 L_gemm1_kernel_end
s_load_dwordx2 s[4:5], s[0:1], 8
s_load_dwordx4 s[8:11], s[0:1], 32
s_load_dwordx2 s[6:7], s[0:1], 80
s_load_dwordx2 s[32:33], s[0:1], 0
s_load_dwordx2 s[34:35], s[0:1], 72
s_getpc_b64 s[98:99]
L_pc_gemm1_kernel:
s_sub_u32 s98, s98, L_pc_gemm1_kernel - gemm1_kernel
s_subb_u32 s99, s99, 0
s_lshr_b32 s97, s2, 3
s_and_b32 s97, s97, 31
s_lshl_b32 s97, s97, 15
v_lshlrev_b32 v62, 7, v0
v_add_u32 v62, s97, v62
s_mov_b32 s97, L_gemm1_kernel_end - gemm1_kernel - 4
v_min_u32 v62, s97, v62
v_and_b32 v62, -4, v62
global_load_dword v63, v62, s[98:99]
v_lshrrev_b32 v1, 6, v0
s_and_b32 s12, s2, 7
s_lshr_b32 s13, s2, 3
v_readfirstlane_b32 s40, v1
s_and_b32 s14, s13, 3
s_lshr_b32 s13, s13, 2
s_and_b32 s15, s12, 1
s_lshl_b32 s15, s15, 2
s_add_u32 s14, s14, s15
s_lshr_b32 s12, s12, 1
s_lshl_b32 s16, s14, 4
s_lshl_b32 s17, s40, 2
s_add_u32 s16, s16, s17
s_waitcnt lgkmcnt(0)
s_lshl_b32 s47, s14, 5
s_lshl_b32 s17, s12, 3
s_add_u32 s47, s47, s17
s_add_u32 s47, s47, s13
s_mov_b32 s76, s32
s_and_b32 s77, s33, 0xffff
s_mov_b32 s78, 0x400000
s_mov_b32 s79, 0x20000
v_and_b32 v196, 7, v0
v_lshrrev_b32 v197, 3, v0
s_lshl_b32 s3, s47, 3
v_add_u32 v192, s3, v196
v_lshlrev_b32 v192, 11, v192
v_lshl_add_u32 v192, v197, 4, v192
buffer_load_dwordx4 v[64:67], v192, s[76:79], 0 offen offset:0
buffer_load_dwordx4 v[68:71], v192, s[76:79], 0 offen offset:512
buffer_load_dwordx4 v[72:75], v192, s[76:79], 0 offen offset:1024
buffer_load_dwordx4 v[76:79], v192, s[76:79], 0 offen offset:1536
s_add_u32 s76, s6, 0x3d00000
s_addc_u32 s77, s7, 0
s_and_b32 s77, s77, 0xffff
s_mov_b32 s78, 0x20000
s_mov_b32 s79, 0x20000
s_lshl_b32 s36, s47, 7
s_add_u32 s36, s36, 0x8000
v_mov_b32 v194, s36
v_mov_b32 v195, 0
buffer_store_dword v195, v194, s[76:79], 0 offen sc1
s_cmp_lt_u32 s13, 3
s_cbranch_scc1 L_gemm1_kernel_qkv
s_cmp_lt_u32 s13, 7
s_cbranch_scc1 L_gemm1_kernel_w12
s_branch L_gemm1_kernel_w8
L_gemm1_kernel_qkv:
s_mul_i32 s19, s12, 3
s_add_u32 s19, s19, s13
s_lshl_b32 s18, s19, 9
s_lshr_b32 s20, s19, 2
s_and_b32 s21, s19, 3
s_lshl_b32 s21, s21, 3
s_cmp_eq_u32 s20, 2
s_cbranch_scc1 L_gemm1_kernel_v
v_and_b32 v2, 63, v0
v_lshlrev_b32 v8, 4, v2
v_add_u32 v9, 32768, v8
v_add_u32 v10, 65536, v8
v_add_u32 v11, 98304, v8
s_mov_b32 s45, 6144
v_and_b32 v2, 63, v0
v_lshrrev_b32 v3, 5, v2
s_mul_i32 s46, s40, 2
v_add_u32 v3, s46, v3
v_and_b32 v2, 31, v2
v_and_b32 v4, 7, v3
v_lshlrev_b32 v4, 1, v4
v_xor_b32 v2, v2, v4
v_lshlrev_b32 v2, 4, v2
v_bfe_u32 v4, v3, 2, 2
v_lshrrev_b32 v5, 4, v3
v_and_b32 v3, 3, v3
v_lshl_add_u32 v3, v4, 3, v3
v_lshl_add_u32 v3, v5, 2, v3
v_mul_lo_u32 v3, v3, s45
v_add_u32 v12, v2, v3
v_add_u32 v13, 98304, v12
v_add_u32 v14, 24576, v12
v_add_u32 v15, 122880, v12
s_lshl_b32 s43, s40, 10
s_mov_b32 s41, 0
s_mov_b32 s42, 0
s_waitcnt lgkmcnt(0)
s_add_u32 s52, s4, s18
s_addc_u32 s53, s5, 0
s_and_b32 s53, s53, 0xffff
s_sub_u32 s54, 0x600000, s18
s_mov_b32 s55, 0x20000
s_lshl_b32 s17, s16, 15
s_add_u32 s48, s6, s17
s_addc_u32 s49, s7, 0
s_and_b32 s49, s49, 0xffff
s_mov_b32 s50, 131072
s_mov_b32 s51, 0x20000
s_add_u32 m0, s43, 0
s_nop 0
buffer_load_dwordx4 v12, s[52:55], s42 offen lds
s_add_u32 m0, s43, 4096
s_nop 0
buffer_load_dwordx4 v13, s[52:55], s42 offen lds
s_add_u32 m0, s43, 8192
s_nop 0
buffer_load_dwordx4 v14, s[52:55], s42 offen lds
s_add_u32 m0, s43, 12288
s_nop 0
buffer_load_dwordx4 v15, s[52:55], s42 offen lds
s_add_u32 s42, s42, 196608
s_add_u32 m0, s43, 16384
s_nop 0
buffer_load_dwordx4 v12, s[52:55], s42 offen lds
s_add_u32 m0, s43, 20480
s_nop 0
buffer_load_dwordx4 v13, s[52:55], s42 offen lds
s_add_u32 m0, s43, 24576
s_nop 0
buffer_load_dwordx4 v14, s[52:55], s42 offen lds
s_add_u32 m0, s43, 28672
s_nop 0
buffer_load_dwordx4 v15, s[52:55], s42 offen lds
s_add_u32 s42, s42, 196608
s_mov_b32 s68, s6
s_and_b32 s69, s7, 0xffff
s_mov_b32 s70, 0x400000
s_mov_b32 s71, 0x20000
s_add_u32 s60, s6, 0x3c00000
s_addc_u32 s61, s7, 0
s_and_b32 s61, s61, 0xffff
s_mov_b32 s62, 0x2000
s_mov_b32 s63, 0x20000
s_mov_b32 s72, s34
s_and_b32 s73, s35, 0xffff
s_mov_b32 s74, 0x100
s_mov_b32 s75, 0x20000
s_lshr_b32 s36, s47, 1
s_lshl_b32 s36, s36, 15
s_and_b32 s37, s47, 1
s_lshl_b32 s37, s37, 7
s_add_u32 s36, s36, s37
v_lshrrev_b32 v193, 2, v197
v_lshlrev_b32 v193, 10, v193
v_and_b32 v198, 3, v197
v_lshl_add_u32 v193, v198, 8, v193
v_lshl_add_u32 v193, v196, 4, v193
v_add_u32 v193, s36, v193
v_lshrrev_b32 v194, 6, v0
v_lshl_add_u32 v194, v194, 3, v196
v_lshlrev_b32 v194, 2, v194
v_add_u32 v194, 131072, v194
v_lshlrev_b32 v195, 2, v196
v_add_u32 v195, 131072, v195
s_waitcnt vmcnt(12)
v_lshlrev_b32 v80, 16, v64
v_and_b32 v81, 0xffff0000, v64
v_lshlrev_b32 v82, 16, v65
v_and_b32 v83, 0xffff0000, v65
v_lshlrev_b32 v84, 16, v66
v_and_b32 v85, 0xffff0000, v66
v_lshlrev_b32 v86, 16, v67
v_and_b32 v87, 0xffff0000, v67
s_waitcnt vmcnt(11)
v_lshlrev_b32 v88, 16, v68
v_and_b32 v89, 0xffff0000, v68
v_lshlrev_b32 v90, 16, v69
v_and_b32 v91, 0xffff0000, v69
v_lshlrev_b32 v92, 16, v70
v_and_b32 v93, 0xffff0000, v70
v_lshlrev_b32 v94, 16, v71
v_and_b32 v95, 0xffff0000, v71
s_waitcnt vmcnt(10)
v_lshlrev_b32 v96, 16, v72
v_and_b32 v97, 0xffff0000, v72
v_lshlrev_b32 v98, 16, v73
v_and_b32 v99, 0xffff0000, v73
v_lshlrev_b32 v100, 16, v74
v_and_b32 v101, 0xffff0000, v74
v_lshlrev_b32 v102, 16, v75
v_and_b32 v103, 0xffff0000, v75
s_waitcnt vmcnt(9)
v_lshlrev_b32 v104, 16, v76
v_and_b32 v105, 0xffff0000, v76
v_lshlrev_b32 v106, 16, v77
v_and_b32 v107, 0xffff0000, v77
v_lshlrev_b32 v108, 16, v78
v_and_b32 v109, 0xffff0000, v78
v_lshlrev_b32 v110, 16, v79
v_and_b32 v111, 0xffff0000, v79
v_pk_mul_f32 v[144:145], v[80:81], v[80:81]
v_pk_mul_f32 v[146:147], v[82:83], v[82:83]
v_pk_mul_f32 v[148:149], v[84:85], v[84:85]
v_pk_mul_f32 v[150:151], v[86:87], v[86:87]
v_pk_fma_f32 v[144:145], v[88:89], v[88:89], v[144:145]
v_pk_fma_f32 v[146:147], v[90:91], v[90:91], v[146:147]
v_pk_fma_f32 v[148:149], v[92:93], v[92:93], v[148:149]
v_pk_fma_f32 v[150:151], v[94:95], v[94:95], v[150:151]
v_pk_fma_f32 v[144:145], v[96:97], v[96:97], v[144:145]
v_pk_fma_f32 v[146:147], v[98:99], v[98:99], v[146:147]
v_pk_fma_f32 v[148:149], v[100:101], v[100:101], v[148:149]
v_pk_fma_f32 v[150:151], v[102:103], v[102:103], v[150:151]
v_pk_fma_f32 v[144:145], v[104:105], v[104:105], v[144:145]
v_pk_fma_f32 v[146:147], v[106:107], v[106:107], v[146:147]
v_pk_fma_f32 v[148:149], v[108:109], v[108:109], v[148:149]
v_pk_fma_f32 v[150:151], v[110:111], v[110:111], v[150:151]
v_pk_add_f32 v[112:113], v[80:81], v[82:83]
v_pk_add_f32 v[114:115], v[84:85], v[86:87]
v_pk_add_f32 v[116:117], v[88:89], v[90:91]
v_pk_add_f32 v[118:119], v[92:93], v[94:95]
v_pk_add_f32 v[120:121], v[96:97], v[98:99]
v_pk_add_f32 v[122:123], v[100:101], v[102:103]
v_pk_add_f32 v[124:125], v[104:105], v[106:107]
v_pk_add_f32 v[126:127], v[108:109], v[110:111]
v_pk_add_f32 v[128:129], v[112:113], v[114:115]
v_pk_add_f32 v[130:131], v[116:117], v[118:119]
v_pk_add_f32 v[132:133], v[120:121], v[122:123]
v_pk_add_f32 v[134:135], v[124:125], v[126:127]
v_pk_add_f32 v[136:137], v[128:129], v[130:131]
v_pk_add_f32 v[138:139], v[132:133], v[134:135]
v_pk_add_f32 v[140:141], v[136:137], v[138:139]
v_add_f32 v200, v140, v141
v_pk_add_f32 v[152:153], v[144:145], v[146:147]
v_pk_add_f32 v[154:155], v[148:149], v[150:151]
v_pk_add_f32 v[156:157], v[152:153], v[154:155]
v_add_f32 v201, v156, v157
s_nop 1
v_add_f32_dpp v200, v200, v200 row_ror:8 row_mask:0xf bank_mask:0xf
v_add_f32_dpp v201, v201, v201 row_ror:8 row_mask:0xf bank_mask:0xf
v_mov_b32 v208, v200
v_mov_b32 v212, v201
s_nop 1
v_permlane16_swap_b32 v200, v208
v_permlane16_swap_b32 v201, v212
s_nop 1
v_add_f32 v200, v200, v208
v_add_f32 v201, v201, v212
v_mov_b32 v208, v200
v_mov_b32 v212, v201
s_nop 1
v_permlane32_swap_b32 v200, v208
v_permlane32_swap_b32 v201, v212
s_nop 1
v_add_f32 v200, v200, v208
v_add_f32 v201, v201, v212
v_lshlrev_b32 v194, 1, v194
v_subrev_u32 v194, 131072, v194
v_lshlrev_b32 v195, 1, v195
v_subrev_u32 v195, 131072, v195
ds_write_b64 v194, v[200:201]
s_waitcnt lgkmcnt(0)
s_barrier
ds_read_b64 v[112:113], v195 offset:0
ds_read_b64 v[114:115], v195 offset:64
ds_read_b64 v[116:117], v195 offset:128
ds_read_b64 v[118:119], v195 offset:192
s_waitcnt lgkmcnt(0)
v_pk_add_f32 v[112:113], v[112:113], v[114:115]
v_pk_add_f32 v[116:117], v[116:117], v[118:119]
v_pk_add_f32 v[112:113], v[112:113], v[116:117]
v_mul_f32 v112, 0x3a800000, v112
v_mul_f32 v200, 0x3a800000, v113
v_fma_f32 v200, -v112, v112, v200
v_max_f32 v200, 0, v200
v_add_f32 v206, 0x3727c5ac, v200
v_rsq_f32 v206, v206
s_nop 0
v_mul_f32 v210, 0x3f014852, v206
v_mul_f32 v211, -v112, v210
v_pk_fma_f32 v[80:81], v[80:81], v[210:211], v[210:211] op_sel:[0,0,1] op_sel_hi:[1,0,1]
v_pk_fma_f32 v[82:83], v[82:83], v[210:211], v[210:211] op_sel:[0,0,1] op_sel_hi:[1,0,1]
v_pk_fma_f32 v[84:85], v[84:85], v[210:211], v[210:211] op_sel:[0,0,1] op_sel_hi:[1,0,1]
v_pk_fma_f32 v[86:87], v[86:87], v[210:211], v[210:211] op_sel:[0,0,1] op_sel_hi:[1,0,1]
v_pk_fma_f32 v[88:89], v[88:89], v[210:211], v[210:211] op_sel:[0,0,1] op_sel_hi:[1,0,1]
v_pk_fma_f32 v[90:91], v[90:91], v[210:211], v[210:211] op_sel:[0,0,1] op_sel_hi:[1,0,1]
v_pk_fma_f32 v[92:93], v[92:93], v[210:211], v[210:211] op_sel:[0,0,1] op_sel_hi:[1,0,1]
v_pk_fma_f32 v[94:95], v[94:95], v[210:211], v[210:211] op_sel:[0,0,1] op_sel_hi:[1,0,1]
v_pk_fma_f32 v[96:97], v[96:97], v[210:211], v[210:211] op_sel:[0,0,1] op_sel_hi:[1,0,1]
v_pk_fma_f32 v[98:99], v[98:99], v[210:211], v[210:211] op_sel:[0,0,1] op_sel_hi:[1,0,1]
v_pk_fma_f32 v[100:101], v[100:101], v[210:211], v[210:211] op_sel:[0,0,1] op_sel_hi:[1,0,1]
v_pk_fma_f32 v[102:103], v[102:103], v[210:211], v[210:211] op_sel:[0,0,1] op_sel_hi:[1,0,1]
v_pk_fma_f32 v[104:105], v[104:105], v[210:211], v[210:211] op_sel:[0,0,1] op_sel_hi:[1,0,1]
v_pk_fma_f32 v[106:107], v[106:107], v[210:211], v[210:211] op_sel:[0,0,1] op_sel_hi:[1,0,1]
v_pk_fma_f32 v[108:109], v[108:109], v[210:211], v[210:211] op_sel:[0,0,1] op_sel_hi:[1,0,1]
v_pk_fma_f32 v[110:111], v[110:111], v[210:211], v[210:211] op_sel:[0,0,1] op_sel_hi:[1,0,1]
v_cvt_pk_bf16_f32 v64, v80, v81
v_cvt_pk_bf16_f32 v65, v82, v83
v_cvt_pk_bf16_f32 v66, v84, v85
v_cvt_pk_bf16_f32 v67, v86, v87
v_cvt_pk_bf16_f32 v68, v88, v89
v_cvt_pk_bf16_f32 v69, v90, v91
v_cvt_pk_bf16_f32 v70, v92, v93
v_cvt_pk_bf16_f32 v71, v94, v95
v_cvt_pk_bf16_f32 v72, v96, v97
v_cvt_pk_bf16_f32 v73, v98, v99
v_cvt_pk_bf16_f32 v74, v100, v101
v_cvt_pk_bf16_f32 v75, v102, v103
v_cvt_pk_bf16_f32 v76, v104, v105
v_cvt_pk_bf16_f32 v77, v106, v107
v_cvt_pk_bf16_f32 v78, v108, v109
v_cvt_pk_bf16_f32 v79, v110, v111
s_mov_b32 s36, 8192
s_mov_b32 s37, 16384
s_mov_b32 s27, 24576
buffer_store_dwordx4 v[64:67], v193, s[68:71], 0 offen sc1
buffer_store_dwordx4 v[68:71], v193, s[68:71], s36 offen sc1
buffer_store_dwordx4 v[72:75], v193, s[68:71], s37 offen sc1
buffer_store_dwordx4 v[76:79], v193, s[68:71], s27 offen sc1
v_mul_f32 v209, v206, v206
v_mul_f32 v209, v209, v200
v_add_f32 v209, 0x3727c5ac, v209
v_rsq_f32 v209, v209
v_add_u32 v198, s3, v196
v_lshlrev_b32 v198, 2, v198
v_mul_f32 v209, 0x3ffd75e0, v209
buffer_store_dword v209, v198, s[60:63], 0 offen sc1
s_waitcnt vmcnt(0)
s_barrier
s_cmp_lg_u32 s40, 0
s_cbranch_scc1 L_gemm1_kernel_qk_ln_nosig
s_lshr_b32 s36, s47, 5
s_lshl_b32 s37, s36, 5
v_mov_b32 v6, s37
v_mov_b32 v7, 1
s_mov_b64 s[38:39], exec
s_mov_b64 exec, 1
buffer_atomic_add v7, v6, s[72:75], 0 offen sc0 sc1
s_mov_b64 exec, s[38:39]
L_gemm1_kernel_qk_ln_nosig:
s_add_u32 m0, s43, 32768
s_nop 0
buffer_load_dwordx4 v12, s[52:55], s42 offen lds
s_add_u32 m0, s43, 36864
s_nop 0
buffer_load_dwordx4 v13, s[52:55], s42 offen lds
s_add_u32 m0, s43, 40960
s_nop 0
buffer_load_dwordx4 v14, s[52:55], s42 offen lds
s_add_u32 m0, s43, 45056
s_nop 0
buffer_load_dwordx4 v15, s[52:55], s42 offen lds
s_add_u32 s42, s42, 196608
s_add_u32 m0, s43, 49152
s_nop 0
buffer_load_dwordx4 v12, s[52:55], s42 offen lds
s_add_u32 m0, s43, 53248
s_nop 0
buffer_load_dwordx4 v13, s[52:55], s42 offen lds
s_add_u32 m0, s43, 57344
s_nop 0
buffer_load_dwordx4 v14, s[52:55], s42 offen lds
s_add_u32 m0, s43, 61440
s_nop 0
buffer_load_dwordx4 v15, s[52:55], s42 offen lds
s_add_u32 s42, s42, 196608
s_add_u32 m0, s43, 65536
s_nop 0
buffer_load_dwordx4 v12, s[52:55], s42 offen lds
s_add_u32 m0, s43, 69632
s_nop 0
buffer_load_dwordx4 v13, s[52:55], s42 offen lds
s_add_u32 m0, s43, 73728
s_nop 0
buffer_load_dwordx4 v14, s[52:55], s42 offen lds
s_add_u32 m0, s43, 77824
s_nop 0
buffer_load_dwordx4 v15, s[52:55], s42 offen lds
s_add_u32 s42, s42, 196608
s_add_u32 m0, s43, 81920
s_nop 0
buffer_load_dwordx4 v12, s[52:55], s42 offen lds
s_add_u32 m0, s43, 86016
s_nop 0
buffer_load_dwordx4 v13, s[52:55], s42 offen lds
s_add_u32 m0, s43, 90112
s_nop 0
buffer_load_dwordx4 v14, s[52:55], s42 offen lds
s_add_u32 m0, s43, 94208
s_nop 0
buffer_load_dwordx4 v15, s[52:55], s42 offen lds
s_add_u32 s42, s42, 196608
s_lshl_b32 s22, s20, 22
s_add_u32 s22, s22, 4194304
s_add_u32 s56, s6, s22
s_addc_u32 s57, s7, 0
s_and_b32 s57, s57, 0xffff
s_mov_b32 s58, 4194304
s_mov_b32 s59, 0x20000
v_and_b32 v1, 63, v0
v_lshlrev_b32 v1, 4, v1
s_lshl_b32 s17, s16, 10
v_add_u32 v1, s17, v1
s_lshl_b32 s23, s21, 17
v_bfe_u32 v3, v0, 2, 4
v_and_b32 v4, 7, v3
v_lshlrev_b32 v4, 5, v4
v_mul_u32_u24 v3, 512, v3
v_and_b32 v2, 3, v0
v_lshl_add_u32 v3, v2, 3, v3
v_xor_b32 v2, 0, v4
v_add_u32 v16, v2, v3
v_add_u32 v24, 65536, v16
v_xor_b32 v2, 32, v4
v_add_u32 v17, v2, v3
v_add_u32 v25, 65536, v17
v_xor_b32 v2, 64, v4
v_add_u32 v18, v2, v3
v_add_u32 v26, 65536, v18
v_xor_b32 v2, 96, v4
v_add_u32 v19, v2, v3
v_add_u32 v27, 65536, v19
v_xor_b32 v2, 128, v4
v_add_u32 v20, v2, v3
v_add_u32 v28, 65536, v20
v_xor_b32 v2, 160, v4
v_add_u32 v21, v2, v3
v_add_u32 v29, 65536, v21
v_xor_b32 v2, 192, v4
v_add_u32 v22, v2, v3
v_add_u32 v30, 65536, v22
v_xor_b32 v2, 224, v4
v_add_u32 v23, v2, v3
v_add_u32 v31, 65536, v23
s_add_u32 s28, s6, 0x3d00000
s_addc_u32 s29, s7, 0
s_and_b32 s29, s29, 0xffff
s_mov_b32 s30, 0x20000
s_mov_b32 s31, 0x20000
s_lshl_b32 s36, s2, 7
s_add_u32 s36, s36, 0x10000
v_and_b32 v5, 31, v0
v_lshlrev_b32 v5, 2, v5
v_add_u32 v5, s36, v5
s_lshl_b32 s36, s2, 6
s_add_u32 s36, s36, 4096
v_mov_b32 v3, s36
v_mov_b32 v2, 0
buffer_store_dword v2, v5, s[28:31], 0 offen
buffer_store_dword v2, v3, s[28:31], 0 offen
s_nop 0
v_mov_b32 v2, 0
v_mov_b32 v3, 0
v_mov_b32 v4, 0
v_mov_b32 v5, 0
s_nop 1
v_mfma_f32_32x32x16_bf16 v[32:47], v[2:5], v[2:5], 0
v_mfma_f32_32x32x16_bf16 v[48:63], v[2:5], v[2:5], 0
v_mfma_f32_32x32x16_bf16 v[64:79], v[2:5], v[2:5], 0
v_mfma_f32_32x32x16_bf16 v[80:95], v[2:5], v[2:5], 0
v_mfma_f32_32x32x16_bf16 v[96:111], v[2:5], v[2:5], 0
v_mfma_f32_32x32x16_bf16 v[112:127], v[2:5], v[2:5], 0
v_mfma_f32_32x32x16_bf16 v[128:143], v[2:5], v[2:5], 0
v_mfma_f32_32x32x16_bf16 v[144:159], v[2:5], v[2:5], 0
v_mfma_f32_32x32x16_bf16 v[160:175], v[2:5], v[2:5], 0
v_mfma_f32_32x32x16_bf16 v[176:191], v[2:5], v[2:5], 0
v_mfma_f32_32x32x16_bf16 v[192:207], v[2:5], v[2:5], 0
v_mfma_f32_32x32x16_bf16 v[208:223], v[2:5], v[2:5], 0
v_mfma_f32_32x32x16_bf16 v[224:239], v[2:5], v[2:5], 0
v_mfma_f32_32x32x16_bf16 v[240:255], v[2:5], v[2:5], 0
v_mfma_f32_32x32x16_bf16 a[96:111], v[2:5], v[2:5], 0
v_mfma_f32_32x32x16_bf16 a[112:127], v[2:5], v[2:5], 0
s_cmp_lg_u32 s40, 0
s_cbranch_scc1 L_gemm1_kernel_qk_ln_join
s_waitcnt vmcnt(18)
v_readfirstlane_b32 s37, v7
s_lshr_b32 s36, s47, 5
s_cmp_eq_u32 s37, 31
s_cbranch_scc0 L_gemm1_kernel_qk_ln_wait
s_lshl_b32 s36, s36, 12
s_add_u32 s36, s36, 0x8000
v_lshlrev_b32 v6, 7, v0
v_add_u32 v6, s36, v6
v_mov_b32 v7, 1
s_mov_b32 exec_hi, 0
buffer_store_dword v7, v6, s[76:79], 0 offen sc1
s_mov_b64 exec, s[38:39]
s_branch L_gemm1_kernel_qk_ln_join
L_gemm1_kernel_qk_ln_wait:
s_lshl_b32 s36, s47, 7
s_add_u32 s36, s36, 0x8000
v_mov_b32 v6, s36
s_mov_b32 s37, 0x80000
L_gemm1_kernel_qk_ln_p:
buffer_load_dword v7, v6, s[76:79], 0 offen sc1
s_waitcnt vmcnt(0)
v_readfirstlane_b32 s36, v7
s_sub_u32 s37, s37, 1
s_cbranch_scc1 L_gemm1_kernel_qk_ln_p_out
s_cmp_ge_u32 s36, 1
s_cbranch_scc1 L_gemm1_kernel_qk_ln_p_out
s_branch L_gemm1_kernel_qk_ln_p
L_gemm1_kernel_qk_ln_p_out:
L_gemm1_kernel_qk_ln_join:
s_barrier
buffer_load_dwordx4 a[0:3], v8, s[48:51], s41 offen sc1
buffer_load_dwordx4 a[4:7], v9, s[48:51], s41 offen sc1
buffer_load_dwordx4 a[8:11], v10, s[48:51], s41 offen sc1
buffer_load_dwordx4 a[12:15], v11, s[48:51], s41 offen sc1
s_add_u32 s41, s41, 1024
buffer_load_dwordx4 a[16:19], v8, s[48:51], s41 offen sc1
buffer_load_dwordx4 a[20:23], v9, s[48:51], s41 offen sc1
buffer_load_dwordx4 a[24:27], v10, s[48:51], s41 offen sc1
buffer_load_dwordx4 a[28:31], v11, s[48:51], s41 offen sc1
s_add_u32 s41, s41, 1024
buffer_load_dwordx4 a[32:35], v8, s[48:51], s41 offen sc1
buffer_load_dwordx4 a[36:39], v9, s[48:51], s41 offen sc1
buffer_load_dwordx4 a[40:43], v10, s[48:51], s41 offen sc1
buffer_load_dwordx4 a[44:47], v11, s[48:51], s41 offen sc1
s_add_u32 s41, s41, 1024
s_waitcnt vmcnt(8)
s_barrier
ds_read_b64_tr_b16 a[64:65], v16 offset:0
ds_read_b64_tr_b16 a[66:67], v16 offset:8192
ds_read_b64_tr_b16 a[68:69], v17 offset:0
ds_read_b64_tr_b16 a[70:71], v17 offset:8192
ds_read_b64_tr_b16 a[72:73], v18 offset:0
ds_read_b64_tr_b16 a[74:75], v18 offset:8192
ds_read_b64_tr_b16 a[76:77], v19 offset:0
ds_read_b64_tr_b16 a[78:79], v19 offset:8192
s_mov_b32 s44, 3
.p2align 4
L_gemm1_kernel_qk_loop0:
s_waitcnt lgkmcnt(6)
v_mfma_f32_16x16x32_bf16 v[32:35], a[64:67], a[0:3], v[32:35]
ds_read_b64_tr_b16 a[80:81], v20 offset:0
v_mfma_f32_16x16x32_bf16 v[36:39], a[64:67], a[4:7], v[36:39]
ds_read_b64_tr_b16 a[82:83], v20 offset:8192
buffer_load_dwordx4 a[48:51], v8, s[48:51], s41 offen sc1
v_mfma_f32_16x16x32_bf16 v[40:43], a[64:67], a[8:11], v[40:43]
v_mfma_f32_16x16x32_bf16 v[44:47], a[64:67], a[12:15], v[44:47]
s_waitcnt lgkmcnt(6)
v_mfma_f32_16x16x32_bf16 v[48:51], a[68:71], a[0:3], v[48:51]
ds_read_b64_tr_b16 a[84:85], v21 offset:0
v_mfma_f32_16x16x32_bf16 v[52:55], a[68:71], a[4:7], v[52:55]
ds_read_b64_tr_b16 a[86:87], v21 offset:8192
v_mfma_f32_16x16x32_bf16 v[56:59], a[68:71], a[8:11], v[56:59]
v_mfma_f32_16x16x32_bf16 v[60:63], a[68:71], a[12:15], v[60:63]
s_waitcnt lgkmcnt(6)
v_mfma_f32_16x16x32_bf16 v[64:67], a[72:75], a[0:3], v[64:67]
ds_read_b64_tr_b16 a[88:89], v22 offset:0
v_mfma_f32_16x16x32_bf16 v[68:71], a[72:75], a[4:7], v[68:71]
ds_read_b64_tr_b16 a[90:91], v22 offset:8192
s_add_u32 m0, s43, 98304
v_mfma_f32_16x16x32_bf16 v[72:75], a[72:75], a[8:11], v[72:75]
buffer_load_dwordx4 v12, s[52:55], s42 offen lds
v_mfma_f32_16x16x32_bf16 v[76:79], a[72:75], a[12:15], v[76:79]
s_waitcnt lgkmcnt(6)
v_mfma_f32_16x16x32_bf16 v[80:83], a[76:79], a[0:3], v[80:83]
ds_read_b64_tr_b16 a[92:93], v23 offset:0
v_mfma_f32_16x16x32_bf16 v[84:87], a[76:79], a[4:7], v[84:87]
ds_read_b64_tr_b16 a[94:95], v23 offset:8192
v_mfma_f32_16x16x32_bf16 v[88:91], a[76:79], a[8:11], v[88:91]
v_mfma_f32_16x16x32_bf16 v[92:95], a[76:79], a[12:15], v[92:95]
s_waitcnt lgkmcnt(6)
v_mfma_f32_16x16x32_bf16 v[96:99], a[80:83], a[0:3], v[96:99]
ds_read_b64_tr_b16 a[64:65], v16 offset:256
v_mfma_f32_16x16x32_bf16 v[100:103], a[80:83], a[4:7], v[100:103]
ds_read_b64_tr_b16 a[66:67], v16 offset:8448
buffer_load_dwordx4 a[52:55], v9, s[48:51], s41 offen sc1
v_mfma_f32_16x16x32_bf16 v[104:107], a[80:83], a[8:11], v[104:107]
v_mfma_f32_16x16x32_bf16 v[108:111], a[80:83], a[12:15], v[108:111]
s_waitcnt lgkmcnt(6)
v_mfma_f32_16x16x32_bf16 v[112:115], a[84:87], a[0:3], v[112:115]
ds_read_b64_tr_b16 a[68:69], v17 offset:256
v_mfma_f32_16x16x32_bf16 v[116:119], a[84:87], a[4:7], v[116:119]
ds_read_b64_tr_b16 a[70:71], v17 offset:8448
v_mfma_f32_16x16x32_bf16 v[120:123], a[84:87], a[8:11], v[120:123]
v_mfma_f32_16x16x32_bf16 v[124:127], a[84:87], a[12:15], v[124:127]
s_waitcnt lgkmcnt(6)
v_mfma_f32_16x16x32_bf16 v[128:131], a[88:91], a[0:3], v[128:131]
ds_read_b64_tr_b16 a[72:73], v18 offset:256
v_mfma_f32_16x16x32_bf16 v[132:135], a[88:91], a[4:7], v[132:135]
ds_read_b64_tr_b16 a[74:75], v18 offset:8448
s_add_u32 m0, s43, 102400
v_mfma_f32_16x16x32_bf16 v[136:139], a[88:91], a[8:11], v[136:139]
buffer_load_dwordx4 v13, s[52:55], s42 offen lds
v_mfma_f32_16x16x32_bf16 v[140:143], a[88:91], a[12:15], v[140:143]
s_waitcnt lgkmcnt(6)
v_mfma_f32_16x16x32_bf16 v[144:147], a[92:95], a[0:3], v[144:147]
ds_read_b64_tr_b16 a[76:77], v19 offset:256
v_mfma_f32_16x16x32_bf16 v[148:151], a[92:95], a[4:7], v[148:151]
ds_read_b64_tr_b16 a[78:79], v19 offset:8448
v_mfma_f32_16x16x32_bf16 v[152:155], a[92:95], a[8:11], v[152:155]
v_mfma_f32_16x16x32_bf16 v[156:159], a[92:95], a[12:15], v[156:159]
s_waitcnt lgkmcnt(6)
v_mfma_f32_16x16x32_bf16 v[160:163], a[64:67], a[0:3], v[160:163]
ds_read_b64_tr_b16 a[80:81], v20 offset:256
v_mfma_f32_16x16x32_bf16 v[164:167], a[64:67], a[4:7], v[164:167]
ds_read_b64_tr_b16 a[82:83], v20 offset:8448
buffer_load_dwordx4 a[56:59], v10, s[48:51], s41 offen sc1
v_mfma_f32_16x16x32_bf16 v[168:171], a[64:67], a[8:11], v[168:171]
v_mfma_f32_16x16x32_bf16 v[172:175], a[64:67], a[12:15], v[172:175]
s_waitcnt lgkmcnt(6)
v_mfma_f32_16x16x32_bf16 v[176:179], a[68:71], a[0:3], v[176:179]
ds_read_b64_tr_b16 a[84:85], v21 offset:256
v_mfma_f32_16x16x32_bf16 v[180:183], a[68:71], a[4:7], v[180:183]
ds_read_b64_tr_b16 a[86:87], v21 offset:8448
v_mfma_f32_16x16x32_bf16 v[184:187], a[68:71], a[8:11], v[184:187]
v_mfma_f32_16x16x32_bf16 v[188:191], a[68:71], a[12:15], v[188:191]
s_waitcnt lgkmcnt(6)
v_mfma_f32_16x16x32_bf16 v[192:195], a[72:75], a[0:3], v[192:195]
ds_read_b64_tr_b16 a[88:89], v22 offset:256
v_mfma_f32_16x16x32_bf16 v[196:199], a[72:75], a[4:7], v[196:199]
ds_read_b64_tr_b16 a[90:91], v22 offset:8448
s_add_u32 m0, s43, 106496
v_mfma_f32_16x16x32_bf16 v[200:203], a[72:75], a[8:11], v[200:203]
buffer_load_dwordx4 v14, s[52:55], s42 offen lds
v_mfma_f32_16x16x32_bf16 v[204:207], a[72:75], a[12:15], v[204:207]
s_waitcnt lgkmcnt(6)
v_mfma_f32_16x16x32_bf16 v[208:211], a[76:79], a[0:3], v[208:211]
ds_read_b64_tr_b16 a[92:93], v23 offset:256
v_mfma_f32_16x16x32_bf16 v[212:215], a[76:79], a[4:7], v[212:215]
ds_read_b64_tr_b16 a[94:95], v23 offset:8448
v_mfma_f32_16x16x32_bf16 v[216:219], a[76:79], a[8:11], v[216:219]
v_mfma_f32_16x16x32_bf16 v[220:223], a[76:79], a[12:15], v[220:223]
s_waitcnt lgkmcnt(6)
v_mfma_f32_16x16x32_bf16 v[224:227], a[80:83], a[0:3], v[224:227]
s_waitcnt vmcnt(10)
s_barrier
ds_read_b64_tr_b16 a[64:65], v16 offset:16384
v_mfma_f32_16x16x32_bf16 v[228:231], a[80:83], a[4:7], v[228:231]
ds_read_b64_tr_b16 a[66:67], v16 offset:24576
buffer_load_dwordx4 a[60:63], v11, s[48:51], s41 offen sc1
s_add_u32 s41, s41, 1024
v_mfma_f32_16x16x32_bf16 v[232:235], a[80:83], a[8:11], v[232:235]
v_mfma_f32_16x16x32_bf16 v[236:239], a[80:83], a[12:15], v[236:239]
s_waitcnt lgkmcnt(6)
v_mfma_f32_16x16x32_bf16 v[240:243], a[84:87], a[0:3], v[240:243]
ds_read_b64_tr_b16 a[68:69], v17 offset:16384
v_mfma_f32_16x16x32_bf16 v[244:247], a[84:87], a[4:7], v[244:247]
ds_read_b64_tr_b16 a[70:71], v17 offset:24576
v_mfma_f32_16x16x32_bf16 v[248:251], a[84:87], a[8:11], v[248:251]
v_mfma_f32_16x16x32_bf16 v[252:255], a[84:87], a[12:15], v[252:255]
s_waitcnt lgkmcnt(6)
v_mfma_f32_16x16x32_bf16 a[96:99], a[88:91], a[0:3], a[96:99]
ds_read_b64_tr_b16 a[72:73], v18 offset:16384
v_mfma_f32_16x16x32_bf16 a[100:103], a[88:91], a[4:7], a[100:103]
ds_read_b64_tr_b16 a[74:75], v18 offset:24576
s_add_u32 m0, s43, 110592
v_mfma_f32_16x16x32_bf16 a[104:107], a[88:91], a[8:11], a[104:107]
buffer_load_dwordx4 v15, s[52:55], s42 offen lds
s_add_u32 s42, s42, 196608
v_mfma_f32_16x16x32_bf16 a[108:111], a[88:91], a[12:15], a[108:111]
s_waitcnt lgkmcnt(6)
v_mfma_f32_16x16x32_bf16 a[112:115], a[92:95], a[0:3], a[112:115]
ds_read_b64_tr_b16 a[76:77], v19 offset:16384
v_mfma_f32_16x16x32_bf16 a[116:119], a[92:95], a[4:7], a[116:119]
ds_read_b64_tr_b16 a[78:79], v19 offset:24576
v_mfma_f32_16x16x32_bf16 a[120:123], a[92:95], a[8:11], a[120:123]
v_mfma_f32_16x16x32_bf16 a[124:127], a[92:95], a[12:15], a[124:127]
s_waitcnt lgkmcnt(6)
v_mfma_f32_16x16x32_bf16 v[32:35], a[64:67], a[16:19], v[32:35]
ds_read_b64_tr_b16 a[80:81], v20 offset:16384
v_mfma_f32_16x16x32_bf16 v[36:39], a[64:67], a[20:23], v[36:39]
ds_read_b64_tr_b16 a[82:83], v20 offset:24576
buffer_load_dwordx4 a[0:3], v8, s[48:51], s41 offen sc1
v_mfma_f32_16x16x32_bf16 v[40:43], a[64:67], a[24:27], v[40:43]
v_mfma_f32_16x16x32_bf16 v[44:47], a[64:67], a[28:31], v[44:47]
s_waitcnt lgkmcnt(6)
v_mfma_f32_16x16x32_bf16 v[48:51], a[68:71], a[16:19], v[48:51]
ds_read_b64_tr_b16 a[84:85], v21 offset:16384
v_mfma_f32_16x16x32_bf16 v[52:55], a[68:71], a[20:23], v[52:55]
ds_read_b64_tr_b16 a[86:87], v21 offset:24576
v_mfma_f32_16x16x32_bf16 v[56:59], a[68:71], a[24:27], v[56:59]
v_mfma_f32_16x16x32_bf16 v[60:63], a[68:71], a[28:31], v[60:63]
s_waitcnt lgkmcnt(6)
v_mfma_f32_16x16x32_bf16 v[64:67], a[72:75], a[16:19], v[64:67]
ds_read_b64_tr_b16 a[88:89], v22 offset:16384
v_mfma_f32_16x16x32_bf16 v[68:71], a[72:75], a[20:23], v[68:71]
ds_read_b64_tr_b16 a[90:91], v22 offset:24576
s_add_u32 m0, s43, 114688
v_mfma_f32_16x16x32_bf16 v[72:75], a[72:75], a[24:27], v[72:75]
buffer_load_dwordx4 v12, s[52:55], s42 offen lds
v_mfma_f32_16x16x32_bf16 v[76:79], a[72:75], a[28:31], v[76:79]
s_waitcnt lgkmcnt(6)
v_mfma_f32_16x16x32_bf16 v[80:83], a[76:79], a[16:19], v[80:83]
ds_read_b64_tr_b16 a[92:93], v23 offset:16384
v_mfma_f32_16x16x32_bf16 v[84:87], a[76:79], a[20:23], v[84:87]
ds_read_b64_tr_b16 a[94:95], v23 offset:24576
v_mfma_f32_16x16x32_bf16 v[88:91], a[76:79], a[24:27], v[88:91]
v_mfma_f32_16x16x32_bf16 v[92:95], a[76:79], a[28:31], v[92:95]
s_waitcnt lgkmcnt(6)
v_mfma_f32_16x16x32_bf16 v[96:99], a[80:83], a[16:19], v[96:99]
ds_read_b64_tr_b16 a[64:65], v16 offset:16640
v_mfma_f32_16x16x32_bf16 v[100:103], a[80:83], a[20:23], v[100:103]
ds_read_b64_tr_b16 a[66:67], v16 offset:24832
buffer_load_dwordx4 a[4:7], v9, s[48:51], s41 offen sc1
v_mfma_f32_16x16x32_bf16 v[104:107], a[80:83], a[24:27], v[104:107]
v_mfma_f32_16x16x32_bf16 v[108:111], a[80:83], a[28:31], v[108:111]
s_waitcnt lgkmcnt(6)
v_mfma_f32_16x16x32_bf16 v[112:115], a[84:87], a[16:19], v[112:115]
ds_read_b64_tr_b16 a[68:69], v17 offset:16640
v_mfma_f32_16x16x32_bf16 v[116:119], a[84:87], a[20:23], v[116:119]
ds_read_b64_tr_b16 a[70:71], v17 offset:24832
v_mfma_f32_16x16x32_bf16 v[120:123], a[84:87], a[24:27], v[120:123]
v_mfma_f32_16x16x32_bf16 v[124:127], a[84:87], a[28:31], v[124:127]
s_waitcnt lgkmcnt(6)
v_mfma_f32_16x16x32_bf16 v[128:131], a[88:91], a[16:19], v[128:131]
ds_read_b64_tr_b16 a[72:73], v18 offset:16640
v_mfma_f32_16x16x32_bf16 v[132:135], a[88:91], a[20:23], v[132:135]
ds_read_b64_tr_b16 a[74:75], v18 offset:24832
s_add_u32 m0, s43, 118784
v_mfma_f32_16x16x32_bf16 v[136:139], a[88:91], a[24:27], v[136:139]
buffer_load_dwordx4 v13, s[52:55], s42 offen lds
v_mfma_f32_16x16x32_bf16 v[140:143], a[88:91], a[28:31], v[140:143]
s_waitcnt lgkmcnt(6)
v_mfma_f32_16x16x32_bf16 v[144:147], a[92:95], a[16:19], v[144:147]
ds_read_b64_tr_b16 a[76:77], v19 offset:16640
v_mfma_f32_16x16x32_bf16 v[148:151], a[92:95], a[20:23], v[148:151]
ds_read_b64_tr_b16 a[78:79], v19 offset:24832
v_mfma_f32_16x16x32_bf16 v[152:155], a[92:95], a[24:27], v[152:155]
v_mfma_f32_16x16x32_bf16 v[156:159], a[92:95], a[28:31], v[156:159]
s_waitcnt lgkmcnt(6)
v_mfma_f32_16x16x32_bf16 v[160:163], a[64:67], a[16:19], v[160:163]
ds_read_b64_tr_b16 a[80:81], v20 offset:16640
v_mfma_f32_16x16x32_bf16 v[164:167], a[64:67], a[20:23], v[164:167]
ds_read_b64_tr_b16 a[82:83], v20 offset:24832
buffer_load_dwordx4 a[8:11], v10, s[48:51], s41 offen sc1
v_mfma_f32_16x16x32_bf16 v[168:171], a[64:67], a[24:27], v[168:171]
v_mfma_f32_16x16x32_bf16 v[172:175], a[64:67], a[28:31], v[172:175]
s_waitcnt lgkmcnt(6)
v_mfma_f32_16x16x32_bf16 v[176:179], a[68:71], a[16:19], v[176:179]
ds_read_b64_tr_b16 a[84:85], v21 offset:16640
v_mfma_f32_16x16x32_bf16 v[180:183], a[68:71], a[20:23], v[180:183]
ds_read_b64_tr_b16 a[86:87], v21 offset:24832
v_mfma_f32_16x16x32_bf16 v[184:187], a[68:71], a[24:27], v[184:187]
v_mfma_f32_16x16x32_bf16 v[188:191], a[68:71], a[28:31], v[188:191]
s_waitcnt lgkmcnt(6)
v_mfma_f32_16x16x32_bf16 v[192:195], a[72:75], a[16:19], v[192:195]
ds_read_b64_tr_b16 a[88:89], v22 offset:16640
v_mfma_f32_16x16x32_bf16 v[196:199], a[72:75], a[20:23], v[196:199]
ds_read_b64_tr_b16 a[90:91], v22 offset:24832
s_add_u32 m0, s43, 122880
v_mfma_f32_16x16x32_bf16 v[200:203], a[72:75], a[24:27], v[200:203]
buffer_load_dwordx4 v14, s[52:55], s42 offen lds
v_mfma_f32_16x16x32_bf16 v[204:207], a[72:75], a[28:31], v[204:207]
s_waitcnt lgkmcnt(6)
v_mfma_f32_16x16x32_bf16 v[208:211], a[76:79], a[16:19], v[208:211]
ds_read_b64_tr_b16 a[92:93], v23 offset:16640
v_mfma_f32_16x16x32_bf16 v[212:215], a[76:79], a[20:23], v[212:215]
ds_read_b64_tr_b16 a[94:95], v23 offset:24832
v_mfma_f32_16x16x32_bf16 v[216:219], a[76:79], a[24:27], v[216:219]
v_mfma_f32_16x16x32_bf16 v[220:223], a[76:79], a[28:31], v[220:223]
s_waitcnt lgkmcnt(6)
v_mfma_f32_16x16x32_bf16 v[224:227], a[80:83], a[16:19], v[224:227]
s_waitcnt vmcnt(14)
s_barrier
ds_read_b64_tr_b16 a[64:65], v16 offset:32768
v_mfma_f32_16x16x32_bf16 v[228:231], a[80:83], a[20:23], v[228:231]
ds_read_b64_tr_b16 a[66:67], v16 offset:40960
buffer_load_dwordx4 a[12:15], v11, s[48:51], s41 offen sc1
s_add_u32 s41, s41, 1024
v_mfma_f32_16x16x32_bf16 v[232:235], a[80:83], a[24:27], v[232:235]
v_mfma_f32_16x16x32_bf16 v[236:239], a[80:83], a[28:31], v[236:239]
s_waitcnt lgkmcnt(6)
v_mfma_f32_16x16x32_bf16 v[240:243], a[84:87], a[16:19], v[240:243]
ds_read_b64_tr_b16 a[68:69], v17 offset:32768
v_mfma_f32_16x16x32_bf16 v[244:247], a[84:87], a[20:23], v[244:247]
ds_read_b64_tr_b16 a[70:71], v17 offset:40960
v_mfma_f32_16x16x32_bf16 v[248:251], a[84:87], a[24:27], v[248:251]
v_mfma_f32_16x16x32_bf16 v[252:255], a[84:87], a[28:31], v[252:255]
s_waitcnt lgkmcnt(6)
v_mfma_f32_16x16x32_bf16 a[96:99], a[88:91], a[16:19], a[96:99]
ds_read_b64_tr_b16 a[72:73], v18 offset:32768
v_mfma_f32_16x16x32_bf16 a[100:103], a[88:91], a[20:23], a[100:103]
ds_read_b64_tr_b16 a[74:75], v18 offset:40960
s_add_u32 m0, s43, 126976
v_mfma_f32_16x16x32_bf16 a[104:107], a[88:91], a[24:27], a[104:107]
buffer_load_dwordx4 v15, s[52:55], s42 offen lds
s_add_u32 s42, s42, 196608
v_mfma_f32_16x16x32_bf16 a[108:111], a[88:91], a[28:31], a[108:111]
s_waitcnt lgkmcnt(6)
v_mfma_f32_16x16x32_bf16 a[112:115], a[92:95], a[16:19], a[112:115]
ds_read_b64_tr_b16 a[76:77], v19 offset:32768
v_mfma_f32_16x16x32_bf16 a[116:119], a[92:95], a[20:23], a[116:119]
ds_read_b64_tr_b16 a[78:79], v19 offset:40960
v_mfma_f32_16x16x32_bf16 a[120:123], a[92:95], a[24:27], a[120:123]
v_mfma_f32_16x16x32_bf16 a[124:127], a[92:95], a[28:31], a[124:127]
s_waitcnt lgkmcnt(6)
v_mfma_f32_16x16x32_bf16 v[32:35], a[64:67], a[32:35], v[32:35]
ds_read_b64_tr_b16 a[80:81], v20 offset:32768
v_mfma_f32_16x16x32_bf16 v[36:39], a[64:67], a[36:39], v[36:39]
ds_read_b64_tr_b16 a[82:83], v20 offset:40960
buffer_load_dwordx4 a[16:19], v8, s[48:51], s41 offen sc1
v_mfma_f32_16x16x32_bf16 v[40:43], a[64:67], a[40:43], v[40:43]
v_mfma_f32_16x16x32_bf16 v[44:47], a[64:67], a[44:47], v[44:47]
s_waitcnt lgkmcnt(6)
v_mfma_f32_16x16x32_bf16 v[48:51], a[68:71], a[32:35], v[48:51]
ds_read_b64_tr_b16 a[84:85], v21 offset:32768
v_mfma_f32_16x16x32_bf16 v[52:55], a[68:71], a[36:39], v[52:55]
ds_read_b64_tr_b16 a[86:87], v21 offset:40960
v_mfma_f32_16x16x32_bf16 v[56:59], a[68:71], a[40:43], v[56:59]
v_mfma_f32_16x16x32_bf16 v[60:63], a[68:71], a[44:47], v[60:63]
s_waitcnt lgkmcnt(6)
v_mfma_f32_16x16x32_bf16 v[64:67], a[72:75], a[32:35], v[64:67]
ds_read_b64_tr_b16 a[88:89], v22 offset:32768
v_mfma_f32_16x16x32_bf16 v[68:71], a[72:75], a[36:39], v[68:71]
ds_read_b64_tr_b16 a[90:91], v22 offset:40960
s_add_u32 m0, s43, 0
v_mfma_f32_16x16x32_bf16 v[72:75], a[72:75], a[40:43], v[72:75]
buffer_load_dwordx4 v12, s[52:55], s42 offen lds
v_mfma_f32_16x16x32_bf16 v[76:79], a[72:75], a[44:47], v[76:79]
s_waitcnt lgkmcnt(6)
v_mfma_f32_16x16x32_bf16 v[80:83], a[76:79], a[32:35], v[80:83]
ds_read_b64_tr_b16 a[92:93], v23 offset:32768
v_mfma_f32_16x16x32_bf16 v[84:87], a[76:79], a[36:39], v[84:87]
ds_read_b64_tr_b16 a[94:95], v23 offset:40960
v_mfma_f32_16x16x32_bf16 v[88:91], a[76:79], a[40:43], v[88:91]
v_mfma_f32_16x16x32_bf16 v[92:95], a[76:79], a[44:47], v[92:95]
s_waitcnt lgkmcnt(6)
v_mfma_f32_16x16x32_bf16 v[96:99], a[80:83], a[32:35], v[96:99]
ds_read_b64_tr_b16 a[64:65], v16 offset:33024
v_mfma_f32_16x16x32_bf16 v[100:103], a[80:83], a[36:39], v[100:103]
ds_read_b64_tr_b16 a[66:67], v16 offset:41216
buffer_load_dwordx4 a[20:23], v9, s[48:51], s41 offen sc1
v_mfma_f32_16x16x32_bf16 v[104:107], a[80:83], a[40:43], v[104:107]
v_mfma_f32_16x16x32_bf16 v[108:111], a[80:83], a[44:47], v[108:111]
s_waitcnt lgkmcnt(6)
v_mfma_f32_16x16x32_bf16 v[112:115], a[84:87], a[32:35], v[112:115]
ds_read_b64_tr_b16 a[68:69], v17 offset:33024
v_mfma_f32_16x16x32_bf16 v[116:119], a[84:87], a[36:39], v[116:119]
ds_read_b64_tr_b16 a[70:71], v17 offset:41216
v_mfma_f32_16x16x32_bf16 v[120:123], a[84:87], a[40:43], v[120:123]
v_mfma_f32_16x16x32_bf16 v[124:127], a[84:87], a[44:47], v[124:127]
s_waitcnt lgkmcnt(6)
v_mfma_f32_16x16x32_bf16 v[128:131], a[88:91], a[32:35], v[128:131]
ds_read_b64_tr_b16 a[72:73], v18 offset:33024
v_mfma_f32_16x16x32_bf16 v[132:135], a[88:91], a[36:39], v[132:135]
ds_read_b64_tr_b16 a[74:75], v18 offset:41216
s_add_u32 m0, s43, 4096
v_mfma_f32_16x16x32_bf16 v[136:139], a[88:91], a[40:43], v[136:139]
buffer_load_dwordx4 v13, s[52:55], s42 offen lds
v_mfma_f32_16x16x32_bf16 v[140:143], a[88:91], a[44:47], v[140:143]
s_waitcnt lgkmcnt(6)
v_mfma_f32_16x16x32_bf16 v[144:147], a[92:95], a[32:35], v[144:147]
ds_read_b64_tr_b16 a[76:77], v19 offset:33024
v_mfma_f32_16x16x32_bf16 v[148:151], a[92:95], a[36:39], v[148:151]
ds_read_b64_tr_b16 a[78:79], v19 offset:41216
v_mfma_f32_16x16x32_bf16 v[152:155], a[92:95], a[40:43], v[152:155]
v_mfma_f32_16x16x32_bf16 v[156:159], a[92:95], a[44:47], v[156:159]
s_waitcnt lgkmcnt(6)
v_mfma_f32_16x16x32_bf16 v[160:163], a[64:67], a[32:35], v[160:163]
ds_read_b64_tr_b16 a[80:81], v20 offset:33024
v_mfma_f32_16x16x32_bf16 v[164:167], a[64:67], a[36:39], v[164:167]
ds_read_b64_tr_b16 a[82:83], v20 offset:41216
buffer_load_dwordx4 a[24:27], v10, s[48:51], s41 offen sc1
v_mfma_f32_16x16x32_bf16 v[168:171], a[64:67], a[40:43], v[168:171]
v_mfma_f32_16x16x32_bf16 v[172:175], a[64:67], a[44:47], v[172:175]
s_waitcnt lgkmcnt(6)
v_mfma_f32_16x16x32_bf16 v[176:179], a[68:71], a[32:35], v[176:179]
ds_read_b64_tr_b16 a[84:85], v21 offset:33024
v_mfma_f32_16x16x32_bf16 v[180:183], a[68:71], a[36:39], v[180:183]
ds_read_b64_tr_b16 a[86:87], v21 offset:41216
v_mfma_f32_16x16x32_bf16 v[184:187], a[68:71], a[40:43], v[184:187]
v_mfma_f32_16x16x32_bf16 v[188:191], a[68:71], a[44:47], v[188:191]
s_waitcnt lgkmcnt(6)
v_mfma_f32_16x16x32_bf16 v[192:195], a[72:75], a[32:35], v[192:195]
ds_read_b64_tr_b16 a[88:89], v22 offset:33024
v_mfma_f32_16x16x32_bf16 v[196:199], a[72:75], a[36:39], v[196:199]
ds_read_b64_tr_b16 a[90:91], v22 offset:41216
s_add_u32 m0, s43, 8192
v_mfma_f32_16x16x32_bf16 v[200:203], a[72:75], a[40:43], v[200:203]
buffer_load_dwordx4 v14, s[52:55], s42 offen lds
v_mfma_f32_16x16x32_bf16 v[204:207], a[72:75], a[44:47], v[204:207]
s_waitcnt lgkmcnt(6)
v_mfma_f32_16x16x32_bf16 v[208:211], a[76:79], a[32:35], v[208:211]
ds_read_b64_tr_b16 a[92:93], v23 offset:33024
v_mfma_f32_16x16x32_bf16 v[212:215], a[76:79], a[36:39], v[212:215]
ds_read_b64_tr_b16 a[94:95], v23 offset:41216
v_mfma_f32_16x16x32_bf16 v[216:219], a[76:79], a[40:43], v[216:219]
v_mfma_f32_16x16x32_bf16 v[220:223], a[76:79], a[44:47], v[220:223]
s_waitcnt lgkmcnt(6)
v_mfma_f32_16x16x32_bf16 v[224:227], a[80:83], a[32:35], v[224:227]
s_waitcnt vmcnt(15)
s_barrier
ds_read_b64_tr_b16 a[64:65], v16 offset:49152
v_mfma_f32_16x16x32_bf16 v[228:231], a[80:83], a[36:39], v[228:231]
ds_read_b64_tr_b16 a[66:67], v16 offset:57344
buffer_load_dwordx4 a[28:31], v11, s[48:51], s41 offen sc1
s_add_u32 s41, s41, 1024
v_mfma_f32_16x16x32_bf16 v[232:235], a[80:83], a[40:43], v[232:235]
v_mfma_f32_16x16x32_bf16 v[236:239], a[80:83], a[44:47], v[236:239]
s_waitcnt lgkmcnt(6)
v_mfma_f32_16x16x32_bf16 v[240:243], a[84:87], a[32:35], v[240:243]
ds_read_b64_tr_b16 a[68:69], v17 offset:49152
v_mfma_f32_16x16x32_bf16 v[244:247], a[84:87], a[36:39], v[244:247]
ds_read_b64_tr_b16 a[70:71], v17 offset:57344
v_mfma_f32_16x16x32_bf16 v[248:251], a[84:87], a[40:43], v[248:251]
v_mfma_f32_16x16x32_bf16 v[252:255], a[84:87], a[44:47], v[252:255]
s_waitcnt lgkmcnt(6)
v_mfma_f32_16x16x32_bf16 a[96:99], a[88:91], a[32:35], a[96:99]
ds_read_b64_tr_b16 a[72:73], v18 offset:49152
v_mfma_f32_16x16x32_bf16 a[100:103], a[88:91], a[36:39], a[100:103]
ds_read_b64_tr_b16 a[74:75], v18 offset:57344
s_add_u32 m0, s43, 12288
v_mfma_f32_16x16x32_bf16 a[104:107], a[88:91], a[40:43], a[104:107]
buffer_load_dwordx4 v15, s[52:55], s42 offen lds
s_add_u32 s42, s42, 196608
v_mfma_f32_16x16x32_bf16 a[108:111], a[88:91], a[44:47], a[108:111]
s_waitcnt lgkmcnt(6)
v_mfma_f32_16x16x32_bf16 a[112:115], a[92:95], a[32:35], a[112:115]
ds_read_b64_tr_b16 a[76:77], v19 offset:49152
v_mfma_f32_16x16x32_bf16 a[116:119], a[92:95], a[36:39], a[116:119]
ds_read_b64_tr_b16 a[78:79], v19 offset:57344
v_mfma_f32_16x16x32_bf16 a[120:123], a[92:95], a[40:43], a[120:123]
v_mfma_f32_16x16x32_bf16 a[124:127], a[92:95], a[44:47], a[124:127]
s_waitcnt lgkmcnt(6)
v_mfma_f32_16x16x32_bf16 v[32:35], a[64:67], a[48:51], v[32:35]
ds_read_b64_tr_b16 a[80:81], v20 offset:49152
v_mfma_f32_16x16x32_bf16 v[36:39], a[64:67], a[52:55], v[36:39]
ds_read_b64_tr_b16 a[82:83], v20 offset:57344
buffer_load_dwordx4 a[32:35], v8, s[48:51], s41 offen sc1
v_mfma_f32_16x16x32_bf16 v[40:43], a[64:67], a[56:59], v[40:43]
v_mfma_f32_16x16x32_bf16 v[44:47], a[64:67], a[60:63], v[44:47]
s_waitcnt lgkmcnt(6)
v_mfma_f32_16x16x32_bf16 v[48:51], a[68:71], a[48:51], v[48:51]
ds_read_b64_tr_b16 a[84:85], v21 offset:49152
v_mfma_f32_16x16x32_bf16 v[52:55], a[68:71], a[52:55], v[52:55]
ds_read_b64_tr_b16 a[86:87], v21 offset:57344
v_mfma_f32_16x16x32_bf16 v[56:59], a[68:71], a[56:59], v[56:59]
v_mfma_f32_16x16x32_bf16 v[60:63], a[68:71], a[60:63], v[60:63]
s_waitcnt lgkmcnt(6)
v_mfma_f32_16x16x32_bf16 v[64:67], a[72:75], a[48:51], v[64:67]
ds_read_b64_tr_b16 a[88:89], v22 offset:49152
v_mfma_f32_16x16x32_bf16 v[68:71], a[72:75], a[52:55], v[68:71]
ds_read_b64_tr_b16 a[90:91], v22 offset:57344
s_add_u32 m0, s43, 16384
v_mfma_f32_16x16x32_bf16 v[72:75], a[72:75], a[56:59], v[72:75]
buffer_load_dwordx4 v12, s[52:55], s42 offen lds
v_mfma_f32_16x16x32_bf16 v[76:79], a[72:75], a[60:63], v[76:79]
s_waitcnt lgkmcnt(6)
v_mfma_f32_16x16x32_bf16 v[80:83], a[76:79], a[48:51], v[80:83]
ds_read_b64_tr_b16 a[92:93], v23 offset:49152
v_mfma_f32_16x16x32_bf16 v[84:87], a[76:79], a[52:55], v[84:87]
ds_read_b64_tr_b16 a[94:95], v23 offset:57344
v_mfma_f32_16x16x32_bf16 v[88:91], a[76:79], a[56:59], v[88:91]
v_mfma_f32_16x16x32_bf16 v[92:95], a[76:79], a[60:63], v[92:95]
s_waitcnt lgkmcnt(6)
v_mfma_f32_16x16x32_bf16 v[96:99], a[80:83], a[48:51], v[96:99]
ds_read_b64_tr_b16 a[64:65], v16 offset:49408
v_mfma_f32_16x16x32_bf16 v[100:103], a[80:83], a[52:55], v[100:103]
ds_read_b64_tr_b16 a[66:67], v16 offset:57600
buffer_load_dwordx4 a[36:39], v9, s[48:51], s41 offen sc1
v_mfma_f32_16x16x32_bf16 v[104:107], a[80:83], a[56:59], v[104:107]
v_mfma_f32_16x16x32_bf16 v[108:111], a[80:83], a[60:63], v[108:111]
s_waitcnt lgkmcnt(6)
v_mfma_f32_16x16x32_bf16 v[112:115], a[84:87], a[48:51], v[112:115]
ds_read_b64_tr_b16 a[68:69], v17 offset:49408
v_mfma_f32_16x16x32_bf16 v[116:119], a[84:87], a[52:55], v[116:119]
ds_read_b64_tr_b16 a[70:71], v17 offset:57600
v_mfma_f32_16x16x32_bf16 v[120:123], a[84:87], a[56:59], v[120:123]
v_mfma_f32_16x16x32_bf16 v[124:127], a[84:87], a[60:63], v[124:127]
s_waitcnt lgkmcnt(6)
v_mfma_f32_16x16x32_bf16 v[128:131], a[88:91], a[48:51], v[128:131]
ds_read_b64_tr_b16 a[72:73], v18 offset:49408
v_mfma_f32_16x16x32_bf16 v[132:135], a[88:91], a[52:55], v[132:135]
ds_read_b64_tr_b16 a[74:75], v18 offset:57600
s_add_u32 m0, s43, 20480
v_mfma_f32_16x16x32_bf16 v[136:139], a[88:91], a[56:59], v[136:139]
buffer_load_dwordx4 v13, s[52:55], s42 offen lds
v_mfma_f32_16x16x32_bf16 v[140:143], a[88:91], a[60:63], v[140:143]
s_waitcnt lgkmcnt(6)
v_mfma_f32_16x16x32_bf16 v[144:147], a[92:95], a[48:51], v[144:147]
ds_read_b64_tr_b16 a[76:77], v19 offset:49408
v_mfma_f32_16x16x32_bf16 v[148:151], a[92:95], a[52:55], v[148:151]
ds_read_b64_tr_b16 a[78:79], v19 offset:57600
v_mfma_f32_16x16x32_bf16 v[152:155], a[92:95], a[56:59], v[152:155]
v_mfma_f32_16x16x32_bf16 v[156:159], a[92:95], a[60:63], v[156:159]
s_waitcnt lgkmcnt(6)
v_mfma_f32_16x16x32_bf16 v[160:163], a[64:67], a[48:51], v[160:163]
ds_read_b64_tr_b16 a[80:81], v20 offset:49408
v_mfma_f32_16x16x32_bf16 v[164:167], a[64:67], a[52:55], v[164:167]
ds_read_b64_tr_b16 a[82:83], v20 offset:57600
buffer_load_dwordx4 a[40:43], v10, s[48:51], s41 offen sc1
v_mfma_f32_16x16x32_bf16 v[168:171], a[64:67], a[56:59], v[168:171]
v_mfma_f32_16x16x32_bf16 v[172:175], a[64:67], a[60:63], v[172:175]
s_waitcnt lgkmcnt(6)
v_mfma_f32_16x16x32_bf16 v[176:179], a[68:71], a[48:51], v[176:179]
ds_read_b64_tr_b16 a[84:85], v21 offset:49408
v_mfma_f32_16x16x32_bf16 v[180:183], a[68:71], a[52:55], v[180:183]
ds_read_b64_tr_b16 a[86:87], v21 offset:57600
v_mfma_f32_16x16x32_bf16 v[184:187], a[68:71], a[56:59], v[184:187]
v_mfma_f32_16x16x32_bf16 v[188:191], a[68:71], a[60:63], v[188:191]
s_waitcnt lgkmcnt(6)
v_mfma_f32_16x16x32_bf16 v[192:195], a[72:75], a[48:51], v[192:195]
ds_read_b64_tr_b16 a[88:89], v22 offset:49408
v_mfma_f32_16x16x32_bf16 v[196:199], a[72:75], a[52:55], v[196:199]
ds_read_b64_tr_b16 a[90:91], v22 offset:57600
s_add_u32 m0, s43, 24576
v_mfma_f32_16x16x32_bf16 v[200:203], a[72:75], a[56:59], v[200:203]
buffer_load_dwordx4 v14, s[52:55], s42 offen lds
v_mfma_f32_16x16x32_bf16 v[204:207], a[72:75], a[60:63], v[204:207]
s_waitcnt lgkmcnt(6)
v_mfma_f32_16x16x32_bf16 v[208:211], a[76:79], a[48:51], v[208:211]
ds_read_b64_tr_b16 a[92:93], v23 offset:49408
v_mfma_f32_16x16x32_bf16 v[212:215], a[76:79], a[52:55], v[212:215]
ds_read_b64_tr_b16 a[94:95], v23 offset:57600
v_mfma_f32_16x16x32_bf16 v[216:219], a[76:79], a[56:59], v[216:219]
v_mfma_f32_16x16x32_bf16 v[220:223], a[76:79], a[60:63], v[220:223]
s_waitcnt lgkmcnt(6)
v_mfma_f32_16x16x32_bf16 v[224:227], a[80:83], a[48:51], v[224:227]
s_waitcnt vmcnt(15)
s_barrier
ds_read_b64_tr_b16 a[64:65], v24 offset:0
v_mfma_f32_16x16x32_bf16 v[228:231], a[80:83], a[52:55], v[228:231]
ds_read_b64_tr_b16 a[66:67], v24 offset:8192
buffer_load_dwordx4 a[44:47], v11, s[48:51], s41 offen sc1
s_add_u32 s41, s41, 1024
v_mfma_f32_16x16x32_bf16 v[232:235], a[80:83], a[56:59], v[232:235]
v_mfma_f32_16x16x32_bf16 v[236:239], a[80:83], a[60:63], v[236:239]
s_waitcnt lgkmcnt(6)
v_mfma_f32_16x16x32_bf16 v[240:243], a[84:87], a[48:51], v[240:243]
ds_read_b64_tr_b16 a[68:69], v25 offset:0
v_mfma_f32_16x16x32_bf16 v[244:247], a[84:87], a[52:55], v[244:247]
ds_read_b64_tr_b16 a[70:71], v25 offset:8192
v_mfma_f32_16x16x32_bf16 v[248:251], a[84:87], a[56:59], v[248:251]
v_mfma_f32_16x16x32_bf16 v[252:255], a[84:87], a[60:63], v[252:255]
s_waitcnt lgkmcnt(6)
v_mfma_f32_16x16x32_bf16 a[96:99], a[88:91], a[48:51], a[96:99]
ds_read_b64_tr_b16 a[72:73], v26 offset:0
v_mfma_f32_16x16x32_bf16 a[100:103], a[88:91], a[52:55], a[100:103]
ds_read_b64_tr_b16 a[74:75], v26 offset:8192
s_add_u32 m0, s43, 28672
v_mfma_f32_16x16x32_bf16 a[104:107], a[88:91], a[56:59], a[104:107]
buffer_load_dwordx4 v15, s[52:55], s42 offen lds
s_add_u32 s42, s42, 196608
v_mfma_f32_16x16x32_bf16 a[108:111], a[88:91], a[60:63], a[108:111]
s_waitcnt lgkmcnt(6)
v_mfma_f32_16x16x32_bf16 a[112:115], a[92:95], a[48:51], a[112:115]
ds_read_b64_tr_b16 a[76:77], v27 offset:0
v_mfma_f32_16x16x32_bf16 a[116:119], a[92:95], a[52:55], a[116:119]
ds_read_b64_tr_b16 a[78:79], v27 offset:8192
v_mfma_f32_16x16x32_bf16 a[120:123], a[92:95], a[56:59], a[120:123]
v_mfma_f32_16x16x32_bf16 a[124:127], a[92:95], a[60:63], a[124:127]
s_waitcnt lgkmcnt(6)
v_mfma_f32_16x16x32_bf16 v[32:35], a[64:67], a[0:3], v[32:35]
ds_read_b64_tr_b16 a[80:81], v28 offset:0
v_mfma_f32_16x16x32_bf16 v[36:39], a[64:67], a[4:7], v[36:39]
ds_read_b64_tr_b16 a[82:83], v28 offset:8192
buffer_load_dwordx4 a[48:51], v8, s[48:51], s41 offen sc1
v_mfma_f32_16x16x32_bf16 v[40:43], a[64:67], a[8:11], v[40:43]
v_mfma_f32_16x16x32_bf16 v[44:47], a[64:67], a[12:15], v[44:47]
s_waitcnt lgkmcnt(6)
v_mfma_f32_16x16x32_bf16 v[48:51], a[68:71], a[0:3], v[48:51]
ds_read_b64_tr_b16 a[84:85], v29 offset:0
v_mfma_f32_16x16x32_bf16 v[52:55], a[68:71], a[4:7], v[52:55]
ds_read_b64_tr_b16 a[86:87], v29 offset:8192
v_mfma_f32_16x16x32_bf16 v[56:59], a[68:71], a[8:11], v[56:59]
v_mfma_f32_16x16x32_bf16 v[60:63], a[68:71], a[12:15], v[60:63]
s_waitcnt lgkmcnt(6)
v_mfma_f32_16x16x32_bf16 v[64:67], a[72:75], a[0:3], v[64:67]
ds_read_b64_tr_b16 a[88:89], v30 offset:0
v_mfma_f32_16x16x32_bf16 v[68:71], a[72:75], a[4:7], v[68:71]
ds_read_b64_tr_b16 a[90:91], v30 offset:8192
s_add_u32 m0, s43, 32768
v_mfma_f32_16x16x32_bf16 v[72:75], a[72:75], a[8:11], v[72:75]
buffer_load_dwordx4 v12, s[52:55], s42 offen lds
v_mfma_f32_16x16x32_bf16 v[76:79], a[72:75], a[12:15], v[76:79]
s_waitcnt lgkmcnt(6)
v_mfma_f32_16x16x32_bf16 v[80:83], a[76:79], a[0:3], v[80:83]
ds_read_b64_tr_b16 a[92:93], v31 offset:0
v_mfma_f32_16x16x32_bf16 v[84:87], a[76:79], a[4:7], v[84:87]
ds_read_b64_tr_b16 a[94:95], v31 offset:8192
v_mfma_f32_16x16x32_bf16 v[88:91], a[76:79], a[8:11], v[88:91]
v_mfma_f32_16x16x32_bf16 v[92:95], a[76:79], a[12:15], v[92:95]
s_waitcnt lgkmcnt(6)
v_mfma_f32_16x16x32_bf16 v[96:99], a[80:83], a[0:3], v[96:99]
ds_read_b64_tr_b16 a[64:65], v24 offset:256
v_mfma_f32_16x16x32_bf16 v[100:103], a[80:83], a[4:7], v[100:103]
ds_read_b64_tr_b16 a[66:67], v24 offset:8448
buffer_load_dwordx4 a[52:55], v9, s[48:51], s41 offen sc1
v_mfma_f32_16x16x32_bf16 v[104:107], a[80:83], a[8:11], v[104:107]
v_mfma_f32_16x16x32_bf16 v[108:111], a[80:83], a[12:15], v[108:111]
s_waitcnt lgkmcnt(6)
v_mfma_f32_16x16x32_bf16 v[112:115], a[84:87], a[0:3], v[112:115]
ds_read_b64_tr_b16 a[68:69], v25 offset:256
v_mfma_f32_16x16x32_bf16 v[116:119], a[84:87], a[4:7], v[116:119]
ds_read_b64_tr_b16 a[70:71], v25 offset:8448
v_mfma_f32_16x16x32_bf16 v[120:123], a[84:87], a[8:11], v[120:123]
v_mfma_f32_16x16x32_bf16 v[124:127], a[84:87], a[12:15], v[124:127]
s_waitcnt lgkmcnt(6)
v_mfma_f32_16x16x32_bf16 v[128:131], a[88:91], a[0:3], v[128:131]
ds_read_b64_tr_b16 a[72:73], v26 offset:256
v_mfma_f32_16x16x32_bf16 v[132:135], a[88:91], a[4:7], v[132:135]
ds_read_b64_tr_b16 a[74:75], v26 offset:8448
s_add_u32 m0, s43, 36864
v_mfma_f32_16x16x32_bf16 v[136:139], a[88:91], a[8:11], v[136:139]
buffer_load_dwordx4 v13, s[52:55], s42 offen lds
v_mfma_f32_16x16x32_bf16 v[140:143], a[88:91], a[12:15], v[140:143]
s_waitcnt lgkmcnt(6)
v_mfma_f32_16x16x32_bf16 v[144:147], a[92:95], a[0:3], v[144:147]
ds_read_b64_tr_b16 a[76:77], v27 offset:256
v_mfma_f32_16x16x32_bf16 v[148:151], a[92:95], a[4:7], v[148:151]
ds_read_b64_tr_b16 a[78:79], v27 offset:8448
v_mfma_f32_16x16x32_bf16 v[152:155], a[92:95], a[8:11], v[152:155]
v_mfma_f32_16x16x32_bf16 v[156:159], a[92:95], a[12:15], v[156:159]
s_waitcnt lgkmcnt(6)
v_mfma_f32_16x16x32_bf16 v[160:163], a[64:67], a[0:3], v[160:163]
ds_read_b64_tr_b16 a[80:81], v28 offset:256
v_mfma_f32_16x16x32_bf16 v[164:167], a[64:67], a[4:7], v[164:167]
ds_read_b64_tr_b16 a[82:83], v28 offset:8448
buffer_load_dwordx4 a[56:59], v10, s[48:51], s41 offen sc1
v_mfma_f32_16x16x32_bf16 v[168:171], a[64:67], a[8:11], v[168:171]
v_mfma_f32_16x16x32_bf16 v[172:175], a[64:67], a[12:15], v[172:175]
s_waitcnt lgkmcnt(6)
v_mfma_f32_16x16x32_bf16 v[176:179], a[68:71], a[0:3], v[176:179]
ds_read_b64_tr_b16 a[84:85], v29 offset:256
v_mfma_f32_16x16x32_bf16 v[180:183], a[68:71], a[4:7], v[180:183]
ds_read_b64_tr_b16 a[86:87], v29 offset:8448
v_mfma_f32_16x16x32_bf16 v[184:187], a[68:71], a[8:11], v[184:187]
v_mfma_f32_16x16x32_bf16 v[188:191], a[68:71], a[12:15], v[188:191]
s_waitcnt lgkmcnt(6)
v_mfma_f32_16x16x32_bf16 v[192:195], a[72:75], a[0:3], v[192:195]
ds_read_b64_tr_b16 a[88:89], v30 offset:256
v_mfma_f32_16x16x32_bf16 v[196:199], a[72:75], a[4:7], v[196:199]
ds_read_b64_tr_b16 a[90:91], v30 offset:8448
s_add_u32 m0, s43, 40960
v_mfma_f32_16x16x32_bf16 v[200:203], a[72:75], a[8:11], v[200:203]
buffer_load_dwordx4 v14, s[52:55], s42 offen lds
v_mfma_f32_16x16x32_bf16 v[204:207], a[72:75], a[12:15], v[204:207]
s_waitcnt lgkmcnt(6)
v_mfma_f32_16x16x32_bf16 v[208:211], a[76:79], a[0:3], v[208:211]
ds_read_b64_tr_b16 a[92:93], v31 offset:256
v_mfma_f32_16x16x32_bf16 v[212:215], a[76:79], a[4:7], v[212:215]
ds_read_b64_tr_b16 a[94:95], v31 offset:8448
v_mfma_f32_16x16x32_bf16 v[216:219], a[76:79], a[8:11], v[216:219]
v_mfma_f32_16x16x32_bf16 v[220:223], a[76:79], a[12:15], v[220:223]
s_waitcnt lgkmcnt(6)
v_mfma_f32_16x16x32_bf16 v[224:227], a[80:83], a[0:3], v[224:227]
s_waitcnt vmcnt(15)
s_barrier
ds_read_b64_tr_b16 a[64:65], v24 offset:16384
v_mfma_f32_16x16x32_bf16 v[228:231], a[80:83], a[4:7], v[228:231]
ds_read_b64_tr_b16 a[66:67], v24 offset:24576
buffer_load_dwordx4 a[60:63], v11, s[48:51], s41 offen sc1
s_add_u32 s41, s41, 1024
v_mfma_f32_16x16x32_bf16 v[232:235], a[80:83], a[8:11], v[232:235]
v_mfma_f32_16x16x32_bf16 v[236:239], a[80:83], a[12:15], v[236:239]
s_waitcnt lgkmcnt(6)
v_mfma_f32_16x16x32_bf16 v[240:243], a[84:87], a[0:3], v[240:243]
ds_read_b64_tr_b16 a[68:69], v25 offset:16384
v_mfma_f32_16x16x32_bf16 v[244:247], a[84:87], a[4:7], v[244:247]
ds_read_b64_tr_b16 a[70:71], v25 offset:24576
v_mfma_f32_16x16x32_bf16 v[248:251], a[84:87], a[8:11], v[248:251]
v_mfma_f32_16x16x32_bf16 v[252:255], a[84:87], a[12:15], v[252:255]
s_waitcnt lgkmcnt(6)
v_mfma_f32_16x16x32_bf16 a[96:99], a[88:91], a[0:3], a[96:99]
ds_read_b64_tr_b16 a[72:73], v26 offset:16384
v_mfma_f32_16x16x32_bf16 a[100:103], a[88:91], a[4:7], a[100:103]
ds_read_b64_tr_b16 a[74:75], v26 offset:24576
s_add_u32 m0, s43, 45056
v_mfma_f32_16x16x32_bf16 a[104:107], a[88:91], a[8:11], a[104:107]
buffer_load_dwordx4 v15, s[52:55], s42 offen lds
s_add_u32 s42, s42, 196608
v_mfma_f32_16x16x32_bf16 a[108:111], a[88:91], a[12:15], a[108:111]
s_waitcnt lgkmcnt(6)
v_mfma_f32_16x16x32_bf16 a[112:115], a[92:95], a[0:3], a[112:115]
ds_read_b64_tr_b16 a[76:77], v27 offset:16384
v_mfma_f32_16x16x32_bf16 a[116:119], a[92:95], a[4:7], a[116:119]
ds_read_b64_tr_b16 a[78:79], v27 offset:24576
v_mfma_f32_16x16x32_bf16 a[120:123], a[92:95], a[8:11], a[120:123]
v_mfma_f32_16x16x32_bf16 a[124:127], a[92:95], a[12:15], a[124:127]
s_waitcnt lgkmcnt(6)
v_mfma_f32_16x16x32_bf16 v[32:35], a[64:67], a[16:19], v[32:35]
ds_read_b64_tr_b16 a[80:81], v28 offset:16384
v_mfma_f32_16x16x32_bf16 v[36:39], a[64:67], a[20:23], v[36:39]
ds_read_b64_tr_b16 a[82:83], v28 offset:24576
buffer_load_dwordx4 a[0:3], v8, s[48:51], s41 offen sc1
v_mfma_f32_16x16x32_bf16 v[40:43], a[64:67], a[24:27], v[40:43]
v_mfma_f32_16x16x32_bf16 v[44:47], a[64:67], a[28:31], v[44:47]
s_waitcnt lgkmcnt(6)
v_mfma_f32_16x16x32_bf16 v[48:51], a[68:71], a[16:19], v[48:51]
ds_read_b64_tr_b16 a[84:85], v29 offset:16384
v_mfma_f32_16x16x32_bf16 v[52:55], a[68:71], a[20:23], v[52:55]
ds_read_b64_tr_b16 a[86:87], v29 offset:24576
v_mfma_f32_16x16x32_bf16 v[56:59], a[68:71], a[24:27], v[56:59]
v_mfma_f32_16x16x32_bf16 v[60:63], a[68:71], a[28:31], v[60:63]
s_waitcnt lgkmcnt(6)
v_mfma_f32_16x16x32_bf16 v[64:67], a[72:75], a[16:19], v[64:67]
ds_read_b64_tr_b16 a[88:89], v30 offset:16384
v_mfma_f32_16x16x32_bf16 v[68:71], a[72:75], a[20:23], v[68:71]
ds_read_b64_tr_b16 a[90:91], v30 offset:24576
s_add_u32 m0, s43, 49152
v_mfma_f32_16x16x32_bf16 v[72:75], a[72:75], a[24:27], v[72:75]
buffer_load_dwordx4 v12, s[52:55], s42 offen lds
v_mfma_f32_16x16x32_bf16 v[76:79], a[72:75], a[28:31], v[76:79]
s_waitcnt lgkmcnt(6)
v_mfma_f32_16x16x32_bf16 v[80:83], a[76:79], a[16:19], v[80:83]
ds_read_b64_tr_b16 a[92:93], v31 offset:16384
v_mfma_f32_16x16x32_bf16 v[84:87], a[76:79], a[20:23], v[84:87]
ds_read_b64_tr_b16 a[94:95], v31 offset:24576
v_mfma_f32_16x16x32_bf16 v[88:91], a[76:79], a[24:27], v[88:91]
v_mfma_f32_16x16x32_bf16 v[92:95], a[76:79], a[28:31], v[92:95]
s_waitcnt lgkmcnt(6)
v_mfma_f32_16x16x32_bf16 v[96:99], a[80:83], a[16:19], v[96:99]
ds_read_b64_tr_b16 a[64:65], v24 offset:16640
v_mfma_f32_16x16x32_bf16 v[100:103], a[80:83], a[20:23], v[100:103]
ds_read_b64_tr_b16 a[66:67], v24 offset:24832
buffer_load_dwordx4 a[4:7], v9, s[48:51], s41 offen sc1
v_mfma_f32_16x16x32_bf16 v[104:107], a[80:83], a[24:27], v[104:107]
v_mfma_f32_16x16x32_bf16 v[108:111], a[80:83], a[28:31], v[108:111]
s_waitcnt lgkmcnt(6)
v_mfma_f32_16x16x32_bf16 v[112:115], a[84:87], a[16:19], v[112:115]
ds_read_b64_tr_b16 a[68:69], v25 offset:16640
v_mfma_f32_16x16x32_bf16 v[116:119], a[84:87], a[20:23], v[116:119]
ds_read_b64_tr_b16 a[70:71], v25 offset:24832
v_mfma_f32_16x16x32_bf16 v[120:123], a[84:87], a[24:27], v[120:123]
v_mfma_f32_16x16x32_bf16 v[124:127], a[84:87], a[28:31], v[124:127]
s_waitcnt lgkmcnt(6)
v_mfma_f32_16x16x32_bf16 v[128:131], a[88:91], a[16:19], v[128:131]
ds_read_b64_tr_b16 a[72:73], v26 offset:16640
v_mfma_f32_16x16x32_bf16 v[132:135], a[88:91], a[20:23], v[132:135]
ds_read_b64_tr_b16 a[74:75], v26 offset:24832
s_add_u32 m0, s43, 53248
v_mfma_f32_16x16x32_bf16 v[136:139], a[88:91], a[24:27], v[136:139]
buffer_load_dwordx4 v13, s[52:55], s42 offen lds
v_mfma_f32_16x16x32_bf16 v[140:143], a[88:91], a[28:31], v[140:143]
s_waitcnt lgkmcnt(6)
v_mfma_f32_16x16x32_bf16 v[144:147], a[92:95], a[16:19], v[144:147]
ds_read_b64_tr_b16 a[76:77], v27 offset:16640
v_mfma_f32_16x16x32_bf16 v[148:151], a[92:95], a[20:23], v[148:151]
ds_read_b64_tr_b16 a[78:79], v27 offset:24832
v_mfma_f32_16x16x32_bf16 v[152:155], a[92:95], a[24:27], v[152:155]
v_mfma_f32_16x16x32_bf16 v[156:159], a[92:95], a[28:31], v[156:159]
s_waitcnt lgkmcnt(6)
v_mfma_f32_16x16x32_bf16 v[160:163], a[64:67], a[16:19], v[160:163]
ds_read_b64_tr_b16 a[80:81], v28 offset:16640
v_mfma_f32_16x16x32_bf16 v[164:167], a[64:67], a[20:23], v[164:167]
ds_read_b64_tr_b16 a[82:83], v28 offset:24832
buffer_load_dwordx4 a[8:11], v10, s[48:51], s41 offen sc1
v_mfma_f32_16x16x32_bf16 v[168:171], a[64:67], a[24:27], v[168:171]
v_mfma_f32_16x16x32_bf16 v[172:175], a[64:67], a[28:31], v[172:175]
s_waitcnt lgkmcnt(6)
v_mfma_f32_16x16x32_bf16 v[176:179], a[68:71], a[16:19], v[176:179]
ds_read_b64_tr_b16 a[84:85], v29 offset:16640
v_mfma_f32_16x16x32_bf16 v[180:183], a[68:71], a[20:23], v[180:183]
ds_read_b64_tr_b16 a[86:87], v29 offset:24832
v_mfma_f32_16x16x32_bf16 v[184:187], a[68:71], a[24:27], v[184:187]
v_mfma_f32_16x16x32_bf16 v[188:191], a[68:71], a[28:31], v[188:191]
s_waitcnt lgkmcnt(6)
v_mfma_f32_16x16x32_bf16 v[192:195], a[72:75], a[16:19], v[192:195]
ds_read_b64_tr_b16 a[88:89], v30 offset:16640
v_mfma_f32_16x16x32_bf16 v[196:199], a[72:75], a[20:23], v[196:199]
ds_read_b64_tr_b16 a[90:91], v30 offset:24832
s_add_u32 m0, s43, 57344
v_mfma_f32_16x16x32_bf16 v[200:203], a[72:75], a[24:27], v[200:203]
buffer_load_dwordx4 v14, s[52:55], s42 offen lds
v_mfma_f32_16x16x32_bf16 v[204:207], a[72:75], a[28:31], v[204:207]
s_waitcnt lgkmcnt(6)
v_mfma_f32_16x16x32_bf16 v[208:211], a[76:79], a[16:19], v[208:211]
ds_read_b64_tr_b16 a[92:93], v31 offset:16640
v_mfma_f32_16x16x32_bf16 v[212:215], a[76:79], a[20:23], v[212:215]
ds_read_b64_tr_b16 a[94:95], v31 offset:24832
v_mfma_f32_16x16x32_bf16 v[216:219], a[76:79], a[24:27], v[216:219]
v_mfma_f32_16x16x32_bf16 v[220:223], a[76:79], a[28:31], v[220:223]
s_waitcnt lgkmcnt(6)
v_mfma_f32_16x16x32_bf16 v[224:227], a[80:83], a[16:19], v[224:227]
s_waitcnt vmcnt(15)
s_barrier
ds_read_b64_tr_b16 a[64:65], v24 offset:32768
v_mfma_f32_16x16x32_bf16 v[228:231], a[80:83], a[20:23], v[228:231]
ds_read_b64_tr_b16 a[66:67], v24 offset:40960
buffer_load_dwordx4 a[12:15], v11, s[48:51], s41 offen sc1
s_add_u32 s41, s41, 1024
v_mfma_f32_16x16x32_bf16 v[232:235], a[80:83], a[24:27], v[232:235]
v_mfma_f32_16x16x32_bf16 v[236:239], a[80:83], a[28:31], v[236:239]
s_waitcnt lgkmcnt(6)
v_mfma_f32_16x16x32_bf16 v[240:243], a[84:87], a[16:19], v[240:243]
ds_read_b64_tr_b16 a[68:69], v25 offset:32768
v_mfma_f32_16x16x32_bf16 v[244:247], a[84:87], a[20:23], v[244:247]
ds_read_b64_tr_b16 a[70:71], v25 offset:40960
v_mfma_f32_16x16x32_bf16 v[248:251], a[84:87], a[24:27], v[248:251]
v_mfma_f32_16x16x32_bf16 v[252:255], a[84:87], a[28:31], v[252:255]
s_waitcnt lgkmcnt(6)
v_mfma_f32_16x16x32_bf16 a[96:99], a[88:91], a[16:19], a[96:99]
ds_read_b64_tr_b16 a[72:73], v26 offset:32768
v_mfma_f32_16x16x32_bf16 a[100:103], a[88:91], a[20:23], a[100:103]
ds_read_b64_tr_b16 a[74:75], v26 offset:40960
s_add_u32 m0, s43, 61440
v_mfma_f32_16x16x32_bf16 a[104:107], a[88:91], a[24:27], a[104:107]
buffer_load_dwordx4 v15, s[52:55], s42 offen lds
s_add_u32 s42, s42, 196608
v_mfma_f32_16x16x32_bf16 a[108:111], a[88:91], a[28:31], a[108:111]
s_waitcnt lgkmcnt(6)
v_mfma_f32_16x16x32_bf16 a[112:115], a[92:95], a[16:19], a[112:115]
ds_read_b64_tr_b16 a[76:77], v27 offset:32768
v_mfma_f32_16x16x32_bf16 a[116:119], a[92:95], a[20:23], a[116:119]
ds_read_b64_tr_b16 a[78:79], v27 offset:40960
v_mfma_f32_16x16x32_bf16 a[120:123], a[92:95], a[24:27], a[120:123]
v_mfma_f32_16x16x32_bf16 a[124:127], a[92:95], a[28:31], a[124:127]
s_waitcnt lgkmcnt(6)
v_mfma_f32_16x16x32_bf16 v[32:35], a[64:67], a[32:35], v[32:35]
ds_read_b64_tr_b16 a[80:81], v28 offset:32768
v_mfma_f32_16x16x32_bf16 v[36:39], a[64:67], a[36:39], v[36:39]
ds_read_b64_tr_b16 a[82:83], v28 offset:40960
buffer_load_dwordx4 a[16:19], v8, s[48:51], s41 offen sc1
v_mfma_f32_16x16x32_bf16 v[40:43], a[64:67], a[40:43], v[40:43]
v_mfma_f32_16x16x32_bf16 v[44:47], a[64:67], a[44:47], v[44:47]
s_waitcnt lgkmcnt(6)
v_mfma_f32_16x16x32_bf16 v[48:51], a[68:71], a[32:35], v[48:51]
ds_read_b64_tr_b16 a[84:85], v29 offset:32768
v_mfma_f32_16x16x32_bf16 v[52:55], a[68:71], a[36:39], v[52:55]
ds_read_b64_tr_b16 a[86:87], v29 offset:40960
v_mfma_f32_16x16x32_bf16 v[56:59], a[68:71], a[40:43], v[56:59]
v_mfma_f32_16x16x32_bf16 v[60:63], a[68:71], a[44:47], v[60:63]
s_waitcnt lgkmcnt(6)
v_mfma_f32_16x16x32_bf16 v[64:67], a[72:75], a[32:35], v[64:67]
ds_read_b64_tr_b16 a[88:89], v30 offset:32768
v_mfma_f32_16x16x32_bf16 v[68:71], a[72:75], a[36:39], v[68:71]
ds_read_b64_tr_b16 a[90:91], v30 offset:40960
s_add_u32 m0, s43, 65536
v_mfma_f32_16x16x32_bf16 v[72:75], a[72:75], a[40:43], v[72:75]
buffer_load_dwordx4 v12, s[52:55], s42 offen lds
v_mfma_f32_16x16x32_bf16 v[76:79], a[72:75], a[44:47], v[76:79]
s_waitcnt lgkmcnt(6)
v_mfma_f32_16x16x32_bf16 v[80:83], a[76:79], a[32:35], v[80:83]
ds_read_b64_tr_b16 a[92:93], v31 offset:32768
v_mfma_f32_16x16x32_bf16 v[84:87], a[76:79], a[36:39], v[84:87]
ds_read_b64_tr_b16 a[94:95], v31 offset:40960
v_mfma_f32_16x16x32_bf16 v[88:91], a[76:79], a[40:43], v[88:91]
v_mfma_f32_16x16x32_bf16 v[92:95], a[76:79], a[44:47], v[92:95]
s_waitcnt lgkmcnt(6)
v_mfma_f32_16x16x32_bf16 v[96:99], a[80:83], a[32:35], v[96:99]
ds_read_b64_tr_b16 a[64:65], v24 offset:33024
v_mfma_f32_16x16x32_bf16 v[100:103], a[80:83], a[36:39], v[100:103]
ds_read_b64_tr_b16 a[66:67], v24 offset:41216
buffer_load_dwordx4 a[20:23], v9, s[48:51], s41 offen sc1
v_mfma_f32_16x16x32_bf16 v[104:107], a[80:83], a[40:43], v[104:107]
v_mfma_f32_16x16x32_bf16 v[108:111], a[80:83], a[44:47], v[108:111]
s_waitcnt lgkmcnt(6)
v_mfma_f32_16x16x32_bf16 v[112:115], a[84:87], a[32:35], v[112:115]
ds_read_b64_tr_b16 a[68:69], v25 offset:33024
v_mfma_f32_16x16x32_bf16 v[116:119], a[84:87], a[36:39], v[116:119]
ds_read_b64_tr_b16 a[70:71], v25 offset:41216
v_mfma_f32_16x16x32_bf16 v[120:123], a[84:87], a[40:43], v[120:123]
v_mfma_f32_16x16x32_bf16 v[124:127], a[84:87], a[44:47], v[124:127]
s_waitcnt lgkmcnt(6)
v_mfma_f32_16x16x32_bf16 v[128:131], a[88:91], a[32:35], v[128:131]
ds_read_b64_tr_b16 a[72:73], v26 offset:33024
v_mfma_f32_16x16x32_bf16 v[132:135], a[88:91], a[36:39], v[132:135]
ds_read_b64_tr_b16 a[74:75], v26 offset:41216
s_add_u32 m0, s43, 69632
v_mfma_f32_16x16x32_bf16 v[136:139], a[88:91], a[40:43], v[136:139]
buffer_load_dwordx4 v13, s[52:55], s42 offen lds
v_mfma_f32_16x16x32_bf16 v[140:143], a[88:91], a[44:47], v[140:143]
s_waitcnt lgkmcnt(6)
v_mfma_f32_16x16x32_bf16 v[144:147], a[92:95], a[32:35], v[144:147]
ds_read_b64_tr_b16 a[76:77], v27 offset:33024
v_mfma_f32_16x16x32_bf16 v[148:151], a[92:95], a[36:39], v[148:151]
ds_read_b64_tr_b16 a[78:79], v27 offset:41216
v_mfma_f32_16x16x32_bf16 v[152:155], a[92:95], a[40:43], v[152:155]
v_mfma_f32_16x16x32_bf16 v[156:159], a[92:95], a[44:47], v[156:159]
s_waitcnt lgkmcnt(6)
v_mfma_f32_16x16x32_bf16 v[160:163], a[64:67], a[32:35], v[160:163]
ds_read_b64_tr_b16 a[80:81], v28 offset:33024
v_mfma_f32_16x16x32_bf16 v[164:167], a[64:67], a[36:39], v[164:167]
ds_read_b64_tr_b16 a[82:83], v28 offset:41216
buffer_load_dwordx4 a[24:27], v10, s[48:51], s41 offen sc1
v_mfma_f32_16x16x32_bf16 v[168:171], a[64:67], a[40:43], v[168:171]
v_mfma_f32_16x16x32_bf16 v[172:175], a[64:67], a[44:47], v[172:175]
s_waitcnt lgkmcnt(6)
v_mfma_f32_16x16x32_bf16 v[176:179], a[68:71], a[32:35], v[176:179]
ds_read_b64_tr_b16 a[84:85], v29 offset:33024
v_mfma_f32_16x16x32_bf16 v[180:183], a[68:71], a[36:39], v[180:183]
ds_read_b64_tr_b16 a[86:87], v29 offset:41216
v_mfma_f32_16x16x32_bf16 v[184:187], a[68:71], a[40:43], v[184:187]
v_mfma_f32_16x16x32_bf16 v[188:191], a[68:71], a[44:47], v[188:191]
s_waitcnt lgkmcnt(6)
v_mfma_f32_16x16x32_bf16 v[192:195], a[72:75], a[32:35], v[192:195]
ds_read_b64_tr_b16 a[88:89], v30 offset:33024
v_mfma_f32_16x16x32_bf16 v[196:199], a[72:75], a[36:39], v[196:199]
ds_read_b64_tr_b16 a[90:91], v30 offset:41216
s_add_u32 m0, s43, 73728
v_mfma_f32_16x16x32_bf16 v[200:203], a[72:75], a[40:43], v[200:203]
buffer_load_dwordx4 v14, s[52:55], s42 offen lds
v_mfma_f32_16x16x32_bf16 v[204:207], a[72:75], a[44:47], v[204:207]
s_waitcnt lgkmcnt(6)
v_mfma_f32_16x16x32_bf16 v[208:211], a[76:79], a[32:35], v[208:211]
ds_read_b64_tr_b16 a[92:93], v31 offset:33024
v_mfma_f32_16x16x32_bf16 v[212:215], a[76:79], a[36:39], v[212:215]
ds_read_b64_tr_b16 a[94:95], v31 offset:41216
v_mfma_f32_16x16x32_bf16 v[216:219], a[76:79], a[40:43], v[216:219]
v_mfma_f32_16x16x32_bf16 v[220:223], a[76:79], a[44:47], v[220:223]
s_waitcnt lgkmcnt(6)
v_mfma_f32_16x16x32_bf16 v[224:227], a[80:83], a[32:35], v[224:227]
s_waitcnt vmcnt(15)
s_barrier
ds_read_b64_tr_b16 a[64:65], v24 offset:49152
v_mfma_f32_16x16x32_bf16 v[228:231], a[80:83], a[36:39], v[228:231]
ds_read_b64_tr_b16 a[66:67], v24 offset:57344
buffer_load_dwordx4 a[28:31], v11, s[48:51], s41 offen sc1
s_add_u32 s41, s41, 1024
v_mfma_f32_16x16x32_bf16 v[232:235], a[80:83], a[40:43], v[232:235]
v_mfma_f32_16x16x32_bf16 v[236:239], a[80:83], a[44:47], v[236:239]
s_waitcnt lgkmcnt(6)
v_mfma_f32_16x16x32_bf16 v[240:243], a[84:87], a[32:35], v[240:243]
ds_read_b64_tr_b16 a[68:69], v25 offset:49152
v_mfma_f32_16x16x32_bf16 v[244:247], a[84:87], a[36:39], v[244:247]
ds_read_b64_tr_b16 a[70:71], v25 offset:57344
v_mfma_f32_16x16x32_bf16 v[248:251], a[84:87], a[40:43], v[248:251]
v_mfma_f32_16x16x32_bf16 v[252:255], a[84:87], a[44:47], v[252:255]
s_waitcnt lgkmcnt(6)
v_mfma_f32_16x16x32_bf16 a[96:99], a[88:91], a[32:35], a[96:99]
ds_read_b64_tr_b16 a[72:73], v26 offset:49152
v_mfma_f32_16x16x32_bf16 a[100:103], a[88:91], a[36:39], a[100:103]
ds_read_b64_tr_b16 a[74:75], v26 offset:57344
s_add_u32 m0, s43, 77824
v_mfma_f32_16x16x32_bf16 a[104:107], a[88:91], a[40:43], a[104:107]
buffer_load_dwordx4 v15, s[52:55], s42 offen lds
s_add_u32 s42, s42, 196608
v_mfma_f32_16x16x32_bf16 a[108:111], a[88:91], a[44:47], a[108:111]
s_waitcnt lgkmcnt(6)
v_mfma_f32_16x16x32_bf16 a[112:115], a[92:95], a[32:35], a[112:115]
ds_read_b64_tr_b16 a[76:77], v27 offset:49152
v_mfma_f32_16x16x32_bf16 a[116:119], a[92:95], a[36:39], a[116:119]
ds_read_b64_tr_b16 a[78:79], v27 offset:57344
v_mfma_f32_16x16x32_bf16 a[120:123], a[92:95], a[40:43], a[120:123]
v_mfma_f32_16x16x32_bf16 a[124:127], a[92:95], a[44:47], a[124:127]
s_waitcnt lgkmcnt(6)
v_mfma_f32_16x16x32_bf16 v[32:35], a[64:67], a[48:51], v[32:35]
ds_read_b64_tr_b16 a[80:81], v28 offset:49152
v_mfma_f32_16x16x32_bf16 v[36:39], a[64:67], a[52:55], v[36:39]
ds_read_b64_tr_b16 a[82:83], v28 offset:57344
buffer_load_dwordx4 a[32:35], v8, s[48:51], s41 offen sc1
v_mfma_f32_16x16x32_bf16 v[40:43], a[64:67], a[56:59], v[40:43]
v_mfma_f32_16x16x32_bf16 v[44:47], a[64:67], a[60:63], v[44:47]
s_waitcnt lgkmcnt(6)
v_mfma_f32_16x16x32_bf16 v[48:51], a[68:71], a[48:51], v[48:51]
ds_read_b64_tr_b16 a[84:85], v29 offset:49152
v_mfma_f32_16x16x32_bf16 v[52:55], a[68:71], a[52:55], v[52:55]
ds_read_b64_tr_b16 a[86:87], v29 offset:57344
v_mfma_f32_16x16x32_bf16 v[56:59], a[68:71], a[56:59], v[56:59]
v_mfma_f32_16x16x32_bf16 v[60:63], a[68:71], a[60:63], v[60:63]
s_waitcnt lgkmcnt(6)
v_mfma_f32_16x16x32_bf16 v[64:67], a[72:75], a[48:51], v[64:67]
ds_read_b64_tr_b16 a[88:89], v30 offset:49152
v_mfma_f32_16x16x32_bf16 v[68:71], a[72:75], a[52:55], v[68:71]
ds_read_b64_tr_b16 a[90:91], v30 offset:57344
s_add_u32 m0, s43, 81920
v_mfma_f32_16x16x32_bf16 v[72:75], a[72:75], a[56:59], v[72:75]
buffer_load_dwordx4 v12, s[52:55], s42 offen lds
v_mfma_f32_16x16x32_bf16 v[76:79], a[72:75], a[60:63], v[76:79]
s_waitcnt lgkmcnt(6)
v_mfma_f32_16x16x32_bf16 v[80:83], a[76:79], a[48:51], v[80:83]
ds_read_b64_tr_b16 a[92:93], v31 offset:49152
v_mfma_f32_16x16x32_bf16 v[84:87], a[76:79], a[52:55], v[84:87]
ds_read_b64_tr_b16 a[94:95], v31 offset:57344
v_mfma_f32_16x16x32_bf16 v[88:91], a[76:79], a[56:59], v[88:91]
v_mfma_f32_16x16x32_bf16 v[92:95], a[76:79], a[60:63], v[92:95]
s_waitcnt lgkmcnt(6)
v_mfma_f32_16x16x32_bf16 v[96:99], a[80:83], a[48:51], v[96:99]
ds_read_b64_tr_b16 a[64:65], v24 offset:49408
v_mfma_f32_16x16x32_bf16 v[100:103], a[80:83], a[52:55], v[100:103]
ds_read_b64_tr_b16 a[66:67], v24 offset:57600
buffer_load_dwordx4 a[36:39], v9, s[48:51], s41 offen sc1
v_mfma_f32_16x16x32_bf16 v[104:107], a[80:83], a[56:59], v[104:107]
v_mfma_f32_16x16x32_bf16 v[108:111], a[80:83], a[60:63], v[108:111]
s_waitcnt lgkmcnt(6)
v_mfma_f32_16x16x32_bf16 v[112:115], a[84:87], a[48:51], v[112:115]
ds_read_b64_tr_b16 a[68:69], v25 offset:49408
v_mfma_f32_16x16x32_bf16 v[116:119], a[84:87], a[52:55], v[116:119]
ds_read_b64_tr_b16 a[70:71], v25 offset:57600
v_mfma_f32_16x16x32_bf16 v[120:123], a[84:87], a[56:59], v[120:123]
v_mfma_f32_16x16x32_bf16 v[124:127], a[84:87], a[60:63], v[124:127]
s_waitcnt lgkmcnt(6)
v_mfma_f32_16x16x32_bf16 v[128:131], a[88:91], a[48:51], v[128:131]
ds_read_b64_tr_b16 a[72:73], v26 offset:49408
v_mfma_f32_16x16x32_bf16 v[132:135], a[88:91], a[52:55], v[132:135]
ds_read_b64_tr_b16 a[74:75], v26 offset:57600
s_add_u32 m0, s43, 86016
v_mfma_f32_16x16x32_bf16 v[136:139], a[88:91], a[56:59], v[136:139]
buffer_load_dwordx4 v13, s[52:55], s42 offen lds
v_mfma_f32_16x16x32_bf16 v[140:143], a[88:91], a[60:63], v[140:143]
s_waitcnt lgkmcnt(6)
v_mfma_f32_16x16x32_bf16 v[144:147], a[92:95], a[48:51], v[144:147]
ds_read_b64_tr_b16 a[76:77], v27 offset:49408
v_mfma_f32_16x16x32_bf16 v[148:151], a[92:95], a[52:55], v[148:151]
ds_read_b64_tr_b16 a[78:79], v27 offset:57600
v_mfma_f32_16x16x32_bf16 v[152:155], a[92:95], a[56:59], v[152:155]
v_mfma_f32_16x16x32_bf16 v[156:159], a[92:95], a[60:63], v[156:159]
s_waitcnt lgkmcnt(6)
v_mfma_f32_16x16x32_bf16 v[160:163], a[64:67], a[48:51], v[160:163]
ds_read_b64_tr_b16 a[80:81], v28 offset:49408
v_mfma_f32_16x16x32_bf16 v[164:167], a[64:67], a[52:55], v[164:167]
ds_read_b64_tr_b16 a[82:83], v28 offset:57600
buffer_load_dwordx4 a[40:43], v10, s[48:51], s41 offen sc1
v_mfma_f32_16x16x32_bf16 v[168:171], a[64:67], a[56:59], v[168:171]
v_mfma_f32_16x16x32_bf16 v[172:175], a[64:67], a[60:63], v[172:175]
s_waitcnt lgkmcnt(6)
v_mfma_f32_16x16x32_bf16 v[176:179], a[68:71], a[48:51], v[176:179]
ds_read_b64_tr_b16 a[84:85], v29 offset:49408
v_mfma_f32_16x16x32_bf16 v[180:183], a[68:71], a[52:55], v[180:183]
ds_read_b64_tr_b16 a[86:87], v29 offset:57600
v_mfma_f32_16x16x32_bf16 v[184:187], a[68:71], a[56:59], v[184:187]
v_mfma_f32_16x16x32_bf16 v[188:191], a[68:71], a[60:63], v[188:191]
s_waitcnt lgkmcnt(6)
v_mfma_f32_16x16x32_bf16 v[192:195], a[72:75], a[48:51], v[192:195]
ds_read_b64_tr_b16 a[88:89], v30 offset:49408
v_mfma_f32_16x16x32_bf16 v[196:199], a[72:75], a[52:55], v[196:199]
ds_read_b64_tr_b16 a[90:91], v30 offset:57600
s_add_u32 m0, s43, 90112
v_mfma_f32_16x16x32_bf16 v[200:203], a[72:75], a[56:59], v[200:203]
buffer_load_dwordx4 v14, s[52:55], s42 offen lds
v_mfma_f32_16x16x32_bf16 v[204:207], a[72:75], a[60:63], v[204:207]
s_waitcnt lgkmcnt(6)
v_mfma_f32_16x16x32_bf16 v[208:211], a[76:79], a[48:51], v[208:211]
ds_read_b64_tr_b16 a[92:93], v31 offset:49408
v_mfma_f32_16x16x32_bf16 v[212:215], a[76:79], a[52:55], v[212:215]
ds_read_b64_tr_b16 a[94:95], v31 offset:57600
v_mfma_f32_16x16x32_bf16 v[216:219], a[76:79], a[56:59], v[216:219]
v_mfma_f32_16x16x32_bf16 v[220:223], a[76:79], a[60:63], v[220:223]
s_waitcnt lgkmcnt(6)
v_mfma_f32_16x16x32_bf16 v[224:227], a[80:83], a[48:51], v[224:227]
s_waitcnt vmcnt(15)
s_barrier
ds_read_b64_tr_b16 a[64:65], v16 offset:0
v_mfma_f32_16x16x32_bf16 v[228:231], a[80:83], a[52:55], v[228:231]
ds_read_b64_tr_b16 a[66:67], v16 offset:8192
buffer_load_dwordx4 a[44:47], v11, s[48:51], s41 offen sc1
s_add_u32 s41, s41, 1024
v_mfma_f32_16x16x32_bf16 v[232:235], a[80:83], a[56:59], v[232:235]
v_mfma_f32_16x16x32_bf16 v[236:239], a[80:83], a[60:63], v[236:239]
s_waitcnt lgkmcnt(6)
v_mfma_f32_16x16x32_bf16 v[240:243], a[84:87], a[48:51], v[240:243]
ds_read_b64_tr_b16 a[68:69], v17 offset:0
v_mfma_f32_16x16x32_bf16 v[244:247], a[84:87], a[52:55], v[244:247]
ds_read_b64_tr_b16 a[70:71], v17 offset:8192
v_mfma_f32_16x16x32_bf16 v[248:251], a[84:87], a[56:59], v[248:251]
v_mfma_f32_16x16x32_bf16 v[252:255], a[84:87], a[60:63], v[252:255]
s_waitcnt lgkmcnt(6)
v_mfma_f32_16x16x32_bf16 a[96:99], a[88:91], a[48:51], a[96:99]
ds_read_b64_tr_b16 a[72:73], v18 offset:0
v_mfma_f32_16x16x32_bf16 a[100:103], a[88:91], a[52:55], a[100:103]
ds_read_b64_tr_b16 a[74:75], v18 offset:8192
s_add_u32 m0, s43, 94208
v_mfma_f32_16x16x32_bf16 a[104:107], a[88:91], a[56:59], a[104:107]
buffer_load_dwordx4 v15, s[52:55], s42 offen lds
s_add_u32 s42, s42, 196608
v_mfma_f32_16x16x32_bf16 a[108:111], a[88:91], a[60:63], a[108:111]
s_waitcnt lgkmcnt(6)
v_mfma_f32_16x16x32_bf16 a[112:115], a[92:95], a[48:51], a[112:115]
ds_read_b64_tr_b16 a[76:77], v19 offset:0
v_mfma_f32_16x16x32_bf16 a[116:119], a[92:95], a[52:55], a[116:119]
ds_read_b64_tr_b16 a[78:79], v19 offset:8192
v_mfma_f32_16x16x32_bf16 a[120:123], a[92:95], a[56:59], a[120:123]
v_mfma_f32_16x16x32_bf16 a[124:127], a[92:95], a[60:63], a[124:127]
s_sub_u32 s44, s44, 1
s_cmp_lg_u32 s44, 0
s_cbranch_scc1 L_gemm1_kernel_qk_loop0
s_waitcnt lgkmcnt(6)
v_mfma_f32_16x16x32_bf16 v[32:35], a[64:67], a[0:3], v[32:35]
ds_read_b64_tr_b16 a[80:81], v20 offset:0
v_mfma_f32_16x16x32_bf16 v[36:39], a[64:67], a[4:7], v[36:39]
ds_read_b64_tr_b16 a[82:83], v20 offset:8192
buffer_load_dwordx4 a[48:51], v8, s[48:51], s41 offen sc1
v_mfma_f32_16x16x32_bf16 v[40:43], a[64:67], a[8:11], v[40:43]
v_mfma_f32_16x16x32_bf16 v[44:47], a[64:67], a[12:15], v[44:47]
s_waitcnt lgkmcnt(6)
v_mfma_f32_16x16x32_bf16 v[48:51], a[68:71], a[0:3], v[48:51]
ds_read_b64_tr_b16 a[84:85], v21 offset:0
v_mfma_f32_16x16x32_bf16 v[52:55], a[68:71], a[4:7], v[52:55]
ds_read_b64_tr_b16 a[86:87], v21 offset:8192
v_mfma_f32_16x16x32_bf16 v[56:59], a[68:71], a[8:11], v[56:59]
v_mfma_f32_16x16x32_bf16 v[60:63], a[68:71], a[12:15], v[60:63]
s_waitcnt lgkmcnt(6)
v_mfma_f32_16x16x32_bf16 v[64:67], a[72:75], a[0:3], v[64:67]
ds_read_b64_tr_b16 a[88:89], v22 offset:0
v_mfma_f32_16x16x32_bf16 v[68:71], a[72:75], a[4:7], v[68:71]
ds_read_b64_tr_b16 a[90:91], v22 offset:8192
s_add_u32 m0, s43, 98304
v_mfma_f32_16x16x32_bf16 v[72:75], a[72:75], a[8:11], v[72:75]
buffer_load_dwordx4 v12, s[52:55], s42 offen lds
v_mfma_f32_16x16x32_bf16 v[76:79], a[72:75], a[12:15], v[76:79]
s_waitcnt lgkmcnt(6)
v_mfma_f32_16x16x32_bf16 v[80:83], a[76:79], a[0:3], v[80:83]
ds_read_b64_tr_b16 a[92:93], v23 offset:0
v_mfma_f32_16x16x32_bf16 v[84:87], a[76:79], a[4:7], v[84:87]
ds_read_b64_tr_b16 a[94:95], v23 offset:8192
v_mfma_f32_16x16x32_bf16 v[88:91], a[76:79], a[8:11], v[88:91]
v_mfma_f32_16x16x32_bf16 v[92:95], a[76:79], a[12:15], v[92:95]
s_waitcnt lgkmcnt(6)
v_mfma_f32_16x16x32_bf16 v[96:99], a[80:83], a[0:3], v[96:99]
ds_read_b64_tr_b16 a[64:65], v16 offset:256
v_mfma_f32_16x16x32_bf16 v[100:103], a[80:83], a[4:7], v[100:103]
ds_read_b64_tr_b16 a[66:67], v16 offset:8448
buffer_load_dwordx4 a[52:55], v9, s[48:51], s41 offen sc1
v_mfma_f32_16x16x32_bf16 v[104:107], a[80:83], a[8:11], v[104:107]
v_mfma_f32_16x16x32_bf16 v[108:111], a[80:83], a[12:15], v[108:111]
s_waitcnt lgkmcnt(6)
v_mfma_f32_16x16x32_bf16 v[112:115], a[84:87], a[0:3], v[112:115]
ds_read_b64_tr_b16 a[68:69], v17 offset:256
v_mfma_f32_16x16x32_bf16 v[116:119], a[84:87], a[4:7], v[116:119]
ds_read_b64_tr_b16 a[70:71], v17 offset:8448
v_mfma_f32_16x16x32_bf16 v[120:123], a[84:87], a[8:11], v[120:123]
v_mfma_f32_16x16x32_bf16 v[124:127], a[84:87], a[12:15], v[124:127]
s_waitcnt lgkmcnt(6)
v_mfma_f32_16x16x32_bf16 v[128:131], a[88:91], a[0:3], v[128:131]
ds_read_b64_tr_b16 a[72:73], v18 offset:256
v_mfma_f32_16x16x32_bf16 v[132:135], a[88:91], a[4:7], v[132:135]
ds_read_b64_tr_b16 a[74:75], v18 offset:8448
s_add_u32 m0, s43, 102400
v_mfma_f32_16x16x32_bf16 v[136:139], a[88:91], a[8:11], v[136:139]
buffer_load_dwordx4 v13, s[52:55], s42 offen lds
v_mfma_f32_16x16x32_bf16 v[140:143], a[88:91], a[12:15], v[140:143]
s_waitcnt lgkmcnt(6)
v_mfma_f32_16x16x32_bf16 v[144:147], a[92:95], a[0:3], v[144:147]
ds_read_b64_tr_b16 a[76:77], v19 offset:256
v_mfma_f32_16x16x32_bf16 v[148:151], a[92:95], a[4:7], v[148:151]
ds_read_b64_tr_b16 a[78:79], v19 offset:8448
v_mfma_f32_16x16x32_bf16 v[152:155], a[92:95], a[8:11], v[152:155]
v_mfma_f32_16x16x32_bf16 v[156:159], a[92:95], a[12:15], v[156:159]
s_waitcnt lgkmcnt(6)
v_mfma_f32_16x16x32_bf16 v[160:163], a[64:67], a[0:3], v[160:163]
ds_read_b64_tr_b16 a[80:81], v20 offset:256
v_mfma_f32_16x16x32_bf16 v[164:167], a[64:67], a[4:7], v[164:167]
ds_read_b64_tr_b16 a[82:83], v20 offset:8448
buffer_load_dwordx4 a[56:59], v10, s[48:51], s41 offen sc1
v_mfma_f32_16x16x32_bf16 v[168:171], a[64:67], a[8:11], v[168:171]
v_mfma_f32_16x16x32_bf16 v[172:175], a[64:67], a[12:15], v[172:175]
s_waitcnt lgkmcnt(6)
v_mfma_f32_16x16x32_bf16 v[176:179], a[68:71], a[0:3], v[176:179]
ds_read_b64_tr_b16 a[84:85], v21 offset:256
v_mfma_f32_16x16x32_bf16 v[180:183], a[68:71], a[4:7], v[180:183]
ds_read_b64_tr_b16 a[86:87], v21 offset:8448
v_mfma_f32_16x16x32_bf16 v[184:187], a[68:71], a[8:11], v[184:187]
v_mfma_f32_16x16x32_bf16 v[188:191], a[68:71], a[12:15], v[188:191]
s_waitcnt lgkmcnt(6)
v_mfma_f32_16x16x32_bf16 v[192:195], a[72:75], a[0:3], v[192:195]
ds_read_b64_tr_b16 a[88:89], v22 offset:256
v_mfma_f32_16x16x32_bf16 v[196:199], a[72:75], a[4:7], v[196:199]
ds_read_b64_tr_b16 a[90:91], v22 offset:8448
s_add_u32 m0, s43, 106496
v_mfma_f32_16x16x32_bf16 v[200:203], a[72:75], a[8:11], v[200:203]
buffer_load_dwordx4 v14, s[52:55], s42 offen lds
v_mfma_f32_16x16x32_bf16 v[204:207], a[72:75], a[12:15], v[204:207]
s_waitcnt lgkmcnt(6)
v_mfma_f32_16x16x32_bf16 v[208:211], a[76:79], a[0:3], v[208:211]
ds_read_b64_tr_b16 a[92:93], v23 offset:256
v_mfma_f32_16x16x32_bf16 v[212:215], a[76:79], a[4:7], v[212:215]
ds_read_b64_tr_b16 a[94:95], v23 offset:8448
v_mfma_f32_16x16x32_bf16 v[216:219], a[76:79], a[8:11], v[216:219]
v_mfma_f32_16x16x32_bf16 v[220:223], a[76:79], a[12:15], v[220:223]
s_waitcnt lgkmcnt(6)
v_mfma_f32_16x16x32_bf16 v[224:227], a[80:83], a[0:3], v[224:227]
s_waitcnt vmcnt(15)
s_barrier
ds_read_b64_tr_b16 a[64:65], v16 offset:16384
v_mfma_f32_16x16x32_bf16 v[228:231], a[80:83], a[4:7], v[228:231]
ds_read_b64_tr_b16 a[66:67], v16 offset:24576
buffer_load_dwordx4 a[60:63], v11, s[48:51], s41 offen sc1
s_add_u32 s41, s41, 1024
v_mfma_f32_16x16x32_bf16 v[232:235], a[80:83], a[8:11], v[232:235]
v_mfma_f32_16x16x32_bf16 v[236:239], a[80:83], a[12:15], v[236:239]
s_waitcnt lgkmcnt(6)
v_mfma_f32_16x16x32_bf16 v[240:243], a[84:87], a[0:3], v[240:243]
ds_read_b64_tr_b16 a[68:69], v17 offset:16384
v_mfma_f32_16x16x32_bf16 v[244:247], a[84:87], a[4:7], v[244:247]
ds_read_b64_tr_b16 a[70:71], v17 offset:24576
v_mfma_f32_16x16x32_bf16 v[248:251], a[84:87], a[8:11], v[248:251]
v_mfma_f32_16x16x32_bf16 v[252:255], a[84:87], a[12:15], v[252:255]
s_waitcnt lgkmcnt(6)
v_mfma_f32_16x16x32_bf16 a[96:99], a[88:91], a[0:3], a[96:99]
ds_read_b64_tr_b16 a[72:73], v18 offset:16384
v_mfma_f32_16x16x32_bf16 a[100:103], a[88:91], a[4:7], a[100:103]
ds_read_b64_tr_b16 a[74:75], v18 offset:24576
s_add_u32 m0, s43, 110592
v_mfma_f32_16x16x32_bf16 a[104:107], a[88:91], a[8:11], a[104:107]
buffer_load_dwordx4 v15, s[52:55], s42 offen lds
s_add_u32 s42, s42, 196608
v_mfma_f32_16x16x32_bf16 a[108:111], a[88:91], a[12:15], a[108:111]
s_waitcnt lgkmcnt(6)
v_mfma_f32_16x16x32_bf16 a[112:115], a[92:95], a[0:3], a[112:115]
ds_read_b64_tr_b16 a[76:77], v19 offset:16384
v_mfma_f32_16x16x32_bf16 a[116:119], a[92:95], a[4:7], a[116:119]
ds_read_b64_tr_b16 a[78:79], v19 offset:24576
v_mfma_f32_16x16x32_bf16 a[120:123], a[92:95], a[8:11], a[120:123]
v_mfma_f32_16x16x32_bf16 a[124:127], a[92:95], a[12:15], a[124:127]
s_waitcnt lgkmcnt(6)
v_mfma_f32_16x16x32_bf16 v[32:35], a[64:67], a[16:19], v[32:35]
ds_read_b64_tr_b16 a[80:81], v20 offset:16384
v_mfma_f32_16x16x32_bf16 v[36:39], a[64:67], a[20:23], v[36:39]
ds_read_b64_tr_b16 a[82:83], v20 offset:24576
buffer_load_dwordx4 a[0:3], v8, s[48:51], s41 offen sc1
v_mfma_f32_16x16x32_bf16 v[40:43], a[64:67], a[24:27], v[40:43]
v_mfma_f32_16x16x32_bf16 v[44:47], a[64:67], a[28:31], v[44:47]
s_waitcnt lgkmcnt(6)
v_mfma_f32_16x16x32_bf16 v[48:51], a[68:71], a[16:19], v[48:51]
ds_read_b64_tr_b16 a[84:85], v21 offset:16384
v_mfma_f32_16x16x32_bf16 v[52:55], a[68:71], a[20:23], v[52:55]
ds_read_b64_tr_b16 a[86:87], v21 offset:24576
v_mfma_f32_16x16x32_bf16 v[56:59], a[68:71], a[24:27], v[56:59]
v_mfma_f32_16x16x32_bf16 v[60:63], a[68:71], a[28:31], v[60:63]
s_waitcnt lgkmcnt(6)
v_mfma_f32_16x16x32_bf16 v[64:67], a[72:75], a[16:19], v[64:67]
ds_read_b64_tr_b16 a[88:89], v22 offset:16384
v_mfma_f32_16x16x32_bf16 v[68:71], a[72:75], a[20:23], v[68:71]
ds_read_b64_tr_b16 a[90:91], v22 offset:24576
s_add_u32 m0, s43, 114688
v_mfma_f32_16x16x32_bf16 v[72:75], a[72:75], a[24:27], v[72:75]
buffer_load_dwordx4 v12, s[52:55], s42 offen lds
v_mfma_f32_16x16x32_bf16 v[76:79], a[72:75], a[28:31], v[76:79]
s_waitcnt lgkmcnt(6)
v_mfma_f32_16x16x32_bf16 v[80:83], a[76:79], a[16:19], v[80:83]
ds_read_b64_tr_b16 a[92:93], v23 offset:16384
v_mfma_f32_16x16x32_bf16 v[84:87], a[76:79], a[20:23], v[84:87]
ds_read_b64_tr_b16 a[94:95], v23 offset:24576
v_mfma_f32_16x16x32_bf16 v[88:91], a[76:79], a[24:27], v[88:91]
v_mfma_f32_16x16x32_bf16 v[92:95], a[76:79], a[28:31], v[92:95]
s_waitcnt lgkmcnt(6)
v_mfma_f32_16x16x32_bf16 v[96:99], a[80:83], a[16:19], v[96:99]
ds_read_b64_tr_b16 a[64:65], v16 offset:16640
v_mfma_f32_16x16x32_bf16 v[100:103], a[80:83], a[20:23], v[100:103]
ds_read_b64_tr_b16 a[66:67], v16 offset:24832
buffer_load_dwordx4 a[4:7], v9, s[48:51], s41 offen sc1
v_mfma_f32_16x16x32_bf16 v[104:107], a[80:83], a[24:27], v[104:107]
v_mfma_f32_16x16x32_bf16 v[108:111], a[80:83], a[28:31], v[108:111]
s_waitcnt lgkmcnt(6)
v_mfma_f32_16x16x32_bf16 v[112:115], a[84:87], a[16:19], v[112:115]
ds_read_b64_tr_b16 a[68:69], v17 offset:16640
v_mfma_f32_16x16x32_bf16 v[116:119], a[84:87], a[20:23], v[116:119]
ds_read_b64_tr_b16 a[70:71], v17 offset:24832
v_mfma_f32_16x16x32_bf16 v[120:123], a[84:87], a[24:27], v[120:123]
v_mfma_f32_16x16x32_bf16 v[124:127], a[84:87], a[28:31], v[124:127]
s_waitcnt lgkmcnt(6)
v_mfma_f32_16x16x32_bf16 v[128:131], a[88:91], a[16:19], v[128:131]
ds_read_b64_tr_b16 a[72:73], v18 offset:16640
v_mfma_f32_16x16x32_bf16 v[132:135], a[88:91], a[20:23], v[132:135]
ds_read_b64_tr_b16 a[74:75], v18 offset:24832
s_add_u32 m0, s43, 118784
v_mfma_f32_16x16x32_bf16 v[136:139], a[88:91], a[24:27], v[136:139]
buffer_load_dwordx4 v13, s[52:55], s42 offen lds
v_mfma_f32_16x16x32_bf16 v[140:143], a[88:91], a[28:31], v[140:143]
s_waitcnt lgkmcnt(6)
v_mfma_f32_16x16x32_bf16 v[144:147], a[92:95], a[16:19], v[144:147]
ds_read_b64_tr_b16 a[76:77], v19 offset:16640
v_mfma_f32_16x16x32_bf16 v[148:151], a[92:95], a[20:23], v[148:151]
ds_read_b64_tr_b16 a[78:79], v19 offset:24832
v_mfma_f32_16x16x32_bf16 v[152:155], a[92:95], a[24:27], v[152:155]
v_mfma_f32_16x16x32_bf16 v[156:159], a[92:95], a[28:31], v[156:159]
s_waitcnt lgkmcnt(6)
v_mfma_f32_16x16x32_bf16 v[160:163], a[64:67], a[16:19], v[160:163]
ds_read_b64_tr_b16 a[80:81], v20 offset:16640
v_mfma_f32_16x16x32_bf16 v[164:167], a[64:67], a[20:23], v[164:167]
ds_read_b64_tr_b16 a[82:83], v20 offset:24832
buffer_load_dwordx4 a[8:11], v10, s[48:51], s41 offen sc1
v_mfma_f32_16x16x32_bf16 v[168:171], a[64:67], a[24:27], v[168:171]
v_mfma_f32_16x16x32_bf16 v[172:175], a[64:67], a[28:31], v[172:175]
s_waitcnt lgkmcnt(6)
v_mfma_f32_16x16x32_bf16 v[176:179], a[68:71], a[16:19], v[176:179]
ds_read_b64_tr_b16 a[84:85], v21 offset:16640
v_mfma_f32_16x16x32_bf16 v[180:183], a[68:71], a[20:23], v[180:183]
ds_read_b64_tr_b16 a[86:87], v21 offset:24832
v_mfma_f32_16x16x32_bf16 v[184:187], a[68:71], a[24:27], v[184:187]
v_mfma_f32_16x16x32_bf16 v[188:191], a[68:71], a[28:31], v[188:191]
s_waitcnt lgkmcnt(6)
v_mfma_f32_16x16x32_bf16 v[192:195], a[72:75], a[16:19], v[192:195]
ds_read_b64_tr_b16 a[88:89], v22 offset:16640
v_mfma_f32_16x16x32_bf16 v[196:199], a[72:75], a[20:23], v[196:199]
ds_read_b64_tr_b16 a[90:91], v22 offset:24832
s_add_u32 m0, s43, 122880
v_mfma_f32_16x16x32_bf16 v[200:203], a[72:75], a[24:27], v[200:203]
buffer_load_dwordx4 v14, s[52:55], s42 offen lds
v_mfma_f32_16x16x32_bf16 v[204:207], a[72:75], a[28:31], v[204:207]
s_waitcnt lgkmcnt(6)
v_mfma_f32_16x16x32_bf16 v[208:211], a[76:79], a[16:19], v[208:211]
ds_read_b64_tr_b16 a[92:93], v23 offset:16640
v_mfma_f32_16x16x32_bf16 v[212:215], a[76:79], a[20:23], v[212:215]
ds_read_b64_tr_b16 a[94:95], v23 offset:24832
v_mfma_f32_16x16x32_bf16 v[216:219], a[76:79], a[24:27], v[216:219]
v_mfma_f32_16x16x32_bf16 v[220:223], a[76:79], a[28:31], v[220:223]
s_waitcnt lgkmcnt(6)
v_mfma_f32_16x16x32_bf16 v[224:227], a[80:83], a[16:19], v[224:227]
s_waitcnt vmcnt(15)
s_barrier
ds_read_b64_tr_b16 a[64:65], v16 offset:32768
v_mfma_f32_16x16x32_bf16 v[228:231], a[80:83], a[20:23], v[228:231]
ds_read_b64_tr_b16 a[66:67], v16 offset:40960
buffer_load_dwordx4 a[12:15], v11, s[48:51], s41 offen sc1
s_add_u32 s41, s41, 1024
v_mfma_f32_16x16x32_bf16 v[232:235], a[80:83], a[24:27], v[232:235]
v_mfma_f32_16x16x32_bf16 v[236:239], a[80:83], a[28:31], v[236:239]
s_waitcnt lgkmcnt(6)
v_mfma_f32_16x16x32_bf16 v[240:243], a[84:87], a[16:19], v[240:243]
ds_read_b64_tr_b16 a[68:69], v17 offset:32768
v_mfma_f32_16x16x32_bf16 v[244:247], a[84:87], a[20:23], v[244:247]
ds_read_b64_tr_b16 a[70:71], v17 offset:40960
v_mfma_f32_16x16x32_bf16 v[248:251], a[84:87], a[24:27], v[248:251]
v_mfma_f32_16x16x32_bf16 v[252:255], a[84:87], a[28:31], v[252:255]
s_waitcnt lgkmcnt(6)
v_mfma_f32_16x16x32_bf16 a[96:99], a[88:91], a[16:19], a[96:99]
ds_read_b64_tr_b16 a[72:73], v18 offset:32768
v_mfma_f32_16x16x32_bf16 a[100:103], a[88:91], a[20:23], a[100:103]
ds_read_b64_tr_b16 a[74:75], v18 offset:40960
s_add_u32 m0, s43, 126976
v_mfma_f32_16x16x32_bf16 a[104:107], a[88:91], a[24:27], a[104:107]
buffer_load_dwordx4 v15, s[52:55], s42 offen lds
s_add_u32 s42, s42, 196608
v_mfma_f32_16x16x32_bf16 a[108:111], a[88:91], a[28:31], a[108:111]
s_waitcnt lgkmcnt(6)
v_mfma_f32_16x16x32_bf16 a[112:115], a[92:95], a[16:19], a[112:115]
ds_read_b64_tr_b16 a[76:77], v19 offset:32768
v_mfma_f32_16x16x32_bf16 a[116:119], a[92:95], a[20:23], a[116:119]
ds_read_b64_tr_b16 a[78:79], v19 offset:40960
v_mfma_f32_16x16x32_bf16 a[120:123], a[92:95], a[24:27], a[120:123]
v_mfma_f32_16x16x32_bf16 a[124:127], a[92:95], a[28:31], a[124:127]
s_waitcnt lgkmcnt(6)
v_mfma_f32_16x16x32_bf16 v[32:35], a[64:67], a[32:35], v[32:35]
ds_read_b64_tr_b16 a[80:81], v20 offset:32768
v_mfma_f32_16x16x32_bf16 v[36:39], a[64:67], a[36:39], v[36:39]
ds_read_b64_tr_b16 a[82:83], v20 offset:40960
buffer_load_dwordx4 a[16:19], v8, s[48:51], s41 offen sc1
v_mfma_f32_16x16x32_bf16 v[40:43], a[64:67], a[40:43], v[40:43]
v_mfma_f32_16x16x32_bf16 v[44:47], a[64:67], a[44:47], v[44:47]
s_waitcnt lgkmcnt(6)
v_mfma_f32_16x16x32_bf16 v[48:51], a[68:71], a[32:35], v[48:51]
ds_read_b64_tr_b16 a[84:85], v21 offset:32768
v_mfma_f32_16x16x32_bf16 v[52:55], a[68:71], a[36:39], v[52:55]
ds_read_b64_tr_b16 a[86:87], v21 offset:40960
v_mfma_f32_16x16x32_bf16 v[56:59], a[68:71], a[40:43], v[56:59]
v_mfma_f32_16x16x32_bf16 v[60:63], a[68:71], a[44:47], v[60:63]
s_waitcnt lgkmcnt(6)
v_mfma_f32_16x16x32_bf16 v[64:67], a[72:75], a[32:35], v[64:67]
ds_read_b64_tr_b16 a[88:89], v22 offset:32768
v_mfma_f32_16x16x32_bf16 v[68:71], a[72:75], a[36:39], v[68:71]
ds_read_b64_tr_b16 a[90:91], v22 offset:40960
v_mfma_f32_16x16x32_bf16 v[72:75], a[72:75], a[40:43], v[72:75]
v_mfma_f32_16x16x32_bf16 v[76:79], a[72:75], a[44:47], v[76:79]
s_waitcnt lgkmcnt(6)
v_mfma_f32_16x16x32_bf16 v[80:83], a[76:79], a[32:35], v[80:83]
ds_read_b64_tr_b16 a[92:93], v23 offset:32768
v_mfma_f32_16x16x32_bf16 v[84:87], a[76:79], a[36:39], v[84:87]
ds_read_b64_tr_b16 a[94:95], v23 offset:40960
v_mfma_f32_16x16x32_bf16 v[88:91], a[76:79], a[40:43], v[88:91]
v_mfma_f32_16x16x32_bf16 v[92:95], a[76:79], a[44:47], v[92:95]
s_waitcnt lgkmcnt(6)
v_mfma_f32_16x16x32_bf16 v[96:99], a[80:83], a[32:35], v[96:99]
ds_read_b64_tr_b16 a[64:65], v16 offset:33024
v_mfma_f32_16x16x32_bf16 v[100:103], a[80:83], a[36:39], v[100:103]
ds_read_b64_tr_b16 a[66:67], v16 offset:41216
buffer_load_dwordx4 a[20:23], v9, s[48:51], s41 offen sc1
v_mfma_f32_16x16x32_bf16 v[104:107], a[80:83], a[40:43], v[104:107]
v_mfma_f32_16x16x32_bf16 v[108:111], a[80:83], a[44:47], v[108:111]
s_waitcnt lgkmcnt(6)
v_mfma_f32_16x16x32_bf16 v[112:115], a[84:87], a[32:35], v[112:115]
ds_read_b64_tr_b16 a[68:69], v17 offset:33024
v_mfma_f32_16x16x32_bf16 v[116:119], a[84:87], a[36:39], v[116:119]
ds_read_b64_tr_b16 a[70:71], v17 offset:41216
v_mfma_f32_16x16x32_bf16 v[120:123], a[84:87], a[40:43], v[120:123]
v_mfma_f32_16x16x32_bf16 v[124:127], a[84:87], a[44:47], v[124:127]
s_waitcnt lgkmcnt(6)
v_mfma_f32_16x16x32_bf16 v[128:131], a[88:91], a[32:35], v[128:131]
ds_read_b64_tr_b16 a[72:73], v18 offset:33024
v_mfma_f32_16x16x32_bf16 v[132:135], a[88:91], a[36:39], v[132:135]
ds_read_b64_tr_b16 a[74:75], v18 offset:41216
v_mfma_f32_16x16x32_bf16 v[136:139], a[88:91], a[40:43], v[136:139]
v_mfma_f32_16x16x32_bf16 v[140:143], a[88:91], a[44:47], v[140:143]
s_waitcnt lgkmcnt(6)
v_mfma_f32_16x16x32_bf16 v[144:147], a[92:95], a[32:35], v[144:147]
ds_read_b64_tr_b16 a[76:77], v19 offset:33024
v_mfma_f32_16x16x32_bf16 v[148:151], a[92:95], a[36:39], v[148:151]
ds_read_b64_tr_b16 a[78:79], v19 offset:41216
v_mfma_f32_16x16x32_bf16 v[152:155], a[92:95], a[40:43], v[152:155]
v_mfma_f32_16x16x32_bf16 v[156:159], a[92:95], a[44:47], v[156:159]
s_waitcnt lgkmcnt(6)
v_mfma_f32_16x16x32_bf16 v[160:163], a[64:67], a[32:35], v[160:163]
ds_read_b64_tr_b16 a[80:81], v20 offset:33024
v_mfma_f32_16x16x32_bf16 v[164:167], a[64:67], a[36:39], v[164:167]
ds_read_b64_tr_b16 a[82:83], v20 offset:41216
buffer_load_dwordx4 a[24:27], v10, s[48:51], s41 offen sc1
v_mfma_f32_16x16x32_bf16 v[168:171], a[64:67], a[40:43], v[168:171]
v_mfma_f32_16x16x32_bf16 v[172:175], a[64:67], a[44:47], v[172:175]
s_waitcnt lgkmcnt(6)
v_mfma_f32_16x16x32_bf16 v[176:179], a[68:71], a[32:35], v[176:179]
ds_read_b64_tr_b16 a[84:85], v21 offset:33024
v_mfma_f32_16x16x32_bf16 v[180:183], a[68:71], a[36:39], v[180:183]
ds_read_b64_tr_b16 a[86:87], v21 offset:41216
v_mfma_f32_16x16x32_bf16 v[184:187], a[68:71], a[40:43], v[184:187]
v_mfma_f32_16x16x32_bf16 v[188:191], a[68:71], a[44:47], v[188:191]
s_waitcnt lgkmcnt(6)
v_mfma_f32_16x16x32_bf16 v[192:195], a[72:75], a[32:35], v[192:195]
ds_read_b64_tr_b16 a[88:89], v22 offset:33024
v_mfma_f32_16x16x32_bf16 v[196:199], a[72:75], a[36:39], v[196:199]
ds_read_b64_tr_b16 a[90:91], v22 offset:41216
v_mfma_f32_16x16x32_bf16 v[200:203], a[72:75], a[40:43], v[200:203]
v_mfma_f32_16x16x32_bf16 v[204:207], a[72:75], a[44:47], v[204:207]
s_waitcnt lgkmcnt(6)
v_mfma_f32_16x16x32_bf16 v[208:211], a[76:79], a[32:35], v[208:211]
ds_read_b64_tr_b16 a[92:93], v23 offset:33024
v_mfma_f32_16x16x32_bf16 v[212:215], a[76:79], a[36:39], v[212:215]
ds_read_b64_tr_b16 a[94:95], v23 offset:41216
v_mfma_f32_16x16x32_bf16 v[216:219], a[76:79], a[40:43], v[216:219]
v_mfma_f32_16x16x32_bf16 v[220:223], a[76:79], a[44:47], v[220:223]
s_waitcnt lgkmcnt(6)
v_mfma_f32_16x16x32_bf16 v[224:227], a[80:83], a[32:35], v[224:227]
s_waitcnt vmcnt(12)
s_barrier
ds_read_b64_tr_b16 a[64:65], v16 offset:49152
v_mfma_f32_16x16x32_bf16 v[228:231], a[80:83], a[36:39], v[228:231]
ds_read_b64_tr_b16 a[66:67], v16 offset:57344
buffer_load_dwordx4 a[28:31], v11, s[48:51], s41 offen sc1
s_add_u32 s41, s41, 1024
v_mfma_f32_16x16x32_bf16 v[232:235], a[80:83], a[40:43], v[232:235]
v_mfma_f32_16x16x32_bf16 v[236:239], a[80:83], a[44:47], v[236:239]
s_waitcnt lgkmcnt(6)
v_mfma_f32_16x16x32_bf16 v[240:243], a[84:87], a[32:35], v[240:243]
ds_read_b64_tr_b16 a[68:69], v17 offset:49152
v_mfma_f32_16x16x32_bf16 v[244:247], a[84:87], a[36:39], v[244:247]
ds_read_b64_tr_b16 a[70:71], v17 offset:57344
v_mfma_f32_16x16x32_bf16 v[248:251], a[84:87], a[40:43], v[248:251]
v_mfma_f32_16x16x32_bf16 v[252:255], a[84:87], a[44:47], v[252:255]
s_waitcnt lgkmcnt(6)
v_mfma_f32_16x16x32_bf16 a[96:99], a[88:91], a[32:35], a[96:99]
ds_read_b64_tr_b16 a[72:73], v18 offset:49152
v_mfma_f32_16x16x32_bf16 a[100:103], a[88:91], a[36:39], a[100:103]
ds_read_b64_tr_b16 a[74:75], v18 offset:57344
v_mfma_f32_16x16x32_bf16 a[104:107], a[88:91], a[40:43], a[104:107]
v_mfma_f32_16x16x32_bf16 a[108:111], a[88:91], a[44:47], a[108:111]
s_waitcnt lgkmcnt(6)
v_mfma_f32_16x16x32_bf16 a[112:115], a[92:95], a[32:35], a[112:115]
ds_read_b64_tr_b16 a[76:77], v19 offset:49152
v_mfma_f32_16x16x32_bf16 a[116:119], a[92:95], a[36:39], a[116:119]
ds_read_b64_tr_b16 a[78:79], v19 offset:57344
v_mfma_f32_16x16x32_bf16 a[120:123], a[92:95], a[40:43], a[120:123]
v_mfma_f32_16x16x32_bf16 a[124:127], a[92:95], a[44:47], a[124:127]
s_waitcnt lgkmcnt(6)
v_mfma_f32_16x16x32_bf16 v[32:35], a[64:67], a[48:51], v[32:35]
ds_read_b64_tr_b16 a[80:81], v20 offset:49152
v_mfma_f32_16x16x32_bf16 v[36:39], a[64:67], a[52:55], v[36:39]
ds_read_b64_tr_b16 a[82:83], v20 offset:57344
buffer_load_dwordx4 a[32:35], v8, s[48:51], s41 offen sc1
v_mfma_f32_16x16x32_bf16 v[40:43], a[64:67], a[56:59], v[40:43]
v_mfma_f32_16x16x32_bf16 v[44:47], a[64:67], a[60:63], v[44:47]
s_waitcnt lgkmcnt(6)
v_mfma_f32_16x16x32_bf16 v[48:51], a[68:71], a[48:51], v[48:51]
ds_read_b64_tr_b16 a[84:85], v21 offset:49152
v_mfma_f32_16x16x32_bf16 v[52:55], a[68:71], a[52:55], v[52:55]
ds_read_b64_tr_b16 a[86:87], v21 offset:57344
v_mfma_f32_16x16x32_bf16 v[56:59], a[68:71], a[56:59], v[56:59]
v_mfma_f32_16x16x32_bf16 v[60:63], a[68:71], a[60:63], v[60:63]
s_waitcnt lgkmcnt(6)
v_mfma_f32_16x16x32_bf16 v[64:67], a[72:75], a[48:51], v[64:67]
ds_read_b64_tr_b16 a[88:89], v22 offset:49152
v_mfma_f32_16x16x32_bf16 v[68:71], a[72:75], a[52:55], v[68:71]
ds_read_b64_tr_b16 a[90:91], v22 offset:57344
v_mfma_f32_16x16x32_bf16 v[72:75], a[72:75], a[56:59], v[72:75]
v_mfma_f32_16x16x32_bf16 v[76:79], a[72:75], a[60:63], v[76:79]
s_waitcnt lgkmcnt(6)
v_mfma_f32_16x16x32_bf16 v[80:83], a[76:79], a[48:51], v[80:83]
ds_read_b64_tr_b16 a[92:93], v23 offset:49152
v_mfma_f32_16x16x32_bf16 v[84:87], a[76:79], a[52:55], v[84:87]
ds_read_b64_tr_b16 a[94:95], v23 offset:57344
v_mfma_f32_16x16x32_bf16 v[88:91], a[76:79], a[56:59], v[88:91]
v_mfma_f32_16x16x32_bf16 v[92:95], a[76:79], a[60:63], v[92:95]
s_waitcnt lgkmcnt(6)
v_mfma_f32_16x16x32_bf16 v[96:99], a[80:83], a[48:51], v[96:99]
ds_read_b64_tr_b16 a[64:65], v16 offset:49408
v_mfma_f32_16x16x32_bf16 v[100:103], a[80:83], a[52:55], v[100:103]
ds_read_b64_tr_b16 a[66:67], v16 offset:57600
buffer_load_dwordx4 a[36:39], v9, s[48:51], s41 offen sc1
v_mfma_f32_16x16x32_bf16 v[104:107], a[80:83], a[56:59], v[104:107]
v_mfma_f32_16x16x32_bf16 v[108:111], a[80:83], a[60:63], v[108:111]
s_waitcnt lgkmcnt(6)
v_mfma_f32_16x16x32_bf16 v[112:115], a[84:87], a[48:51], v[112:115]
ds_read_b64_tr_b16 a[68:69], v17 offset:49408
v_mfma_f32_16x16x32_bf16 v[116:119], a[84:87], a[52:55], v[116:119]
ds_read_b64_tr_b16 a[70:71], v17 offset:57600
v_mfma_f32_16x16x32_bf16 v[120:123], a[84:87], a[56:59], v[120:123]
v_mfma_f32_16x16x32_bf16 v[124:127], a[84:87], a[60:63], v[124:127]
s_waitcnt lgkmcnt(6)
v_mfma_f32_16x16x32_bf16 v[128:131], a[88:91], a[48:51], v[128:131]
ds_read_b64_tr_b16 a[72:73], v18 offset:49408
v_mfma_f32_16x16x32_bf16 v[132:135], a[88:91], a[52:55], v[132:135]
ds_read_b64_tr_b16 a[74:75], v18 offset:57600
v_mfma_f32_16x16x32_bf16 v[136:139], a[88:91], a[56:59], v[136:139]
v_mfma_f32_16x16x32_bf16 v[140:143], a[88:91], a[60:63], v[140:143]
s_waitcnt lgkmcnt(6)
v_mfma_f32_16x16x32_bf16 v[144:147], a[92:95], a[48:51], v[144:147]
ds_read_b64_tr_b16 a[76:77], v19 offset:49408
v_mfma_f32_16x16x32_bf16 v[148:151], a[92:95], a[52:55], v[148:151]
ds_read_b64_tr_b16 a[78:79], v19 offset:57600
v_mfma_f32_16x16x32_bf16 v[152:155], a[92:95], a[56:59], v[152:155]
v_mfma_f32_16x16x32_bf16 v[156:159], a[92:95], a[60:63], v[156:159]
s_waitcnt lgkmcnt(6)
v_mfma_f32_16x16x32_bf16 v[160:163], a[64:67], a[48:51], v[160:163]
ds_read_b64_tr_b16 a[80:81], v20 offset:49408
v_mfma_f32_16x16x32_bf16 v[164:167], a[64:67], a[52:55], v[164:167]
ds_read_b64_tr_b16 a[82:83], v20 offset:57600
buffer_load_dwordx4 a[40:43], v10, s[48:51], s41 offen sc1
v_mfma_f32_16x16x32_bf16 v[168:171], a[64:67], a[56:59], v[168:171]
v_mfma_f32_16x16x32_bf16 v[172:175], a[64:67], a[60:63], v[172:175]
s_waitcnt lgkmcnt(6)
v_mfma_f32_16x16x32_bf16 v[176:179], a[68:71], a[48:51], v[176:179]
ds_read_b64_tr_b16 a[84:85], v21 offset:49408
v_mfma_f32_16x16x32_bf16 v[180:183], a[68:71], a[52:55], v[180:183]
ds_read_b64_tr_b16 a[86:87], v21 offset:57600
v_mfma_f32_16x16x32_bf16 v[184:187], a[68:71], a[56:59], v[184:187]
v_mfma_f32_16x16x32_bf16 v[188:191], a[68:71], a[60:63], v[188:191]
s_waitcnt lgkmcnt(6)
v_mfma_f32_16x16x32_bf16 v[192:195], a[72:75], a[48:51], v[192:195]
ds_read_b64_tr_b16 a[88:89], v22 offset:49408
v_mfma_f32_16x16x32_bf16 v[196:199], a[72:75], a[52:55], v[196:199]
ds_read_b64_tr_b16 a[90:91], v22 offset:57600
v_mfma_f32_16x16x32_bf16 v[200:203], a[72:75], a[56:59], v[200:203]
v_mfma_f32_16x16x32_bf16 v[204:207], a[72:75], a[60:63], v[204:207]
s_waitcnt lgkmcnt(6)
v_mfma_f32_16x16x32_bf16 v[208:211], a[76:79], a[48:51], v[208:211]
ds_read_b64_tr_b16 a[92:93], v23 offset:49408
v_mfma_f32_16x16x32_bf16 v[212:215], a[76:79], a[52:55], v[212:215]
ds_read_b64_tr_b16 a[94:95], v23 offset:57600
v_mfma_f32_16x16x32_bf16 v[216:219], a[76:79], a[56:59], v[216:219]
v_mfma_f32_16x16x32_bf16 v[220:223], a[76:79], a[60:63], v[220:223]
s_waitcnt lgkmcnt(6)
v_mfma_f32_16x16x32_bf16 v[224:227], a[80:83], a[48:51], v[224:227]
s_waitcnt vmcnt(8)
s_barrier
ds_read_b64_tr_b16 a[64:65], v24 offset:0
v_mfma_f32_16x16x32_bf16 v[228:231], a[80:83], a[52:55], v[228:231]
ds_read_b64_tr_b16 a[66:67], v24 offset:8192
buffer_load_dwordx4 a[44:47], v11, s[48:51], s41 offen sc1
s_add_u32 s41, s41, 1024
v_mfma_f32_16x16x32_bf16 v[232:235], a[80:83], a[56:59], v[232:235]
v_mfma_f32_16x16x32_bf16 v[236:239], a[80:83], a[60:63], v[236:239]
s_waitcnt lgkmcnt(6)
v_mfma_f32_16x16x32_bf16 v[240:243], a[84:87], a[48:51], v[240:243]
ds_read_b64_tr_b16 a[68:69], v25 offset:0
v_mfma_f32_16x16x32_bf16 v[244:247], a[84:87], a[52:55], v[244:247]
ds_read_b64_tr_b16 a[70:71], v25 offset:8192
v_mfma_f32_16x16x32_bf16 v[248:251], a[84:87], a[56:59], v[248:251]
v_mfma_f32_16x16x32_bf16 v[252:255], a[84:87], a[60:63], v[252:255]
s_waitcnt lgkmcnt(6)
v_mfma_f32_16x16x32_bf16 a[96:99], a[88:91], a[48:51], a[96:99]
ds_read_b64_tr_b16 a[72:73], v26 offset:0
v_mfma_f32_16x16x32_bf16 a[100:103], a[88:91], a[52:55], a[100:103]
ds_read_b64_tr_b16 a[74:75], v26 offset:8192
v_mfma_f32_16x16x32_bf16 a[104:107], a[88:91], a[56:59], a[104:107]
v_mfma_f32_16x16x32_bf16 a[108:111], a[88:91], a[60:63], a[108:111]
s_waitcnt lgkmcnt(6)
v_mfma_f32_16x16x32_bf16 a[112:115], a[92:95], a[48:51], a[112:115]
ds_read_b64_tr_b16 a[76:77], v27 offset:0
v_mfma_f32_16x16x32_bf16 a[116:119], a[92:95], a[52:55], a[116:119]
ds_read_b64_tr_b16 a[78:79], v27 offset:8192
v_mfma_f32_16x16x32_bf16 a[120:123], a[92:95], a[56:59], a[120:123]
v_mfma_f32_16x16x32_bf16 a[124:127], a[92:95], a[60:63], a[124:127]
s_waitcnt lgkmcnt(6)
v_mfma_f32_16x16x32_bf16 v[32:35], a[64:67], a[0:3], v[32:35]
ds_read_b64_tr_b16 a[80:81], v28 offset:0
v_mfma_f32_16x16x32_bf16 v[36:39], a[64:67], a[4:7], v[36:39]
ds_read_b64_tr_b16 a[82:83], v28 offset:8192
buffer_load_dwordx4 a[48:51], v8, s[48:51], s41 offen sc1
v_mfma_f32_16x16x32_bf16 v[40:43], a[64:67], a[8:11], v[40:43]
v_mfma_f32_16x16x32_bf16 v[44:47], a[64:67], a[12:15], v[44:47]
s_waitcnt lgkmcnt(6)
v_mfma_f32_16x16x32_bf16 v[48:51], a[68:71], a[0:3], v[48:51]
ds_read_b64_tr_b16 a[84:85], v29 offset:0
v_mfma_f32_16x16x32_bf16 v[52:55], a[68:71], a[4:7], v[52:55]
ds_read_b64_tr_b16 a[86:87], v29 offset:8192
v_mfma_f32_16x16x32_bf16 v[56:59], a[68:71], a[8:11], v[56:59]
v_mfma_f32_16x16x32_bf16 v[60:63], a[68:71], a[12:15], v[60:63]
s_waitcnt lgkmcnt(6)
v_mfma_f32_16x16x32_bf16 v[64:67], a[72:75], a[0:3], v[64:67]
ds_read_b64_tr_b16 a[88:89], v30 offset:0
v_mfma_f32_16x16x32_bf16 v[68:71], a[72:75], a[4:7], v[68:71]
ds_read_b64_tr_b16 a[90:91], v30 offset:8192
v_mfma_f32_16x16x32_bf16 v[72:75], a[72:75], a[8:11], v[72:75]
v_mfma_f32_16x16x32_bf16 v[76:79], a[72:75], a[12:15], v[76:79]
s_waitcnt lgkmcnt(6)
v_mfma_f32_16x16x32_bf16 v[80:83], a[76:79], a[0:3], v[80:83]
ds_read_b64_tr_b16 a[92:93], v31 offset:0
v_mfma_f32_16x16x32_bf16 v[84:87], a[76:79], a[4:7], v[84:87]
ds_read_b64_tr_b16 a[94:95], v31 offset:8192
v_mfma_f32_16x16x32_bf16 v[88:91], a[76:79], a[8:11], v[88:91]
v_mfma_f32_16x16x32_bf16 v[92:95], a[76:79], a[12:15], v[92:95]
s_waitcnt lgkmcnt(6)
v_mfma_f32_16x16x32_bf16 v[96:99], a[80:83], a[0:3], v[96:99]
ds_read_b64_tr_b16 a[64:65], v24 offset:256
v_mfma_f32_16x16x32_bf16 v[100:103], a[80:83], a[4:7], v[100:103]
ds_read_b64_tr_b16 a[66:67], v24 offset:8448
buffer_load_dwordx4 a[52:55], v9, s[48:51], s41 offen sc1
v_mfma_f32_16x16x32_bf16 v[104:107], a[80:83], a[8:11], v[104:107]
v_mfma_f32_16x16x32_bf16 v[108:111], a[80:83], a[12:15], v[108:111]
s_waitcnt lgkmcnt(6)
v_mfma_f32_16x16x32_bf16 v[112:115], a[84:87], a[0:3], v[112:115]
ds_read_b64_tr_b16 a[68:69], v25 offset:256
v_mfma_f32_16x16x32_bf16 v[116:119], a[84:87], a[4:7], v[116:119]
ds_read_b64_tr_b16 a[70:71], v25 offset:8448
v_mfma_f32_16x16x32_bf16 v[120:123], a[84:87], a[8:11], v[120:123]
v_mfma_f32_16x16x32_bf16 v[124:127], a[84:87], a[12:15], v[124:127]
s_waitcnt lgkmcnt(6)
v_mfma_f32_16x16x32_bf16 v[128:131], a[88:91], a[0:3], v[128:131]
ds_read_b64_tr_b16 a[72:73], v26 offset:256
v_mfma_f32_16x16x32_bf16 v[132:135], a[88:91], a[4:7], v[132:135]
ds_read_b64_tr_b16 a[74:75], v26 offset:8448
v_mfma_f32_16x16x32_bf16 v[136:139], a[88:91], a[8:11], v[136:139]
v_mfma_f32_16x16x32_bf16 v[140:143], a[88:91], a[12:15], v[140:143]
s_waitcnt lgkmcnt(6)
v_mfma_f32_16x16x32_bf16 v[144:147], a[92:95], a[0:3], v[144:147]
ds_read_b64_tr_b16 a[76:77], v27 offset:256
v_mfma_f32_16x16x32_bf16 v[148:151], a[92:95], a[4:7], v[148:151]
ds_read_b64_tr_b16 a[78:79], v27 offset:8448
v_mfma_f32_16x16x32_bf16 v[152:155], a[92:95], a[8:11], v[152:155]
v_mfma_f32_16x16x32_bf16 v[156:159], a[92:95], a[12:15], v[156:159]
s_waitcnt lgkmcnt(6)
v_mfma_f32_16x16x32_bf16 v[160:163], a[64:67], a[0:3], v[160:163]
ds_read_b64_tr_b16 a[80:81], v28 offset:256
v_mfma_f32_16x16x32_bf16 v[164:167], a[64:67], a[4:7], v[164:167]
ds_read_b64_tr_b16 a[82:83], v28 offset:8448
buffer_load_dwordx4 a[56:59], v10, s[48:51], s41 offen sc1
v_mfma_f32_16x16x32_bf16 v[168:171], a[64:67], a[8:11], v[168:171]
v_mfma_f32_16x16x32_bf16 v[172:175], a[64:67], a[12:15], v[172:175]
s_waitcnt lgkmcnt(6)
v_mfma_f32_16x16x32_bf16 v[176:179], a[68:71], a[0:3], v[176:179]
ds_read_b64_tr_b16 a[84:85], v29 offset:256
v_mfma_f32_16x16x32_bf16 v[180:183], a[68:71], a[4:7], v[180:183]
ds_read_b64_tr_b16 a[86:87], v29 offset:8448
v_mfma_f32_16x16x32_bf16 v[184:187], a[68:71], a[8:11], v[184:187]
v_mfma_f32_16x16x32_bf16 v[188:191], a[68:71], a[12:15], v[188:191]
s_waitcnt lgkmcnt(6)
v_mfma_f32_16x16x32_bf16 v[192:195], a[72:75], a[0:3], v[192:195]
ds_read_b64_tr_b16 a[88:89], v30 offset:256
v_mfma_f32_16x16x32_bf16 v[196:199], a[72:75], a[4:7], v[196:199]
ds_read_b64_tr_b16 a[90:91], v30 offset:8448
v_mfma_f32_16x16x32_bf16 v[200:203], a[72:75], a[8:11], v[200:203]
v_mfma_f32_16x16x32_bf16 v[204:207], a[72:75], a[12:15], v[204:207]
s_waitcnt lgkmcnt(6)
v_mfma_f32_16x16x32_bf16 v[208:211], a[76:79], a[0:3], v[208:211]
ds_read_b64_tr_b16 a[92:93], v31 offset:256
v_mfma_f32_16x16x32_bf16 v[212:215], a[76:79], a[4:7], v[212:215]
ds_read_b64_tr_b16 a[94:95], v31 offset:8448
v_mfma_f32_16x16x32_bf16 v[216:219], a[76:79], a[8:11], v[216:219]
v_mfma_f32_16x16x32_bf16 v[220:223], a[76:79], a[12:15], v[220:223]
s_waitcnt lgkmcnt(6)
v_mfma_f32_16x16x32_bf16 v[224:227], a[80:83], a[0:3], v[224:227]
s_waitcnt vmcnt(7)
s_barrier
ds_read_b64_tr_b16 a[64:65], v24 offset:16384
v_mfma_f32_16x16x32_bf16 v[228:231], a[80:83], a[4:7], v[228:231]
ds_read_b64_tr_b16 a[66:67], v24 offset:24576
buffer_load_dwordx4 a[60:63], v11, s[48:51], s41 offen sc1
s_add_u32 s41, s41, 1024
v_mfma_f32_16x16x32_bf16 v[232:235], a[80:83], a[8:11], v[232:235]
v_mfma_f32_16x16x32_bf16 v[236:239], a[80:83], a[12:15], v[236:239]
s_waitcnt lgkmcnt(6)
v_mfma_f32_16x16x32_bf16 v[240:243], a[84:87], a[0:3], v[240:243]
ds_read_b64_tr_b16 a[68:69], v25 offset:16384
v_mfma_f32_16x16x32_bf16 v[244:247], a[84:87], a[4:7], v[244:247]
ds_read_b64_tr_b16 a[70:71], v25 offset:24576
v_mfma_f32_16x16x32_bf16 v[248:251], a[84:87], a[8:11], v[248:251]
v_mfma_f32_16x16x32_bf16 v[252:255], a[84:87], a[12:15], v[252:255]
s_waitcnt lgkmcnt(6)
v_mfma_f32_16x16x32_bf16 a[96:99], a[88:91], a[0:3], a[96:99]
ds_read_b64_tr_b16 a[72:73], v26 offset:16384
v_mfma_f32_16x16x32_bf16 a[100:103], a[88:91], a[4:7], a[100:103]
ds_read_b64_tr_b16 a[74:75], v26 offset:24576
v_mfma_f32_16x16x32_bf16 a[104:107], a[88:91], a[8:11], a[104:107]
v_mfma_f32_16x16x32_bf16 a[108:111], a[88:91], a[12:15], a[108:111]
s_waitcnt lgkmcnt(6)
v_mfma_f32_16x16x32_bf16 a[112:115], a[92:95], a[0:3], a[112:115]
ds_read_b64_tr_b16 a[76:77], v27 offset:16384
v_mfma_f32_16x16x32_bf16 a[116:119], a[92:95], a[4:7], a[116:119]
ds_read_b64_tr_b16 a[78:79], v27 offset:24576
v_mfma_f32_16x16x32_bf16 a[120:123], a[92:95], a[8:11], a[120:123]
v_mfma_f32_16x16x32_bf16 a[124:127], a[92:95], a[12:15], a[124:127]
s_waitcnt lgkmcnt(6)
v_mfma_f32_16x16x32_bf16 v[32:35], a[64:67], a[16:19], v[32:35]
ds_read_b64_tr_b16 a[80:81], v28 offset:16384
v_mfma_f32_16x16x32_bf16 v[36:39], a[64:67], a[20:23], v[36:39]
ds_read_b64_tr_b16 a[82:83], v28 offset:24576
v_mfma_f32_16x16x32_bf16 v[40:43], a[64:67], a[24:27], v[40:43]
v_mfma_f32_16x16x32_bf16 v[44:47], a[64:67], a[28:31], v[44:47]
s_waitcnt lgkmcnt(6)
v_mfma_f32_16x16x32_bf16 v[48:51], a[68:71], a[16:19], v[48:51]
ds_read_b64_tr_b16 a[84:85], v29 offset:16384
v_mfma_f32_16x16x32_bf16 v[52:55], a[68:71], a[20:23], v[52:55]
ds_read_b64_tr_b16 a[86:87], v29 offset:24576
v_mfma_f32_16x16x32_bf16 v[56:59], a[68:71], a[24:27], v[56:59]
v_mfma_f32_16x16x32_bf16 v[60:63], a[68:71], a[28:31], v[60:63]
s_waitcnt lgkmcnt(6)
v_mfma_f32_16x16x32_bf16 v[64:67], a[72:75], a[16:19], v[64:67]
ds_read_b64_tr_b16 a[88:89], v30 offset:16384
v_mfma_f32_16x16x32_bf16 v[68:71], a[72:75], a[20:23], v[68:71]
ds_read_b64_tr_b16 a[90:91], v30 offset:24576
v_mfma_f32_16x16x32_bf16 v[72:75], a[72:75], a[24:27], v[72:75]
v_mfma_f32_16x16x32_bf16 v[76:79], a[72:75], a[28:31], v[76:79]
s_waitcnt lgkmcnt(6)
v_mfma_f32_16x16x32_bf16 v[80:83], a[76:79], a[16:19], v[80:83]
ds_read_b64_tr_b16 a[92:93], v31 offset:16384
v_mfma_f32_16x16x32_bf16 v[84:87], a[76:79], a[20:23], v[84:87]
ds_read_b64_tr_b16 a[94:95], v31 offset:24576
v_mfma_f32_16x16x32_bf16 v[88:91], a[76:79], a[24:27], v[88:91]
v_mfma_f32_16x16x32_bf16 v[92:95], a[76:79], a[28:31], v[92:95]
s_waitcnt lgkmcnt(6)
v_mfma_f32_16x16x32_bf16 v[96:99], a[80:83], a[16:19], v[96:99]
ds_read_b64_tr_b16 a[64:65], v24 offset:16640
v_mfma_f32_16x16x32_bf16 v[100:103], a[80:83], a[20:23], v[100:103]
ds_read_b64_tr_b16 a[66:67], v24 offset:24832
v_mfma_f32_16x16x32_bf16 v[104:107], a[80:83], a[24:27], v[104:107]
v_mfma_f32_16x16x32_bf16 v[108:111], a[80:83], a[28:31], v[108:111]
s_waitcnt lgkmcnt(6)
v_mfma_f32_16x16x32_bf16 v[112:115], a[84:87], a[16:19], v[112:115]
ds_read_b64_tr_b16 a[68:69], v25 offset:16640
v_mfma_f32_16x16x32_bf16 v[116:119], a[84:87], a[20:23], v[116:119]
ds_read_b64_tr_b16 a[70:71], v25 offset:24832
v_mfma_f32_16x16x32_bf16 v[120:123], a[84:87], a[24:27], v[120:123]
v_mfma_f32_16x16x32_bf16 v[124:127], a[84:87], a[28:31], v[124:127]
s_waitcnt lgkmcnt(6)
v_mfma_f32_16x16x32_bf16 v[128:131], a[88:91], a[16:19], v[128:131]
ds_read_b64_tr_b16 a[72:73], v26 offset:16640
v_mfma_f32_16x16x32_bf16 v[132:135], a[88:91], a[20:23], v[132:135]
ds_read_b64_tr_b16 a[74:75], v26 offset:24832
v_mfma_f32_16x16x32_bf16 v[136:139], a[88:91], a[24:27], v[136:139]
v_mfma_f32_16x16x32_bf16 v[140:143], a[88:91], a[28:31], v[140:143]
s_waitcnt lgkmcnt(6)
v_mfma_f32_16x16x32_bf16 v[144:147], a[92:95], a[16:19], v[144:147]
ds_read_b64_tr_b16 a[76:77], v27 offset:16640
v_mfma_f32_16x16x32_bf16 v[148:151], a[92:95], a[20:23], v[148:151]
ds_read_b64_tr_b16 a[78:79], v27 offset:24832
v_mfma_f32_16x16x32_bf16 v[152:155], a[92:95], a[24:27], v[152:155]
v_mfma_f32_16x16x32_bf16 v[156:159], a[92:95], a[28:31], v[156:159]
s_waitcnt lgkmcnt(6)
v_mfma_f32_16x16x32_bf16 v[160:163], a[64:67], a[16:19], v[160:163]
ds_read_b64_tr_b16 a[80:81], v28 offset:16640
v_mfma_f32_16x16x32_bf16 v[164:167], a[64:67], a[20:23], v[164:167]
ds_read_b64_tr_b16 a[82:83], v28 offset:24832
v_mfma_f32_16x16x32_bf16 v[168:171], a[64:67], a[24:27], v[168:171]
v_mfma_f32_16x16x32_bf16 v[172:175], a[64:67], a[28:31], v[172:175]
s_waitcnt lgkmcnt(6)
v_mfma_f32_16x16x32_bf16 v[176:179], a[68:71], a[16:19], v[176:179]
ds_read_b64_tr_b16 a[84:85], v29 offset:16640
v_mfma_f32_16x16x32_bf16 v[180:183], a[68:71], a[20:23], v[180:183]
ds_read_b64_tr_b16 a[86:87], v29 offset:24832
v_mfma_f32_16x16x32_bf16 v[184:187], a[68:71], a[24:27], v[184:187]
v_mfma_f32_16x16x32_bf16 v[188:191], a[68:71], a[28:31], v[188:191]
s_waitcnt lgkmcnt(6)
v_mfma_f32_16x16x32_bf16 v[192:195], a[72:75], a[16:19], v[192:195]
ds_read_b64_tr_b16 a[88:89], v30 offset:16640
v_mfma_f32_16x16x32_bf16 v[196:199], a[72:75], a[20:23], v[196:199]
ds_read_b64_tr_b16 a[90:91], v30 offset:24832
v_mfma_f32_16x16x32_bf16 v[200:203], a[72:75], a[24:27], v[200:203]
v_mfma_f32_16x16x32_bf16 v[204:207], a[72:75], a[28:31], v[204:207]
s_waitcnt lgkmcnt(6)
v_mfma_f32_16x16x32_bf16 v[208:211], a[76:79], a[16:19], v[208:211]
ds_read_b64_tr_b16 a[92:93], v31 offset:16640
v_mfma_f32_16x16x32_bf16 v[212:215], a[76:79], a[20:23], v[212:215]
ds_read_b64_tr_b16 a[94:95], v31 offset:24832
v_mfma_f32_16x16x32_bf16 v[216:219], a[76:79], a[24:27], v[216:219]
v_mfma_f32_16x16x32_bf16 v[220:223], a[76:79], a[28:31], v[220:223]
s_waitcnt lgkmcnt(6)
v_mfma_f32_16x16x32_bf16 v[224:227], a[80:83], a[16:19], v[224:227]
s_waitcnt vmcnt(4)
s_barrier
ds_read_b64_tr_b16 a[64:65], v24 offset:32768
v_mfma_f32_16x16x32_bf16 v[228:231], a[80:83], a[20:23], v[228:231]
ds_read_b64_tr_b16 a[66:67], v24 offset:40960
v_mfma_f32_16x16x32_bf16 v[232:235], a[80:83], a[24:27], v[232:235]
v_mfma_f32_16x16x32_bf16 v[236:239], a[80:83], a[28:31], v[236:239]
s_waitcnt lgkmcnt(6)
v_mfma_f32_16x16x32_bf16 v[240:243], a[84:87], a[16:19], v[240:243]
ds_read_b64_tr_b16 a[68:69], v25 offset:32768
v_mfma_f32_16x16x32_bf16 v[244:247], a[84:87], a[20:23], v[244:247]
ds_read_b64_tr_b16 a[70:71], v25 offset:40960
v_mfma_f32_16x16x32_bf16 v[248:251], a[84:87], a[24:27], v[248:251]
v_mfma_f32_16x16x32_bf16 v[252:255], a[84:87], a[28:31], v[252:255]
s_waitcnt lgkmcnt(6)
v_mfma_f32_16x16x32_bf16 a[96:99], a[88:91], a[16:19], a[96:99]
ds_read_b64_tr_b16 a[72:73], v26 offset:32768
v_mfma_f32_16x16x32_bf16 a[100:103], a[88:91], a[20:23], a[100:103]
ds_read_b64_tr_b16 a[74:75], v26 offset:40960
v_mfma_f32_16x16x32_bf16 a[104:107], a[88:91], a[24:27], a[104:107]
v_mfma_f32_16x16x32_bf16 a[108:111], a[88:91], a[28:31], a[108:111]
s_waitcnt lgkmcnt(6)
v_mfma_f32_16x16x32_bf16 a[112:115], a[92:95], a[16:19], a[112:115]
ds_read_b64_tr_b16 a[76:77], v27 offset:32768
v_mfma_f32_16x16x32_bf16 a[116:119], a[92:95], a[20:23], a[116:119]
ds_read_b64_tr_b16 a[78:79], v27 offset:40960
v_mfma_f32_16x16x32_bf16 a[120:123], a[92:95], a[24:27], a[120:123]
v_mfma_f32_16x16x32_bf16 a[124:127], a[92:95], a[28:31], a[124:127]
s_waitcnt lgkmcnt(6)
v_mfma_f32_16x16x32_bf16 v[32:35], a[64:67], a[32:35], v[32:35]
ds_read_b64_tr_b16 a[80:81], v28 offset:32768
v_mfma_f32_16x16x32_bf16 v[36:39], a[64:67], a[36:39], v[36:39]
ds_read_b64_tr_b16 a[82:83], v28 offset:40960
v_mfma_f32_16x16x32_bf16 v[40:43], a[64:67], a[40:43], v[40:43]
v_mfma_f32_16x16x32_bf16 v[44:47], a[64:67], a[44:47], v[44:47]
s_waitcnt lgkmcnt(6)
v_mfma_f32_16x16x32_bf16 v[48:51], a[68:71], a[32:35], v[48:51]
ds_read_b64_tr_b16 a[84:85], v29 offset:32768
v_mfma_f32_16x16x32_bf16 v[52:55], a[68:71], a[36:39], v[52:55]
ds_read_b64_tr_b16 a[86:87], v29 offset:40960
v_mfma_f32_16x16x32_bf16 v[56:59], a[68:71], a[40:43], v[56:59]
v_mfma_f32_16x16x32_bf16 v[60:63], a[68:71], a[44:47], v[60:63]
s_waitcnt lgkmcnt(6)
v_mfma_f32_16x16x32_bf16 v[64:67], a[72:75], a[32:35], v[64:67]
ds_read_b64_tr_b16 a[88:89], v30 offset:32768
v_mfma_f32_16x16x32_bf16 v[68:71], a[72:75], a[36:39], v[68:71]
ds_read_b64_tr_b16 a[90:91], v30 offset:40960
v_mfma_f32_16x16x32_bf16 v[72:75], a[72:75], a[40:43], v[72:75]
v_mfma_f32_16x16x32_bf16 v[76:79], a[72:75], a[44:47], v[76:79]
s_waitcnt lgkmcnt(6)
v_mfma_f32_16x16x32_bf16 v[80:83], a[76:79], a[32:35], v[80:83]
ds_read_b64_tr_b16 a[92:93], v31 offset:32768
v_mfma_f32_16x16x32_bf16 v[84:87], a[76:79], a[36:39], v[84:87]
ds_read_b64_tr_b16 a[94:95], v31 offset:40960
v_mfma_f32_16x16x32_bf16 v[88:91], a[76:79], a[40:43], v[88:91]
v_mfma_f32_16x16x32_bf16 v[92:95], a[76:79], a[44:47], v[92:95]
s_waitcnt lgkmcnt(6)
v_mfma_f32_16x16x32_bf16 v[96:99], a[80:83], a[32:35], v[96:99]
ds_read_b64_tr_b16 a[64:65], v24 offset:33024
v_mfma_f32_16x16x32_bf16 v[100:103], a[80:83], a[36:39], v[100:103]
ds_read_b64_tr_b16 a[66:67], v24 offset:41216
v_mfma_f32_16x16x32_bf16 v[104:107], a[80:83], a[40:43], v[104:107]
v_mfma_f32_16x16x32_bf16 v[108:111], a[80:83], a[44:47], v[108:111]
s_waitcnt lgkmcnt(6)
v_mfma_f32_16x16x32_bf16 v[112:115], a[84:87], a[32:35], v[112:115]
ds_read_b64_tr_b16 a[68:69], v25 offset:33024
v_mfma_f32_16x16x32_bf16 v[116:119], a[84:87], a[36:39], v[116:119]
ds_read_b64_tr_b16 a[70:71], v25 offset:41216
v_mfma_f32_16x16x32_bf16 v[120:123], a[84:87], a[40:43], v[120:123]
v_mfma_f32_16x16x32_bf16 v[124:127], a[84:87], a[44:47], v[124:127]
s_waitcnt lgkmcnt(6)
v_mfma_f32_16x16x32_bf16 v[128:131], a[88:91], a[32:35], v[128:131]
ds_read_b64_tr_b16 a[72:73], v26 offset:33024
v_mfma_f32_16x16x32_bf16 v[132:135], a[88:91], a[36:39], v[132:135]
ds_read_b64_tr_b16 a[74:75], v26 offset:41216
v_mfma_f32_16x16x32_bf16 v[136:139], a[88:91], a[40:43], v[136:139]
v_mfma_f32_16x16x32_bf16 v[140:143], a[88:91], a[44:47], v[140:143]
s_waitcnt lgkmcnt(6)
v_mfma_f32_16x16x32_bf16 v[144:147], a[92:95], a[32:35], v[144:147]
ds_read_b64_tr_b16 a[76:77], v27 offset:33024
v_mfma_f32_16x16x32_bf16 v[148:151], a[92:95], a[36:39], v[148:151]
ds_read_b64_tr_b16 a[78:79], v27 offset:41216
v_mfma_f32_16x16x32_bf16 v[152:155], a[92:95], a[40:43], v[152:155]
v_mfma_f32_16x16x32_bf16 v[156:159], a[92:95], a[44:47], v[156:159]
s_waitcnt lgkmcnt(6)
v_mfma_f32_16x16x32_bf16 v[160:163], a[64:67], a[32:35], v[160:163]
ds_read_b64_tr_b16 a[80:81], v28 offset:33024
v_mfma_f32_16x16x32_bf16 v[164:167], a[64:67], a[36:39], v[164:167]
ds_read_b64_tr_b16 a[82:83], v28 offset:41216
v_mfma_f32_16x16x32_bf16 v[168:171], a[64:67], a[40:43], v[168:171]
v_mfma_f32_16x16x32_bf16 v[172:175], a[64:67], a[44:47], v[172:175]
s_waitcnt lgkmcnt(6)
v_mfma_f32_16x16x32_bf16 v[176:179], a[68:71], a[32:35], v[176:179]
ds_read_b64_tr_b16 a[84:85], v29 offset:33024
v_mfma_f32_16x16x32_bf16 v[180:183], a[68:71], a[36:39], v[180:183]
ds_read_b64_tr_b16 a[86:87], v29 offset:41216
v_mfma_f32_16x16x32_bf16 v[184:187], a[68:71], a[40:43], v[184:187]
v_mfma_f32_16x16x32_bf16 v[188:191], a[68:71], a[44:47], v[188:191]
s_waitcnt lgkmcnt(6)
v_mfma_f32_16x16x32_bf16 v[192:195], a[72:75], a[32:35], v[192:195]
ds_read_b64_tr_b16 a[88:89], v30 offset:33024
v_mfma_f32_16x16x32_bf16 v[196:199], a[72:75], a[36:39], v[196:199]
ds_read_b64_tr_b16 a[90:91], v30 offset:41216
v_mfma_f32_16x16x32_bf16 v[200:203], a[72:75], a[40:43], v[200:203]
v_mfma_f32_16x16x32_bf16 v[204:207], a[72:75], a[44:47], v[204:207]
s_waitcnt lgkmcnt(6)
v_mfma_f32_16x16x32_bf16 v[208:211], a[76:79], a[32:35], v[208:211]
ds_read_b64_tr_b16 a[92:93], v31 offset:33024
v_mfma_f32_16x16x32_bf16 v[212:215], a[76:79], a[36:39], v[212:215]
ds_read_b64_tr_b16 a[94:95], v31 offset:41216
v_mfma_f32_16x16x32_bf16 v[216:219], a[76:79], a[40:43], v[216:219]
v_mfma_f32_16x16x32_bf16 v[220:223], a[76:79], a[44:47], v[220:223]
s_waitcnt lgkmcnt(6)
v_mfma_f32_16x16x32_bf16 v[224:227], a[80:83], a[32:35], v[224:227]
s_waitcnt vmcnt(0)
s_barrier
ds_read_b64_tr_b16 a[64:65], v24 offset:49152
v_mfma_f32_16x16x32_bf16 v[228:231], a[80:83], a[36:39], v[228:231]
ds_read_b64_tr_b16 a[66:67], v24 offset:57344
v_mfma_f32_16x16x32_bf16 v[232:235], a[80:83], a[40:43], v[232:235]
v_mfma_f32_16x16x32_bf16 v[236:239], a[80:83], a[44:47], v[236:239]
s_waitcnt lgkmcnt(6)
v_mfma_f32_16x16x32_bf16 v[240:243], a[84:87], a[32:35], v[240:243]
ds_read_b64_tr_b16 a[68:69], v25 offset:49152
v_mfma_f32_16x16x32_bf16 v[244:247], a[84:87], a[36:39], v[244:247]
ds_read_b64_tr_b16 a[70:71], v25 offset:57344
v_mfma_f32_16x16x32_bf16 v[248:251], a[84:87], a[40:43], v[248:251]
v_mfma_f32_16x16x32_bf16 v[252:255], a[84:87], a[44:47], v[252:255]
s_waitcnt lgkmcnt(6)
v_mfma_f32_16x16x32_bf16 a[96:99], a[88:91], a[32:35], a[96:99]
ds_read_b64_tr_b16 a[72:73], v26 offset:49152
v_mfma_f32_16x16x32_bf16 a[100:103], a[88:91], a[36:39], a[100:103]
ds_read_b64_tr_b16 a[74:75], v26 offset:57344
v_mfma_f32_16x16x32_bf16 a[104:107], a[88:91], a[40:43], a[104:107]
v_mfma_f32_16x16x32_bf16 a[108:111], a[88:91], a[44:47], a[108:111]
s_waitcnt lgkmcnt(6)
v_mfma_f32_16x16x32_bf16 a[112:115], a[92:95], a[32:35], a[112:115]
ds_read_b64_tr_b16 a[76:77], v27 offset:49152
v_mfma_f32_16x16x32_bf16 a[116:119], a[92:95], a[36:39], a[116:119]
ds_read_b64_tr_b16 a[78:79], v27 offset:57344
v_mfma_f32_16x16x32_bf16 a[120:123], a[92:95], a[40:43], a[120:123]
v_mfma_f32_16x16x32_bf16 a[124:127], a[92:95], a[44:47], a[124:127]
s_waitcnt lgkmcnt(6)
v_mfma_f32_16x16x32_bf16 v[32:35], a[64:67], a[48:51], v[32:35]
ds_read_b64_tr_b16 a[80:81], v28 offset:49152
v_mfma_f32_16x16x32_bf16 v[36:39], a[64:67], a[52:55], v[36:39]
ds_read_b64_tr_b16 a[82:83], v28 offset:57344
v_mfma_f32_16x16x32_bf16 v[40:43], a[64:67], a[56:59], v[40:43]
v_mfma_f32_16x16x32_bf16 v[44:47], a[64:67], a[60:63], v[44:47]
s_waitcnt lgkmcnt(6)
v_mfma_f32_16x16x32_bf16 v[48:51], a[68:71], a[48:51], v[48:51]
ds_read_b64_tr_b16 a[84:85], v29 offset:49152
v_mfma_f32_16x16x32_bf16 v[52:55], a[68:71], a[52:55], v[52:55]
ds_read_b64_tr_b16 a[86:87], v29 offset:57344
v_mfma_f32_16x16x32_bf16 v[56:59], a[68:71], a[56:59], v[56:59]
v_mfma_f32_16x16x32_bf16 v[60:63], a[68:71], a[60:63], v[60:63]
s_waitcnt lgkmcnt(6)
v_mfma_f32_16x16x32_bf16 v[64:67], a[72:75], a[48:51], v[64:67]
ds_read_b64_tr_b16 a[88:89], v30 offset:49152
v_mfma_f32_16x16x32_bf16 v[68:71], a[72:75], a[52:55], v[68:71]
ds_read_b64_tr_b16 a[90:91], v30 offset:57344
v_mfma_f32_16x16x32_bf16 v[72:75], a[72:75], a[56:59], v[72:75]
v_mfma_f32_16x16x32_bf16 v[76:79], a[72:75], a[60:63], v[76:79]
s_waitcnt lgkmcnt(6)
v_mfma_f32_16x16x32_bf16 v[80:83], a[76:79], a[48:51], v[80:83]
ds_read_b64_tr_b16 a[92:93], v31 offset:49152
v_mfma_f32_16x16x32_bf16 v[84:87], a[76:79], a[52:55], v[84:87]
ds_read_b64_tr_b16 a[94:95], v31 offset:57344
v_mfma_f32_16x16x32_bf16 v[88:91], a[76:79], a[56:59], v[88:91]
v_mfma_f32_16x16x32_bf16 v[92:95], a[76:79], a[60:63], v[92:95]
s_waitcnt lgkmcnt(6)
v_mfma_f32_16x16x32_bf16 v[96:99], a[80:83], a[48:51], v[96:99]
ds_read_b64_tr_b16 a[64:65], v24 offset:49408
v_cvt_pk_bf16_f32 v32, v32, v33
v_cvt_pk_bf16_f32 v33, v34, v35
v_mfma_f32_16x16x32_bf16 v[100:103], a[80:83], a[52:55], v[100:103]
ds_read_b64_tr_b16 a[66:67], v24 offset:57600
v_cvt_pk_bf16_f32 v34, v48, v49
v_cvt_pk_bf16_f32 v35, v50, v51
buffer_store_dwordx4 v[32:35], v1, s[56:59], s23 offen offset:0
v_mfma_f32_16x16x32_bf16 v[104:107], a[80:83], a[56:59], v[104:107]
v_cvt_pk_bf16_f32 v36, v36, v37
v_cvt_pk_bf16_f32 v37, v38, v39
v_mfma_f32_16x16x32_bf16 v[108:111], a[80:83], a[60:63], v[108:111]
v_cvt_pk_bf16_f32 v38, v52, v53
v_cvt_pk_bf16_f32 v39, v54, v55
buffer_store_dwordx4 v[36:39], v1, s[56:59], s23 offen offset:1024
s_waitcnt lgkmcnt(6)
v_mfma_f32_16x16x32_bf16 v[112:115], a[84:87], a[48:51], v[112:115]
ds_read_b64_tr_b16 a[68:69], v25 offset:49408
v_cvt_pk_bf16_f32 v40, v40, v41
v_cvt_pk_bf16_f32 v41, v42, v43
v_cvt_pk_bf16_f32 v42, v56, v57
v_mfma_f32_16x16x32_bf16 v[116:119], a[84:87], a[52:55], v[116:119]
ds_read_b64_tr_b16 a[70:71], v25 offset:57600
v_cvt_pk_bf16_f32 v43, v58, v59
buffer_store_dwordx4 v[40:43], v1, s[56:59], s23 offen offset:2048
v_mfma_f32_16x16x32_bf16 v[120:123], a[84:87], a[56:59], v[120:123]
v_cvt_pk_bf16_f32 v44, v44, v45
v_cvt_pk_bf16_f32 v45, v46, v47
v_cvt_pk_bf16_f32 v46, v60, v61
v_mfma_f32_16x16x32_bf16 v[124:127], a[84:87], a[60:63], v[124:127]
v_cvt_pk_bf16_f32 v47, v62, v63
buffer_store_dwordx4 v[44:47], v1, s[56:59], s23 offen offset:3072
s_add_u32 s23, s23, 131072
s_waitcnt lgkmcnt(6)
v_mfma_f32_16x16x32_bf16 v[128:131], a[88:91], a[48:51], v[128:131]
ds_read_b64_tr_b16 a[72:73], v26 offset:49408
v_cvt_pk_bf16_f32 v64, v64, v65
v_cvt_pk_bf16_f32 v65, v66, v67
v_mfma_f32_16x16x32_bf16 v[132:135], a[88:91], a[52:55], v[132:135]
ds_read_b64_tr_b16 a[74:75], v26 offset:57600
v_cvt_pk_bf16_f32 v66, v80, v81
v_cvt_pk_bf16_f32 v67, v82, v83
buffer_store_dwordx4 v[64:67], v1, s[56:59], s23 offen offset:0
v_mfma_f32_16x16x32_bf16 v[136:139], a[88:91], a[56:59], v[136:139]
v_cvt_pk_bf16_f32 v68, v68, v69
v_cvt_pk_bf16_f32 v69, v70, v71
v_mfma_f32_16x16x32_bf16 v[140:143], a[88:91], a[60:63], v[140:143]
v_cvt_pk_bf16_f32 v70, v84, v85
v_cvt_pk_bf16_f32 v71, v86, v87
buffer_store_dwordx4 v[68:71], v1, s[56:59], s23 offen offset:1024
s_waitcnt lgkmcnt(6)
v_mfma_f32_16x16x32_bf16 v[144:147], a[92:95], a[48:51], v[144:147]
ds_read_b64_tr_b16 a[76:77], v27 offset:49408
v_cvt_pk_bf16_f32 v72, v72, v73
v_cvt_pk_bf16_f32 v73, v74, v75
v_cvt_pk_bf16_f32 v74, v88, v89
v_mfma_f32_16x16x32_bf16 v[148:151], a[92:95], a[52:55], v[148:151]
ds_read_b64_tr_b16 a[78:79], v27 offset:57600
v_cvt_pk_bf16_f32 v75, v90, v91
buffer_store_dwordx4 v[72:75], v1, s[56:59], s23 offen offset:2048
v_mfma_f32_16x16x32_bf16 v[152:155], a[92:95], a[56:59], v[152:155]
v_cvt_pk_bf16_f32 v76, v76, v77
v_cvt_pk_bf16_f32 v77, v78, v79
v_cvt_pk_bf16_f32 v78, v92, v93
v_mfma_f32_16x16x32_bf16 v[156:159], a[92:95], a[60:63], v[156:159]
v_cvt_pk_bf16_f32 v79, v94, v95
buffer_store_dwordx4 v[76:79], v1, s[56:59], s23 offen offset:3072
s_add_u32 s23, s23, 131072
s_waitcnt lgkmcnt(6)
v_mfma_f32_16x16x32_bf16 v[160:163], a[64:67], a[48:51], v[160:163]
ds_read_b64_tr_b16 a[80:81], v28 offset:49408
v_cvt_pk_bf16_f32 v96, v96, v97
v_cvt_pk_bf16_f32 v97, v98, v99
v_mfma_f32_16x16x32_bf16 v[164:167], a[64:67], a[52:55], v[164:167]
ds_read_b64_tr_b16 a[82:83], v28 offset:57600
v_cvt_pk_bf16_f32 v98, v112, v113
v_cvt_pk_bf16_f32 v99, v114, v115
buffer_store_dwordx4 v[96:99], v1, s[56:59], s23 offen offset:0
v_mfma_f32_16x16x32_bf16 v[168:171], a[64:67], a[56:59], v[168:171]
v_cvt_pk_bf16_f32 v100, v100, v101
v_cvt_pk_bf16_f32 v101, v102, v103
v_mfma_f32_16x16x32_bf16 v[172:175], a[64:67], a[60:63], v[172:175]
v_cvt_pk_bf16_f32 v102, v116, v117
v_cvt_pk_bf16_f32 v103, v118, v119
buffer_store_dwordx4 v[100:103], v1, s[56:59], s23 offen offset:1024
s_waitcnt lgkmcnt(6)
v_mfma_f32_16x16x32_bf16 v[176:179], a[68:71], a[48:51], v[176:179]
ds_read_b64_tr_b16 a[84:85], v29 offset:49408
v_cvt_pk_bf16_f32 v104, v104, v105
v_cvt_pk_bf16_f32 v105, v106, v107
v_cvt_pk_bf16_f32 v106, v120, v121
v_mfma_f32_16x16x32_bf16 v[180:183], a[68:71], a[52:55], v[180:183]
ds_read_b64_tr_b16 a[86:87], v29 offset:57600
v_cvt_pk_bf16_f32 v107, v122, v123
buffer_store_dwordx4 v[104:107], v1, s[56:59], s23 offen offset:2048
v_mfma_f32_16x16x32_bf16 v[184:187], a[68:71], a[56:59], v[184:187]
v_cvt_pk_bf16_f32 v108, v108, v109
v_cvt_pk_bf16_f32 v109, v110, v111
v_cvt_pk_bf16_f32 v110, v124, v125
v_mfma_f32_16x16x32_bf16 v[188:191], a[68:71], a[60:63], v[188:191]
v_cvt_pk_bf16_f32 v111, v126, v127
buffer_store_dwordx4 v[108:111], v1, s[56:59], s23 offen offset:3072
s_add_u32 s23, s23, 131072
s_waitcnt lgkmcnt(6)
v_mfma_f32_16x16x32_bf16 v[192:195], a[72:75], a[48:51], v[192:195]
ds_read_b64_tr_b16 a[88:89], v30 offset:49408
v_cvt_pk_bf16_f32 v128, v128, v129
v_cvt_pk_bf16_f32 v129, v130, v131
v_mfma_f32_16x16x32_bf16 v[196:199], a[72:75], a[52:55], v[196:199]
ds_read_b64_tr_b16 a[90:91], v30 offset:57600
v_cvt_pk_bf16_f32 v130, v144, v145
v_cvt_pk_bf16_f32 v131, v146, v147
buffer_store_dwordx4 v[128:131], v1, s[56:59], s23 offen offset:0
v_mfma_f32_16x16x32_bf16 v[200:203], a[72:75], a[56:59], v[200:203]
v_cvt_pk_bf16_f32 v132, v132, v133
v_cvt_pk_bf16_f32 v133, v134, v135
v_mfma_f32_16x16x32_bf16 v[204:207], a[72:75], a[60:63], v[204:207]
v_cvt_pk_bf16_f32 v134, v148, v149
v_cvt_pk_bf16_f32 v135, v150, v151
buffer_store_dwordx4 v[132:135], v1, s[56:59], s23 offen offset:1024
s_waitcnt lgkmcnt(6)
v_mfma_f32_16x16x32_bf16 v[208:211], a[76:79], a[48:51], v[208:211]
ds_read_b64_tr_b16 a[92:93], v31 offset:49408
v_cvt_pk_bf16_f32 v136, v136, v137
v_cvt_pk_bf16_f32 v137, v138, v139
v_cvt_pk_bf16_f32 v138, v152, v153
v_mfma_f32_16x16x32_bf16 v[212:215], a[76:79], a[52:55], v[212:215]
ds_read_b64_tr_b16 a[94:95], v31 offset:57600
v_cvt_pk_bf16_f32 v139, v154, v155
buffer_store_dwordx4 v[136:139], v1, s[56:59], s23 offen offset:2048
v_mfma_f32_16x16x32_bf16 v[216:219], a[76:79], a[56:59], v[216:219]
v_cvt_pk_bf16_f32 v140, v140, v141
v_cvt_pk_bf16_f32 v141, v142, v143
v_cvt_pk_bf16_f32 v142, v156, v157
v_mfma_f32_16x16x32_bf16 v[220:223], a[76:79], a[60:63], v[220:223]
v_cvt_pk_bf16_f32 v143, v158, v159
buffer_store_dwordx4 v[140:143], v1, s[56:59], s23 offen offset:3072
s_add_u32 s23, s23, 131072
s_waitcnt lgkmcnt(6)
v_mfma_f32_16x16x32_bf16 v[224:227], a[80:83], a[48:51], v[224:227]
v_cvt_pk_bf16_f32 v160, v160, v161
v_cvt_pk_bf16_f32 v161, v162, v163
v_mfma_f32_16x16x32_bf16 v[228:231], a[80:83], a[52:55], v[228:231]
v_cvt_pk_bf16_f32 v162, v176, v177
v_cvt_pk_bf16_f32 v163, v178, v179
buffer_store_dwordx4 v[160:163], v1, s[56:59], s23 offen offset:0
v_mfma_f32_16x16x32_bf16 v[232:235], a[80:83], a[56:59], v[232:235]
v_cvt_pk_bf16_f32 v164, v164, v165
v_cvt_pk_bf16_f32 v165, v166, v167
v_mfma_f32_16x16x32_bf16 v[236:239], a[80:83], a[60:63], v[236:239]
v_cvt_pk_bf16_f32 v166, v180, v181
v_cvt_pk_bf16_f32 v167, v182, v183
buffer_store_dwordx4 v[164:167], v1, s[56:59], s23 offen offset:1024
s_waitcnt lgkmcnt(4)
v_mfma_f32_16x16x32_bf16 v[240:243], a[84:87], a[48:51], v[240:243]
v_cvt_pk_bf16_f32 v168, v168, v169
v_cvt_pk_bf16_f32 v169, v170, v171
v_cvt_pk_bf16_f32 v170, v184, v185
v_mfma_f32_16x16x32_bf16 v[244:247], a[84:87], a[52:55], v[244:247]
v_cvt_pk_bf16_f32 v171, v186, v187
buffer_store_dwordx4 v[168:171], v1, s[56:59], s23 offen offset:2048
v_mfma_f32_16x16x32_bf16 v[248:251], a[84:87], a[56:59], v[248:251]
v_cvt_pk_bf16_f32 v172, v172, v173
v_cvt_pk_bf16_f32 v173, v174, v175
v_cvt_pk_bf16_f32 v174, v188, v189
v_mfma_f32_16x16x32_bf16 v[252:255], a[84:87], a[60:63], v[252:255]
v_cvt_pk_bf16_f32 v175, v190, v191
buffer_store_dwordx4 v[172:175], v1, s[56:59], s23 offen offset:3072
s_add_u32 s23, s23, 131072
s_waitcnt lgkmcnt(2)
v_mfma_f32_16x16x32_bf16 a[96:99], a[88:91], a[48:51], a[96:99]
v_cvt_pk_bf16_f32 v192, v192, v193
v_cvt_pk_bf16_f32 v193, v194, v195
v_mfma_f32_16x16x32_bf16 a[100:103], a[88:91], a[52:55], a[100:103]
v_cvt_pk_bf16_f32 v194, v208, v209
v_cvt_pk_bf16_f32 v195, v210, v211
buffer_store_dwordx4 v[192:195], v1, s[56:59], s23 offen offset:0
v_mfma_f32_16x16x32_bf16 a[104:107], a[88:91], a[56:59], a[104:107]
v_cvt_pk_bf16_f32 v196, v196, v197
v_cvt_pk_bf16_f32 v197, v198, v199
v_mfma_f32_16x16x32_bf16 a[108:111], a[88:91], a[60:63], a[108:111]
v_cvt_pk_bf16_f32 v198, v212, v213
v_cvt_pk_bf16_f32 v199, v214, v215
buffer_store_dwordx4 v[196:199], v1, s[56:59], s23 offen offset:1024
s_waitcnt lgkmcnt(0)
v_mfma_f32_16x16x32_bf16 a[112:115], a[92:95], a[48:51], a[112:115]
v_cvt_pk_bf16_f32 v200, v200, v201
v_cvt_pk_bf16_f32 v201, v202, v203
v_cvt_pk_bf16_f32 v202, v216, v217
v_mfma_f32_16x16x32_bf16 a[116:119], a[92:95], a[52:55], a[116:119]
v_cvt_pk_bf16_f32 v203, v218, v219
buffer_store_dwordx4 v[200:203], v1, s[56:59], s23 offen offset:2048
v_mfma_f32_16x16x32_bf16 a[120:123], a[92:95], a[56:59], a[120:123]
v_cvt_pk_bf16_f32 v204, v204, v205
v_cvt_pk_bf16_f32 v205, v206, v207
v_cvt_pk_bf16_f32 v206, v220, v221
v_mfma_f32_16x16x32_bf16 a[124:127], a[92:95], a[60:63], a[124:127]
v_cvt_pk_bf16_f32 v207, v222, v223
buffer_store_dwordx4 v[204:207], v1, s[56:59], s23 offen offset:3072
s_add_u32 s23, s23, 131072
s_nop 7
v_cvt_pk_bf16_f32 v224, v224, v225
v_cvt_pk_bf16_f32 v225, v226, v227
v_cvt_pk_bf16_f32 v226, v240, v241
v_cvt_pk_bf16_f32 v227, v242, v243
buffer_store_dwordx4 v[224:227], v1, s[56:59], s23 offen offset:0
v_cvt_pk_bf16_f32 v228, v228, v229
v_cvt_pk_bf16_f32 v229, v230, v231
v_cvt_pk_bf16_f32 v230, v244, v245
v_cvt_pk_bf16_f32 v231, v246, v247
buffer_store_dwordx4 v[228:231], v1, s[56:59], s23 offen offset:1024
v_cvt_pk_bf16_f32 v232, v232, v233
v_cvt_pk_bf16_f32 v233, v234, v235
v_cvt_pk_bf16_f32 v234, v248, v249
v_cvt_pk_bf16_f32 v235, v250, v251
buffer_store_dwordx4 v[232:235], v1, s[56:59], s23 offen offset:2048
v_cvt_pk_bf16_f32 v236, v236, v237
v_cvt_pk_bf16_f32 v237, v238, v239
v_cvt_pk_bf16_f32 v238, v252, v253
v_cvt_pk_bf16_f32 v239, v254, v255
buffer_store_dwordx4 v[236:239], v1, s[56:59], s23 offen offset:3072
s_add_u32 s23, s23, 131072
v_accvgpr_read_b32 v8, a96
v_accvgpr_read_b32 v9, a97
v_accvgpr_read_b32 v10, a98
v_accvgpr_read_b32 v11, a99
v_accvgpr_read_b32 v12, a112
v_accvgpr_read_b32 v13, a113
v_accvgpr_read_b32 v14, a114
v_accvgpr_read_b32 v15, a115
v_cvt_pk_bf16_f32 v8, v8, v9
v_cvt_pk_bf16_f32 v9, v10, v11
v_cvt_pk_bf16_f32 v10, v12, v13
v_cvt_pk_bf16_f32 v11, v14, v15
buffer_store_dwordx4 v[8:11], v1, s[56:59], s23 offen offset:0
s_nop 1
v_accvgpr_read_b32 v8, a100
v_accvgpr_read_b32 v9, a101
v_accvgpr_read_b32 v10, a102
v_accvgpr_read_b32 v11, a103
v_accvgpr_read_b32 v12, a116
v_accvgpr_read_b32 v13, a117
v_accvgpr_read_b32 v14, a118
v_accvgpr_read_b32 v15, a119
v_cvt_pk_bf16_f32 v8, v8, v9
v_cvt_pk_bf16_f32 v9, v10, v11
v_cvt_pk_bf16_f32 v10, v12, v13
v_cvt_pk_bf16_f32 v11, v14, v15
buffer_store_dwordx4 v[8:11], v1, s[56:59], s23 offen offset:1024
s_nop 1
v_accvgpr_read_b32 v8, a104
v_accvgpr_read_b32 v9, a105
v_accvgpr_read_b32 v10, a106
v_accvgpr_read_b32 v11, a107
v_accvgpr_read_b32 v12, a120
v_accvgpr_read_b32 v13, a121
v_accvgpr_read_b32 v14, a122
v_accvgpr_read_b32 v15, a123
v_cvt_pk_bf16_f32 v8, v8, v9
v_cvt_pk_bf16_f32 v9, v10, v11
v_cvt_pk_bf16_f32 v10, v12, v13
v_cvt_pk_bf16_f32 v11, v14, v15
buffer_store_dwordx4 v[8:11], v1, s[56:59], s23 offen offset:2048
s_nop 1
v_accvgpr_read_b32 v8, a108
v_accvgpr_read_b32 v9, a109
v_accvgpr_read_b32 v10, a110
v_accvgpr_read_b32 v11, a111
v_accvgpr_read_b32 v12, a124
v_accvgpr_read_b32 v13, a125
v_accvgpr_read_b32 v14, a126
v_accvgpr_read_b32 v15, a127
v_cvt_pk_bf16_f32 v8, v8, v9
v_cvt_pk_bf16_f32 v9, v10, v11
v_cvt_pk_bf16_f32 v10, v12, v13
v_cvt_pk_bf16_f32 v11, v14, v15
buffer_store_dwordx4 v[8:11], v1, s[56:59], s23 offen offset:3072
s_nop 1
s_add_u32 s23, s23, 131072
s_endpgm
L_gemm1_kernel_v:
v_and_b32 v2, 63, v0
v_lshlrev_b32 v8, 4, v2
v_add_u32 v9, 32768, v8
v_add_u32 v10, 65536, v8
v_add_u32 v11, 98304, v8
s_mov_b32 s45, 6144
v_and_b32 v2, 63, v0
v_lshrrev_b32 v3, 5, v2
s_mul_i32 s46, s40, 2
v_add_u32 v3, s46, v3
v_and_b32 v2, 31, v2
v_and_b32 v4, 7, v3
v_lshlrev_b32 v4, 1, v4
v_xor_b32 v2, v2, v4
v_lshlrev_b32 v2, 4, v2
v_bfe_u32 v4, v3, 2, 2
v_lshrrev_b32 v5, 4, v3
v_and_b32 v3, 3, v3
v_lshl_add_u32 v3, v4, 3, v3
v_lshl_add_u32 v3, v5, 2, v3
v_mul_lo_u32 v3, v3, s45
v_add_u32 v12, v2, v3
v_add_u32 v13, 98304, v12
v_add_u32 v14, 24576, v12
v_add_u32 v15, 122880, v12
s_lshl_b32 s43, s40, 10
s_mov_b32 s41, 0
s_mov_b32 s42, 0
s_waitcnt lgkmcnt(0)
s_add_u32 s52, s4, s18
s_addc_u32 s53, s5, 0
s_and_b32 s53, s53, 0xffff
s_sub_u32 s54, 0x600000, s18
s_mov_b32 s55, 0x20000
s_lshl_b32 s17, s16, 15
s_add_u32 s48, s6, s17
s_addc_u32 s49, s7, 0
s_and_b32 s49, s49, 0xffff
s_mov_b32 s50, 131072
s_mov_b32 s51, 0x20000
s_add_u32 m0, s43, 0
s_nop 0
buffer_load_dwordx4 v12, s[52:55], s42 offen lds
s_add_u32 m0, s43, 4096
s_nop 0
buffer_load_dwordx4 v13, s[52:55], s42 offen lds
s_add_u32 m0, s43, 8192
s_nop 0
buffer_load_dwordx4 v14, s[52:55], s42 offen lds
s_add_u32 m0, s43, 12288
s_nop 0
buffer_load_dwordx4 v15, s[52:55], s42 offen lds
s_add_u32 s42, s42, 196608
s_add_u32 m0, s43, 16384
s_nop 0
buffer_load_dwordx4 v12, s[52:55], s42 offen lds
s_add_u32 m0, s43, 20480
s_nop 0
buffer_load_dwordx4 v13, s[52:55], s42 offen lds
s_add_u32 m0, s43, 24576
s_nop 0
buffer_load_dwordx4 v14, s[52:55], s42 offen lds
s_add_u32 m0, s43, 28672
s_nop 0
buffer_load_dwordx4 v15, s[52:55], s42 offen lds
s_add_u32 s42, s42, 196608
s_mov_b32 s68, s6
s_and_b32 s69, s7, 0xffff
s_mov_b32 s70, 0x400000
s_mov_b32 s71, 0x20000
s_add_u32 s60, s6, 0x3c00000
s_addc_u32 s61, s7, 0
s_and_b32 s61, s61, 0xffff
s_mov_b32 s62, 0x2000
s_mov_b32 s63, 0x20000
s_mov_b32 s72, s34
s_and_b32 s73, s35, 0xffff
s_mov_b32 s74, 0x100
s_mov_b32 s75, 0x20000
s_lshr_b32 s36, s47, 1
s_lshl_b32 s36, s36, 15
s_and_b32 s37, s47, 1
s_lshl_b32 s37, s37, 7
s_add_u32 s36, s36, s37
v_lshrrev_b32 v193, 2, v197
v_lshlrev_b32 v193, 10, v193
v_and_b32 v198, 3, v197
v_lshl_add_u32 v193, v198, 8, v193
v_lshl_add_u32 v193, v196, 4, v193
v_add_u32 v193, s36, v193
v_lshrrev_b32 v194, 6, v0
v_lshl_add_u32 v194, v194, 3, v196
v_lshlrev_b32 v194, 2, v194
v_add_u32 v194, 131072, v194
v_lshlrev_b32 v195, 2, v196
v_add_u32 v195, 131072, v195
s_waitcnt vmcnt(12)
v_lshlrev_b32 v80, 16, v64
v_and_b32 v81, 0xffff0000, v64
v_lshlrev_b32 v82, 16, v65
v_and_b32 v83, 0xffff0000, v65
v_lshlrev_b32 v84, 16, v66
v_and_b32 v85, 0xffff0000, v66
v_lshlrev_b32 v86, 16, v67
v_and_b32 v87, 0xffff0000, v67
s_waitcnt vmcnt(11)
v_lshlrev_b32 v88, 16, v68
v_and_b32 v89, 0xffff0000, v68
v_lshlrev_b32 v90, 16, v69
v_and_b32 v91, 0xffff0000, v69
v_lshlrev_b32 v92, 16, v70
v_and_b32 v93, 0xffff0000, v70
v_lshlrev_b32 v94, 16, v71
v_and_b32 v95, 0xffff0000, v71
s_waitcnt vmcnt(10)
v_lshlrev_b32 v96, 16, v72
v_and_b32 v97, 0xffff0000, v72
v_lshlrev_b32 v98, 16, v73
v_and_b32 v99, 0xffff0000, v73
v_lshlrev_b32 v100, 16, v74
v_and_b32 v101, 0xffff0000, v74
v_lshlrev_b32 v102, 16, v75
v_and_b32 v103, 0xffff0000, v75
s_waitcnt vmcnt(9)
v_lshlrev_b32 v104, 16, v76
v_and_b32 v105, 0xffff0000, v76
v_lshlrev_b32 v106, 16, v77
v_and_b32 v107, 0xffff0000, v77
v_lshlrev_b32 v108, 16, v78
v_and_b32 v109, 0xffff0000, v78
v_lshlrev_b32 v110, 16, v79
v_and_b32 v111, 0xffff0000, v79
v_pk_mul_f32 v[144:145], v[80:81], v[80:81]
v_pk_mul_f32 v[146:147], v[82:83], v[82:83]
v_pk_mul_f32 v[148:149], v[84:85], v[84:85]
v_pk_mul_f32 v[150:151], v[86:87], v[86:87]
v_pk_fma_f32 v[144:145], v[88:89], v[88:89], v[144:145]
v_pk_fma_f32 v[146:147], v[90:91], v[90:91], v[146:147]
v_pk_fma_f32 v[148:149], v[92:93], v[92:93], v[148:149]
v_pk_fma_f32 v[150:151], v[94:95], v[94:95], v[150:151]
v_pk_fma_f32 v[144:145], v[96:97], v[96:97], v[144:145]
v_pk_fma_f32 v[146:147], v[98:99], v[98:99], v[146:147]
v_pk_fma_f32 v[148:149], v[100:101], v[100:101], v[148:149]
v_pk_fma_f32 v[150:151], v[102:103], v[102:103], v[150:151]
v_pk_fma_f32 v[144:145], v[104:105], v[104:105], v[144:145]
v_pk_fma_f32 v[146:147], v[106:107], v[106:107], v[146:147]
v_pk_fma_f32 v[148:149], v[108:109], v[108:109], v[148:149]
v_pk_fma_f32 v[150:151], v[110:111], v[110:111], v[150:151]
v_pk_add_f32 v[112:113], v[80:81], v[82:83]
v_pk_add_f32 v[114:115], v[84:85], v[86:87]
v_pk_add_f32 v[116:117], v[88:89], v[90:91]
v_pk_add_f32 v[118:119], v[92:93], v[94:95]
v_pk_add_f32 v[120:121], v[96:97], v[98:99]
v_pk_add_f32 v[122:123], v[100:101], v[102:103]
v_pk_add_f32 v[124:125], v[104:105], v[106:107]
v_pk_add_f32 v[126:127], v[108:109], v[110:111]
v_pk_add_f32 v[128:129], v[112:113], v[114:115]
v_pk_add_f32 v[130:131], v[116:117], v[118:119]
v_pk_add_f32 v[132:133], v[120:121], v[122:123]
v_pk_add_f32 v[134:135], v[124:125], v[126:127]
v_pk_add_f32 v[136:137], v[128:129], v[130:131]
v_pk_add_f32 v[138:139], v[132:133], v[134:135]
v_pk_add_f32 v[140:141], v[136:137], v[138:139]
v_add_f32 v200, v140, v141
v_pk_add_f32 v[152:153], v[144:145], v[146:147]
v_pk_add_f32 v[154:155], v[148:149], v[150:151]
v_pk_add_f32 v[156:157], v[152:153], v[154:155]
v_add_f32 v201, v156, v157
s_nop 1
v_add_f32_dpp v200, v200, v200 row_ror:8 row_mask:0xf bank_mask:0xf
v_add_f32_dpp v201, v201, v201 row_ror:8 row_mask:0xf bank_mask:0xf
v_mov_b32 v208, v200
v_mov_b32 v212, v201
s_nop 1
v_permlane16_swap_b32 v200, v208
v_permlane16_swap_b32 v201, v212
s_nop 1
v_add_f32 v200, v200, v208
v_add_f32 v201, v201, v212
v_mov_b32 v208, v200
v_mov_b32 v212, v201
s_nop 1
v_permlane32_swap_b32 v200, v208
v_permlane32_swap_b32 v201, v212
s_nop 1
v_add_f32 v200, v200, v208
v_add_f32 v201, v201, v212
v_lshlrev_b32 v194, 1, v194
v_subrev_u32 v194, 131072, v194
v_lshlrev_b32 v195, 1, v195
v_subrev_u32 v195, 131072, v195
ds_write_b64 v194, v[200:201]
s_waitcnt lgkmcnt(0)
s_barrier
ds_read_b64 v[112:113], v195 offset:0
ds_read_b64 v[114:115], v195 offset:64
ds_read_b64 v[116:117], v195 offset:128
ds_read_b64 v[118:119], v195 offset:192
s_waitcnt lgkmcnt(0)
v_pk_add_f32 v[112:113], v[112:113], v[114:115]
v_pk_add_f32 v[116:117], v[116:117], v[118:119]
v_pk_add_f32 v[112:113], v[112:113], v[116:117]
v_mul_f32 v112, 0x3a800000, v112
v_mul_f32 v200, 0x3a800000, v113
v_fma_f32 v200, -v112, v112, v200
v_max_f32 v200, 0, v200
v_add_f32 v206, 0x3727c5ac, v200
v_rsq_f32 v206, v206
s_nop 0
v_mul_f32 v210, 0x3f014852, v206
v_mul_f32 v211, -v112, v210
v_pk_fma_f32 v[80:81], v[80:81], v[210:211], v[210:211] op_sel:[0,0,1] op_sel_hi:[1,0,1]
v_pk_fma_f32 v[82:83], v[82:83], v[210:211], v[210:211] op_sel:[0,0,1] op_sel_hi:[1,0,1]
v_pk_fma_f32 v[84:85], v[84:85], v[210:211], v[210:211] op_sel:[0,0,1] op_sel_hi:[1,0,1]
v_pk_fma_f32 v[86:87], v[86:87], v[210:211], v[210:211] op_sel:[0,0,1] op_sel_hi:[1,0,1]
v_pk_fma_f32 v[88:89], v[88:89], v[210:211], v[210:211] op_sel:[0,0,1] op_sel_hi:[1,0,1]
v_pk_fma_f32 v[90:91], v[90:91], v[210:211], v[210:211] op_sel:[0,0,1] op_sel_hi:[1,0,1]
v_pk_fma_f32 v[92:93], v[92:93], v[210:211], v[210:211] op_sel:[0,0,1] op_sel_hi:[1,0,1]
v_pk_fma_f32 v[94:95], v[94:95], v[210:211], v[210:211] op_sel:[0,0,1] op_sel_hi:[1,0,1]
v_pk_fma_f32 v[96:97], v[96:97], v[210:211], v[210:211] op_sel:[0,0,1] op_sel_hi:[1,0,1]
v_pk_fma_f32 v[98:99], v[98:99], v[210:211], v[210:211] op_sel:[0,0,1] op_sel_hi:[1,0,1]
v_pk_fma_f32 v[100:101], v[100:101], v[210:211], v[210:211] op_sel:[0,0,1] op_sel_hi:[1,0,1]
v_pk_fma_f32 v[102:103], v[102:103], v[210:211], v[210:211] op_sel:[0,0,1] op_sel_hi:[1,0,1]
v_pk_fma_f32 v[104:105], v[104:105], v[210:211], v[210:211] op_sel:[0,0,1] op_sel_hi:[1,0,1]
v_pk_fma_f32 v[106:107], v[106:107], v[210:211], v[210:211] op_sel:[0,0,1] op_sel_hi:[1,0,1]
v_pk_fma_f32 v[108:109], v[108:109], v[210:211], v[210:211] op_sel:[0,0,1] op_sel_hi:[1,0,1]
v_pk_fma_f32 v[110:111], v[110:111], v[210:211], v[210:211] op_sel:[0,0,1] op_sel_hi:[1,0,1]
v_cvt_pk_bf16_f32 v64, v80, v81
v_cvt_pk_bf16_f32 v65, v82, v83
v_cvt_pk_bf16_f32 v66, v84, v85
v_cvt_pk_bf16_f32 v67, v86, v87
v_cvt_pk_bf16_f32 v68, v88, v89
v_cvt_pk_bf16_f32 v69, v90, v91
v_cvt_pk_bf16_f32 v70, v92, v93
v_cvt_pk_bf16_f32 v71, v94, v95
v_cvt_pk_bf16_f32 v72, v96, v97
v_cvt_pk_bf16_f32 v73, v98, v99
v_cvt_pk_bf16_f32 v74, v100, v101
v_cvt_pk_bf16_f32 v75, v102, v103
v_cvt_pk_bf16_f32 v76, v104, v105
v_cvt_pk_bf16_f32 v77, v106, v107
v_cvt_pk_bf16_f32 v78, v108, v109
v_cvt_pk_bf16_f32 v79, v110, v111
s_mov_b32 s36, 8192
s_mov_b32 s37, 16384
s_mov_b32 s27, 24576
buffer_store_dwordx4 v[64:67], v193, s[68:71], 0 offen sc1
buffer_store_dwordx4 v[68:71], v193, s[68:71], s36 offen sc1
buffer_store_dwordx4 v[72:75], v193, s[68:71], s37 offen sc1
buffer_store_dwordx4 v[76:79], v193, s[68:71], s27 offen sc1
v_mul_f32 v209, v206, v206
v_mul_f32 v209, v209, v200
v_add_f32 v209, 0x3727c5ac, v209
v_rsq_f32 v209, v209
v_add_u32 v198, s3, v196
v_lshlrev_b32 v198, 2, v198
v_mul_f32 v209, 0x3ffd75e0, v209
buffer_store_dword v209, v198, s[60:63], 0 offen sc1
s_waitcnt vmcnt(0)
s_barrier
s_cmp_lg_u32 s40, 0
s_cbranch_scc1 L_gemm1_kernel_v_ln_nosig
s_lshr_b32 s36, s47, 5
s_lshl_b32 s37, s36, 5
v_mov_b32 v6, s37
v_mov_b32 v7, 1
s_mov_b64 s[38:39], exec
s_mov_b64 exec, 1
buffer_atomic_add v7, v6, s[72:75], 0 offen sc0 sc1
s_mov_b64 exec, s[38:39]
L_gemm1_kernel_v_ln_nosig:
s_add_u32 m0, s43, 32768
s_nop 0
buffer_load_dwordx4 v12, s[52:55], s42 offen lds
s_add_u32 m0, s43, 36864
s_nop 0
buffer_load_dwordx4 v13, s[52:55], s42 offen lds
s_add_u32 m0, s43, 40960
s_nop 0
buffer_load_dwordx4 v14, s[52:55], s42 offen lds
s_add_u32 m0, s43, 45056
s_nop 0
buffer_load_dwordx4 v15, s[52:55], s42 offen lds
s_add_u32 s42, s42, 196608
s_add_u32 m0, s43, 49152
s_nop 0
buffer_load_dwordx4 v12, s[52:55], s42 offen lds
s_add_u32 m0, s43, 53248
s_nop 0
buffer_load_dwordx4 v13, s[52:55], s42 offen lds
s_add_u32 m0, s43, 57344
s_nop 0
buffer_load_dwordx4 v14, s[52:55], s42 offen lds
s_add_u32 m0, s43, 61440
s_nop 0
buffer_load_dwordx4 v15, s[52:55], s42 offen lds
s_add_u32 s42, s42, 196608
s_add_u32 m0, s43, 65536
s_nop 0
buffer_load_dwordx4 v12, s[52:55], s42 offen lds
s_add_u32 m0, s43, 69632
s_nop 0
buffer_load_dwordx4 v13, s[52:55], s42 offen lds
s_add_u32 m0, s43, 73728
s_nop 0
buffer_load_dwordx4 v14, s[52:55], s42 offen lds
s_add_u32 m0, s43, 77824
s_nop 0
buffer_load_dwordx4 v15, s[52:55], s42 offen lds
s_add_u32 s42, s42, 196608
s_add_u32 m0, s43, 81920
s_nop 0
buffer_load_dwordx4 v12, s[52:55], s42 offen lds
s_add_u32 m0, s43, 86016
s_nop 0
buffer_load_dwordx4 v13, s[52:55], s42 offen lds
s_add_u32 m0, s43, 90112
s_nop 0
buffer_load_dwordx4 v14, s[52:55], s42 offen lds
s_add_u32 m0, s43, 94208
s_nop 0
buffer_load_dwordx4 v15, s[52:55], s42 offen lds
s_add_u32 s42, s42, 196608
s_lshl_b32 s22, s20, 22
s_add_u32 s22, s22, 4194304
s_add_u32 s56, s6, s22
s_addc_u32 s57, s7, 0
s_and_b32 s57, s57, 0xffff
s_mov_b32 s58, 4194304
s_mov_b32 s59, 0x20000
v_and_b32 v1, 63, v0
v_lshlrev_b32 v1, 4, v1
s_lshr_b32 s17, s16, 1
s_lshl_b32 s17, s17, 11
v_add_u32 v1, s17, v1
s_lshl_b32 s23, s21, 17
v_bfe_u32 v3, v0, 2, 4
v_and_b32 v4, 7, v3
v_lshlrev_b32 v4, 5, v4
v_mul_u32_u24 v3, 512, v3
v_and_b32 v2, 3, v0
v_lshl_add_u32 v3, v2, 3, v3
v_xor_b32 v2, 0, v4
v_add_u32 v16, v2, v3
v_add_u32 v24, 65536, v16
v_xor_b32 v2, 32, v4
v_add_u32 v17, v2, v3
v_add_u32 v25, 65536, v17
v_xor_b32 v2, 64, v4
v_add_u32 v18, v2, v3
v_add_u32 v26, 65536, v18
v_xor_b32 v2, 96, v4
v_add_u32 v19, v2, v3
v_add_u32 v27, 65536, v19
v_xor_b32 v2, 128, v4
v_add_u32 v20, v2, v3
v_add_u32 v28, 65536, v20
v_xor_b32 v2, 160, v4
v_add_u32 v21, v2, v3
v_add_u32 v29, 65536, v21
v_xor_b32 v2, 192, v4
v_add_u32 v22, v2, v3
v_add_u32 v30, 65536, v22
v_xor_b32 v2, 224, v4
v_add_u32 v23, v2, v3
v_add_u32 v31, 65536, v23
s_add_u32 s28, s6, 0x3d00000
s_addc_u32 s29, s7, 0
s_and_b32 s29, s29, 0xffff
s_mov_b32 s30, 0x20000
s_mov_b32 s31, 0x20000
s_lshl_b32 s36, s2, 7
s_add_u32 s36, s36, 0x10000
v_and_b32 v5, 31, v0
v_lshlrev_b32 v5, 2, v5
v_add_u32 v5, s36, v5
s_lshl_b32 s36, s2, 6
s_add_u32 s36, s36, 4096
v_mov_b32 v3, s36
v_mov_b32 v2, 0
buffer_store_dword v2, v5, s[28:31], 0 offen
buffer_store_dword v2, v3, s[28:31], 0 offen
s_nop 0
v_mov_b32 v2, 0
v_mov_b32 v3, 0
v_mov_b32 v4, 0
v_mov_b32 v5, 0
s_nop 1
v_mfma_f32_32x32x16_bf16 v[32:47], v[2:5], v[2:5], 0
v_mfma_f32_32x32x16_bf16 v[48:63], v[2:5], v[2:5], 0
v_mfma_f32_32x32x16_bf16 v[64:79], v[2:5], v[2:5], 0
v_mfma_f32_32x32x16_bf16 v[80:95], v[2:5], v[2:5], 0
v_mfma_f32_32x32x16_bf16 v[96:111], v[2:5], v[2:5], 0
v_mfma_f32_32x32x16_bf16 v[112:127], v[2:5], v[2:5], 0
v_mfma_f32_32x32x16_bf16 v[128:143], v[2:5], v[2:5], 0
v_mfma_f32_32x32x16_bf16 v[144:159], v[2:5], v[2:5], 0
v_mfma_f32_32x32x16_bf16 v[160:175], v[2:5], v[2:5], 0
v_mfma_f32_32x32x16_bf16 v[176:191], v[2:5], v[2:5], 0
v_mfma_f32_32x32x16_bf16 v[192:207], v[2:5], v[2:5], 0
v_mfma_f32_32x32x16_bf16 v[208:223], v[2:5], v[2:5], 0
v_mfma_f32_32x32x16_bf16 v[224:239], v[2:5], v[2:5], 0
v_mfma_f32_32x32x16_bf16 v[240:255], v[2:5], v[2:5], 0
v_mfma_f32_32x32x16_bf16 a[96:111], v[2:5], v[2:5], 0
v_mfma_f32_32x32x16_bf16 a[112:127], v[2:5], v[2:5], 0
s_cmp_lg_u32 s40, 0
s_cbranch_scc1 L_gemm1_kernel_v_ln_join
s_waitcnt vmcnt(18)
v_readfirstlane_b32 s37, v7
s_lshr_b32 s36, s47, 5
s_cmp_eq_u32 s37, 31
s_cbranch_scc0 L_gemm1_kernel_v_ln_wait
s_lshl_b32 s36, s36, 12
s_add_u32 s36, s36, 0x8000
v_lshlrev_b32 v6, 7, v0
v_add_u32 v6, s36, v6
v_mov_b32 v7, 1
s_mov_b32 exec_hi, 0
buffer_store_dword v7, v6, s[76:79], 0 offen sc1
s_mov_b64 exec, s[38:39]
s_branch L_gemm1_kernel_v_ln_join
L_gemm1_kernel_v_ln_wait:
s_lshl_b32 s36, s47, 7
s_add_u32 s36, s36, 0x8000
v_mov_b32 v6, s36
s_mov_b32 s37, 0x80000
L_gemm1_kernel_v_ln_p:
buffer_load_dword v7, v6, s[76:79], 0 offen sc1
s_waitcnt vmcnt(0)
v_readfirstlane_b32 s36, v7
s_sub_u32 s37, s37, 1
s_cbranch_scc1 L_gemm1_kernel_v_ln_p_out
s_cmp_ge_u32 s36, 1
s_cbranch_scc1 L_gemm1_kernel_v_ln_p_out
s_branch L_gemm1_kernel_v_ln_p
L_gemm1_kernel_v_ln_p_out:
L_gemm1_kernel_v_ln_join:
s_barrier
buffer_load_dwordx4 a[0:3], v8, s[48:51], s41 offen sc1
buffer_load_dwordx4 a[4:7], v9, s[48:51], s41 offen sc1
buffer_load_dwordx4 a[8:11], v10, s[48:51], s41 offen sc1
buffer_load_dwordx4 a[12:15], v11, s[48:51], s41 offen sc1
s_add_u32 s41, s41, 1024
buffer_load_dwordx4 a[16:19], v8, s[48:51], s41 offen sc1
buffer_load_dwordx4 a[20:23], v9, s[48:51], s41 offen sc1
buffer_load_dwordx4 a[24:27], v10, s[48:51], s41 offen sc1
buffer_load_dwordx4 a[28:31], v11, s[48:51], s41 offen sc1
s_add_u32 s41, s41, 1024
buffer_load_dwordx4 a[32:35], v8, s[48:51], s41 offen sc1
buffer_load_dwordx4 a[36:39], v9, s[48:51], s41 offen sc1
buffer_load_dwordx4 a[40:43], v10, s[48:51], s41 offen sc1
buffer_load_dwordx4 a[44:47], v11, s[48:51], s41 offen sc1
s_add_u32 s41, s41, 1024
s_waitcnt vmcnt(8)
s_barrier
ds_read_b64_tr_b16 a[64:65], v16 offset:0
ds_read_b64_tr_b16 a[66:67], v16 offset:8192
ds_read_b64_tr_b16 a[68:69], v17 offset:0
ds_read_b64_tr_b16 a[70:71], v17 offset:8192
ds_read_b64_tr_b16 a[72:73], v18 offset:0
ds_read_b64_tr_b16 a[74:75], v18 offset:8192
ds_read_b64_tr_b16 a[76:77], v19 offset:0
ds_read_b64_tr_b16 a[78:79], v19 offset:8192
s_mov_b32 s44, 3
.p2align 4
L_gemm1_kernel_v_loop0:
s_waitcnt lgkmcnt(6)
v_mfma_f32_16x16x32_bf16 v[32:35], a[0:3], a[64:67], v[32:35]
ds_read_b64_tr_b16 a[80:81], v20 offset:0
v_mfma_f32_16x16x32_bf16 v[36:39], a[4:7], a[64:67], v[36:39]
ds_read_b64_tr_b16 a[82:83], v20 offset:8192
buffer_load_dwordx4 a[48:51], v8, s[48:51], s41 offen sc1
v_mfma_f32_16x16x32_bf16 v[40:43], a[8:11], a[64:67], v[40:43]
v_mfma_f32_16x16x32_bf16 v[44:47], a[12:15], a[64:67], v[44:47]
s_waitcnt lgkmcnt(6)
v_mfma_f32_16x16x32_bf16 v[48:51], a[0:3], a[68:71], v[48:51]
ds_read_b64_tr_b16 a[84:85], v21 offset:0
v_mfma_f32_16x16x32_bf16 v[52:55], a[4:7], a[68:71], v[52:55]
ds_read_b64_tr_b16 a[86:87], v21 offset:8192
v_mfma_f32_16x16x32_bf16 v[56:59], a[8:11], a[68:71], v[56:59]
v_mfma_f32_16x16x32_bf16 v[60:63], a[12:15], a[68:71], v[60:63]
s_waitcnt lgkmcnt(6)
v_mfma_f32_16x16x32_bf16 v[64:67], a[0:3], a[72:75], v[64:67]
ds_read_b64_tr_b16 a[88:89], v22 offset:0
v_mfma_f32_16x16x32_bf16 v[68:71], a[4:7], a[72:75], v[68:71]
ds_read_b64_tr_b16 a[90:91], v22 offset:8192
s_add_u32 m0, s43, 98304
v_mfma_f32_16x16x32_bf16 v[72:75], a[8:11], a[72:75], v[72:75]
buffer_load_dwordx4 v12, s[52:55], s42 offen lds
v_mfma_f32_16x16x32_bf16 v[76:79], a[12:15], a[72:75], v[76:79]
s_waitcnt lgkmcnt(6)
v_mfma_f32_16x16x32_bf16 v[80:83], a[0:3], a[76:79], v[80:83]
ds_read_b64_tr_b16 a[92:93], v23 offset:0
v_mfma_f32_16x16x32_bf16 v[84:87], a[4:7], a[76:79], v[84:87]
ds_read_b64_tr_b16 a[94:95], v23 offset:8192
v_mfma_f32_16x16x32_bf16 v[88:91], a[8:11], a[76:79], v[88:91]
v_mfma_f32_16x16x32_bf16 v[92:95], a[12:15], a[76:79], v[92:95]
s_waitcnt lgkmcnt(6)
v_mfma_f32_16x16x32_bf16 v[96:99], a[0:3], a[80:83], v[96:99]
ds_read_b64_tr_b16 a[64:65], v16 offset:256
v_mfma_f32_16x16x32_bf16 v[100:103], a[4:7], a[80:83], v[100:103]
ds_read_b64_tr_b16 a[66:67], v16 offset:8448
buffer_load_dwordx4 a[52:55], v9, s[48:51], s41 offen sc1
v_mfma_f32_16x16x32_bf16 v[104:107], a[8:11], a[80:83], v[104:107]
v_mfma_f32_16x16x32_bf16 v[108:111], a[12:15], a[80:83], v[108:111]
s_waitcnt lgkmcnt(6)
v_mfma_f32_16x16x32_bf16 v[112:115], a[0:3], a[84:87], v[112:115]
ds_read_b64_tr_b16 a[68:69], v17 offset:256
v_mfma_f32_16x16x32_bf16 v[116:119], a[4:7], a[84:87], v[116:119]
ds_read_b64_tr_b16 a[70:71], v17 offset:8448
v_mfma_f32_16x16x32_bf16 v[120:123], a[8:11], a[84:87], v[120:123]
v_mfma_f32_16x16x32_bf16 v[124:127], a[12:15], a[84:87], v[124:127]
s_waitcnt lgkmcnt(6)
v_mfma_f32_16x16x32_bf16 v[128:131], a[0:3], a[88:91], v[128:131]
ds_read_b64_tr_b16 a[72:73], v18 offset:256
v_mfma_f32_16x16x32_bf16 v[132:135], a[4:7], a[88:91], v[132:135]
ds_read_b64_tr_b16 a[74:75], v18 offset:8448
s_add_u32 m0, s43, 102400
v_mfma_f32_16x16x32_bf16 v[136:139], a[8:11], a[88:91], v[136:139]
buffer_load_dwordx4 v13, s[52:55], s42 offen lds
v_mfma_f32_16x16x32_bf16 v[140:143], a[12:15], a[88:91], v[140:143]
s_waitcnt lgkmcnt(6)
v_mfma_f32_16x16x32_bf16 v[144:147], a[0:3], a[92:95], v[144:147]
ds_read_b64_tr_b16 a[76:77], v19 offset:256
v_mfma_f32_16x16x32_bf16 v[148:151], a[4:7], a[92:95], v[148:151]
ds_read_b64_tr_b16 a[78:79], v19 offset:8448
v_mfma_f32_16x16x32_bf16 v[152:155], a[8:11], a[92:95], v[152:155]
v_mfma_f32_16x16x32_bf16 v[156:159], a[12:15], a[92:95], v[156:159]
s_waitcnt lgkmcnt(6)
v_mfma_f32_16x16x32_bf16 v[160:163], a[0:3], a[64:67], v[160:163]
ds_read_b64_tr_b16 a[80:81], v20 offset:256
v_mfma_f32_16x16x32_bf16 v[164:167], a[4:7], a[64:67], v[164:167]
ds_read_b64_tr_b16 a[82:83], v20 offset:8448
buffer_load_dwordx4 a[56:59], v10, s[48:51], s41 offen sc1
v_mfma_f32_16x16x32_bf16 v[168:171], a[8:11], a[64:67], v[168:171]
v_mfma_f32_16x16x32_bf16 v[172:175], a[12:15], a[64:67], v[172:175]
s_waitcnt lgkmcnt(6)
v_mfma_f32_16x16x32_bf16 v[176:179], a[0:3], a[68:71], v[176:179]
ds_read_b64_tr_b16 a[84:85], v21 offset:256
v_mfma_f32_16x16x32_bf16 v[180:183], a[4:7], a[68:71], v[180:183]
ds_read_b64_tr_b16 a[86:87], v21 offset:8448
v_mfma_f32_16x16x32_bf16 v[184:187], a[8:11], a[68:71], v[184:187]
v_mfma_f32_16x16x32_bf16 v[188:191], a[12:15], a[68:71], v[188:191]
s_waitcnt lgkmcnt(6)
v_mfma_f32_16x16x32_bf16 v[192:195], a[0:3], a[72:75], v[192:195]
ds_read_b64_tr_b16 a[88:89], v22 offset:256
v_mfma_f32_16x16x32_bf16 v[196:199], a[4:7], a[72:75], v[196:199]
ds_read_b64_tr_b16 a[90:91], v22 offset:8448
s_add_u32 m0, s43, 106496
v_mfma_f32_16x16x32_bf16 v[200:203], a[8:11], a[72:75], v[200:203]
buffer_load_dwordx4 v14, s[52:55], s42 offen lds
v_mfma_f32_16x16x32_bf16 v[204:207], a[12:15], a[72:75], v[204:207]
s_waitcnt lgkmcnt(6)
v_mfma_f32_16x16x32_bf16 v[208:211], a[0:3], a[76:79], v[208:211]
ds_read_b64_tr_b16 a[92:93], v23 offset:256
v_mfma_f32_16x16x32_bf16 v[212:215], a[4:7], a[76:79], v[212:215]
ds_read_b64_tr_b16 a[94:95], v23 offset:8448
v_mfma_f32_16x16x32_bf16 v[216:219], a[8:11], a[76:79], v[216:219]
v_mfma_f32_16x16x32_bf16 v[220:223], a[12:15], a[76:79], v[220:223]
s_waitcnt lgkmcnt(6)
v_mfma_f32_16x16x32_bf16 v[224:227], a[0:3], a[80:83], v[224:227]
s_waitcnt vmcnt(10)
s_barrier
ds_read_b64_tr_b16 a[64:65], v16 offset:16384
v_mfma_f32_16x16x32_bf16 v[228:231], a[4:7], a[80:83], v[228:231]
ds_read_b64_tr_b16 a[66:67], v16 offset:24576
buffer_load_dwordx4 a[60:63], v11, s[48:51], s41 offen sc1
s_add_u32 s41, s41, 1024
v_mfma_f32_16x16x32_bf16 v[232:235], a[8:11], a[80:83], v[232:235]
v_mfma_f32_16x16x32_bf16 v[236:239], a[12:15], a[80:83], v[236:239]
s_waitcnt lgkmcnt(6)
v_mfma_f32_16x16x32_bf16 v[240:243], a[0:3], a[84:87], v[240:243]
ds_read_b64_tr_b16 a[68:69], v17 offset:16384
v_mfma_f32_16x16x32_bf16 v[244:247], a[4:7], a[84:87], v[244:247]
ds_read_b64_tr_b16 a[70:71], v17 offset:24576
v_mfma_f32_16x16x32_bf16 v[248:251], a[8:11], a[84:87], v[248:251]
v_mfma_f32_16x16x32_bf16 v[252:255], a[12:15], a[84:87], v[252:255]
s_waitcnt lgkmcnt(6)
v_mfma_f32_16x16x32_bf16 a[96:99], a[0:3], a[88:91], a[96:99]
ds_read_b64_tr_b16 a[72:73], v18 offset:16384
v_mfma_f32_16x16x32_bf16 a[100:103], a[4:7], a[88:91], a[100:103]
ds_read_b64_tr_b16 a[74:75], v18 offset:24576
s_add_u32 m0, s43, 110592
v_mfma_f32_16x16x32_bf16 a[104:107], a[8:11], a[88:91], a[104:107]
buffer_load_dwordx4 v15, s[52:55], s42 offen lds
s_add_u32 s42, s42, 196608
v_mfma_f32_16x16x32_bf16 a[108:111], a[12:15], a[88:91], a[108:111]
s_waitcnt lgkmcnt(6)
v_mfma_f32_16x16x32_bf16 a[112:115], a[0:3], a[92:95], a[112:115]
ds_read_b64_tr_b16 a[76:77], v19 offset:16384
v_mfma_f32_16x16x32_bf16 a[116:119], a[4:7], a[92:95], a[116:119]
ds_read_b64_tr_b16 a[78:79], v19 offset:24576
v_mfma_f32_16x16x32_bf16 a[120:123], a[8:11], a[92:95], a[120:123]
v_mfma_f32_16x16x32_bf16 a[124:127], a[12:15], a[92:95], a[124:127]
s_waitcnt lgkmcnt(6)
v_mfma_f32_16x16x32_bf16 v[32:35], a[16:19], a[64:67], v[32:35]
ds_read_b64_tr_b16 a[80:81], v20 offset:16384
v_mfma_f32_16x16x32_bf16 v[36:39], a[20:23], a[64:67], v[36:39]
ds_read_b64_tr_b16 a[82:83], v20 offset:24576
buffer_load_dwordx4 a[0:3], v8, s[48:51], s41 offen sc1
v_mfma_f32_16x16x32_bf16 v[40:43], a[24:27], a[64:67], v[40:43]
v_mfma_f32_16x16x32_bf16 v[44:47], a[28:31], a[64:67], v[44:47]
s_waitcnt lgkmcnt(6)
v_mfma_f32_16x16x32_bf16 v[48:51], a[16:19], a[68:71], v[48:51]
ds_read_b64_tr_b16 a[84:85], v21 offset:16384
v_mfma_f32_16x16x32_bf16 v[52:55], a[20:23], a[68:71], v[52:55]
ds_read_b64_tr_b16 a[86:87], v21 offset:24576
v_mfma_f32_16x16x32_bf16 v[56:59], a[24:27], a[68:71], v[56:59]
v_mfma_f32_16x16x32_bf16 v[60:63], a[28:31], a[68:71], v[60:63]
s_waitcnt lgkmcnt(6)
v_mfma_f32_16x16x32_bf16 v[64:67], a[16:19], a[72:75], v[64:67]
ds_read_b64_tr_b16 a[88:89], v22 offset:16384
v_mfma_f32_16x16x32_bf16 v[68:71], a[20:23], a[72:75], v[68:71]
ds_read_b64_tr_b16 a[90:91], v22 offset:24576
s_add_u32 m0, s43, 114688
v_mfma_f32_16x16x32_bf16 v[72:75], a[24:27], a[72:75], v[72:75]
buffer_load_dwordx4 v12, s[52:55], s42 offen lds
v_mfma_f32_16x16x32_bf16 v[76:79], a[28:31], a[72:75], v[76:79]
s_waitcnt lgkmcnt(6)
v_mfma_f32_16x16x32_bf16 v[80:83], a[16:19], a[76:79], v[80:83]
ds_read_b64_tr_b16 a[92:93], v23 offset:16384
v_mfma_f32_16x16x32_bf16 v[84:87], a[20:23], a[76:79], v[84:87]
ds_read_b64_tr_b16 a[94:95], v23 offset:24576
v_mfma_f32_16x16x32_bf16 v[88:91], a[24:27], a[76:79], v[88:91]
v_mfma_f32_16x16x32_bf16 v[92:95], a[28:31], a[76:79], v[92:95]
s_waitcnt lgkmcnt(6)
v_mfma_f32_16x16x32_bf16 v[96:99], a[16:19], a[80:83], v[96:99]
ds_read_b64_tr_b16 a[64:65], v16 offset:16640
v_mfma_f32_16x16x32_bf16 v[100:103], a[20:23], a[80:83], v[100:103]
ds_read_b64_tr_b16 a[66:67], v16 offset:24832
buffer_load_dwordx4 a[4:7], v9, s[48:51], s41 offen sc1
v_mfma_f32_16x16x32_bf16 v[104:107], a[24:27], a[80:83], v[104:107]
v_mfma_f32_16x16x32_bf16 v[108:111], a[28:31], a[80:83], v[108:111]
s_waitcnt lgkmcnt(6)
v_mfma_f32_16x16x32_bf16 v[112:115], a[16:19], a[84:87], v[112:115]
ds_read_b64_tr_b16 a[68:69], v17 offset:16640
v_mfma_f32_16x16x32_bf16 v[116:119], a[20:23], a[84:87], v[116:119]
ds_read_b64_tr_b16 a[70:71], v17 offset:24832
v_mfma_f32_16x16x32_bf16 v[120:123], a[24:27], a[84:87], v[120:123]
v_mfma_f32_16x16x32_bf16 v[124:127], a[28:31], a[84:87], v[124:127]
s_waitcnt lgkmcnt(6)
v_mfma_f32_16x16x32_bf16 v[128:131], a[16:19], a[88:91], v[128:131]
ds_read_b64_tr_b16 a[72:73], v18 offset:16640
v_mfma_f32_16x16x32_bf16 v[132:135], a[20:23], a[88:91], v[132:135]
ds_read_b64_tr_b16 a[74:75], v18 offset:24832
s_add_u32 m0, s43, 118784
v_mfma_f32_16x16x32_bf16 v[136:139], a[24:27], a[88:91], v[136:139]
buffer_load_dwordx4 v13, s[52:55], s42 offen lds
v_mfma_f32_16x16x32_bf16 v[140:143], a[28:31], a[88:91], v[140:143]
s_waitcnt lgkmcnt(6)
v_mfma_f32_16x16x32_bf16 v[144:147], a[16:19], a[92:95], v[144:147]
ds_read_b64_tr_b16 a[76:77], v19 offset:16640
v_mfma_f32_16x16x32_bf16 v[148:151], a[20:23], a[92:95], v[148:151]
ds_read_b64_tr_b16 a[78:79], v19 offset:24832
v_mfma_f32_16x16x32_bf16 v[152:155], a[24:27], a[92:95], v[152:155]
v_mfma_f32_16x16x32_bf16 v[156:159], a[28:31], a[92:95], v[156:159]
s_waitcnt lgkmcnt(6)
v_mfma_f32_16x16x32_bf16 v[160:163], a[16:19], a[64:67], v[160:163]
ds_read_b64_tr_b16 a[80:81], v20 offset:16640
v_mfma_f32_16x16x32_bf16 v[164:167], a[20:23], a[64:67], v[164:167]
ds_read_b64_tr_b16 a[82:83], v20 offset:24832
buffer_load_dwordx4 a[8:11], v10, s[48:51], s41 offen sc1
v_mfma_f32_16x16x32_bf16 v[168:171], a[24:27], a[64:67], v[168:171]
v_mfma_f32_16x16x32_bf16 v[172:175], a[28:31], a[64:67], v[172:175]
s_waitcnt lgkmcnt(6)
v_mfma_f32_16x16x32_bf16 v[176:179], a[16:19], a[68:71], v[176:179]
ds_read_b64_tr_b16 a[84:85], v21 offset:16640
v_mfma_f32_16x16x32_bf16 v[180:183], a[20:23], a[68:71], v[180:183]
ds_read_b64_tr_b16 a[86:87], v21 offset:24832
v_mfma_f32_16x16x32_bf16 v[184:187], a[24:27], a[68:71], v[184:187]
v_mfma_f32_16x16x32_bf16 v[188:191], a[28:31], a[68:71], v[188:191]
s_waitcnt lgkmcnt(6)
v_mfma_f32_16x16x32_bf16 v[192:195], a[16:19], a[72:75], v[192:195]
ds_read_b64_tr_b16 a[88:89], v22 offset:16640
v_mfma_f32_16x16x32_bf16 v[196:199], a[20:23], a[72:75], v[196:199]
ds_read_b64_tr_b16 a[90:91], v22 offset:24832
s_add_u32 m0, s43, 122880
v_mfma_f32_16x16x32_bf16 v[200:203], a[24:27], a[72:75], v[200:203]
buffer_load_dwordx4 v14, s[52:55], s42 offen lds
v_mfma_f32_16x16x32_bf16 v[204:207], a[28:31], a[72:75], v[204:207]
s_waitcnt lgkmcnt(6)
v_mfma_f32_16x16x32_bf16 v[208:211], a[16:19], a[76:79], v[208:211]
ds_read_b64_tr_b16 a[92:93], v23 offset:16640
v_mfma_f32_16x16x32_bf16 v[212:215], a[20:23], a[76:79], v[212:215]
ds_read_b64_tr_b16 a[94:95], v23 offset:24832
v_mfma_f32_16x16x32_bf16 v[216:219], a[24:27], a[76:79], v[216:219]
v_mfma_f32_16x16x32_bf16 v[220:223], a[28:31], a[76:79], v[220:223]
s_waitcnt lgkmcnt(6)
v_mfma_f32_16x16x32_bf16 v[224:227], a[16:19], a[80:83], v[224:227]
s_waitcnt vmcnt(14)
s_barrier
ds_read_b64_tr_b16 a[64:65], v16 offset:32768
v_mfma_f32_16x16x32_bf16 v[228:231], a[20:23], a[80:83], v[228:231]
ds_read_b64_tr_b16 a[66:67], v16 offset:40960
buffer_load_dwordx4 a[12:15], v11, s[48:51], s41 offen sc1
s_add_u32 s41, s41, 1024
v_mfma_f32_16x16x32_bf16 v[232:235], a[24:27], a[80:83], v[232:235]
v_mfma_f32_16x16x32_bf16 v[236:239], a[28:31], a[80:83], v[236:239]
s_waitcnt lgkmcnt(6)
v_mfma_f32_16x16x32_bf16 v[240:243], a[16:19], a[84:87], v[240:243]
ds_read_b64_tr_b16 a[68:69], v17 offset:32768
v_mfma_f32_16x16x32_bf16 v[244:247], a[20:23], a[84:87], v[244:247]
ds_read_b64_tr_b16 a[70:71], v17 offset:40960
v_mfma_f32_16x16x32_bf16 v[248:251], a[24:27], a[84:87], v[248:251]
v_mfma_f32_16x16x32_bf16 v[252:255], a[28:31], a[84:87], v[252:255]
s_waitcnt lgkmcnt(6)
v_mfma_f32_16x16x32_bf16 a[96:99], a[16:19], a[88:91], a[96:99]
ds_read_b64_tr_b16 a[72:73], v18 offset:32768
v_mfma_f32_16x16x32_bf16 a[100:103], a[20:23], a[88:91], a[100:103]
ds_read_b64_tr_b16 a[74:75], v18 offset:40960
s_add_u32 m0, s43, 126976
v_mfma_f32_16x16x32_bf16 a[104:107], a[24:27], a[88:91], a[104:107]
buffer_load_dwordx4 v15, s[52:55], s42 offen lds
s_add_u32 s42, s42, 196608
v_mfma_f32_16x16x32_bf16 a[108:111], a[28:31], a[88:91], a[108:111]
s_waitcnt lgkmcnt(6)
v_mfma_f32_16x16x32_bf16 a[112:115], a[16:19], a[92:95], a[112:115]
ds_read_b64_tr_b16 a[76:77], v19 offset:32768
v_mfma_f32_16x16x32_bf16 a[116:119], a[20:23], a[92:95], a[116:119]
ds_read_b64_tr_b16 a[78:79], v19 offset:40960
v_mfma_f32_16x16x32_bf16 a[120:123], a[24:27], a[92:95], a[120:123]
v_mfma_f32_16x16x32_bf16 a[124:127], a[28:31], a[92:95], a[124:127]
s_waitcnt lgkmcnt(6)
v_mfma_f32_16x16x32_bf16 v[32:35], a[32:35], a[64:67], v[32:35]
ds_read_b64_tr_b16 a[80:81], v20 offset:32768
v_mfma_f32_16x16x32_bf16 v[36:39], a[36:39], a[64:67], v[36:39]
ds_read_b64_tr_b16 a[82:83], v20 offset:40960
buffer_load_dwordx4 a[16:19], v8, s[48:51], s41 offen sc1
v_mfma_f32_16x16x32_bf16 v[40:43], a[40:43], a[64:67], v[40:43]
v_mfma_f32_16x16x32_bf16 v[44:47], a[44:47], a[64:67], v[44:47]
s_waitcnt lgkmcnt(6)
v_mfma_f32_16x16x32_bf16 v[48:51], a[32:35], a[68:71], v[48:51]
ds_read_b64_tr_b16 a[84:85], v21 offset:32768
v_mfma_f32_16x16x32_bf16 v[52:55], a[36:39], a[68:71], v[52:55]
ds_read_b64_tr_b16 a[86:87], v21 offset:40960
v_mfma_f32_16x16x32_bf16 v[56:59], a[40:43], a[68:71], v[56:59]
v_mfma_f32_16x16x32_bf16 v[60:63], a[44:47], a[68:71], v[60:63]
s_waitcnt lgkmcnt(6)
v_mfma_f32_16x16x32_bf16 v[64:67], a[32:35], a[72:75], v[64:67]
ds_read_b64_tr_b16 a[88:89], v22 offset:32768
v_mfma_f32_16x16x32_bf16 v[68:71], a[36:39], a[72:75], v[68:71]
ds_read_b64_tr_b16 a[90:91], v22 offset:40960
s_add_u32 m0, s43, 0
v_mfma_f32_16x16x32_bf16 v[72:75], a[40:43], a[72:75], v[72:75]
buffer_load_dwordx4 v12, s[52:55], s42 offen lds
v_mfma_f32_16x16x32_bf16 v[76:79], a[44:47], a[72:75], v[76:79]
s_waitcnt lgkmcnt(6)
v_mfma_f32_16x16x32_bf16 v[80:83], a[32:35], a[76:79], v[80:83]
ds_read_b64_tr_b16 a[92:93], v23 offset:32768
v_mfma_f32_16x16x32_bf16 v[84:87], a[36:39], a[76:79], v[84:87]
ds_read_b64_tr_b16 a[94:95], v23 offset:40960
v_mfma_f32_16x16x32_bf16 v[88:91], a[40:43], a[76:79], v[88:91]
v_mfma_f32_16x16x32_bf16 v[92:95], a[44:47], a[76:79], v[92:95]
s_waitcnt lgkmcnt(6)
v_mfma_f32_16x16x32_bf16 v[96:99], a[32:35], a[80:83], v[96:99]
ds_read_b64_tr_b16 a[64:65], v16 offset:33024
v_mfma_f32_16x16x32_bf16 v[100:103], a[36:39], a[80:83], v[100:103]
ds_read_b64_tr_b16 a[66:67], v16 offset:41216
buffer_load_dwordx4 a[20:23], v9, s[48:51], s41 offen sc1
v_mfma_f32_16x16x32_bf16 v[104:107], a[40:43], a[80:83], v[104:107]
v_mfma_f32_16x16x32_bf16 v[108:111], a[44:47], a[80:83], v[108:111]
s_waitcnt lgkmcnt(6)
v_mfma_f32_16x16x32_bf16 v[112:115], a[32:35], a[84:87], v[112:115]
ds_read_b64_tr_b16 a[68:69], v17 offset:33024
v_mfma_f32_16x16x32_bf16 v[116:119], a[36:39], a[84:87], v[116:119]
ds_read_b64_tr_b16 a[70:71], v17 offset:41216
v_mfma_f32_16x16x32_bf16 v[120:123], a[40:43], a[84:87], v[120:123]
v_mfma_f32_16x16x32_bf16 v[124:127], a[44:47], a[84:87], v[124:127]
s_waitcnt lgkmcnt(6)
v_mfma_f32_16x16x32_bf16 v[128:131], a[32:35], a[88:91], v[128:131]
ds_read_b64_tr_b16 a[72:73], v18 offset:33024
v_mfma_f32_16x16x32_bf16 v[132:135], a[36:39], a[88:91], v[132:135]
ds_read_b64_tr_b16 a[74:75], v18 offset:41216
s_add_u32 m0, s43, 4096
v_mfma_f32_16x16x32_bf16 v[136:139], a[40:43], a[88:91], v[136:139]
buffer_load_dwordx4 v13, s[52:55], s42 offen lds
v_mfma_f32_16x16x32_bf16 v[140:143], a[44:47], a[88:91], v[140:143]
s_waitcnt lgkmcnt(6)
v_mfma_f32_16x16x32_bf16 v[144:147], a[32:35], a[92:95], v[144:147]
ds_read_b64_tr_b16 a[76:77], v19 offset:33024
v_mfma_f32_16x16x32_bf16 v[148:151], a[36:39], a[92:95], v[148:151]
ds_read_b64_tr_b16 a[78:79], v19 offset:41216
v_mfma_f32_16x16x32_bf16 v[152:155], a[40:43], a[92:95], v[152:155]
v_mfma_f32_16x16x32_bf16 v[156:159], a[44:47], a[92:95], v[156:159]
s_waitcnt lgkmcnt(6)
v_mfma_f32_16x16x32_bf16 v[160:163], a[32:35], a[64:67], v[160:163]
ds_read_b64_tr_b16 a[80:81], v20 offset:33024
v_mfma_f32_16x16x32_bf16 v[164:167], a[36:39], a[64:67], v[164:167]
ds_read_b64_tr_b16 a[82:83], v20 offset:41216
buffer_load_dwordx4 a[24:27], v10, s[48:51], s41 offen sc1
v_mfma_f32_16x16x32_bf16 v[168:171], a[40:43], a[64:67], v[168:171]
v_mfma_f32_16x16x32_bf16 v[172:175], a[44:47], a[64:67], v[172:175]
s_waitcnt lgkmcnt(6)
v_mfma_f32_16x16x32_bf16 v[176:179], a[32:35], a[68:71], v[176:179]
ds_read_b64_tr_b16 a[84:85], v21 offset:33024
v_mfma_f32_16x16x32_bf16 v[180:183], a[36:39], a[68:71], v[180:183]
ds_read_b64_tr_b16 a[86:87], v21 offset:41216
v_mfma_f32_16x16x32_bf16 v[184:187], a[40:43], a[68:71], v[184:187]
v_mfma_f32_16x16x32_bf16 v[188:191], a[44:47], a[68:71], v[188:191]
s_waitcnt lgkmcnt(6)
v_mfma_f32_16x16x32_bf16 v[192:195], a[32:35], a[72:75], v[192:195]
ds_read_b64_tr_b16 a[88:89], v22 offset:33024
v_mfma_f32_16x16x32_bf16 v[196:199], a[36:39], a[72:75], v[196:199]
ds_read_b64_tr_b16 a[90:91], v22 offset:41216
s_add_u32 m0, s43, 8192
v_mfma_f32_16x16x32_bf16 v[200:203], a[40:43], a[72:75], v[200:203]
buffer_load_dwordx4 v14, s[52:55], s42 offen lds
v_mfma_f32_16x16x32_bf16 v[204:207], a[44:47], a[72:75], v[204:207]
s_waitcnt lgkmcnt(6)
v_mfma_f32_16x16x32_bf16 v[208:211], a[32:35], a[76:79], v[208:211]
ds_read_b64_tr_b16 a[92:93], v23 offset:33024
v_mfma_f32_16x16x32_bf16 v[212:215], a[36:39], a[76:79], v[212:215]
ds_read_b64_tr_b16 a[94:95], v23 offset:41216
v_mfma_f32_16x16x32_bf16 v[216:219], a[40:43], a[76:79], v[216:219]
v_mfma_f32_16x16x32_bf16 v[220:223], a[44:47], a[76:79], v[220:223]
s_waitcnt lgkmcnt(6)
v_mfma_f32_16x16x32_bf16 v[224:227], a[32:35], a[80:83], v[224:227]
s_waitcnt vmcnt(15)
s_barrier
ds_read_b64_tr_b16 a[64:65], v16 offset:49152
v_mfma_f32_16x16x32_bf16 v[228:231], a[36:39], a[80:83], v[228:231]
ds_read_b64_tr_b16 a[66:67], v16 offset:57344
buffer_load_dwordx4 a[28:31], v11, s[48:51], s41 offen sc1
s_add_u32 s41, s41, 1024
v_mfma_f32_16x16x32_bf16 v[232:235], a[40:43], a[80:83], v[232:235]
v_mfma_f32_16x16x32_bf16 v[236:239], a[44:47], a[80:83], v[236:239]
s_waitcnt lgkmcnt(6)
v_mfma_f32_16x16x32_bf16 v[240:243], a[32:35], a[84:87], v[240:243]
ds_read_b64_tr_b16 a[68:69], v17 offset:49152
v_mfma_f32_16x16x32_bf16 v[244:247], a[36:39], a[84:87], v[244:247]
ds_read_b64_tr_b16 a[70:71], v17 offset:57344
v_mfma_f32_16x16x32_bf16 v[248:251], a[40:43], a[84:87], v[248:251]
v_mfma_f32_16x16x32_bf16 v[252:255], a[44:47], a[84:87], v[252:255]
s_waitcnt lgkmcnt(6)
v_mfma_f32_16x16x32_bf16 a[96:99], a[32:35], a[88:91], a[96:99]
ds_read_b64_tr_b16 a[72:73], v18 offset:49152
v_mfma_f32_16x16x32_bf16 a[100:103], a[36:39], a[88:91], a[100:103]
ds_read_b64_tr_b16 a[74:75], v18 offset:57344
s_add_u32 m0, s43, 12288
v_mfma_f32_16x16x32_bf16 a[104:107], a[40:43], a[88:91], a[104:107]
buffer_load_dwordx4 v15, s[52:55], s42 offen lds
s_add_u32 s42, s42, 196608
v_mfma_f32_16x16x32_bf16 a[108:111], a[44:47], a[88:91], a[108:111]
s_waitcnt lgkmcnt(6)
v_mfma_f32_16x16x32_bf16 a[112:115], a[32:35], a[92:95], a[112:115]
ds_read_b64_tr_b16 a[76:77], v19 offset:49152
v_mfma_f32_16x16x32_bf16 a[116:119], a[36:39], a[92:95], a[116:119]
ds_read_b64_tr_b16 a[78:79], v19 offset:57344
v_mfma_f32_16x16x32_bf16 a[120:123], a[40:43], a[92:95], a[120:123]
v_mfma_f32_16x16x32_bf16 a[124:127], a[44:47], a[92:95], a[124:127]
s_waitcnt lgkmcnt(6)
v_mfma_f32_16x16x32_bf16 v[32:35], a[48:51], a[64:67], v[32:35]
ds_read_b64_tr_b16 a[80:81], v20 offset:49152
v_mfma_f32_16x16x32_bf16 v[36:39], a[52:55], a[64:67], v[36:39]
ds_read_b64_tr_b16 a[82:83], v20 offset:57344
buffer_load_dwordx4 a[32:35], v8, s[48:51], s41 offen sc1
v_mfma_f32_16x16x32_bf16 v[40:43], a[56:59], a[64:67], v[40:43]
v_mfma_f32_16x16x32_bf16 v[44:47], a[60:63], a[64:67], v[44:47]
s_waitcnt lgkmcnt(6)
v_mfma_f32_16x16x32_bf16 v[48:51], a[48:51], a[68:71], v[48:51]
ds_read_b64_tr_b16 a[84:85], v21 offset:49152
v_mfma_f32_16x16x32_bf16 v[52:55], a[52:55], a[68:71], v[52:55]
ds_read_b64_tr_b16 a[86:87], v21 offset:57344
v_mfma_f32_16x16x32_bf16 v[56:59], a[56:59], a[68:71], v[56:59]
v_mfma_f32_16x16x32_bf16 v[60:63], a[60:63], a[68:71], v[60:63]
s_waitcnt lgkmcnt(6)
v_mfma_f32_16x16x32_bf16 v[64:67], a[48:51], a[72:75], v[64:67]
ds_read_b64_tr_b16 a[88:89], v22 offset:49152
v_mfma_f32_16x16x32_bf16 v[68:71], a[52:55], a[72:75], v[68:71]
ds_read_b64_tr_b16 a[90:91], v22 offset:57344
s_add_u32 m0, s43, 16384
v_mfma_f32_16x16x32_bf16 v[72:75], a[56:59], a[72:75], v[72:75]
buffer_load_dwordx4 v12, s[52:55], s42 offen lds
v_mfma_f32_16x16x32_bf16 v[76:79], a[60:63], a[72:75], v[76:79]
s_waitcnt lgkmcnt(6)
v_mfma_f32_16x16x32_bf16 v[80:83], a[48:51], a[76:79], v[80:83]
ds_read_b64_tr_b16 a[92:93], v23 offset:49152
v_mfma_f32_16x16x32_bf16 v[84:87], a[52:55], a[76:79], v[84:87]
ds_read_b64_tr_b16 a[94:95], v23 offset:57344
v_mfma_f32_16x16x32_bf16 v[88:91], a[56:59], a[76:79], v[88:91]
v_mfma_f32_16x16x32_bf16 v[92:95], a[60:63], a[76:79], v[92:95]
s_waitcnt lgkmcnt(6)
v_mfma_f32_16x16x32_bf16 v[96:99], a[48:51], a[80:83], v[96:99]
ds_read_b64_tr_b16 a[64:65], v16 offset:49408
v_mfma_f32_16x16x32_bf16 v[100:103], a[52:55], a[80:83], v[100:103]
ds_read_b64_tr_b16 a[66:67], v16 offset:57600
buffer_load_dwordx4 a[36:39], v9, s[48:51], s41 offen sc1
v_mfma_f32_16x16x32_bf16 v[104:107], a[56:59], a[80:83], v[104:107]
v_mfma_f32_16x16x32_bf16 v[108:111], a[60:63], a[80:83], v[108:111]
s_waitcnt lgkmcnt(6)
v_mfma_f32_16x16x32_bf16 v[112:115], a[48:51], a[84:87], v[112:115]
ds_read_b64_tr_b16 a[68:69], v17 offset:49408
v_mfma_f32_16x16x32_bf16 v[116:119], a[52:55], a[84:87], v[116:119]
ds_read_b64_tr_b16 a[70:71], v17 offset:57600
v_mfma_f32_16x16x32_bf16 v[120:123], a[56:59], a[84:87], v[120:123]
v_mfma_f32_16x16x32_bf16 v[124:127], a[60:63], a[84:87], v[124:127]
s_waitcnt lgkmcnt(6)
v_mfma_f32_16x16x32_bf16 v[128:131], a[48:51], a[88:91], v[128:131]
ds_read_b64_tr_b16 a[72:73], v18 offset:49408
v_mfma_f32_16x16x32_bf16 v[132:135], a[52:55], a[88:91], v[132:135]
ds_read_b64_tr_b16 a[74:75], v18 offset:57600
s_add_u32 m0, s43, 20480
v_mfma_f32_16x16x32_bf16 v[136:139], a[56:59], a[88:91], v[136:139]
buffer_load_dwordx4 v13, s[52:55], s42 offen lds
v_mfma_f32_16x16x32_bf16 v[140:143], a[60:63], a[88:91], v[140:143]
s_waitcnt lgkmcnt(6)
v_mfma_f32_16x16x32_bf16 v[144:147], a[48:51], a[92:95], v[144:147]
ds_read_b64_tr_b16 a[76:77], v19 offset:49408
v_mfma_f32_16x16x32_bf16 v[148:151], a[52:55], a[92:95], v[148:151]
ds_read_b64_tr_b16 a[78:79], v19 offset:57600
v_mfma_f32_16x16x32_bf16 v[152:155], a[56:59], a[92:95], v[152:155]
v_mfma_f32_16x16x32_bf16 v[156:159], a[60:63], a[92:95], v[156:159]
s_waitcnt lgkmcnt(6)
v_mfma_f32_16x16x32_bf16 v[160:163], a[48:51], a[64:67], v[160:163]
ds_read_b64_tr_b16 a[80:81], v20 offset:49408
v_mfma_f32_16x16x32_bf16 v[164:167], a[52:55], a[64:67], v[164:167]
ds_read_b64_tr_b16 a[82:83], v20 offset:57600
buffer_load_dwordx4 a[40:43], v10, s[48:51], s41 offen sc1
v_mfma_f32_16x16x32_bf16 v[168:171], a[56:59], a[64:67], v[168:171]
v_mfma_f32_16x16x32_bf16 v[172:175], a[60:63], a[64:67], v[172:175]
s_waitcnt lgkmcnt(6)
v_mfma_f32_16x16x32_bf16 v[176:179], a[48:51], a[68:71], v[176:179]
ds_read_b64_tr_b16 a[84:85], v21 offset:49408
v_mfma_f32_16x16x32_bf16 v[180:183], a[52:55], a[68:71], v[180:183]
ds_read_b64_tr_b16 a[86:87], v21 offset:57600
v_mfma_f32_16x16x32_bf16 v[184:187], a[56:59], a[68:71], v[184:187]
v_mfma_f32_16x16x32_bf16 v[188:191], a[60:63], a[68:71], v[188:191]
s_waitcnt lgkmcnt(6)
v_mfma_f32_16x16x32_bf16 v[192:195], a[48:51], a[72:75], v[192:195]
ds_read_b64_tr_b16 a[88:89], v22 offset:49408
v_mfma_f32_16x16x32_bf16 v[196:199], a[52:55], a[72:75], v[196:199]
ds_read_b64_tr_b16 a[90:91], v22 offset:57600
s_add_u32 m0, s43, 24576
v_mfma_f32_16x16x32_bf16 v[200:203], a[56:59], a[72:75], v[200:203]
buffer_load_dwordx4 v14, s[52:55], s42 offen lds
v_mfma_f32_16x16x32_bf16 v[204:207], a[60:63], a[72:75], v[204:207]
s_waitcnt lgkmcnt(6)
v_mfma_f32_16x16x32_bf16 v[208:211], a[48:51], a[76:79], v[208:211]
ds_read_b64_tr_b16 a[92:93], v23 offset:49408
v_mfma_f32_16x16x32_bf16 v[212:215], a[52:55], a[76:79], v[212:215]
ds_read_b64_tr_b16 a[94:95], v23 offset:57600
v_mfma_f32_16x16x32_bf16 v[216:219], a[56:59], a[76:79], v[216:219]
v_mfma_f32_16x16x32_bf16 v[220:223], a[60:63], a[76:79], v[220:223]
s_waitcnt lgkmcnt(6)
v_mfma_f32_16x16x32_bf16 v[224:227], a[48:51], a[80:83], v[224:227]
s_waitcnt vmcnt(15)
s_barrier
ds_read_b64_tr_b16 a[64:65], v24 offset:0
v_mfma_f32_16x16x32_bf16 v[228:231], a[52:55], a[80:83], v[228:231]
ds_read_b64_tr_b16 a[66:67], v24 offset:8192
buffer_load_dwordx4 a[44:47], v11, s[48:51], s41 offen sc1
s_add_u32 s41, s41, 1024
v_mfma_f32_16x16x32_bf16 v[232:235], a[56:59], a[80:83], v[232:235]
v_mfma_f32_16x16x32_bf16 v[236:239], a[60:63], a[80:83], v[236:239]
s_waitcnt lgkmcnt(6)
v_mfma_f32_16x16x32_bf16 v[240:243], a[48:51], a[84:87], v[240:243]
ds_read_b64_tr_b16 a[68:69], v25 offset:0
v_mfma_f32_16x16x32_bf16 v[244:247], a[52:55], a[84:87], v[244:247]
ds_read_b64_tr_b16 a[70:71], v25 offset:8192
v_mfma_f32_16x16x32_bf16 v[248:251], a[56:59], a[84:87], v[248:251]
v_mfma_f32_16x16x32_bf16 v[252:255], a[60:63], a[84:87], v[252:255]
s_waitcnt lgkmcnt(6)
v_mfma_f32_16x16x32_bf16 a[96:99], a[48:51], a[88:91], a[96:99]
ds_read_b64_tr_b16 a[72:73], v26 offset:0
v_mfma_f32_16x16x32_bf16 a[100:103], a[52:55], a[88:91], a[100:103]
ds_read_b64_tr_b16 a[74:75], v26 offset:8192
s_add_u32 m0, s43, 28672
v_mfma_f32_16x16x32_bf16 a[104:107], a[56:59], a[88:91], a[104:107]
buffer_load_dwordx4 v15, s[52:55], s42 offen lds
s_add_u32 s42, s42, 196608
v_mfma_f32_16x16x32_bf16 a[108:111], a[60:63], a[88:91], a[108:111]
s_waitcnt lgkmcnt(6)
v_mfma_f32_16x16x32_bf16 a[112:115], a[48:51], a[92:95], a[112:115]
ds_read_b64_tr_b16 a[76:77], v27 offset:0
v_mfma_f32_16x16x32_bf16 a[116:119], a[52:55], a[92:95], a[116:119]
ds_read_b64_tr_b16 a[78:79], v27 offset:8192
v_mfma_f32_16x16x32_bf16 a[120:123], a[56:59], a[92:95], a[120:123]
v_mfma_f32_16x16x32_bf16 a[124:127], a[60:63], a[92:95], a[124:127]
s_waitcnt lgkmcnt(6)
v_mfma_f32_16x16x32_bf16 v[32:35], a[0:3], a[64:67], v[32:35]
ds_read_b64_tr_b16 a[80:81], v28 offset:0
v_mfma_f32_16x16x32_bf16 v[36:39], a[4:7], a[64:67], v[36:39]
ds_read_b64_tr_b16 a[82:83], v28 offset:8192
buffer_load_dwordx4 a[48:51], v8, s[48:51], s41 offen sc1
v_mfma_f32_16x16x32_bf16 v[40:43], a[8:11], a[64:67], v[40:43]
v_mfma_f32_16x16x32_bf16 v[44:47], a[12:15], a[64:67], v[44:47]
s_waitcnt lgkmcnt(6)
v_mfma_f32_16x16x32_bf16 v[48:51], a[0:3], a[68:71], v[48:51]
ds_read_b64_tr_b16 a[84:85], v29 offset:0
v_mfma_f32_16x16x32_bf16 v[52:55], a[4:7], a[68:71], v[52:55]
ds_read_b64_tr_b16 a[86:87], v29 offset:8192
v_mfma_f32_16x16x32_bf16 v[56:59], a[8:11], a[68:71], v[56:59]
v_mfma_f32_16x16x32_bf16 v[60:63], a[12:15], a[68:71], v[60:63]
s_waitcnt lgkmcnt(6)
v_mfma_f32_16x16x32_bf16 v[64:67], a[0:3], a[72:75], v[64:67]
ds_read_b64_tr_b16 a[88:89], v30 offset:0
v_mfma_f32_16x16x32_bf16 v[68:71], a[4:7], a[72:75], v[68:71]
ds_read_b64_tr_b16 a[90:91], v30 offset:8192
s_add_u32 m0, s43, 32768
v_mfma_f32_16x16x32_bf16 v[72:75], a[8:11], a[72:75], v[72:75]
buffer_load_dwordx4 v12, s[52:55], s42 offen lds
v_mfma_f32_16x16x32_bf16 v[76:79], a[12:15], a[72:75], v[76:79]
s_waitcnt lgkmcnt(6)
v_mfma_f32_16x16x32_bf16 v[80:83], a[0:3], a[76:79], v[80:83]
ds_read_b64_tr_b16 a[92:93], v31 offset:0
v_mfma_f32_16x16x32_bf16 v[84:87], a[4:7], a[76:79], v[84:87]
ds_read_b64_tr_b16 a[94:95], v31 offset:8192
v_mfma_f32_16x16x32_bf16 v[88:91], a[8:11], a[76:79], v[88:91]
v_mfma_f32_16x16x32_bf16 v[92:95], a[12:15], a[76:79], v[92:95]
s_waitcnt lgkmcnt(6)
v_mfma_f32_16x16x32_bf16 v[96:99], a[0:3], a[80:83], v[96:99]
ds_read_b64_tr_b16 a[64:65], v24 offset:256
v_mfma_f32_16x16x32_bf16 v[100:103], a[4:7], a[80:83], v[100:103]
ds_read_b64_tr_b16 a[66:67], v24 offset:8448
buffer_load_dwordx4 a[52:55], v9, s[48:51], s41 offen sc1
v_mfma_f32_16x16x32_bf16 v[104:107], a[8:11], a[80:83], v[104:107]
v_mfma_f32_16x16x32_bf16 v[108:111], a[12:15], a[80:83], v[108:111]
s_waitcnt lgkmcnt(6)
v_mfma_f32_16x16x32_bf16 v[112:115], a[0:3], a[84:87], v[112:115]
ds_read_b64_tr_b16 a[68:69], v25 offset:256
v_mfma_f32_16x16x32_bf16 v[116:119], a[4:7], a[84:87], v[116:119]
ds_read_b64_tr_b16 a[70:71], v25 offset:8448
v_mfma_f32_16x16x32_bf16 v[120:123], a[8:11], a[84:87], v[120:123]
v_mfma_f32_16x16x32_bf16 v[124:127], a[12:15], a[84:87], v[124:127]
s_waitcnt lgkmcnt(6)
v_mfma_f32_16x16x32_bf16 v[128:131], a[0:3], a[88:91], v[128:131]
ds_read_b64_tr_b16 a[72:73], v26 offset:256
v_mfma_f32_16x16x32_bf16 v[132:135], a[4:7], a[88:91], v[132:135]
ds_read_b64_tr_b16 a[74:75], v26 offset:8448
s_add_u32 m0, s43, 36864
v_mfma_f32_16x16x32_bf16 v[136:139], a[8:11], a[88:91], v[136:139]
buffer_load_dwordx4 v13, s[52:55], s42 offen lds
v_mfma_f32_16x16x32_bf16 v[140:143], a[12:15], a[88:91], v[140:143]
s_waitcnt lgkmcnt(6)
v_mfma_f32_16x16x32_bf16 v[144:147], a[0:3], a[92:95], v[144:147]
ds_read_b64_tr_b16 a[76:77], v27 offset:256
v_mfma_f32_16x16x32_bf16 v[148:151], a[4:7], a[92:95], v[148:151]
ds_read_b64_tr_b16 a[78:79], v27 offset:8448
v_mfma_f32_16x16x32_bf16 v[152:155], a[8:11], a[92:95], v[152:155]
v_mfma_f32_16x16x32_bf16 v[156:159], a[12:15], a[92:95], v[156:159]
s_waitcnt lgkmcnt(6)
v_mfma_f32_16x16x32_bf16 v[160:163], a[0:3], a[64:67], v[160:163]
ds_read_b64_tr_b16 a[80:81], v28 offset:256
v_mfma_f32_16x16x32_bf16 v[164:167], a[4:7], a[64:67], v[164:167]
ds_read_b64_tr_b16 a[82:83], v28 offset:8448
buffer_load_dwordx4 a[56:59], v10, s[48:51], s41 offen sc1
v_mfma_f32_16x16x32_bf16 v[168:171], a[8:11], a[64:67], v[168:171]
v_mfma_f32_16x16x32_bf16 v[172:175], a[12:15], a[64:67], v[172:175]
s_waitcnt lgkmcnt(6)
v_mfma_f32_16x16x32_bf16 v[176:179], a[0:3], a[68:71], v[176:179]
ds_read_b64_tr_b16 a[84:85], v29 offset:256
v_mfma_f32_16x16x32_bf16 v[180:183], a[4:7], a[68:71], v[180:183]
ds_read_b64_tr_b16 a[86:87], v29 offset:8448
v_mfma_f32_16x16x32_bf16 v[184:187], a[8:11], a[68:71], v[184:187]
v_mfma_f32_16x16x32_bf16 v[188:191], a[12:15], a[68:71], v[188:191]
s_waitcnt lgkmcnt(6)
v_mfma_f32_16x16x32_bf16 v[192:195], a[0:3], a[72:75], v[192:195]
ds_read_b64_tr_b16 a[88:89], v30 offset:256
v_mfma_f32_16x16x32_bf16 v[196:199], a[4:7], a[72:75], v[196:199]
ds_read_b64_tr_b16 a[90:91], v30 offset:8448
s_add_u32 m0, s43, 40960
v_mfma_f32_16x16x32_bf16 v[200:203], a[8:11], a[72:75], v[200:203]
buffer_load_dwordx4 v14, s[52:55], s42 offen lds
v_mfma_f32_16x16x32_bf16 v[204:207], a[12:15], a[72:75], v[204:207]
s_waitcnt lgkmcnt(6)
v_mfma_f32_16x16x32_bf16 v[208:211], a[0:3], a[76:79], v[208:211]
ds_read_b64_tr_b16 a[92:93], v31 offset:256
v_mfma_f32_16x16x32_bf16 v[212:215], a[4:7], a[76:79], v[212:215]
ds_read_b64_tr_b16 a[94:95], v31 offset:8448
v_mfma_f32_16x16x32_bf16 v[216:219], a[8:11], a[76:79], v[216:219]
v_mfma_f32_16x16x32_bf16 v[220:223], a[12:15], a[76:79], v[220:223]
s_waitcnt lgkmcnt(6)
v_mfma_f32_16x16x32_bf16 v[224:227], a[0:3], a[80:83], v[224:227]
s_waitcnt vmcnt(15)
s_barrier
ds_read_b64_tr_b16 a[64:65], v24 offset:16384
v_mfma_f32_16x16x32_bf16 v[228:231], a[4:7], a[80:83], v[228:231]
ds_read_b64_tr_b16 a[66:67], v24 offset:24576
buffer_load_dwordx4 a[60:63], v11, s[48:51], s41 offen sc1
s_add_u32 s41, s41, 1024
v_mfma_f32_16x16x32_bf16 v[232:235], a[8:11], a[80:83], v[232:235]
v_mfma_f32_16x16x32_bf16 v[236:239], a[12:15], a[80:83], v[236:239]
s_waitcnt lgkmcnt(6)
v_mfma_f32_16x16x32_bf16 v[240:243], a[0:3], a[84:87], v[240:243]
ds_read_b64_tr_b16 a[68:69], v25 offset:16384
v_mfma_f32_16x16x32_bf16 v[244:247], a[4:7], a[84:87], v[244:247]
ds_read_b64_tr_b16 a[70:71], v25 offset:24576
v_mfma_f32_16x16x32_bf16 v[248:251], a[8:11], a[84:87], v[248:251]
v_mfma_f32_16x16x32_bf16 v[252:255], a[12:15], a[84:87], v[252:255]
s_waitcnt lgkmcnt(6)
v_mfma_f32_16x16x32_bf16 a[96:99], a[0:3], a[88:91], a[96:99]
ds_read_b64_tr_b16 a[72:73], v26 offset:16384
v_mfma_f32_16x16x32_bf16 a[100:103], a[4:7], a[88:91], a[100:103]
ds_read_b64_tr_b16 a[74:75], v26 offset:24576
s_add_u32 m0, s43, 45056
v_mfma_f32_16x16x32_bf16 a[104:107], a[8:11], a[88:91], a[104:107]
buffer_load_dwordx4 v15, s[52:55], s42 offen lds
s_add_u32 s42, s42, 196608
v_mfma_f32_16x16x32_bf16 a[108:111], a[12:15], a[88:91], a[108:111]
s_waitcnt lgkmcnt(6)
v_mfma_f32_16x16x32_bf16 a[112:115], a[0:3], a[92:95], a[112:115]
ds_read_b64_tr_b16 a[76:77], v27 offset:16384
v_mfma_f32_16x16x32_bf16 a[116:119], a[4:7], a[92:95], a[116:119]
ds_read_b64_tr_b16 a[78:79], v27 offset:24576
v_mfma_f32_16x16x32_bf16 a[120:123], a[8:11], a[92:95], a[120:123]
v_mfma_f32_16x16x32_bf16 a[124:127], a[12:15], a[92:95], a[124:127]
s_waitcnt lgkmcnt(6)
v_mfma_f32_16x16x32_bf16 v[32:35], a[16:19], a[64:67], v[32:35]
ds_read_b64_tr_b16 a[80:81], v28 offset:16384
v_mfma_f32_16x16x32_bf16 v[36:39], a[20:23], a[64:67], v[36:39]
ds_read_b64_tr_b16 a[82:83], v28 offset:24576
buffer_load_dwordx4 a[0:3], v8, s[48:51], s41 offen sc1
v_mfma_f32_16x16x32_bf16 v[40:43], a[24:27], a[64:67], v[40:43]
v_mfma_f32_16x16x32_bf16 v[44:47], a[28:31], a[64:67], v[44:47]
s_waitcnt lgkmcnt(6)
v_mfma_f32_16x16x32_bf16 v[48:51], a[16:19], a[68:71], v[48:51]
ds_read_b64_tr_b16 a[84:85], v29 offset:16384
v_mfma_f32_16x16x32_bf16 v[52:55], a[20:23], a[68:71], v[52:55]
ds_read_b64_tr_b16 a[86:87], v29 offset:24576
v_mfma_f32_16x16x32_bf16 v[56:59], a[24:27], a[68:71], v[56:59]
v_mfma_f32_16x16x32_bf16 v[60:63], a[28:31], a[68:71], v[60:63]
s_waitcnt lgkmcnt(6)
v_mfma_f32_16x16x32_bf16 v[64:67], a[16:19], a[72:75], v[64:67]
ds_read_b64_tr_b16 a[88:89], v30 offset:16384
v_mfma_f32_16x16x32_bf16 v[68:71], a[20:23], a[72:75], v[68:71]
ds_read_b64_tr_b16 a[90:91], v30 offset:24576
s_add_u32 m0, s43, 49152
v_mfma_f32_16x16x32_bf16 v[72:75], a[24:27], a[72:75], v[72:75]
buffer_load_dwordx4 v12, s[52:55], s42 offen lds
v_mfma_f32_16x16x32_bf16 v[76:79], a[28:31], a[72:75], v[76:79]
s_waitcnt lgkmcnt(6)
v_mfma_f32_16x16x32_bf16 v[80:83], a[16:19], a[76:79], v[80:83]
ds_read_b64_tr_b16 a[92:93], v31 offset:16384
v_mfma_f32_16x16x32_bf16 v[84:87], a[20:23], a[76:79], v[84:87]
ds_read_b64_tr_b16 a[94:95], v31 offset:24576
v_mfma_f32_16x16x32_bf16 v[88:91], a[24:27], a[76:79], v[88:91]
v_mfma_f32_16x16x32_bf16 v[92:95], a[28:31], a[76:79], v[92:95]
s_waitcnt lgkmcnt(6)
v_mfma_f32_16x16x32_bf16 v[96:99], a[16:19], a[80:83], v[96:99]
ds_read_b64_tr_b16 a[64:65], v24 offset:16640
v_mfma_f32_16x16x32_bf16 v[100:103], a[20:23], a[80:83], v[100:103]
ds_read_b64_tr_b16 a[66:67], v24 offset:24832
buffer_load_dwordx4 a[4:7], v9, s[48:51], s41 offen sc1
v_mfma_f32_16x16x32_bf16 v[104:107], a[24:27], a[80:83], v[104:107]
v_mfma_f32_16x16x32_bf16 v[108:111], a[28:31], a[80:83], v[108:111]
s_waitcnt lgkmcnt(6)
v_mfma_f32_16x16x32_bf16 v[112:115], a[16:19], a[84:87], v[112:115]
ds_read_b64_tr_b16 a[68:69], v25 offset:16640
v_mfma_f32_16x16x32_bf16 v[116:119], a[20:23], a[84:87], v[116:119]
ds_read_b64_tr_b16 a[70:71], v25 offset:24832
v_mfma_f32_16x16x32_bf16 v[120:123], a[24:27], a[84:87], v[120:123]
v_mfma_f32_16x16x32_bf16 v[124:127], a[28:31], a[84:87], v[124:127]
s_waitcnt lgkmcnt(6)
v_mfma_f32_16x16x32_bf16 v[128:131], a[16:19], a[88:91], v[128:131]
ds_read_b64_tr_b16 a[72:73], v26 offset:16640
v_mfma_f32_16x16x32_bf16 v[132:135], a[20:23], a[88:91], v[132:135]
ds_read_b64_tr_b16 a[74:75], v26 offset:24832
s_add_u32 m0, s43, 53248
v_mfma_f32_16x16x32_bf16 v[136:139], a[24:27], a[88:91], v[136:139]
buffer_load_dwordx4 v13, s[52:55], s42 offen lds
v_mfma_f32_16x16x32_bf16 v[140:143], a[28:31], a[88:91], v[140:143]
s_waitcnt lgkmcnt(6)
v_mfma_f32_16x16x32_bf16 v[144:147], a[16:19], a[92:95], v[144:147]
ds_read_b64_tr_b16 a[76:77], v27 offset:16640
v_mfma_f32_16x16x32_bf16 v[148:151], a[20:23], a[92:95], v[148:151]
ds_read_b64_tr_b16 a[78:79], v27 offset:24832
v_mfma_f32_16x16x32_bf16 v[152:155], a[24:27], a[92:95], v[152:155]
v_mfma_f32_16x16x32_bf16 v[156:159], a[28:31], a[92:95], v[156:159]
s_waitcnt lgkmcnt(6)
v_mfma_f32_16x16x32_bf16 v[160:163], a[16:19], a[64:67], v[160:163]
ds_read_b64_tr_b16 a[80:81], v28 offset:16640
v_mfma_f32_16x16x32_bf16 v[164:167], a[20:23], a[64:67], v[164:167]
ds_read_b64_tr_b16 a[82:83], v28 offset:24832
buffer_load_dwordx4 a[8:11], v10, s[48:51], s41 offen sc1
v_mfma_f32_16x16x32_bf16 v[168:171], a[24:27], a[64:67], v[168:171]
v_mfma_f32_16x16x32_bf16 v[172:175], a[28:31], a[64:67], v[172:175]
s_waitcnt lgkmcnt(6)
v_mfma_f32_16x16x32_bf16 v[176:179], a[16:19], a[68:71], v[176:179]
ds_read_b64_tr_b16 a[84:85], v29 offset:16640
v_mfma_f32_16x16x32_bf16 v[180:183], a[20:23], a[68:71], v[180:183]
ds_read_b64_tr_b16 a[86:87], v29 offset:24832
v_mfma_f32_16x16x32_bf16 v[184:187], a[24:27], a[68:71], v[184:187]
v_mfma_f32_16x16x32_bf16 v[188:191], a[28:31], a[68:71], v[188:191]
s_waitcnt lgkmcnt(6)
v_mfma_f32_16x16x32_bf16 v[192:195], a[16:19], a[72:75], v[192:195]
ds_read_b64_tr_b16 a[88:89], v30 offset:16640
v_mfma_f32_16x16x32_bf16 v[196:199], a[20:23], a[72:75], v[196:199]
ds_read_b64_tr_b16 a[90:91], v30 offset:24832
s_add_u32 m0, s43, 57344
v_mfma_f32_16x16x32_bf16 v[200:203], a[24:27], a[72:75], v[200:203]
buffer_load_dwordx4 v14, s[52:55], s42 offen lds
v_mfma_f32_16x16x32_bf16 v[204:207], a[28:31], a[72:75], v[204:207]
s_waitcnt lgkmcnt(6)
v_mfma_f32_16x16x32_bf16 v[208:211], a[16:19], a[76:79], v[208:211]
ds_read_b64_tr_b16 a[92:93], v31 offset:16640
v_mfma_f32_16x16x32_bf16 v[212:215], a[20:23], a[76:79], v[212:215]
ds_read_b64_tr_b16 a[94:95], v31 offset:24832
v_mfma_f32_16x16x32_bf16 v[216:219], a[24:27], a[76:79], v[216:219]
v_mfma_f32_16x16x32_bf16 v[220:223], a[28:31], a[76:79], v[220:223]
s_waitcnt lgkmcnt(6)
v_mfma_f32_16x16x32_bf16 v[224:227], a[16:19], a[80:83], v[224:227]
s_waitcnt vmcnt(15)
s_barrier
ds_read_b64_tr_b16 a[64:65], v24 offset:32768
v_mfma_f32_16x16x32_bf16 v[228:231], a[20:23], a[80:83], v[228:231]
ds_read_b64_tr_b16 a[66:67], v24 offset:40960
buffer_load_dwordx4 a[12:15], v11, s[48:51], s41 offen sc1
s_add_u32 s41, s41, 1024
v_mfma_f32_16x16x32_bf16 v[232:235], a[24:27], a[80:83], v[232:235]
v_mfma_f32_16x16x32_bf16 v[236:239], a[28:31], a[80:83], v[236:239]
s_waitcnt lgkmcnt(6)
v_mfma_f32_16x16x32_bf16 v[240:243], a[16:19], a[84:87], v[240:243]
ds_read_b64_tr_b16 a[68:69], v25 offset:32768
v_mfma_f32_16x16x32_bf16 v[244:247], a[20:23], a[84:87], v[244:247]
ds_read_b64_tr_b16 a[70:71], v25 offset:40960
v_mfma_f32_16x16x32_bf16 v[248:251], a[24:27], a[84:87], v[248:251]
v_mfma_f32_16x16x32_bf16 v[252:255], a[28:31], a[84:87], v[252:255]
s_waitcnt lgkmcnt(6)
v_mfma_f32_16x16x32_bf16 a[96:99], a[16:19], a[88:91], a[96:99]
ds_read_b64_tr_b16 a[72:73], v26 offset:32768
v_mfma_f32_16x16x32_bf16 a[100:103], a[20:23], a[88:91], a[100:103]
ds_read_b64_tr_b16 a[74:75], v26 offset:40960
s_add_u32 m0, s43, 61440
v_mfma_f32_16x16x32_bf16 a[104:107], a[24:27], a[88:91], a[104:107]
buffer_load_dwordx4 v15, s[52:55], s42 offen lds
s_add_u32 s42, s42, 196608
v_mfma_f32_16x16x32_bf16 a[108:111], a[28:31], a[88:91], a[108:111]
s_waitcnt lgkmcnt(6)
v_mfma_f32_16x16x32_bf16 a[112:115], a[16:19], a[92:95], a[112:115]
ds_read_b64_tr_b16 a[76:77], v27 offset:32768
v_mfma_f32_16x16x32_bf16 a[116:119], a[20:23], a[92:95], a[116:119]
ds_read_b64_tr_b16 a[78:79], v27 offset:40960
v_mfma_f32_16x16x32_bf16 a[120:123], a[24:27], a[92:95], a[120:123]
v_mfma_f32_16x16x32_bf16 a[124:127], a[28:31], a[92:95], a[124:127]
s_waitcnt lgkmcnt(6)
v_mfma_f32_16x16x32_bf16 v[32:35], a[32:35], a[64:67], v[32:35]
ds_read_b64_tr_b16 a[80:81], v28 offset:32768
v_mfma_f32_16x16x32_bf16 v[36:39], a[36:39], a[64:67], v[36:39]
ds_read_b64_tr_b16 a[82:83], v28 offset:40960
buffer_load_dwordx4 a[16:19], v8, s[48:51], s41 offen sc1
v_mfma_f32_16x16x32_bf16 v[40:43], a[40:43], a[64:67], v[40:43]
v_mfma_f32_16x16x32_bf16 v[44:47], a[44:47], a[64:67], v[44:47]
s_waitcnt lgkmcnt(6)
v_mfma_f32_16x16x32_bf16 v[48:51], a[32:35], a[68:71], v[48:51]
ds_read_b64_tr_b16 a[84:85], v29 offset:32768
v_mfma_f32_16x16x32_bf16 v[52:55], a[36:39], a[68:71], v[52:55]
ds_read_b64_tr_b16 a[86:87], v29 offset:40960
v_mfma_f32_16x16x32_bf16 v[56:59], a[40:43], a[68:71], v[56:59]
v_mfma_f32_16x16x32_bf16 v[60:63], a[44:47], a[68:71], v[60:63]
s_waitcnt lgkmcnt(6)
v_mfma_f32_16x16x32_bf16 v[64:67], a[32:35], a[72:75], v[64:67]
ds_read_b64_tr_b16 a[88:89], v30 offset:32768
v_mfma_f32_16x16x32_bf16 v[68:71], a[36:39], a[72:75], v[68:71]
ds_read_b64_tr_b16 a[90:91], v30 offset:40960
s_add_u32 m0, s43, 65536
v_mfma_f32_16x16x32_bf16 v[72:75], a[40:43], a[72:75], v[72:75]
buffer_load_dwordx4 v12, s[52:55], s42 offen lds
v_mfma_f32_16x16x32_bf16 v[76:79], a[44:47], a[72:75], v[76:79]
s_waitcnt lgkmcnt(6)
v_mfma_f32_16x16x32_bf16 v[80:83], a[32:35], a[76:79], v[80:83]
ds_read_b64_tr_b16 a[92:93], v31 offset:32768
v_mfma_f32_16x16x32_bf16 v[84:87], a[36:39], a[76:79], v[84:87]
ds_read_b64_tr_b16 a[94:95], v31 offset:40960
v_mfma_f32_16x16x32_bf16 v[88:91], a[40:43], a[76:79], v[88:91]
v_mfma_f32_16x16x32_bf16 v[92:95], a[44:47], a[76:79], v[92:95]
s_waitcnt lgkmcnt(6)
v_mfma_f32_16x16x32_bf16 v[96:99], a[32:35], a[80:83], v[96:99]
ds_read_b64_tr_b16 a[64:65], v24 offset:33024
v_mfma_f32_16x16x32_bf16 v[100:103], a[36:39], a[80:83], v[100:103]
ds_read_b64_tr_b16 a[66:67], v24 offset:41216
buffer_load_dwordx4 a[20:23], v9, s[48:51], s41 offen sc1
v_mfma_f32_16x16x32_bf16 v[104:107], a[40:43], a[80:83], v[104:107]
v_mfma_f32_16x16x32_bf16 v[108:111], a[44:47], a[80:83], v[108:111]
s_waitcnt lgkmcnt(6)
v_mfma_f32_16x16x32_bf16 v[112:115], a[32:35], a[84:87], v[112:115]
ds_read_b64_tr_b16 a[68:69], v25 offset:33024
v_mfma_f32_16x16x32_bf16 v[116:119], a[36:39], a[84:87], v[116:119]
ds_read_b64_tr_b16 a[70:71], v25 offset:41216
v_mfma_f32_16x16x32_bf16 v[120:123], a[40:43], a[84:87], v[120:123]
v_mfma_f32_16x16x32_bf16 v[124:127], a[44:47], a[84:87], v[124:127]
s_waitcnt lgkmcnt(6)
v_mfma_f32_16x16x32_bf16 v[128:131], a[32:35], a[88:91], v[128:131]
ds_read_b64_tr_b16 a[72:73], v26 offset:33024
v_mfma_f32_16x16x32_bf16 v[132:135], a[36:39], a[88:91], v[132:135]
ds_read_b64_tr_b16 a[74:75], v26 offset:41216
s_add_u32 m0, s43, 69632
v_mfma_f32_16x16x32_bf16 v[136:139], a[40:43], a[88:91], v[136:139]
buffer_load_dwordx4 v13, s[52:55], s42 offen lds
v_mfma_f32_16x16x32_bf16 v[140:143], a[44:47], a[88:91], v[140:143]
s_waitcnt lgkmcnt(6)
v_mfma_f32_16x16x32_bf16 v[144:147], a[32:35], a[92:95], v[144:147]
ds_read_b64_tr_b16 a[76:77], v27 offset:33024
v_mfma_f32_16x16x32_bf16 v[148:151], a[36:39], a[92:95], v[148:151]
ds_read_b64_tr_b16 a[78:79], v27 offset:41216
v_mfma_f32_16x16x32_bf16 v[152:155], a[40:43], a[92:95], v[152:155]
v_mfma_f32_16x16x32_bf16 v[156:159], a[44:47], a[92:95], v[156:159]
s_waitcnt lgkmcnt(6)
v_mfma_f32_16x16x32_bf16 v[160:163], a[32:35], a[64:67], v[160:163]
ds_read_b64_tr_b16 a[80:81], v28 offset:33024
v_mfma_f32_16x16x32_bf16 v[164:167], a[36:39], a[64:67], v[164:167]
ds_read_b64_tr_b16 a[82:83], v28 offset:41216
buffer_load_dwordx4 a[24:27], v10, s[48:51], s41 offen sc1
v_mfma_f32_16x16x32_bf16 v[168:171], a[40:43], a[64:67], v[168:171]
v_mfma_f32_16x16x32_bf16 v[172:175], a[44:47], a[64:67], v[172:175]
s_waitcnt lgkmcnt(6)
v_mfma_f32_16x16x32_bf16 v[176:179], a[32:35], a[68:71], v[176:179]
ds_read_b64_tr_b16 a[84:85], v29 offset:33024
v_mfma_f32_16x16x32_bf16 v[180:183], a[36:39], a[68:71], v[180:183]
ds_read_b64_tr_b16 a[86:87], v29 offset:41216
v_mfma_f32_16x16x32_bf16 v[184:187], a[40:43], a[68:71], v[184:187]
v_mfma_f32_16x16x32_bf16 v[188:191], a[44:47], a[68:71], v[188:191]
s_waitcnt lgkmcnt(6)
v_mfma_f32_16x16x32_bf16 v[192:195], a[32:35], a[72:75], v[192:195]
ds_read_b64_tr_b16 a[88:89], v30 offset:33024
v_mfma_f32_16x16x32_bf16 v[196:199], a[36:39], a[72:75], v[196:199]
ds_read_b64_tr_b16 a[90:91], v30 offset:41216
s_add_u32 m0, s43, 73728
v_mfma_f32_16x16x32_bf16 v[200:203], a[40:43], a[72:75], v[200:203]
buffer_load_dwordx4 v14, s[52:55], s42 offen lds
v_mfma_f32_16x16x32_bf16 v[204:207], a[44:47], a[72:75], v[204:207]
s_waitcnt lgkmcnt(6)
v_mfma_f32_16x16x32_bf16 v[208:211], a[32:35], a[76:79], v[208:211]
ds_read_b64_tr_b16 a[92:93], v31 offset:33024
v_mfma_f32_16x16x32_bf16 v[212:215], a[36:39], a[76:79], v[212:215]
ds_read_b64_tr_b16 a[94:95], v31 offset:41216
v_mfma_f32_16x16x32_bf16 v[216:219], a[40:43], a[76:79], v[216:219]
v_mfma_f32_16x16x32_bf16 v[220:223], a[44:47], a[76:79], v[220:223]
s_waitcnt lgkmcnt(6)
v_mfma_f32_16x16x32_bf16 v[224:227], a[32:35], a[80:83], v[224:227]
s_waitcnt vmcnt(15)
s_barrier
ds_read_b64_tr_b16 a[64:65], v24 offset:49152
v_mfma_f32_16x16x32_bf16 v[228:231], a[36:39], a[80:83], v[228:231]
ds_read_b64_tr_b16 a[66:67], v24 offset:57344
buffer_load_dwordx4 a[28:31], v11, s[48:51], s41 offen sc1
s_add_u32 s41, s41, 1024
v_mfma_f32_16x16x32_bf16 v[232:235], a[40:43], a[80:83], v[232:235]
v_mfma_f32_16x16x32_bf16 v[236:239], a[44:47], a[80:83], v[236:239]
s_waitcnt lgkmcnt(6)
v_mfma_f32_16x16x32_bf16 v[240:243], a[32:35], a[84:87], v[240:243]
ds_read_b64_tr_b16 a[68:69], v25 offset:49152
v_mfma_f32_16x16x32_bf16 v[244:247], a[36:39], a[84:87], v[244:247]
ds_read_b64_tr_b16 a[70:71], v25 offset:57344
v_mfma_f32_16x16x32_bf16 v[248:251], a[40:43], a[84:87], v[248:251]
v_mfma_f32_16x16x32_bf16 v[252:255], a[44:47], a[84:87], v[252:255]
s_waitcnt lgkmcnt(6)
v_mfma_f32_16x16x32_bf16 a[96:99], a[32:35], a[88:91], a[96:99]
ds_read_b64_tr_b16 a[72:73], v26 offset:49152
v_mfma_f32_16x16x32_bf16 a[100:103], a[36:39], a[88:91], a[100:103]
ds_read_b64_tr_b16 a[74:75], v26 offset:57344
s_add_u32 m0, s43, 77824
v_mfma_f32_16x16x32_bf16 a[104:107], a[40:43], a[88:91], a[104:107]
buffer_load_dwordx4 v15, s[52:55], s42 offen lds
s_add_u32 s42, s42, 196608
v_mfma_f32_16x16x32_bf16 a[108:111], a[44:47], a[88:91], a[108:111]
s_waitcnt lgkmcnt(6)
v_mfma_f32_16x16x32_bf16 a[112:115], a[32:35], a[92:95], a[112:115]
ds_read_b64_tr_b16 a[76:77], v27 offset:49152
v_mfma_f32_16x16x32_bf16 a[116:119], a[36:39], a[92:95], a[116:119]
ds_read_b64_tr_b16 a[78:79], v27 offset:57344
v_mfma_f32_16x16x32_bf16 a[120:123], a[40:43], a[92:95], a[120:123]
v_mfma_f32_16x16x32_bf16 a[124:127], a[44:47], a[92:95], a[124:127]
s_waitcnt lgkmcnt(6)
v_mfma_f32_16x16x32_bf16 v[32:35], a[48:51], a[64:67], v[32:35]
ds_read_b64_tr_b16 a[80:81], v28 offset:49152
v_mfma_f32_16x16x32_bf16 v[36:39], a[52:55], a[64:67], v[36:39]
ds_read_b64_tr_b16 a[82:83], v28 offset:57344
buffer_load_dwordx4 a[32:35], v8, s[48:51], s41 offen sc1
v_mfma_f32_16x16x32_bf16 v[40:43], a[56:59], a[64:67], v[40:43]
v_mfma_f32_16x16x32_bf16 v[44:47], a[60:63], a[64:67], v[44:47]
s_waitcnt lgkmcnt(6)
v_mfma_f32_16x16x32_bf16 v[48:51], a[48:51], a[68:71], v[48:51]
ds_read_b64_tr_b16 a[84:85], v29 offset:49152
v_mfma_f32_16x16x32_bf16 v[52:55], a[52:55], a[68:71], v[52:55]
ds_read_b64_tr_b16 a[86:87], v29 offset:57344
v_mfma_f32_16x16x32_bf16 v[56:59], a[56:59], a[68:71], v[56:59]
v_mfma_f32_16x16x32_bf16 v[60:63], a[60:63], a[68:71], v[60:63]
s_waitcnt lgkmcnt(6)
v_mfma_f32_16x16x32_bf16 v[64:67], a[48:51], a[72:75], v[64:67]
ds_read_b64_tr_b16 a[88:89], v30 offset:49152
v_mfma_f32_16x16x32_bf16 v[68:71], a[52:55], a[72:75], v[68:71]
ds_read_b64_tr_b16 a[90:91], v30 offset:57344
s_add_u32 m0, s43, 81920
v_mfma_f32_16x16x32_bf16 v[72:75], a[56:59], a[72:75], v[72:75]
buffer_load_dwordx4 v12, s[52:55], s42 offen lds
v_mfma_f32_16x16x32_bf16 v[76:79], a[60:63], a[72:75], v[76:79]
s_waitcnt lgkmcnt(6)
v_mfma_f32_16x16x32_bf16 v[80:83], a[48:51], a[76:79], v[80:83]
ds_read_b64_tr_b16 a[92:93], v31 offset:49152
v_mfma_f32_16x16x32_bf16 v[84:87], a[52:55], a[76:79], v[84:87]
ds_read_b64_tr_b16 a[94:95], v31 offset:57344
v_mfma_f32_16x16x32_bf16 v[88:91], a[56:59], a[76:79], v[88:91]
v_mfma_f32_16x16x32_bf16 v[92:95], a[60:63], a[76:79], v[92:95]
s_waitcnt lgkmcnt(6)
v_mfma_f32_16x16x32_bf16 v[96:99], a[48:51], a[80:83], v[96:99]
ds_read_b64_tr_b16 a[64:65], v24 offset:49408
v_mfma_f32_16x16x32_bf16 v[100:103], a[52:55], a[80:83], v[100:103]
ds_read_b64_tr_b16 a[66:67], v24 offset:57600
buffer_load_dwordx4 a[36:39], v9, s[48:51], s41 offen sc1
v_mfma_f32_16x16x32_bf16 v[104:107], a[56:59], a[80:83], v[104:107]
v_mfma_f32_16x16x32_bf16 v[108:111], a[60:63], a[80:83], v[108:111]
s_waitcnt lgkmcnt(6)
v_mfma_f32_16x16x32_bf16 v[112:115], a[48:51], a[84:87], v[112:115]
ds_read_b64_tr_b16 a[68:69], v25 offset:49408
v_mfma_f32_16x16x32_bf16 v[116:119], a[52:55], a[84:87], v[116:119]
ds_read_b64_tr_b16 a[70:71], v25 offset:57600
v_mfma_f32_16x16x32_bf16 v[120:123], a[56:59], a[84:87], v[120:123]
v_mfma_f32_16x16x32_bf16 v[124:127], a[60:63], a[84:87], v[124:127]
s_waitcnt lgkmcnt(6)
v_mfma_f32_16x16x32_bf16 v[128:131], a[48:51], a[88:91], v[128:131]
ds_read_b64_tr_b16 a[72:73], v26 offset:49408
v_mfma_f32_16x16x32_bf16 v[132:135], a[52:55], a[88:91], v[132:135]
ds_read_b64_tr_b16 a[74:75], v26 offset:57600
s_add_u32 m0, s43, 86016
v_mfma_f32_16x16x32_bf16 v[136:139], a[56:59], a[88:91], v[136:139]
buffer_load_dwordx4 v13, s[52:55], s42 offen lds
v_mfma_f32_16x16x32_bf16 v[140:143], a[60:63], a[88:91], v[140:143]
s_waitcnt lgkmcnt(6)
v_mfma_f32_16x16x32_bf16 v[144:147], a[48:51], a[92:95], v[144:147]
ds_read_b64_tr_b16 a[76:77], v27 offset:49408
v_mfma_f32_16x16x32_bf16 v[148:151], a[52:55], a[92:95], v[148:151]
ds_read_b64_tr_b16 a[78:79], v27 offset:57600
v_mfma_f32_16x16x32_bf16 v[152:155], a[56:59], a[92:95], v[152:155]
v_mfma_f32_16x16x32_bf16 v[156:159], a[60:63], a[92:95], v[156:159]
s_waitcnt lgkmcnt(6)
v_mfma_f32_16x16x32_bf16 v[160:163], a[48:51], a[64:67], v[160:163]
ds_read_b64_tr_b16 a[80:81], v28 offset:49408
v_mfma_f32_16x16x32_bf16 v[164:167], a[52:55], a[64:67], v[164:167]
ds_read_b64_tr_b16 a[82:83], v28 offset:57600
buffer_load_dwordx4 a[40:43], v10, s[48:51], s41 offen sc1
v_mfma_f32_16x16x32_bf16 v[168:171], a[56:59], a[64:67], v[168:171]
v_mfma_f32_16x16x32_bf16 v[172:175], a[60:63], a[64:67], v[172:175]
s_waitcnt lgkmcnt(6)
v_mfma_f32_16x16x32_bf16 v[176:179], a[48:51], a[68:71], v[176:179]
ds_read_b64_tr_b16 a[84:85], v29 offset:49408
v_mfma_f32_16x16x32_bf16 v[180:183], a[52:55], a[68:71], v[180:183]
ds_read_b64_tr_b16 a[86:87], v29 offset:57600
v_mfma_f32_16x16x32_bf16 v[184:187], a[56:59], a[68:71], v[184:187]
v_mfma_f32_16x16x32_bf16 v[188:191], a[60:63], a[68:71], v[188:191]
s_waitcnt lgkmcnt(6)
v_mfma_f32_16x16x32_bf16 v[192:195], a[48:51], a[72:75], v[192:195]
ds_read_b64_tr_b16 a[88:89], v30 offset:49408
v_mfma_f32_16x16x32_bf16 v[196:199], a[52:55], a[72:75], v[196:199]
ds_read_b64_tr_b16 a[90:91], v30 offset:57600
s_add_u32 m0, s43, 90112
v_mfma_f32_16x16x32_bf16 v[200:203], a[56:59], a[72:75], v[200:203]
buffer_load_dwordx4 v14, s[52:55], s42 offen lds
v_mfma_f32_16x16x32_bf16 v[204:207], a[60:63], a[72:75], v[204:207]
s_waitcnt lgkmcnt(6)
v_mfma_f32_16x16x32_bf16 v[208:211], a[48:51], a[76:79], v[208:211]
ds_read_b64_tr_b16 a[92:93], v31 offset:49408
v_mfma_f32_16x16x32_bf16 v[212:215], a[52:55], a[76:79], v[212:215]
ds_read_b64_tr_b16 a[94:95], v31 offset:57600
v_mfma_f32_16x16x32_bf16 v[216:219], a[56:59], a[76:79], v[216:219]
v_mfma_f32_16x16x32_bf16 v[220:223], a[60:63], a[76:79], v[220:223]
s_waitcnt lgkmcnt(6)
v_mfma_f32_16x16x32_bf16 v[224:227], a[48:51], a[80:83], v[224:227]
s_waitcnt vmcnt(15)
s_barrier
ds_read_b64_tr_b16 a[64:65], v16 offset:0
v_mfma_f32_16x16x32_bf16 v[228:231], a[52:55], a[80:83], v[228:231]
ds_read_b64_tr_b16 a[66:67], v16 offset:8192
buffer_load_dwordx4 a[44:47], v11, s[48:51], s41 offen sc1
s_add_u32 s41, s41, 1024
v_mfma_f32_16x16x32_bf16 v[232:235], a[56:59], a[80:83], v[232:235]
v_mfma_f32_16x16x32_bf16 v[236:239], a[60:63], a[80:83], v[236:239]
s_waitcnt lgkmcnt(6)
v_mfma_f32_16x16x32_bf16 v[240:243], a[48:51], a[84:87], v[240:243]
ds_read_b64_tr_b16 a[68:69], v17 offset:0
v_mfma_f32_16x16x32_bf16 v[244:247], a[52:55], a[84:87], v[244:247]
ds_read_b64_tr_b16 a[70:71], v17 offset:8192
v_mfma_f32_16x16x32_bf16 v[248:251], a[56:59], a[84:87], v[248:251]
v_mfma_f32_16x16x32_bf16 v[252:255], a[60:63], a[84:87], v[252:255]
s_waitcnt lgkmcnt(6)
v_mfma_f32_16x16x32_bf16 a[96:99], a[48:51], a[88:91], a[96:99]
ds_read_b64_tr_b16 a[72:73], v18 offset:0
v_mfma_f32_16x16x32_bf16 a[100:103], a[52:55], a[88:91], a[100:103]
ds_read_b64_tr_b16 a[74:75], v18 offset:8192
s_add_u32 m0, s43, 94208
v_mfma_f32_16x16x32_bf16 a[104:107], a[56:59], a[88:91], a[104:107]
buffer_load_dwordx4 v15, s[52:55], s42 offen lds
s_add_u32 s42, s42, 196608
v_mfma_f32_16x16x32_bf16 a[108:111], a[60:63], a[88:91], a[108:111]
s_waitcnt lgkmcnt(6)
v_mfma_f32_16x16x32_bf16 a[112:115], a[48:51], a[92:95], a[112:115]
ds_read_b64_tr_b16 a[76:77], v19 offset:0
v_mfma_f32_16x16x32_bf16 a[116:119], a[52:55], a[92:95], a[116:119]
ds_read_b64_tr_b16 a[78:79], v19 offset:8192
v_mfma_f32_16x16x32_bf16 a[120:123], a[56:59], a[92:95], a[120:123]
v_mfma_f32_16x16x32_bf16 a[124:127], a[60:63], a[92:95], a[124:127]
s_sub_u32 s44, s44, 1
s_cmp_lg_u32 s44, 0
s_cbranch_scc1 L_gemm1_kernel_v_loop0
s_waitcnt lgkmcnt(6)
v_mfma_f32_16x16x32_bf16 v[32:35], a[0:3], a[64:67], v[32:35]
ds_read_b64_tr_b16 a[80:81], v20 offset:0
v_mfma_f32_16x16x32_bf16 v[36:39], a[4:7], a[64:67], v[36:39]
ds_read_b64_tr_b16 a[82:83], v20 offset:8192
buffer_load_dwordx4 a[48:51], v8, s[48:51], s41 offen sc1
v_mfma_f32_16x16x32_bf16 v[40:43], a[8:11], a[64:67], v[40:43]
v_mfma_f32_16x16x32_bf16 v[44:47], a[12:15], a[64:67], v[44:47]
s_waitcnt lgkmcnt(6)
v_mfma_f32_16x16x32_bf16 v[48:51], a[0:3], a[68:71], v[48:51]
ds_read_b64_tr_b16 a[84:85], v21 offset:0
v_mfma_f32_16x16x32_bf16 v[52:55], a[4:7], a[68:71], v[52:55]
ds_read_b64_tr_b16 a[86:87], v21 offset:8192
v_mfma_f32_16x16x32_bf16 v[56:59], a[8:11], a[68:71], v[56:59]
v_mfma_f32_16x16x32_bf16 v[60:63], a[12:15], a[68:71], v[60:63]
s_waitcnt lgkmcnt(6)
v_mfma_f32_16x16x32_bf16 v[64:67], a[0:3], a[72:75], v[64:67]
ds_read_b64_tr_b16 a[88:89], v22 offset:0
v_mfma_f32_16x16x32_bf16 v[68:71], a[4:7], a[72:75], v[68:71]
ds_read_b64_tr_b16 a[90:91], v22 offset:8192
s_add_u32 m0, s43, 98304
v_mfma_f32_16x16x32_bf16 v[72:75], a[8:11], a[72:75], v[72:75]
buffer_load_dwordx4 v12, s[52:55], s42 offen lds
v_mfma_f32_16x16x32_bf16 v[76:79], a[12:15], a[72:75], v[76:79]
s_waitcnt lgkmcnt(6)
v_mfma_f32_16x16x32_bf16 v[80:83], a[0:3], a[76:79], v[80:83]
ds_read_b64_tr_b16 a[92:93], v23 offset:0
v_mfma_f32_16x16x32_bf16 v[84:87], a[4:7], a[76:79], v[84:87]
ds_read_b64_tr_b16 a[94:95], v23 offset:8192
v_mfma_f32_16x16x32_bf16 v[88:91], a[8:11], a[76:79], v[88:91]
v_mfma_f32_16x16x32_bf16 v[92:95], a[12:15], a[76:79], v[92:95]
s_waitcnt lgkmcnt(6)
v_mfma_f32_16x16x32_bf16 v[96:99], a[0:3], a[80:83], v[96:99]
ds_read_b64_tr_b16 a[64:65], v16 offset:256
v_mfma_f32_16x16x32_bf16 v[100:103], a[4:7], a[80:83], v[100:103]
ds_read_b64_tr_b16 a[66:67], v16 offset:8448
buffer_load_dwordx4 a[52:55], v9, s[48:51], s41 offen sc1
v_mfma_f32_16x16x32_bf16 v[104:107], a[8:11], a[80:83], v[104:107]
v_mfma_f32_16x16x32_bf16 v[108:111], a[12:15], a[80:83], v[108:111]
s_waitcnt lgkmcnt(6)
v_mfma_f32_16x16x32_bf16 v[112:115], a[0:3], a[84:87], v[112:115]
ds_read_b64_tr_b16 a[68:69], v17 offset:256
v_mfma_f32_16x16x32_bf16 v[116:119], a[4:7], a[84:87], v[116:119]
ds_read_b64_tr_b16 a[70:71], v17 offset:8448
v_mfma_f32_16x16x32_bf16 v[120:123], a[8:11], a[84:87], v[120:123]
v_mfma_f32_16x16x32_bf16 v[124:127], a[12:15], a[84:87], v[124:127]
s_waitcnt lgkmcnt(6)
v_mfma_f32_16x16x32_bf16 v[128:131], a[0:3], a[88:91], v[128:131]
ds_read_b64_tr_b16 a[72:73], v18 offset:256
v_mfma_f32_16x16x32_bf16 v[132:135], a[4:7], a[88:91], v[132:135]
ds_read_b64_tr_b16 a[74:75], v18 offset:8448
s_add_u32 m0, s43, 102400
v_mfma_f32_16x16x32_bf16 v[136:139], a[8:11], a[88:91], v[136:139]
buffer_load_dwordx4 v13, s[52:55], s42 offen lds
v_mfma_f32_16x16x32_bf16 v[140:143], a[12:15], a[88:91], v[140:143]
s_waitcnt lgkmcnt(6)
v_mfma_f32_16x16x32_bf16 v[144:147], a[0:3], a[92:95], v[144:147]
ds_read_b64_tr_b16 a[76:77], v19 offset:256
v_mfma_f32_16x16x32_bf16 v[148:151], a[4:7], a[92:95], v[148:151]
ds_read_b64_tr_b16 a[78:79], v19 offset:8448
v_mfma_f32_16x16x32_bf16 v[152:155], a[8:11], a[92:95], v[152:155]
v_mfma_f32_16x16x32_bf16 v[156:159], a[12:15], a[92:95], v[156:159]
s_waitcnt lgkmcnt(6)
v_mfma_f32_16x16x32_bf16 v[160:163], a[0:3], a[64:67], v[160:163]
ds_read_b64_tr_b16 a[80:81], v20 offset:256
v_mfma_f32_16x16x32_bf16 v[164:167], a[4:7], a[64:67], v[164:167]
ds_read_b64_tr_b16 a[82:83], v20 offset:8448
buffer_load_dwordx4 a[56:59], v10, s[48:51], s41 offen sc1
v_mfma_f32_16x16x32_bf16 v[168:171], a[8:11], a[64:67], v[168:171]
v_mfma_f32_16x16x32_bf16 v[172:175], a[12:15], a[64:67], v[172:175]
s_waitcnt lgkmcnt(6)
v_mfma_f32_16x16x32_bf16 v[176:179], a[0:3], a[68:71], v[176:179]
ds_read_b64_tr_b16 a[84:85], v21 offset:256
v_mfma_f32_16x16x32_bf16 v[180:183], a[4:7], a[68:71], v[180:183]
ds_read_b64_tr_b16 a[86:87], v21 offset:8448
v_mfma_f32_16x16x32_bf16 v[184:187], a[8:11], a[68:71], v[184:187]
v_mfma_f32_16x16x32_bf16 v[188:191], a[12:15], a[68:71], v[188:191]
s_waitcnt lgkmcnt(6)
v_mfma_f32_16x16x32_bf16 v[192:195], a[0:3], a[72:75], v[192:195]
ds_read_b64_tr_b16 a[88:89], v22 offset:256
v_mfma_f32_16x16x32_bf16 v[196:199], a[4:7], a[72:75], v[196:199]
ds_read_b64_tr_b16 a[90:91], v22 offset:8448
s_add_u32 m0, s43, 106496
v_mfma_f32_16x16x32_bf16 v[200:203], a[8:11], a[72:75], v[200:203]
buffer_load_dwordx4 v14, s[52:55], s42 offen lds
v_mfma_f32_16x16x32_bf16 v[204:207], a[12:15], a[72:75], v[204:207]
s_waitcnt lgkmcnt(6)
v_mfma_f32_16x16x32_bf16 v[208:211], a[0:3], a[76:79], v[208:211]
ds_read_b64_tr_b16 a[92:93], v23 offset:256
v_mfma_f32_16x16x32_bf16 v[212:215], a[4:7], a[76:79], v[212:215]
ds_read_b64_tr_b16 a[94:95], v23 offset:8448
v_mfma_f32_16x16x32_bf16 v[216:219], a[8:11], a[76:79], v[216:219]
v_mfma_f32_16x16x32_bf16 v[220:223], a[12:15], a[76:79], v[220:223]
s_waitcnt lgkmcnt(6)
v_mfma_f32_16x16x32_bf16 v[224:227], a[0:3], a[80:83], v[224:227]
s_waitcnt vmcnt(15)
s_barrier
ds_read_b64_tr_b16 a[64:65], v16 offset:16384
v_mfma_f32_16x16x32_bf16 v[228:231], a[4:7], a[80:83], v[228:231]
ds_read_b64_tr_b16 a[66:67], v16 offset:24576
buffer_load_dwordx4 a[60:63], v11, s[48:51], s41 offen sc1
s_add_u32 s41, s41, 1024
v_mfma_f32_16x16x32_bf16 v[232:235], a[8:11], a[80:83], v[232:235]
v_mfma_f32_16x16x32_bf16 v[236:239], a[12:15], a[80:83], v[236:239]
s_waitcnt lgkmcnt(6)
v_mfma_f32_16x16x32_bf16 v[240:243], a[0:3], a[84:87], v[240:243]
ds_read_b64_tr_b16 a[68:69], v17 offset:16384
v_mfma_f32_16x16x32_bf16 v[244:247], a[4:7], a[84:87], v[244:247]
ds_read_b64_tr_b16 a[70:71], v17 offset:24576
v_mfma_f32_16x16x32_bf16 v[248:251], a[8:11], a[84:87], v[248:251]
v_mfma_f32_16x16x32_bf16 v[252:255], a[12:15], a[84:87], v[252:255]
s_waitcnt lgkmcnt(6)
v_mfma_f32_16x16x32_bf16 a[96:99], a[0:3], a[88:91], a[96:99]
ds_read_b64_tr_b16 a[72:73], v18 offset:16384
v_mfma_f32_16x16x32_bf16 a[100:103], a[4:7], a[88:91], a[100:103]
ds_read_b64_tr_b16 a[74:75], v18 offset:24576
s_add_u32 m0, s43, 110592
v_mfma_f32_16x16x32_bf16 a[104:107], a[8:11], a[88:91], a[104:107]
buffer_load_dwordx4 v15, s[52:55], s42 offen lds
s_add_u32 s42, s42, 196608
v_mfma_f32_16x16x32_bf16 a[108:111], a[12:15], a[88:91], a[108:111]
s_waitcnt lgkmcnt(6)
v_mfma_f32_16x16x32_bf16 a[112:115], a[0:3], a[92:95], a[112:115]
ds_read_b64_tr_b16 a[76:77], v19 offset:16384
v_mfma_f32_16x16x32_bf16 a[116:119], a[4:7], a[92:95], a[116:119]
ds_read_b64_tr_b16 a[78:79], v19 offset:24576
v_mfma_f32_16x16x32_bf16 a[120:123], a[8:11], a[92:95], a[120:123]
v_mfma_f32_16x16x32_bf16 a[124:127], a[12:15], a[92:95], a[124:127]
s_waitcnt lgkmcnt(6)
v_mfma_f32_16x16x32_bf16 v[32:35], a[16:19], a[64:67], v[32:35]
ds_read_b64_tr_b16 a[80:81], v20 offset:16384
v_mfma_f32_16x16x32_bf16 v[36:39], a[20:23], a[64:67], v[36:39]
ds_read_b64_tr_b16 a[82:83], v20 offset:24576
buffer_load_dwordx4 a[0:3], v8, s[48:51], s41 offen sc1
v_mfma_f32_16x16x32_bf16 v[40:43], a[24:27], a[64:67], v[40:43]
v_mfma_f32_16x16x32_bf16 v[44:47], a[28:31], a[64:67], v[44:47]
s_waitcnt lgkmcnt(6)
v_mfma_f32_16x16x32_bf16 v[48:51], a[16:19], a[68:71], v[48:51]
ds_read_b64_tr_b16 a[84:85], v21 offset:16384
v_mfma_f32_16x16x32_bf16 v[52:55], a[20:23], a[68:71], v[52:55]
ds_read_b64_tr_b16 a[86:87], v21 offset:24576
v_mfma_f32_16x16x32_bf16 v[56:59], a[24:27], a[68:71], v[56:59]
v_mfma_f32_16x16x32_bf16 v[60:63], a[28:31], a[68:71], v[60:63]
s_waitcnt lgkmcnt(6)
v_mfma_f32_16x16x32_bf16 v[64:67], a[16:19], a[72:75], v[64:67]
ds_read_b64_tr_b16 a[88:89], v22 offset:16384
v_mfma_f32_16x16x32_bf16 v[68:71], a[20:23], a[72:75], v[68:71]
ds_read_b64_tr_b16 a[90:91], v22 offset:24576
s_add_u32 m0, s43, 114688
v_mfma_f32_16x16x32_bf16 v[72:75], a[24:27], a[72:75], v[72:75]
buffer_load_dwordx4 v12, s[52:55], s42 offen lds
v_mfma_f32_16x16x32_bf16 v[76:79], a[28:31], a[72:75], v[76:79]
s_waitcnt lgkmcnt(6)
v_mfma_f32_16x16x32_bf16 v[80:83], a[16:19], a[76:79], v[80:83]
ds_read_b64_tr_b16 a[92:93], v23 offset:16384
v_mfma_f32_16x16x32_bf16 v[84:87], a[20:23], a[76:79], v[84:87]
ds_read_b64_tr_b16 a[94:95], v23 offset:24576
v_mfma_f32_16x16x32_bf16 v[88:91], a[24:27], a[76:79], v[88:91]
v_mfma_f32_16x16x32_bf16 v[92:95], a[28:31], a[76:79], v[92:95]
s_waitcnt lgkmcnt(6)
v_mfma_f32_16x16x32_bf16 v[96:99], a[16:19], a[80:83], v[96:99]
ds_read_b64_tr_b16 a[64:65], v16 offset:16640
v_mfma_f32_16x16x32_bf16 v[100:103], a[20:23], a[80:83], v[100:103]
ds_read_b64_tr_b16 a[66:67], v16 offset:24832
buffer_load_dwordx4 a[4:7], v9, s[48:51], s41 offen sc1
v_mfma_f32_16x16x32_bf16 v[104:107], a[24:27], a[80:83], v[104:107]
v_mfma_f32_16x16x32_bf16 v[108:111], a[28:31], a[80:83], v[108:111]
s_waitcnt lgkmcnt(6)
v_mfma_f32_16x16x32_bf16 v[112:115], a[16:19], a[84:87], v[112:115]
ds_read_b64_tr_b16 a[68:69], v17 offset:16640
v_mfma_f32_16x16x32_bf16 v[116:119], a[20:23], a[84:87], v[116:119]
ds_read_b64_tr_b16 a[70:71], v17 offset:24832
v_mfma_f32_16x16x32_bf16 v[120:123], a[24:27], a[84:87], v[120:123]
v_mfma_f32_16x16x32_bf16 v[124:127], a[28:31], a[84:87], v[124:127]
s_waitcnt lgkmcnt(6)
v_mfma_f32_16x16x32_bf16 v[128:131], a[16:19], a[88:91], v[128:131]
ds_read_b64_tr_b16 a[72:73], v18 offset:16640
v_mfma_f32_16x16x32_bf16 v[132:135], a[20:23], a[88:91], v[132:135]
ds_read_b64_tr_b16 a[74:75], v18 offset:24832
s_add_u32 m0, s43, 118784
v_mfma_f32_16x16x32_bf16 v[136:139], a[24:27], a[88:91], v[136:139]
buffer_load_dwordx4 v13, s[52:55], s42 offen lds
v_mfma_f32_16x16x32_bf16 v[140:143], a[28:31], a[88:91], v[140:143]
s_waitcnt lgkmcnt(6)
v_mfma_f32_16x16x32_bf16 v[144:147], a[16:19], a[92:95], v[144:147]
ds_read_b64_tr_b16 a[76:77], v19 offset:16640
v_mfma_f32_16x16x32_bf16 v[148:151], a[20:23], a[92:95], v[148:151]
ds_read_b64_tr_b16 a[78:79], v19 offset:24832
v_mfma_f32_16x16x32_bf16 v[152:155], a[24:27], a[92:95], v[152:155]
v_mfma_f32_16x16x32_bf16 v[156:159], a[28:31], a[92:95], v[156:159]
s_waitcnt lgkmcnt(6)
v_mfma_f32_16x16x32_bf16 v[160:163], a[16:19], a[64:67], v[160:163]
ds_read_b64_tr_b16 a[80:81], v20 offset:16640
v_mfma_f32_16x16x32_bf16 v[164:167], a[20:23], a[64:67], v[164:167]
ds_read_b64_tr_b16 a[82:83], v20 offset:24832
buffer_load_dwordx4 a[8:11], v10, s[48:51], s41 offen sc1
v_mfma_f32_16x16x32_bf16 v[168:171], a[24:27], a[64:67], v[168:171]
v_mfma_f32_16x16x32_bf16 v[172:175], a[28:31], a[64:67], v[172:175]
s_waitcnt lgkmcnt(6)
v_mfma_f32_16x16x32_bf16 v[176:179], a[16:19], a[68:71], v[176:179]
ds_read_b64_tr_b16 a[84:85], v21 offset:16640
v_mfma_f32_16x16x32_bf16 v[180:183], a[20:23], a[68:71], v[180:183]
ds_read_b64_tr_b16 a[86:87], v21 offset:24832
v_mfma_f32_16x16x32_bf16 v[184:187], a[24:27], a[68:71], v[184:187]
v_mfma_f32_16x16x32_bf16 v[188:191], a[28:31], a[68:71], v[188:191]
s_waitcnt lgkmcnt(6)
v_mfma_f32_16x16x32_bf16 v[192:195], a[16:19], a[72:75], v[192:195]
ds_read_b64_tr_b16 a[88:89], v22 offset:16640
v_mfma_f32_16x16x32_bf16 v[196:199], a[20:23], a[72:75], v[196:199]
ds_read_b64_tr_b16 a[90:91], v22 offset:24832
s_add_u32 m0, s43, 122880
v_mfma_f32_16x16x32_bf16 v[200:203], a[24:27], a[72:75], v[200:203]
buffer_load_dwordx4 v14, s[52:55], s42 offen lds
v_mfma_f32_16x16x32_bf16 v[204:207], a[28:31], a[72:75], v[204:207]
s_waitcnt lgkmcnt(6)
v_mfma_f32_16x16x32_bf16 v[208:211], a[16:19], a[76:79], v[208:211]
ds_read_b64_tr_b16 a[92:93], v23 offset:16640
v_mfma_f32_16x16x32_bf16 v[212:215], a[20:23], a[76:79], v[212:215]
ds_read_b64_tr_b16 a[94:95], v23 offset:24832
v_mfma_f32_16x16x32_bf16 v[216:219], a[24:27], a[76:79], v[216:219]
v_mfma_f32_16x16x32_bf16 v[220:223], a[28:31], a[76:79], v[220:223]
s_waitcnt lgkmcnt(6)
v_mfma_f32_16x16x32_bf16 v[224:227], a[16:19], a[80:83], v[224:227]
s_waitcnt vmcnt(15)
s_barrier
ds_read_b64_tr_b16 a[64:65], v16 offset:32768
v_mfma_f32_16x16x32_bf16 v[228:231], a[20:23], a[80:83], v[228:231]
ds_read_b64_tr_b16 a[66:67], v16 offset:40960
buffer_load_dwordx4 a[12:15], v11, s[48:51], s41 offen sc1
s_add_u32 s41, s41, 1024
v_mfma_f32_16x16x32_bf16 v[232:235], a[24:27], a[80:83], v[232:235]
v_mfma_f32_16x16x32_bf16 v[236:239], a[28:31], a[80:83], v[236:239]
s_waitcnt lgkmcnt(6)
v_mfma_f32_16x16x32_bf16 v[240:243], a[16:19], a[84:87], v[240:243]
ds_read_b64_tr_b16 a[68:69], v17 offset:32768
v_mfma_f32_16x16x32_bf16 v[244:247], a[20:23], a[84:87], v[244:247]
ds_read_b64_tr_b16 a[70:71], v17 offset:40960
v_mfma_f32_16x16x32_bf16 v[248:251], a[24:27], a[84:87], v[248:251]
v_mfma_f32_16x16x32_bf16 v[252:255], a[28:31], a[84:87], v[252:255]
s_waitcnt lgkmcnt(6)
v_mfma_f32_16x16x32_bf16 a[96:99], a[16:19], a[88:91], a[96:99]
ds_read_b64_tr_b16 a[72:73], v18 offset:32768
v_mfma_f32_16x16x32_bf16 a[100:103], a[20:23], a[88:91], a[100:103]
ds_read_b64_tr_b16 a[74:75], v18 offset:40960
s_add_u32 m0, s43, 126976
v_mfma_f32_16x16x32_bf16 a[104:107], a[24:27], a[88:91], a[104:107]
buffer_load_dwordx4 v15, s[52:55], s42 offen lds
s_add_u32 s42, s42, 196608
v_mfma_f32_16x16x32_bf16 a[108:111], a[28:31], a[88:91], a[108:111]
s_waitcnt lgkmcnt(6)
v_mfma_f32_16x16x32_bf16 a[112:115], a[16:19], a[92:95], a[112:115]
ds_read_b64_tr_b16 a[76:77], v19 offset:32768
v_mfma_f32_16x16x32_bf16 a[116:119], a[20:23], a[92:95], a[116:119]
ds_read_b64_tr_b16 a[78:79], v19 offset:40960
v_mfma_f32_16x16x32_bf16 a[120:123], a[24:27], a[92:95], a[120:123]
v_mfma_f32_16x16x32_bf16 a[124:127], a[28:31], a[92:95], a[124:127]
s_waitcnt lgkmcnt(6)
v_mfma_f32_16x16x32_bf16 v[32:35], a[32:35], a[64:67], v[32:35]
ds_read_b64_tr_b16 a[80:81], v20 offset:32768
v_mfma_f32_16x16x32_bf16 v[36:39], a[36:39], a[64:67], v[36:39]
ds_read_b64_tr_b16 a[82:83], v20 offset:40960
buffer_load_dwordx4 a[16:19], v8, s[48:51], s41 offen sc1
v_mfma_f32_16x16x32_bf16 v[40:43], a[40:43], a[64:67], v[40:43]
v_mfma_f32_16x16x32_bf16 v[44:47], a[44:47], a[64:67], v[44:47]
s_waitcnt lgkmcnt(6)
v_mfma_f32_16x16x32_bf16 v[48:51], a[32:35], a[68:71], v[48:51]
ds_read_b64_tr_b16 a[84:85], v21 offset:32768
v_mfma_f32_16x16x32_bf16 v[52:55], a[36:39], a[68:71], v[52:55]
ds_read_b64_tr_b16 a[86:87], v21 offset:40960
v_mfma_f32_16x16x32_bf16 v[56:59], a[40:43], a[68:71], v[56:59]
v_mfma_f32_16x16x32_bf16 v[60:63], a[44:47], a[68:71], v[60:63]
s_waitcnt lgkmcnt(6)
v_mfma_f32_16x16x32_bf16 v[64:67], a[32:35], a[72:75], v[64:67]
ds_read_b64_tr_b16 a[88:89], v22 offset:32768
v_mfma_f32_16x16x32_bf16 v[68:71], a[36:39], a[72:75], v[68:71]
ds_read_b64_tr_b16 a[90:91], v22 offset:40960
v_mfma_f32_16x16x32_bf16 v[72:75], a[40:43], a[72:75], v[72:75]
v_mfma_f32_16x16x32_bf16 v[76:79], a[44:47], a[72:75], v[76:79]
s_waitcnt lgkmcnt(6)
v_mfma_f32_16x16x32_bf16 v[80:83], a[32:35], a[76:79], v[80:83]
ds_read_b64_tr_b16 a[92:93], v23 offset:32768
v_mfma_f32_16x16x32_bf16 v[84:87], a[36:39], a[76:79], v[84:87]
ds_read_b64_tr_b16 a[94:95], v23 offset:40960
v_mfma_f32_16x16x32_bf16 v[88:91], a[40:43], a[76:79], v[88:91]
v_mfma_f32_16x16x32_bf16 v[92:95], a[44:47], a[76:79], v[92:95]
s_waitcnt lgkmcnt(6)
v_mfma_f32_16x16x32_bf16 v[96:99], a[32:35], a[80:83], v[96:99]
ds_read_b64_tr_b16 a[64:65], v16 offset:33024
v_mfma_f32_16x16x32_bf16 v[100:103], a[36:39], a[80:83], v[100:103]
ds_read_b64_tr_b16 a[66:67], v16 offset:41216
buffer_load_dwordx4 a[20:23], v9, s[48:51], s41 offen sc1
v_mfma_f32_16x16x32_bf16 v[104:107], a[40:43], a[80:83], v[104:107]
v_mfma_f32_16x16x32_bf16 v[108:111], a[44:47], a[80:83], v[108:111]
s_waitcnt lgkmcnt(6)
v_mfma_f32_16x16x32_bf16 v[112:115], a[32:35], a[84:87], v[112:115]
ds_read_b64_tr_b16 a[68:69], v17 offset:33024
v_mfma_f32_16x16x32_bf16 v[116:119], a[36:39], a[84:87], v[116:119]
ds_read_b64_tr_b16 a[70:71], v17 offset:41216
v_mfma_f32_16x16x32_bf16 v[120:123], a[40:43], a[84:87], v[120:123]
v_mfma_f32_16x16x32_bf16 v[124:127], a[44:47], a[84:87], v[124:127]
s_waitcnt lgkmcnt(6)
v_mfma_f32_16x16x32_bf16 v[128:131], a[32:35], a[88:91], v[128:131]
ds_read_b64_tr_b16 a[72:73], v18 offset:33024
v_mfma_f32_16x16x32_bf16 v[132:135], a[36:39], a[88:91], v[132:135]
ds_read_b64_tr_b16 a[74:75], v18 offset:41216
v_mfma_f32_16x16x32_bf16 v[136:139], a[40:43], a[88:91], v[136:139]
v_mfma_f32_16x16x32_bf16 v[140:143], a[44:47], a[88:91], v[140:143]
s_waitcnt lgkmcnt(6)
v_mfma_f32_16x16x32_bf16 v[144:147], a[32:35], a[92:95], v[144:147]
ds_read_b64_tr_b16 a[76:77], v19 offset:33024
v_mfma_f32_16x16x32_bf16 v[148:151], a[36:39], a[92:95], v[148:151]
ds_read_b64_tr_b16 a[78:79], v19 offset:41216
v_mfma_f32_16x16x32_bf16 v[152:155], a[40:43], a[92:95], v[152:155]
v_mfma_f32_16x16x32_bf16 v[156:159], a[44:47], a[92:95], v[156:159]
s_waitcnt lgkmcnt(6)
v_mfma_f32_16x16x32_bf16 v[160:163], a[32:35], a[64:67], v[160:163]
ds_read_b64_tr_b16 a[80:81], v20 offset:33024
v_mfma_f32_16x16x32_bf16 v[164:167], a[36:39], a[64:67], v[164:167]
ds_read_b64_tr_b16 a[82:83], v20 offset:41216
buffer_load_dwordx4 a[24:27], v10, s[48:51], s41 offen sc1
v_mfma_f32_16x16x32_bf16 v[168:171], a[40:43], a[64:67], v[168:171]
v_mfma_f32_16x16x32_bf16 v[172:175], a[44:47], a[64:67], v[172:175]
s_waitcnt lgkmcnt(6)
v_mfma_f32_16x16x32_bf16 v[176:179], a[32:35], a[68:71], v[176:179]
ds_read_b64_tr_b16 a[84:85], v21 offset:33024
v_mfma_f32_16x16x32_bf16 v[180:183], a[36:39], a[68:71], v[180:183]
ds_read_b64_tr_b16 a[86:87], v21 offset:41216
v_mfma_f32_16x16x32_bf16 v[184:187], a[40:43], a[68:71], v[184:187]
v_mfma_f32_16x16x32_bf16 v[188:191], a[44:47], a[68:71], v[188:191]
s_waitcnt lgkmcnt(6)
v_mfma_f32_16x16x32_bf16 v[192:195], a[32:35], a[72:75], v[192:195]
ds_read_b64_tr_b16 a[88:89], v22 offset:33024
v_mfma_f32_16x16x32_bf16 v[196:199], a[36:39], a[72:75], v[196:199]
ds_read_b64_tr_b16 a[90:91], v22 offset:41216
v_mfma_f32_16x16x32_bf16 v[200:203], a[40:43], a[72:75], v[200:203]
v_mfma_f32_16x16x32_bf16 v[204:207], a[44:47], a[72:75], v[204:207]
s_waitcnt lgkmcnt(6)
v_mfma_f32_16x16x32_bf16 v[208:211], a[32:35], a[76:79], v[208:211]
ds_read_b64_tr_b16 a[92:93], v23 offset:33024
v_mfma_f32_16x16x32_bf16 v[212:215], a[36:39], a[76:79], v[212:215]
ds_read_b64_tr_b16 a[94:95], v23 offset:41216
v_mfma_f32_16x16x32_bf16 v[216:219], a[40:43], a[76:79], v[216:219]
v_mfma_f32_16x16x32_bf16 v[220:223], a[44:47], a[76:79], v[220:223]
s_waitcnt lgkmcnt(6)
v_mfma_f32_16x16x32_bf16 v[224:227], a[32:35], a[80:83], v[224:227]
s_waitcnt vmcnt(12)
s_barrier
ds_read_b64_tr_b16 a[64:65], v16 offset:49152
v_mfma_f32_16x16x32_bf16 v[228:231], a[36:39], a[80:83], v[228:231]
ds_read_b64_tr_b16 a[66:67], v16 offset:57344
buffer_load_dwordx4 a[28:31], v11, s[48:51], s41 offen sc1
s_add_u32 s41, s41, 1024
v_mfma_f32_16x16x32_bf16 v[232:235], a[40:43], a[80:83], v[232:235]
v_mfma_f32_16x16x32_bf16 v[236:239], a[44:47], a[80:83], v[236:239]
s_waitcnt lgkmcnt(6)
v_mfma_f32_16x16x32_bf16 v[240:243], a[32:35], a[84:87], v[240:243]
ds_read_b64_tr_b16 a[68:69], v17 offset:49152
v_mfma_f32_16x16x32_bf16 v[244:247], a[36:39], a[84:87], v[244:247]
ds_read_b64_tr_b16 a[70:71], v17 offset:57344
v_mfma_f32_16x16x32_bf16 v[248:251], a[40:43], a[84:87], v[248:251]
v_mfma_f32_16x16x32_bf16 v[252:255], a[44:47], a[84:87], v[252:255]
s_waitcnt lgkmcnt(6)
v_mfma_f32_16x16x32_bf16 a[96:99], a[32:35], a[88:91], a[96:99]
ds_read_b64_tr_b16 a[72:73], v18 offset:49152
v_mfma_f32_16x16x32_bf16 a[100:103], a[36:39], a[88:91], a[100:103]
ds_read_b64_tr_b16 a[74:75], v18 offset:57344
v_mfma_f32_16x16x32_bf16 a[104:107], a[40:43], a[88:91], a[104:107]
v_mfma_f32_16x16x32_bf16 a[108:111], a[44:47], a[88:91], a[108:111]
s_waitcnt lgkmcnt(6)
v_mfma_f32_16x16x32_bf16 a[112:115], a[32:35], a[92:95], a[112:115]
ds_read_b64_tr_b16 a[76:77], v19 offset:49152
v_mfma_f32_16x16x32_bf16 a[116:119], a[36:39], a[92:95], a[116:119]
ds_read_b64_tr_b16 a[78:79], v19 offset:57344
v_mfma_f32_16x16x32_bf16 a[120:123], a[40:43], a[92:95], a[120:123]
v_mfma_f32_16x16x32_bf16 a[124:127], a[44:47], a[92:95], a[124:127]
s_waitcnt lgkmcnt(6)
v_mfma_f32_16x16x32_bf16 v[32:35], a[48:51], a[64:67], v[32:35]
ds_read_b64_tr_b16 a[80:81], v20 offset:49152
v_mfma_f32_16x16x32_bf16 v[36:39], a[52:55], a[64:67], v[36:39]
ds_read_b64_tr_b16 a[82:83], v20 offset:57344
buffer_load_dwordx4 a[32:35], v8, s[48:51], s41 offen sc1
v_mfma_f32_16x16x32_bf16 v[40:43], a[56:59], a[64:67], v[40:43]
v_mfma_f32_16x16x32_bf16 v[44:47], a[60:63], a[64:67], v[44:47]
s_waitcnt lgkmcnt(6)
v_mfma_f32_16x16x32_bf16 v[48:51], a[48:51], a[68:71], v[48:51]
ds_read_b64_tr_b16 a[84:85], v21 offset:49152
v_mfma_f32_16x16x32_bf16 v[52:55], a[52:55], a[68:71], v[52:55]
ds_read_b64_tr_b16 a[86:87], v21 offset:57344
v_mfma_f32_16x16x32_bf16 v[56:59], a[56:59], a[68:71], v[56:59]
v_mfma_f32_16x16x32_bf16 v[60:63], a[60:63], a[68:71], v[60:63]
s_waitcnt lgkmcnt(6)
v_mfma_f32_16x16x32_bf16 v[64:67], a[48:51], a[72:75], v[64:67]
ds_read_b64_tr_b16 a[88:89], v22 offset:49152
v_mfma_f32_16x16x32_bf16 v[68:71], a[52:55], a[72:75], v[68:71]
ds_read_b64_tr_b16 a[90:91], v22 offset:57344
v_mfma_f32_16x16x32_bf16 v[72:75], a[56:59], a[72:75], v[72:75]
v_mfma_f32_16x16x32_bf16 v[76:79], a[60:63], a[72:75], v[76:79]
s_waitcnt lgkmcnt(6)
v_mfma_f32_16x16x32_bf16 v[80:83], a[48:51], a[76:79], v[80:83]
ds_read_b64_tr_b16 a[92:93], v23 offset:49152
v_mfma_f32_16x16x32_bf16 v[84:87], a[52:55], a[76:79], v[84:87]
ds_read_b64_tr_b16 a[94:95], v23 offset:57344
v_mfma_f32_16x16x32_bf16 v[88:91], a[56:59], a[76:79], v[88:91]
v_mfma_f32_16x16x32_bf16 v[92:95], a[60:63], a[76:79], v[92:95]
s_waitcnt lgkmcnt(6)
v_mfma_f32_16x16x32_bf16 v[96:99], a[48:51], a[80:83], v[96:99]
ds_read_b64_tr_b16 a[64:65], v16 offset:49408
v_mfma_f32_16x16x32_bf16 v[100:103], a[52:55], a[80:83], v[100:103]
ds_read_b64_tr_b16 a[66:67], v16 offset:57600
buffer_load_dwordx4 a[36:39], v9, s[48:51], s41 offen sc1
v_mfma_f32_16x16x32_bf16 v[104:107], a[56:59], a[80:83], v[104:107]
v_mfma_f32_16x16x32_bf16 v[108:111], a[60:63], a[80:83], v[108:111]
s_waitcnt lgkmcnt(6)
v_mfma_f32_16x16x32_bf16 v[112:115], a[48:51], a[84:87], v[112:115]
ds_read_b64_tr_b16 a[68:69], v17 offset:49408
v_mfma_f32_16x16x32_bf16 v[116:119], a[52:55], a[84:87], v[116:119]
ds_read_b64_tr_b16 a[70:71], v17 offset:57600
v_mfma_f32_16x16x32_bf16 v[120:123], a[56:59], a[84:87], v[120:123]
v_mfma_f32_16x16x32_bf16 v[124:127], a[60:63], a[84:87], v[124:127]
s_waitcnt lgkmcnt(6)
v_mfma_f32_16x16x32_bf16 v[128:131], a[48:51], a[88:91], v[128:131]
ds_read_b64_tr_b16 a[72:73], v18 offset:49408
v_mfma_f32_16x16x32_bf16 v[132:135], a[52:55], a[88:91], v[132:135]
ds_read_b64_tr_b16 a[74:75], v18 offset:57600
v_mfma_f32_16x16x32_bf16 v[136:139], a[56:59], a[88:91], v[136:139]
v_mfma_f32_16x16x32_bf16 v[140:143], a[60:63], a[88:91], v[140:143]
s_waitcnt lgkmcnt(6)
v_mfma_f32_16x16x32_bf16 v[144:147], a[48:51], a[92:95], v[144:147]
ds_read_b64_tr_b16 a[76:77], v19 offset:49408
v_mfma_f32_16x16x32_bf16 v[148:151], a[52:55], a[92:95], v[148:151]
ds_read_b64_tr_b16 a[78:79], v19 offset:57600
v_mfma_f32_16x16x32_bf16 v[152:155], a[56:59], a[92:95], v[152:155]
v_mfma_f32_16x16x32_bf16 v[156:159], a[60:63], a[92:95], v[156:159]
s_waitcnt lgkmcnt(6)
v_mfma_f32_16x16x32_bf16 v[160:163], a[48:51], a[64:67], v[160:163]
ds_read_b64_tr_b16 a[80:81], v20 offset:49408
v_mfma_f32_16x16x32_bf16 v[164:167], a[52:55], a[64:67], v[164:167]
ds_read_b64_tr_b16 a[82:83], v20 offset:57600
buffer_load_dwordx4 a[40:43], v10, s[48:51], s41 offen sc1
v_mfma_f32_16x16x32_bf16 v[168:171], a[56:59], a[64:67], v[168:171]
v_mfma_f32_16x16x32_bf16 v[172:175], a[60:63], a[64:67], v[172:175]
s_waitcnt lgkmcnt(6)
v_mfma_f32_16x16x32_bf16 v[176:179], a[48:51], a[68:71], v[176:179]
ds_read_b64_tr_b16 a[84:85], v21 offset:49408
v_mfma_f32_16x16x32_bf16 v[180:183], a[52:55], a[68:71], v[180:183]
ds_read_b64_tr_b16 a[86:87], v21 offset:57600
v_mfma_f32_16x16x32_bf16 v[184:187], a[56:59], a[68:71], v[184:187]
v_mfma_f32_16x16x32_bf16 v[188:191], a[60:63], a[68:71], v[188:191]
s_waitcnt lgkmcnt(6)
v_mfma_f32_16x16x32_bf16 v[192:195], a[48:51], a[72:75], v[192:195]
ds_read_b64_tr_b16 a[88:89], v22 offset:49408
v_mfma_f32_16x16x32_bf16 v[196:199], a[52:55], a[72:75], v[196:199]
ds_read_b64_tr_b16 a[90:91], v22 offset:57600
v_mfma_f32_16x16x32_bf16 v[200:203], a[56:59], a[72:75], v[200:203]
v_mfma_f32_16x16x32_bf16 v[204:207], a[60:63], a[72:75], v[204:207]
s_waitcnt lgkmcnt(6)
v_mfma_f32_16x16x32_bf16 v[208:211], a[48:51], a[76:79], v[208:211]
ds_read_b64_tr_b16 a[92:93], v23 offset:49408
v_mfma_f32_16x16x32_bf16 v[212:215], a[52:55], a[76:79], v[212:215]
ds_read_b64_tr_b16 a[94:95], v23 offset:57600
v_mfma_f32_16x16x32_bf16 v[216:219], a[56:59], a[76:79], v[216:219]
v_mfma_f32_16x16x32_bf16 v[220:223], a[60:63], a[76:79], v[220:223]
s_waitcnt lgkmcnt(6)
v_mfma_f32_16x16x32_bf16 v[224:227], a[48:51], a[80:83], v[224:227]
s_waitcnt vmcnt(8)
s_barrier
ds_read_b64_tr_b16 a[64:65], v24 offset:0
v_mfma_f32_16x16x32_bf16 v[228:231], a[52:55], a[80:83], v[228:231]
ds_read_b64_tr_b16 a[66:67], v24 offset:8192
buffer_load_dwordx4 a[44:47], v11, s[48:51], s41 offen sc1
s_add_u32 s41, s41, 1024
v_mfma_f32_16x16x32_bf16 v[232:235], a[56:59], a[80:83], v[232:235]
v_mfma_f32_16x16x32_bf16 v[236:239], a[60:63], a[80:83], v[236:239]
s_waitcnt lgkmcnt(6)
v_mfma_f32_16x16x32_bf16 v[240:243], a[48:51], a[84:87], v[240:243]
ds_read_b64_tr_b16 a[68:69], v25 offset:0
v_mfma_f32_16x16x32_bf16 v[244:247], a[52:55], a[84:87], v[244:247]
ds_read_b64_tr_b16 a[70:71], v25 offset:8192
v_mfma_f32_16x16x32_bf16 v[248:251], a[56:59], a[84:87], v[248:251]
v_mfma_f32_16x16x32_bf16 v[252:255], a[60:63], a[84:87], v[252:255]
s_waitcnt lgkmcnt(6)
v_mfma_f32_16x16x32_bf16 a[96:99], a[48:51], a[88:91], a[96:99]
ds_read_b64_tr_b16 a[72:73], v26 offset:0
v_mfma_f32_16x16x32_bf16 a[100:103], a[52:55], a[88:91], a[100:103]
ds_read_b64_tr_b16 a[74:75], v26 offset:8192
v_mfma_f32_16x16x32_bf16 a[104:107], a[56:59], a[88:91], a[104:107]
v_mfma_f32_16x16x32_bf16 a[108:111], a[60:63], a[88:91], a[108:111]
s_waitcnt lgkmcnt(6)
v_mfma_f32_16x16x32_bf16 a[112:115], a[48:51], a[92:95], a[112:115]
ds_read_b64_tr_b16 a[76:77], v27 offset:0
v_mfma_f32_16x16x32_bf16 a[116:119], a[52:55], a[92:95], a[116:119]
ds_read_b64_tr_b16 a[78:79], v27 offset:8192
v_mfma_f32_16x16x32_bf16 a[120:123], a[56:59], a[92:95], a[120:123]
v_mfma_f32_16x16x32_bf16 a[124:127], a[60:63], a[92:95], a[124:127]
s_waitcnt lgkmcnt(6)
v_mfma_f32_16x16x32_bf16 v[32:35], a[0:3], a[64:67], v[32:35]
ds_read_b64_tr_b16 a[80:81], v28 offset:0
v_mfma_f32_16x16x32_bf16 v[36:39], a[4:7], a[64:67], v[36:39]
ds_read_b64_tr_b16 a[82:83], v28 offset:8192
buffer_load_dwordx4 a[48:51], v8, s[48:51], s41 offen sc1
v_mfma_f32_16x16x32_bf16 v[40:43], a[8:11], a[64:67], v[40:43]
v_mfma_f32_16x16x32_bf16 v[44:47], a[12:15], a[64:67], v[44:47]
s_waitcnt lgkmcnt(6)
v_mfma_f32_16x16x32_bf16 v[48:51], a[0:3], a[68:71], v[48:51]
ds_read_b64_tr_b16 a[84:85], v29 offset:0
v_mfma_f32_16x16x32_bf16 v[52:55], a[4:7], a[68:71], v[52:55]
ds_read_b64_tr_b16 a[86:87], v29 offset:8192
v_mfma_f32_16x16x32_bf16 v[56:59], a[8:11], a[68:71], v[56:59]
v_mfma_f32_16x16x32_bf16 v[60:63], a[12:15], a[68:71], v[60:63]
s_waitcnt lgkmcnt(6)
v_mfma_f32_16x16x32_bf16 v[64:67], a[0:3], a[72:75], v[64:67]
ds_read_b64_tr_b16 a[88:89], v30 offset:0
v_mfma_f32_16x16x32_bf16 v[68:71], a[4:7], a[72:75], v[68:71]
ds_read_b64_tr_b16 a[90:91], v30 offset:8192
v_mfma_f32_16x16x32_bf16 v[72:75], a[8:11], a[72:75], v[72:75]
v_mfma_f32_16x16x32_bf16 v[76:79], a[12:15], a[72:75], v[76:79]
s_waitcnt lgkmcnt(6)
v_mfma_f32_16x16x32_bf16 v[80:83], a[0:3], a[76:79], v[80:83]
ds_read_b64_tr_b16 a[92:93], v31 offset:0
v_mfma_f32_16x16x32_bf16 v[84:87], a[4:7], a[76:79], v[84:87]
ds_read_b64_tr_b16 a[94:95], v31 offset:8192
v_mfma_f32_16x16x32_bf16 v[88:91], a[8:11], a[76:79], v[88:91]
v_mfma_f32_16x16x32_bf16 v[92:95], a[12:15], a[76:79], v[92:95]
s_waitcnt lgkmcnt(6)
v_mfma_f32_16x16x32_bf16 v[96:99], a[0:3], a[80:83], v[96:99]
ds_read_b64_tr_b16 a[64:65], v24 offset:256
v_mfma_f32_16x16x32_bf16 v[100:103], a[4:7], a[80:83], v[100:103]
ds_read_b64_tr_b16 a[66:67], v24 offset:8448
buffer_load_dwordx4 a[52:55], v9, s[48:51], s41 offen sc1
v_mfma_f32_16x16x32_bf16 v[104:107], a[8:11], a[80:83], v[104:107]
v_mfma_f32_16x16x32_bf16 v[108:111], a[12:15], a[80:83], v[108:111]
s_waitcnt lgkmcnt(6)
v_mfma_f32_16x16x32_bf16 v[112:115], a[0:3], a[84:87], v[112:115]
ds_read_b64_tr_b16 a[68:69], v25 offset:256
v_mfma_f32_16x16x32_bf16 v[116:119], a[4:7], a[84:87], v[116:119]
ds_read_b64_tr_b16 a[70:71], v25 offset:8448
v_mfma_f32_16x16x32_bf16 v[120:123], a[8:11], a[84:87], v[120:123]
v_mfma_f32_16x16x32_bf16 v[124:127], a[12:15], a[84:87], v[124:127]
s_waitcnt lgkmcnt(6)
v_mfma_f32_16x16x32_bf16 v[128:131], a[0:3], a[88:91], v[128:131]
ds_read_b64_tr_b16 a[72:73], v26 offset:256
v_mfma_f32_16x16x32_bf16 v[132:135], a[4:7], a[88:91], v[132:135]
ds_read_b64_tr_b16 a[74:75], v26 offset:8448
v_mfma_f32_16x16x32_bf16 v[136:139], a[8:11], a[88:91], v[136:139]
v_mfma_f32_16x16x32_bf16 v[140:143], a[12:15], a[88:91], v[140:143]
s_waitcnt lgkmcnt(6)
v_mfma_f32_16x16x32_bf16 v[144:147], a[0:3], a[92:95], v[144:147]
ds_read_b64_tr_b16 a[76:77], v27 offset:256
v_mfma_f32_16x16x32_bf16 v[148:151], a[4:7], a[92:95], v[148:151]
ds_read_b64_tr_b16 a[78:79], v27 offset:8448
v_mfma_f32_16x16x32_bf16 v[152:155], a[8:11], a[92:95], v[152:155]
v_mfma_f32_16x16x32_bf16 v[156:159], a[12:15], a[92:95], v[156:159]
s_waitcnt lgkmcnt(6)
v_mfma_f32_16x16x32_bf16 v[160:163], a[0:3], a[64:67], v[160:163]
ds_read_b64_tr_b16 a[80:81], v28 offset:256
v_mfma_f32_16x16x32_bf16 v[164:167], a[4:7], a[64:67], v[164:167]
ds_read_b64_tr_b16 a[82:83], v28 offset:8448
buffer_load_dwordx4 a[56:59], v10, s[48:51], s41 offen sc1
v_mfma_f32_16x16x32_bf16 v[168:171], a[8:11], a[64:67], v[168:171]
v_mfma_f32_16x16x32_bf16 v[172:175], a[12:15], a[64:67], v[172:175]
s_waitcnt lgkmcnt(6)
v_mfma_f32_16x16x32_bf16 v[176:179], a[0:3], a[68:71], v[176:179]
ds_read_b64_tr_b16 a[84:85], v29 offset:256
v_mfma_f32_16x16x32_bf16 v[180:183], a[4:7], a[68:71], v[180:183]
ds_read_b64_tr_b16 a[86:87], v29 offset:8448
v_mfma_f32_16x16x32_bf16 v[184:187], a[8:11], a[68:71], v[184:187]
v_mfma_f32_16x16x32_bf16 v[188:191], a[12:15], a[68:71], v[188:191]
s_waitcnt lgkmcnt(6)
v_mfma_f32_16x16x32_bf16 v[192:195], a[0:3], a[72:75], v[192:195]
ds_read_b64_tr_b16 a[88:89], v30 offset:256
v_mfma_f32_16x16x32_bf16 v[196:199], a[4:7], a[72:75], v[196:199]
ds_read_b64_tr_b16 a[90:91], v30 offset:8448
v_mfma_f32_16x16x32_bf16 v[200:203], a[8:11], a[72:75], v[200:203]
v_mfma_f32_16x16x32_bf16 v[204:207], a[12:15], a[72:75], v[204:207]
s_waitcnt lgkmcnt(6)
v_mfma_f32_16x16x32_bf16 v[208:211], a[0:3], a[76:79], v[208:211]
ds_read_b64_tr_b16 a[92:93], v31 offset:256
v_mfma_f32_16x16x32_bf16 v[212:215], a[4:7], a[76:79], v[212:215]
ds_read_b64_tr_b16 a[94:95], v31 offset:8448
v_mfma_f32_16x16x32_bf16 v[216:219], a[8:11], a[76:79], v[216:219]
v_mfma_f32_16x16x32_bf16 v[220:223], a[12:15], a[76:79], v[220:223]
s_waitcnt lgkmcnt(6)
v_mfma_f32_16x16x32_bf16 v[224:227], a[0:3], a[80:83], v[224:227]
s_waitcnt vmcnt(7)
s_barrier
ds_read_b64_tr_b16 a[64:65], v24 offset:16384
v_mfma_f32_16x16x32_bf16 v[228:231], a[4:7], a[80:83], v[228:231]
ds_read_b64_tr_b16 a[66:67], v24 offset:24576
buffer_load_dwordx4 a[60:63], v11, s[48:51], s41 offen sc1
s_add_u32 s41, s41, 1024
v_mfma_f32_16x16x32_bf16 v[232:235], a[8:11], a[80:83], v[232:235]
v_mfma_f32_16x16x32_bf16 v[236:239], a[12:15], a[80:83], v[236:239]
s_waitcnt lgkmcnt(6)
v_mfma_f32_16x16x32_bf16 v[240:243], a[0:3], a[84:87], v[240:243]
ds_read_b64_tr_b16 a[68:69], v25 offset:16384
v_mfma_f32_16x16x32_bf16 v[244:247], a[4:7], a[84:87], v[244:247]
ds_read_b64_tr_b16 a[70:71], v25 offset:24576
v_mfma_f32_16x16x32_bf16 v[248:251], a[8:11], a[84:87], v[248:251]
v_mfma_f32_16x16x32_bf16 v[252:255], a[12:15], a[84:87], v[252:255]
s_waitcnt lgkmcnt(6)
v_mfma_f32_16x16x32_bf16 a[96:99], a[0:3], a[88:91], a[96:99]
ds_read_b64_tr_b16 a[72:73], v26 offset:16384
v_mfma_f32_16x16x32_bf16 a[100:103], a[4:7], a[88:91], a[100:103]
ds_read_b64_tr_b16 a[74:75], v26 offset:24576
v_mfma_f32_16x16x32_bf16 a[104:107], a[8:11], a[88:91], a[104:107]
v_mfma_f32_16x16x32_bf16 a[108:111], a[12:15], a[88:91], a[108:111]
s_waitcnt lgkmcnt(6)
v_mfma_f32_16x16x32_bf16 a[112:115], a[0:3], a[92:95], a[112:115]
ds_read_b64_tr_b16 a[76:77], v27 offset:16384
v_mfma_f32_16x16x32_bf16 a[116:119], a[4:7], a[92:95], a[116:119]
ds_read_b64_tr_b16 a[78:79], v27 offset:24576
v_mfma_f32_16x16x32_bf16 a[120:123], a[8:11], a[92:95], a[120:123]
v_mfma_f32_16x16x32_bf16 a[124:127], a[12:15], a[92:95], a[124:127]
s_waitcnt lgkmcnt(6)
v_mfma_f32_16x16x32_bf16 v[32:35], a[16:19], a[64:67], v[32:35]
ds_read_b64_tr_b16 a[80:81], v28 offset:16384
v_mfma_f32_16x16x32_bf16 v[36:39], a[20:23], a[64:67], v[36:39]
ds_read_b64_tr_b16 a[82:83], v28 offset:24576
v_mfma_f32_16x16x32_bf16 v[40:43], a[24:27], a[64:67], v[40:43]
v_mfma_f32_16x16x32_bf16 v[44:47], a[28:31], a[64:67], v[44:47]
s_waitcnt lgkmcnt(6)
v_mfma_f32_16x16x32_bf16 v[48:51], a[16:19], a[68:71], v[48:51]
ds_read_b64_tr_b16 a[84:85], v29 offset:16384
v_mfma_f32_16x16x32_bf16 v[52:55], a[20:23], a[68:71], v[52:55]
ds_read_b64_tr_b16 a[86:87], v29 offset:24576
v_mfma_f32_16x16x32_bf16 v[56:59], a[24:27], a[68:71], v[56:59]
v_mfma_f32_16x16x32_bf16 v[60:63], a[28:31], a[68:71], v[60:63]
s_waitcnt lgkmcnt(6)
v_mfma_f32_16x16x32_bf16 v[64:67], a[16:19], a[72:75], v[64:67]
ds_read_b64_tr_b16 a[88:89], v30 offset:16384
v_mfma_f32_16x16x32_bf16 v[68:71], a[20:23], a[72:75], v[68:71]
ds_read_b64_tr_b16 a[90:91], v30 offset:24576
v_mfma_f32_16x16x32_bf16 v[72:75], a[24:27], a[72:75], v[72:75]
v_mfma_f32_16x16x32_bf16 v[76:79], a[28:31], a[72:75], v[76:79]
s_waitcnt lgkmcnt(6)
v_mfma_f32_16x16x32_bf16 v[80:83], a[16:19], a[76:79], v[80:83]
ds_read_b64_tr_b16 a[92:93], v31 offset:16384
v_mfma_f32_16x16x32_bf16 v[84:87], a[20:23], a[76:79], v[84:87]
ds_read_b64_tr_b16 a[94:95], v31 offset:24576
v_mfma_f32_16x16x32_bf16 v[88:91], a[24:27], a[76:79], v[88:91]
v_mfma_f32_16x16x32_bf16 v[92:95], a[28:31], a[76:79], v[92:95]
s_waitcnt lgkmcnt(6)
v_mfma_f32_16x16x32_bf16 v[96:99], a[16:19], a[80:83], v[96:99]
ds_read_b64_tr_b16 a[64:65], v24 offset:16640
v_mfma_f32_16x16x32_bf16 v[100:103], a[20:23], a[80:83], v[100:103]
ds_read_b64_tr_b16 a[66:67], v24 offset:24832
v_mfma_f32_16x16x32_bf16 v[104:107], a[24:27], a[80:83], v[104:107]
v_mfma_f32_16x16x32_bf16 v[108:111], a[28:31], a[80:83], v[108:111]
s_waitcnt lgkmcnt(6)
v_mfma_f32_16x16x32_bf16 v[112:115], a[16:19], a[84:87], v[112:115]
ds_read_b64_tr_b16 a[68:69], v25 offset:16640
v_mfma_f32_16x16x32_bf16 v[116:119], a[20:23], a[84:87], v[116:119]
ds_read_b64_tr_b16 a[70:71], v25 offset:24832
v_mfma_f32_16x16x32_bf16 v[120:123], a[24:27], a[84:87], v[120:123]
v_mfma_f32_16x16x32_bf16 v[124:127], a[28:31], a[84:87], v[124:127]
s_waitcnt lgkmcnt(6)
v_mfma_f32_16x16x32_bf16 v[128:131], a[16:19], a[88:91], v[128:131]
ds_read_b64_tr_b16 a[72:73], v26 offset:16640
v_mfma_f32_16x16x32_bf16 v[132:135], a[20:23], a[88:91], v[132:135]
ds_read_b64_tr_b16 a[74:75], v26 offset:24832
v_mfma_f32_16x16x32_bf16 v[136:139], a[24:27], a[88:91], v[136:139]
v_mfma_f32_16x16x32_bf16 v[140:143], a[28:31], a[88:91], v[140:143]
s_waitcnt lgkmcnt(6)
v_mfma_f32_16x16x32_bf16 v[144:147], a[16:19], a[92:95], v[144:147]
ds_read_b64_tr_b16 a[76:77], v27 offset:16640
v_mfma_f32_16x16x32_bf16 v[148:151], a[20:23], a[92:95], v[148:151]
ds_read_b64_tr_b16 a[78:79], v27 offset:24832
v_mfma_f32_16x16x32_bf16 v[152:155], a[24:27], a[92:95], v[152:155]
v_mfma_f32_16x16x32_bf16 v[156:159], a[28:31], a[92:95], v[156:159]
s_waitcnt lgkmcnt(6)
v_mfma_f32_16x16x32_bf16 v[160:163], a[16:19], a[64:67], v[160:163]
ds_read_b64_tr_b16 a[80:81], v28 offset:16640
v_mfma_f32_16x16x32_bf16 v[164:167], a[20:23], a[64:67], v[164:167]
ds_read_b64_tr_b16 a[82:83], v28 offset:24832
v_mfma_f32_16x16x32_bf16 v[168:171], a[24:27], a[64:67], v[168:171]
v_mfma_f32_16x16x32_bf16 v[172:175], a[28:31], a[64:67], v[172:175]
s_waitcnt lgkmcnt(6)
v_mfma_f32_16x16x32_bf16 v[176:179], a[16:19], a[68:71], v[176:179]
ds_read_b64_tr_b16 a[84:85], v29 offset:16640
v_mfma_f32_16x16x32_bf16 v[180:183], a[20:23], a[68:71], v[180:183]
ds_read_b64_tr_b16 a[86:87], v29 offset:24832
v_mfma_f32_16x16x32_bf16 v[184:187], a[24:27], a[68:71], v[184:187]
v_mfma_f32_16x16x32_bf16 v[188:191], a[28:31], a[68:71], v[188:191]
s_waitcnt lgkmcnt(6)
v_mfma_f32_16x16x32_bf16 v[192:195], a[16:19], a[72:75], v[192:195]
ds_read_b64_tr_b16 a[88:89], v30 offset:16640
v_mfma_f32_16x16x32_bf16 v[196:199], a[20:23], a[72:75], v[196:199]
ds_read_b64_tr_b16 a[90:91], v30 offset:24832
v_mfma_f32_16x16x32_bf16 v[200:203], a[24:27], a[72:75], v[200:203]
v_mfma_f32_16x16x32_bf16 v[204:207], a[28:31], a[72:75], v[204:207]
s_waitcnt lgkmcnt(6)
v_mfma_f32_16x16x32_bf16 v[208:211], a[16:19], a[76:79], v[208:211]
ds_read_b64_tr_b16 a[92:93], v31 offset:16640
v_mfma_f32_16x16x32_bf16 v[212:215], a[20:23], a[76:79], v[212:215]
ds_read_b64_tr_b16 a[94:95], v31 offset:24832
v_mfma_f32_16x16x32_bf16 v[216:219], a[24:27], a[76:79], v[216:219]
v_mfma_f32_16x16x32_bf16 v[220:223], a[28:31], a[76:79], v[220:223]
s_waitcnt lgkmcnt(6)
v_mfma_f32_16x16x32_bf16 v[224:227], a[16:19], a[80:83], v[224:227]
s_waitcnt vmcnt(4)
s_barrier
ds_read_b64_tr_b16 a[64:65], v24 offset:32768
v_mfma_f32_16x16x32_bf16 v[228:231], a[20:23], a[80:83], v[228:231]
ds_read_b64_tr_b16 a[66:67], v24 offset:40960
v_mfma_f32_16x16x32_bf16 v[232:235], a[24:27], a[80:83], v[232:235]
v_mfma_f32_16x16x32_bf16 v[236:239], a[28:31], a[80:83], v[236:239]
s_waitcnt lgkmcnt(6)
v_mfma_f32_16x16x32_bf16 v[240:243], a[16:19], a[84:87], v[240:243]
ds_read_b64_tr_b16 a[68:69], v25 offset:32768
v_mfma_f32_16x16x32_bf16 v[244:247], a[20:23], a[84:87], v[244:247]
ds_read_b64_tr_b16 a[70:71], v25 offset:40960
v_mfma_f32_16x16x32_bf16 v[248:251], a[24:27], a[84:87], v[248:251]
v_mfma_f32_16x16x32_bf16 v[252:255], a[28:31], a[84:87], v[252:255]
s_waitcnt lgkmcnt(6)
v_mfma_f32_16x16x32_bf16 a[96:99], a[16:19], a[88:91], a[96:99]
ds_read_b64_tr_b16 a[72:73], v26 offset:32768
v_mfma_f32_16x16x32_bf16 a[100:103], a[20:23], a[88:91], a[100:103]
ds_read_b64_tr_b16 a[74:75], v26 offset:40960
v_mfma_f32_16x16x32_bf16 a[104:107], a[24:27], a[88:91], a[104:107]
v_mfma_f32_16x16x32_bf16 a[108:111], a[28:31], a[88:91], a[108:111]
s_waitcnt lgkmcnt(6)
v_mfma_f32_16x16x32_bf16 a[112:115], a[16:19], a[92:95], a[112:115]
ds_read_b64_tr_b16 a[76:77], v27 offset:32768
v_mfma_f32_16x16x32_bf16 a[116:119], a[20:23], a[92:95], a[116:119]
ds_read_b64_tr_b16 a[78:79], v27 offset:40960
v_mfma_f32_16x16x32_bf16 a[120:123], a[24:27], a[92:95], a[120:123]
v_mfma_f32_16x16x32_bf16 a[124:127], a[28:31], a[92:95], a[124:127]
s_waitcnt lgkmcnt(6)
v_mfma_f32_16x16x32_bf16 v[32:35], a[32:35], a[64:67], v[32:35]
ds_read_b64_tr_b16 a[80:81], v28 offset:32768
v_mfma_f32_16x16x32_bf16 v[36:39], a[36:39], a[64:67], v[36:39]
ds_read_b64_tr_b16 a[82:83], v28 offset:40960
v_mfma_f32_16x16x32_bf16 v[40:43], a[40:43], a[64:67], v[40:43]
v_mfma_f32_16x16x32_bf16 v[44:47], a[44:47], a[64:67], v[44:47]
s_waitcnt lgkmcnt(6)
v_mfma_f32_16x16x32_bf16 v[48:51], a[32:35], a[68:71], v[48:51]
ds_read_b64_tr_b16 a[84:85], v29 offset:32768
v_mfma_f32_16x16x32_bf16 v[52:55], a[36:39], a[68:71], v[52:55]
ds_read_b64_tr_b16 a[86:87], v29 offset:40960
v_mfma_f32_16x16x32_bf16 v[56:59], a[40:43], a[68:71], v[56:59]
v_mfma_f32_16x16x32_bf16 v[60:63], a[44:47], a[68:71], v[60:63]
s_waitcnt lgkmcnt(6)
v_mfma_f32_16x16x32_bf16 v[64:67], a[32:35], a[72:75], v[64:67]
ds_read_b64_tr_b16 a[88:89], v30 offset:32768
v_mfma_f32_16x16x32_bf16 v[68:71], a[36:39], a[72:75], v[68:71]
ds_read_b64_tr_b16 a[90:91], v30 offset:40960
v_mfma_f32_16x16x32_bf16 v[72:75], a[40:43], a[72:75], v[72:75]
v_mfma_f32_16x16x32_bf16 v[76:79], a[44:47], a[72:75], v[76:79]
s_waitcnt lgkmcnt(6)
v_mfma_f32_16x16x32_bf16 v[80:83], a[32:35], a[76:79], v[80:83]
ds_read_b64_tr_b16 a[92:93], v31 offset:32768
v_mfma_f32_16x16x32_bf16 v[84:87], a[36:39], a[76:79], v[84:87]
ds_read_b64_tr_b16 a[94:95], v31 offset:40960
v_mfma_f32_16x16x32_bf16 v[88:91], a[40:43], a[76:79], v[88:91]
v_mfma_f32_16x16x32_bf16 v[92:95], a[44:47], a[76:79], v[92:95]
s_waitcnt lgkmcnt(6)
v_mfma_f32_16x16x32_bf16 v[96:99], a[32:35], a[80:83], v[96:99]
ds_read_b64_tr_b16 a[64:65], v24 offset:33024
v_mfma_f32_16x16x32_bf16 v[100:103], a[36:39], a[80:83], v[100:103]
ds_read_b64_tr_b16 a[66:67], v24 offset:41216
v_mfma_f32_16x16x32_bf16 v[104:107], a[40:43], a[80:83], v[104:107]
v_mfma_f32_16x16x32_bf16 v[108:111], a[44:47], a[80:83], v[108:111]
s_waitcnt lgkmcnt(6)
v_mfma_f32_16x16x32_bf16 v[112:115], a[32:35], a[84:87], v[112:115]
ds_read_b64_tr_b16 a[68:69], v25 offset:33024
v_mfma_f32_16x16x32_bf16 v[116:119], a[36:39], a[84:87], v[116:119]
ds_read_b64_tr_b16 a[70:71], v25 offset:41216
v_mfma_f32_16x16x32_bf16 v[120:123], a[40:43], a[84:87], v[120:123]
v_mfma_f32_16x16x32_bf16 v[124:127], a[44:47], a[84:87], v[124:127]
s_waitcnt lgkmcnt(6)
v_mfma_f32_16x16x32_bf16 v[128:131], a[32:35], a[88:91], v[128:131]
ds_read_b64_tr_b16 a[72:73], v26 offset:33024
v_mfma_f32_16x16x32_bf16 v[132:135], a[36:39], a[88:91], v[132:135]
ds_read_b64_tr_b16 a[74:75], v26 offset:41216
v_mfma_f32_16x16x32_bf16 v[136:139], a[40:43], a[88:91], v[136:139]
v_mfma_f32_16x16x32_bf16 v[140:143], a[44:47], a[88:91], v[140:143]
s_waitcnt lgkmcnt(6)
v_mfma_f32_16x16x32_bf16 v[144:147], a[32:35], a[92:95], v[144:147]
ds_read_b64_tr_b16 a[76:77], v27 offset:33024
v_mfma_f32_16x16x32_bf16 v[148:151], a[36:39], a[92:95], v[148:151]
ds_read_b64_tr_b16 a[78:79], v27 offset:41216
v_mfma_f32_16x16x32_bf16 v[152:155], a[40:43], a[92:95], v[152:155]
v_mfma_f32_16x16x32_bf16 v[156:159], a[44:47], a[92:95], v[156:159]
s_waitcnt lgkmcnt(6)
v_mfma_f32_16x16x32_bf16 v[160:163], a[32:35], a[64:67], v[160:163]
ds_read_b64_tr_b16 a[80:81], v28 offset:33024
v_mfma_f32_16x16x32_bf16 v[164:167], a[36:39], a[64:67], v[164:167]
ds_read_b64_tr_b16 a[82:83], v28 offset:41216
v_mfma_f32_16x16x32_bf16 v[168:171], a[40:43], a[64:67], v[168:171]
v_mfma_f32_16x16x32_bf16 v[172:175], a[44:47], a[64:67], v[172:175]
s_waitcnt lgkmcnt(6)
v_mfma_f32_16x16x32_bf16 v[176:179], a[32:35], a[68:71], v[176:179]
ds_read_b64_tr_b16 a[84:85], v29 offset:33024
v_mfma_f32_16x16x32_bf16 v[180:183], a[36:39], a[68:71], v[180:183]
ds_read_b64_tr_b16 a[86:87], v29 offset:41216
v_mfma_f32_16x16x32_bf16 v[184:187], a[40:43], a[68:71], v[184:187]
v_mfma_f32_16x16x32_bf16 v[188:191], a[44:47], a[68:71], v[188:191]
s_waitcnt lgkmcnt(6)
v_mfma_f32_16x16x32_bf16 v[192:195], a[32:35], a[72:75], v[192:195]
ds_read_b64_tr_b16 a[88:89], v30 offset:33024
v_mfma_f32_16x16x32_bf16 v[196:199], a[36:39], a[72:75], v[196:199]
ds_read_b64_tr_b16 a[90:91], v30 offset:41216
v_mfma_f32_16x16x32_bf16 v[200:203], a[40:43], a[72:75], v[200:203]
v_mfma_f32_16x16x32_bf16 v[204:207], a[44:47], a[72:75], v[204:207]
s_waitcnt lgkmcnt(6)
v_mfma_f32_16x16x32_bf16 v[208:211], a[32:35], a[76:79], v[208:211]
ds_read_b64_tr_b16 a[92:93], v31 offset:33024
v_mfma_f32_16x16x32_bf16 v[212:215], a[36:39], a[76:79], v[212:215]
ds_read_b64_tr_b16 a[94:95], v31 offset:41216
v_mfma_f32_16x16x32_bf16 v[216:219], a[40:43], a[76:79], v[216:219]
v_mfma_f32_16x16x32_bf16 v[220:223], a[44:47], a[76:79], v[220:223]
s_waitcnt lgkmcnt(6)
v_mfma_f32_16x16x32_bf16 v[224:227], a[32:35], a[80:83], v[224:227]
s_waitcnt vmcnt(0)
s_barrier
ds_read_b64_tr_b16 a[64:65], v24 offset:49152
v_mfma_f32_16x16x32_bf16 v[228:231], a[36:39], a[80:83], v[228:231]
ds_read_b64_tr_b16 a[66:67], v24 offset:57344
v_mfma_f32_16x16x32_bf16 v[232:235], a[40:43], a[80:83], v[232:235]
v_mfma_f32_16x16x32_bf16 v[236:239], a[44:47], a[80:83], v[236:239]
s_waitcnt lgkmcnt(6)
v_mfma_f32_16x16x32_bf16 v[240:243], a[32:35], a[84:87], v[240:243]
ds_read_b64_tr_b16 a[68:69], v25 offset:49152
v_mfma_f32_16x16x32_bf16 v[244:247], a[36:39], a[84:87], v[244:247]
ds_read_b64_tr_b16 a[70:71], v25 offset:57344
v_mfma_f32_16x16x32_bf16 v[248:251], a[40:43], a[84:87], v[248:251]
v_mfma_f32_16x16x32_bf16 v[252:255], a[44:47], a[84:87], v[252:255]
s_waitcnt lgkmcnt(6)
v_mfma_f32_16x16x32_bf16 a[96:99], a[32:35], a[88:91], a[96:99]
ds_read_b64_tr_b16 a[72:73], v26 offset:49152
v_mfma_f32_16x16x32_bf16 a[100:103], a[36:39], a[88:91], a[100:103]
ds_read_b64_tr_b16 a[74:75], v26 offset:57344
v_mfma_f32_16x16x32_bf16 a[104:107], a[40:43], a[88:91], a[104:107]
v_mfma_f32_16x16x32_bf16 a[108:111], a[44:47], a[88:91], a[108:111]
s_waitcnt lgkmcnt(6)
v_mfma_f32_16x16x32_bf16 a[112:115], a[32:35], a[92:95], a[112:115]
ds_read_b64_tr_b16 a[76:77], v27 offset:49152
v_mfma_f32_16x16x32_bf16 a[116:119], a[36:39], a[92:95], a[116:119]
ds_read_b64_tr_b16 a[78:79], v27 offset:57344
v_mfma_f32_16x16x32_bf16 a[120:123], a[40:43], a[92:95], a[120:123]
v_mfma_f32_16x16x32_bf16 a[124:127], a[44:47], a[92:95], a[124:127]
s_waitcnt lgkmcnt(6)
v_mfma_f32_16x16x32_bf16 v[32:35], a[48:51], a[64:67], v[32:35]
ds_read_b64_tr_b16 a[80:81], v28 offset:49152
v_mfma_f32_16x16x32_bf16 v[36:39], a[52:55], a[64:67], v[36:39]
ds_read_b64_tr_b16 a[82:83], v28 offset:57344
v_mfma_f32_16x16x32_bf16 v[40:43], a[56:59], a[64:67], v[40:43]
v_mfma_f32_16x16x32_bf16 v[44:47], a[60:63], a[64:67], v[44:47]
s_waitcnt lgkmcnt(6)
v_mfma_f32_16x16x32_bf16 v[48:51], a[48:51], a[68:71], v[48:51]
ds_read_b64_tr_b16 a[84:85], v29 offset:49152
v_mfma_f32_16x16x32_bf16 v[52:55], a[52:55], a[68:71], v[52:55]
ds_read_b64_tr_b16 a[86:87], v29 offset:57344
v_mfma_f32_16x16x32_bf16 v[56:59], a[56:59], a[68:71], v[56:59]
v_mfma_f32_16x16x32_bf16 v[60:63], a[60:63], a[68:71], v[60:63]
s_waitcnt lgkmcnt(6)
v_mfma_f32_16x16x32_bf16 v[64:67], a[48:51], a[72:75], v[64:67]
ds_read_b64_tr_b16 a[88:89], v30 offset:49152
v_mfma_f32_16x16x32_bf16 v[68:71], a[52:55], a[72:75], v[68:71]
ds_read_b64_tr_b16 a[90:91], v30 offset:57344
v_mfma_f32_16x16x32_bf16 v[72:75], a[56:59], a[72:75], v[72:75]
v_mfma_f32_16x16x32_bf16 v[76:79], a[60:63], a[72:75], v[76:79]
s_waitcnt lgkmcnt(6)
v_mfma_f32_16x16x32_bf16 v[80:83], a[48:51], a[76:79], v[80:83]
ds_read_b64_tr_b16 a[92:93], v31 offset:49152
v_mfma_f32_16x16x32_bf16 v[84:87], a[52:55], a[76:79], v[84:87]
ds_read_b64_tr_b16 a[94:95], v31 offset:57344
v_mfma_f32_16x16x32_bf16 v[88:91], a[56:59], a[76:79], v[88:91]
v_mfma_f32_16x16x32_bf16 v[92:95], a[60:63], a[76:79], v[92:95]
s_waitcnt lgkmcnt(6)
v_mfma_f32_16x16x32_bf16 v[96:99], a[48:51], a[80:83], v[96:99]
ds_read_b64_tr_b16 a[64:65], v24 offset:49408
v_cvt_pk_bf16_f32 v32, v32, v33
v_cvt_pk_bf16_f32 v33, v34, v35
v_mfma_f32_16x16x32_bf16 v[100:103], a[52:55], a[80:83], v[100:103]
ds_read_b64_tr_b16 a[66:67], v24 offset:57600
v_cvt_pk_bf16_f32 v34, v36, v37
v_cvt_pk_bf16_f32 v35, v38, v39
buffer_store_dwordx4 v[32:35], v1, s[56:59], s23 offen offset:0
v_mfma_f32_16x16x32_bf16 v[104:107], a[56:59], a[80:83], v[104:107]
v_cvt_pk_bf16_f32 v40, v40, v41
v_cvt_pk_bf16_f32 v41, v42, v43
v_mfma_f32_16x16x32_bf16 v[108:111], a[60:63], a[80:83], v[108:111]
v_cvt_pk_bf16_f32 v42, v44, v45
v_cvt_pk_bf16_f32 v43, v46, v47
buffer_store_dwordx4 v[40:43], v1, s[56:59], s23 offen offset:2048
s_waitcnt lgkmcnt(6)
v_mfma_f32_16x16x32_bf16 v[112:115], a[48:51], a[84:87], v[112:115]
ds_read_b64_tr_b16 a[68:69], v25 offset:49408
v_cvt_pk_bf16_f32 v48, v48, v49
v_cvt_pk_bf16_f32 v49, v50, v51
v_cvt_pk_bf16_f32 v50, v52, v53
v_mfma_f32_16x16x32_bf16 v[116:119], a[52:55], a[84:87], v[116:119]
ds_read_b64_tr_b16 a[70:71], v25 offset:57600
v_cvt_pk_bf16_f32 v51, v54, v55
buffer_store_dwordx4 v[48:51], v1, s[56:59], s23 offen offset:1024
v_mfma_f32_16x16x32_bf16 v[120:123], a[56:59], a[84:87], v[120:123]
v_cvt_pk_bf16_f32 v56, v56, v57
v_cvt_pk_bf16_f32 v57, v58, v59
v_cvt_pk_bf16_f32 v58, v60, v61
v_mfma_f32_16x16x32_bf16 v[124:127], a[60:63], a[84:87], v[124:127]
v_cvt_pk_bf16_f32 v59, v62, v63
buffer_store_dwordx4 v[56:59], v1, s[56:59], s23 offen offset:3072
s_add_u32 s23, s23, 131072
s_waitcnt lgkmcnt(6)
v_mfma_f32_16x16x32_bf16 v[128:131], a[48:51], a[88:91], v[128:131]
ds_read_b64_tr_b16 a[72:73], v26 offset:49408
v_cvt_pk_bf16_f32 v64, v64, v65
v_cvt_pk_bf16_f32 v65, v66, v67
v_mfma_f32_16x16x32_bf16 v[132:135], a[52:55], a[88:91], v[132:135]
ds_read_b64_tr_b16 a[74:75], v26 offset:57600
v_cvt_pk_bf16_f32 v66, v68, v69
v_cvt_pk_bf16_f32 v67, v70, v71
buffer_store_dwordx4 v[64:67], v1, s[56:59], s23 offen offset:0
v_mfma_f32_16x16x32_bf16 v[136:139], a[56:59], a[88:91], v[136:139]
v_cvt_pk_bf16_f32 v72, v72, v73
v_cvt_pk_bf16_f32 v73, v74, v75
v_mfma_f32_16x16x32_bf16 v[140:143], a[60:63], a[88:91], v[140:143]
v_cvt_pk_bf16_f32 v74, v76, v77
v_cvt_pk_bf16_f32 v75, v78, v79
buffer_store_dwordx4 v[72:75], v1, s[56:59], s23 offen offset:2048
s_waitcnt lgkmcnt(6)
v_mfma_f32_16x16x32_bf16 v[144:147], a[48:51], a[92:95], v[144:147]
ds_read_b64_tr_b16 a[76:77], v27 offset:49408
v_cvt_pk_bf16_f32 v80, v80, v81
v_cvt_pk_bf16_f32 v81, v82, v83
v_cvt_pk_bf16_f32 v82, v84, v85
v_mfma_f32_16x16x32_bf16 v[148:151], a[52:55], a[92:95], v[148:151]
ds_read_b64_tr_b16 a[78:79], v27 offset:57600
v_cvt_pk_bf16_f32 v83, v86, v87
buffer_store_dwordx4 v[80:83], v1, s[56:59], s23 offen offset:1024
v_mfma_f32_16x16x32_bf16 v[152:155], a[56:59], a[92:95], v[152:155]
v_cvt_pk_bf16_f32 v88, v88, v89
v_cvt_pk_bf16_f32 v89, v90, v91
v_cvt_pk_bf16_f32 v90, v92, v93
v_mfma_f32_16x16x32_bf16 v[156:159], a[60:63], a[92:95], v[156:159]
v_cvt_pk_bf16_f32 v91, v94, v95
buffer_store_dwordx4 v[88:91], v1, s[56:59], s23 offen offset:3072
s_add_u32 s23, s23, 131072
s_waitcnt lgkmcnt(6)
v_mfma_f32_16x16x32_bf16 v[160:163], a[48:51], a[64:67], v[160:163]
ds_read_b64_tr_b16 a[80:81], v28 offset:49408
v_cvt_pk_bf16_f32 v96, v96, v97
v_cvt_pk_bf16_f32 v97, v98, v99
v_mfma_f32_16x16x32_bf16 v[164:167], a[52:55], a[64:67], v[164:167]
ds_read_b64_tr_b16 a[82:83], v28 offset:57600
v_cvt_pk_bf16_f32 v98, v100, v101
v_cvt_pk_bf16_f32 v99, v102, v103
buffer_store_dwordx4 v[96:99], v1, s[56:59], s23 offen offset:0
v_mfma_f32_16x16x32_bf16 v[168:171], a[56:59], a[64:67], v[168:171]
v_cvt_pk_bf16_f32 v104, v104, v105
v_cvt_pk_bf16_f32 v105, v106, v107
v_mfma_f32_16x16x32_bf16 v[172:175], a[60:63], a[64:67], v[172:175]
v_cvt_pk_bf16_f32 v106, v108, v109
v_cvt_pk_bf16_f32 v107, v110, v111
buffer_store_dwordx4 v[104:107], v1, s[56:59], s23 offen offset:2048
s_waitcnt lgkmcnt(6)
v_mfma_f32_16x16x32_bf16 v[176:179], a[48:51], a[68:71], v[176:179]
ds_read_b64_tr_b16 a[84:85], v29 offset:49408
v_cvt_pk_bf16_f32 v112, v112, v113
v_cvt_pk_bf16_f32 v113, v114, v115
v_cvt_pk_bf16_f32 v114, v116, v117
v_mfma_f32_16x16x32_bf16 v[180:183], a[52:55], a[68:71], v[180:183]
ds_read_b64_tr_b16 a[86:87], v29 offset:57600
v_cvt_pk_bf16_f32 v115, v118, v119
buffer_store_dwordx4 v[112:115], v1, s[56:59], s23 offen offset:1024
v_mfma_f32_16x16x32_bf16 v[184:187], a[56:59], a[68:71], v[184:187]
v_cvt_pk_bf16_f32 v120, v120, v121
v_cvt_pk_bf16_f32 v121, v122, v123
v_cvt_pk_bf16_f32 v122, v124, v125
v_mfma_f32_16x16x32_bf16 v[188:191], a[60:63], a[68:71], v[188:191]
v_cvt_pk_bf16_f32 v123, v126, v127
buffer_store_dwordx4 v[120:123], v1, s[56:59], s23 offen offset:3072
s_add_u32 s23, s23, 131072
s_waitcnt lgkmcnt(6)
v_mfma_f32_16x16x32_bf16 v[192:195], a[48:51], a[72:75], v[192:195]
ds_read_b64_tr_b16 a[88:89], v30 offset:49408
v_cvt_pk_bf16_f32 v128, v128, v129
v_cvt_pk_bf16_f32 v129, v130, v131
v_mfma_f32_16x16x32_bf16 v[196:199], a[52:55], a[72:75], v[196:199]
ds_read_b64_tr_b16 a[90:91], v30 offset:57600
v_cvt_pk_bf16_f32 v130, v132, v133
v_cvt_pk_bf16_f32 v131, v134, v135
buffer_store_dwordx4 v[128:131], v1, s[56:59], s23 offen offset:0
v_mfma_f32_16x16x32_bf16 v[200:203], a[56:59], a[72:75], v[200:203]
v_cvt_pk_bf16_f32 v136, v136, v137
v_cvt_pk_bf16_f32 v137, v138, v139
v_mfma_f32_16x16x32_bf16 v[204:207], a[60:63], a[72:75], v[204:207]
v_cvt_pk_bf16_f32 v138, v140, v141
v_cvt_pk_bf16_f32 v139, v142, v143
buffer_store_dwordx4 v[136:139], v1, s[56:59], s23 offen offset:2048
s_waitcnt lgkmcnt(6)
v_mfma_f32_16x16x32_bf16 v[208:211], a[48:51], a[76:79], v[208:211]
ds_read_b64_tr_b16 a[92:93], v31 offset:49408
v_cvt_pk_bf16_f32 v144, v144, v145
v_cvt_pk_bf16_f32 v145, v146, v147
v_cvt_pk_bf16_f32 v146, v148, v149
v_mfma_f32_16x16x32_bf16 v[212:215], a[52:55], a[76:79], v[212:215]
ds_read_b64_tr_b16 a[94:95], v31 offset:57600
v_cvt_pk_bf16_f32 v147, v150, v151
buffer_store_dwordx4 v[144:147], v1, s[56:59], s23 offen offset:1024
v_mfma_f32_16x16x32_bf16 v[216:219], a[56:59], a[76:79], v[216:219]
v_cvt_pk_bf16_f32 v152, v152, v153
v_cvt_pk_bf16_f32 v153, v154, v155
v_cvt_pk_bf16_f32 v154, v156, v157
v_mfma_f32_16x16x32_bf16 v[220:223], a[60:63], a[76:79], v[220:223]
v_cvt_pk_bf16_f32 v155, v158, v159
buffer_store_dwordx4 v[152:155], v1, s[56:59], s23 offen offset:3072
s_add_u32 s23, s23, 131072
s_waitcnt lgkmcnt(6)
v_mfma_f32_16x16x32_bf16 v[224:227], a[48:51], a[80:83], v[224:227]
v_cvt_pk_bf16_f32 v160, v160, v161
v_cvt_pk_bf16_f32 v161, v162, v163
v_mfma_f32_16x16x32_bf16 v[228:231], a[52:55], a[80:83], v[228:231]
v_cvt_pk_bf16_f32 v162, v164, v165
v_cvt_pk_bf16_f32 v163, v166, v167
buffer_store_dwordx4 v[160:163], v1, s[56:59], s23 offen offset:0
v_mfma_f32_16x16x32_bf16 v[232:235], a[56:59], a[80:83], v[232:235]
v_cvt_pk_bf16_f32 v168, v168, v169
v_cvt_pk_bf16_f32 v169, v170, v171
v_mfma_f32_16x16x32_bf16 v[236:239], a[60:63], a[80:83], v[236:239]
v_cvt_pk_bf16_f32 v170, v172, v173
v_cvt_pk_bf16_f32 v171, v174, v175
buffer_store_dwordx4 v[168:171], v1, s[56:59], s23 offen offset:2048
s_waitcnt lgkmcnt(4)
v_mfma_f32_16x16x32_bf16 v[240:243], a[48:51], a[84:87], v[240:243]
v_cvt_pk_bf16_f32 v176, v176, v177
v_cvt_pk_bf16_f32 v177, v178, v179
v_cvt_pk_bf16_f32 v178, v180, v181
v_mfma_f32_16x16x32_bf16 v[244:247], a[52:55], a[84:87], v[244:247]
v_cvt_pk_bf16_f32 v179, v182, v183
buffer_store_dwordx4 v[176:179], v1, s[56:59], s23 offen offset:1024
v_mfma_f32_16x16x32_bf16 v[248:251], a[56:59], a[84:87], v[248:251]
v_cvt_pk_bf16_f32 v184, v184, v185
v_cvt_pk_bf16_f32 v185, v186, v187
v_cvt_pk_bf16_f32 v186, v188, v189
v_mfma_f32_16x16x32_bf16 v[252:255], a[60:63], a[84:87], v[252:255]
v_cvt_pk_bf16_f32 v187, v190, v191
buffer_store_dwordx4 v[184:187], v1, s[56:59], s23 offen offset:3072
s_add_u32 s23, s23, 131072
s_waitcnt lgkmcnt(2)
v_mfma_f32_16x16x32_bf16 a[96:99], a[48:51], a[88:91], a[96:99]
v_cvt_pk_bf16_f32 v192, v192, v193
v_cvt_pk_bf16_f32 v193, v194, v195
v_mfma_f32_16x16x32_bf16 a[100:103], a[52:55], a[88:91], a[100:103]
v_cvt_pk_bf16_f32 v194, v196, v197
v_cvt_pk_bf16_f32 v195, v198, v199
buffer_store_dwordx4 v[192:195], v1, s[56:59], s23 offen offset:0
v_mfma_f32_16x16x32_bf16 a[104:107], a[56:59], a[88:91], a[104:107]
v_cvt_pk_bf16_f32 v200, v200, v201
v_cvt_pk_bf16_f32 v201, v202, v203
v_mfma_f32_16x16x32_bf16 a[108:111], a[60:63], a[88:91], a[108:111]
v_cvt_pk_bf16_f32 v202, v204, v205
v_cvt_pk_bf16_f32 v203, v206, v207
buffer_store_dwordx4 v[200:203], v1, s[56:59], s23 offen offset:2048
s_waitcnt lgkmcnt(0)
v_mfma_f32_16x16x32_bf16 a[112:115], a[48:51], a[92:95], a[112:115]
v_cvt_pk_bf16_f32 v208, v208, v209
v_cvt_pk_bf16_f32 v209, v210, v211
v_cvt_pk_bf16_f32 v210, v212, v213
v_mfma_f32_16x16x32_bf16 a[116:119], a[52:55], a[92:95], a[116:119]
v_cvt_pk_bf16_f32 v211, v214, v215
buffer_store_dwordx4 v[208:211], v1, s[56:59], s23 offen offset:1024
v_mfma_f32_16x16x32_bf16 a[120:123], a[56:59], a[92:95], a[120:123]
v_cvt_pk_bf16_f32 v216, v216, v217
v_cvt_pk_bf16_f32 v217, v218, v219
v_cvt_pk_bf16_f32 v218, v220, v221
v_mfma_f32_16x16x32_bf16 a[124:127], a[60:63], a[92:95], a[124:127]
v_cvt_pk_bf16_f32 v219, v222, v223
buffer_store_dwordx4 v[216:219], v1, s[56:59], s23 offen offset:3072
s_add_u32 s23, s23, 131072
s_nop 7
v_cvt_pk_bf16_f32 v224, v224, v225
v_cvt_pk_bf16_f32 v225, v226, v227
v_cvt_pk_bf16_f32 v226, v228, v229
v_cvt_pk_bf16_f32 v227, v230, v231
buffer_store_dwordx4 v[224:227], v1, s[56:59], s23 offen offset:0
v_cvt_pk_bf16_f32 v232, v232, v233
v_cvt_pk_bf16_f32 v233, v234, v235
v_cvt_pk_bf16_f32 v234, v236, v237
v_cvt_pk_bf16_f32 v235, v238, v239
buffer_store_dwordx4 v[232:235], v1, s[56:59], s23 offen offset:2048
v_cvt_pk_bf16_f32 v240, v240, v241
v_cvt_pk_bf16_f32 v241, v242, v243
v_cvt_pk_bf16_f32 v242, v244, v245
v_cvt_pk_bf16_f32 v243, v246, v247
buffer_store_dwordx4 v[240:243], v1, s[56:59], s23 offen offset:1024
v_cvt_pk_bf16_f32 v248, v248, v249
v_cvt_pk_bf16_f32 v249, v250, v251
v_cvt_pk_bf16_f32 v250, v252, v253
v_cvt_pk_bf16_f32 v251, v254, v255
buffer_store_dwordx4 v[248:251], v1, s[56:59], s23 offen offset:3072
s_add_u32 s23, s23, 131072
v_accvgpr_read_b32 v8, a96
v_accvgpr_read_b32 v9, a97
v_accvgpr_read_b32 v10, a98
v_accvgpr_read_b32 v11, a99
v_accvgpr_read_b32 v12, a100
v_accvgpr_read_b32 v13, a101
v_accvgpr_read_b32 v14, a102
v_accvgpr_read_b32 v15, a103
v_cvt_pk_bf16_f32 v8, v8, v9
v_cvt_pk_bf16_f32 v9, v10, v11
v_cvt_pk_bf16_f32 v10, v12, v13
v_cvt_pk_bf16_f32 v11, v14, v15
buffer_store_dwordx4 v[8:11], v1, s[56:59], s23 offen offset:0
s_nop 1
v_accvgpr_read_b32 v8, a104
v_accvgpr_read_b32 v9, a105
v_accvgpr_read_b32 v10, a106
v_accvgpr_read_b32 v11, a107
v_accvgpr_read_b32 v12, a108
v_accvgpr_read_b32 v13, a109
v_accvgpr_read_b32 v14, a110
v_accvgpr_read_b32 v15, a111
v_cvt_pk_bf16_f32 v8, v8, v9
v_cvt_pk_bf16_f32 v9, v10, v11
v_cvt_pk_bf16_f32 v10, v12, v13
v_cvt_pk_bf16_f32 v11, v14, v15
buffer_store_dwordx4 v[8:11], v1, s[56:59], s23 offen offset:2048
s_nop 1
v_accvgpr_read_b32 v8, a112
v_accvgpr_read_b32 v9, a113
v_accvgpr_read_b32 v10, a114
v_accvgpr_read_b32 v11, a115
v_accvgpr_read_b32 v12, a116
v_accvgpr_read_b32 v13, a117
v_accvgpr_read_b32 v14, a118
v_accvgpr_read_b32 v15, a119
v_cvt_pk_bf16_f32 v8, v8, v9
v_cvt_pk_bf16_f32 v9, v10, v11
v_cvt_pk_bf16_f32 v10, v12, v13
v_cvt_pk_bf16_f32 v11, v14, v15
buffer_store_dwordx4 v[8:11], v1, s[56:59], s23 offen offset:1024
s_nop 1
v_accvgpr_read_b32 v8, a120
v_accvgpr_read_b32 v9, a121
v_accvgpr_read_b32 v10, a122
v_accvgpr_read_b32 v11, a123
v_accvgpr_read_b32 v12, a124
v_accvgpr_read_b32 v13, a125
v_accvgpr_read_b32 v14, a126
v_accvgpr_read_b32 v15, a127
v_cvt_pk_bf16_f32 v8, v8, v9
v_cvt_pk_bf16_f32 v9, v10, v11
v_cvt_pk_bf16_f32 v10, v12, v13
v_cvt_pk_bf16_f32 v11, v14, v15
buffer_store_dwordx4 v[8:11], v1, s[56:59], s23 offen offset:3072
s_nop 1
s_add_u32 s23, s23, 131072
s_endpgm
L_gemm1_kernel_w12:
s_lshl_b32 s19, s12, 2
s_add_u32 s19, s19, s13
s_sub_u32 s19, s19, 3
s_mul_i32 s26, s19, 192
s_lshl_b32 s18, s26, 1
v_and_b32 v2, 63, v0
v_lshlrev_b32 v8, 4, v2
v_add_u32 v9, 32768, v8
v_add_u32 v10, 65536, v8
v_add_u32 v11, 98304, v8
s_mov_b32 s45, 7168
s_lshl_b32 s46, s40, 3
v_and_b32 v2, 63, v0
v_mul_u32_u24 v3, 2731, v2
v_lshrrev_b32 v3, 16, v3
v_mul_u32_u24 v4, 24, v3
v_sub_u32 v2, v2, v4
v_bfe_u32 v4, v3, 1, 2
v_lshlrev_b32 v4, 1, v4
v_xor_b32 v2, v2, v4
v_lshlrev_b32 v2, 4, v2
v_add_u32 v3, s46, v3
v_bfe_u32 v4, v3, 2, 2
v_lshrrev_b32 v5, 4, v3
v_and_b32 v3, 3, v3
v_lshl_add_u32 v3, v4, 3, v3
v_lshl_add_u32 v3, v5, 2, v3
v_mul_lo_u32 v3, v3, s45
v_add_u32 v12, v2, v3
v_and_b32 v2, 63, v0
v_add_u32 v2, 64, v2
v_mul_u32_u24 v3, 2731, v2
v_lshrrev_b32 v3, 16, v3
v_mul_u32_u24 v4, 24, v3
v_sub_u32 v2, v2, v4
v_bfe_u32 v4, v3, 1, 2
v_lshlrev_b32 v4, 1, v4
v_xor_b32 v2, v2, v4
v_lshlrev_b32 v2, 4, v2
v_add_u32 v3, s46, v3
v_bfe_u32 v4, v3, 2, 2
v_lshrrev_b32 v5, 4, v3
v_and_b32 v3, 3, v3
v_lshl_add_u32 v3, v4, 3, v3
v_lshl_add_u32 v3, v5, 2, v3
v_mul_lo_u32 v3, v3, s45
v_add_u32 v13, v2, v3
v_and_b32 v2, 63, v0
v_add_u32 v2, 128, v2
v_mul_u32_u24 v3, 2731, v2
v_lshrrev_b32 v3, 16, v3
v_mul_u32_u24 v4, 24, v3
v_sub_u32 v2, v2, v4
v_bfe_u32 v4, v3, 1, 2
v_lshlrev_b32 v4, 1, v4
v_xor_b32 v2, v2, v4
v_lshlrev_b32 v2, 4, v2
v_add_u32 v3, s46, v3
v_bfe_u32 v4, v3, 2, 2
v_lshrrev_b32 v5, 4, v3
v_and_b32 v3, 3, v3
v_lshl_add_u32 v3, v4, 3, v3
v_lshl_add_u32 v3, v5, 2, v3
v_mul_lo_u32 v3, v3, s45
v_add_u32 v14, v2, v3
s_mul_i32 s43, s40, 3072
s_mov_b32 s41, 0
s_mov_b32 s42, 0
s_waitcnt lgkmcnt(0)
s_add_u32 s52, s8, s18
s_addc_u32 s53, s9, 0
s_and_b32 s53, s53, 0xffff
s_sub_u32 s54, 0x700000, s18
s_mov_b32 s55, 0x20000
s_lshl_b32 s17, s16, 15
s_add_u32 s48, s6, s17
s_addc_u32 s49, s7, 0
s_and_b32 s49, s49, 0xffff
s_mov_b32 s50, 131072
s_mov_b32 s51, 0x20000
s_add_u32 s60, s6, 0x3c00000
s_addc_u32 s61, s7, 0
s_and_b32 s61, s61, 0xffff
s_mov_b32 s62, 0x2000
s_mov_b32 s63, 0x20000
s_mov_b32 s64, s10
s_and_b32 s65, s11, 0xffff
s_mov_b32 s66, 0x1c00
s_mov_b32 s67, 0x20000
v_and_b32 v4, 15, v0
s_lshl_b32 s17, s16, 6
v_lshlrev_b32 v60, 2, v4
v_add_u32 v60, s17, v60
v_bfe_u32 v61, v0, 4, 2
v_lshlrev_b32 v61, 3, v61
v_add_u32 v61, s18, v61
s_add_u32 m0, s43, 0
s_nop 0
buffer_load_dwordx4 v12, s[52:55], s42 offen lds
s_add_u32 m0, s43, 1024
s_nop 0
buffer_load_dwordx4 v13, s[52:55], s42 offen lds
s_add_u32 m0, s43, 2048
s_nop 0
buffer_load_dwordx4 v14, s[52:55], s42 offen lds
s_add_u32 s42, s42, 229376
s_add_u32 m0, s43, 12288
s_nop 0
buffer_load_dwordx4 v12, s[52:55], s42 offen lds
s_add_u32 m0, s43, 13312
s_nop 0
buffer_load_dwordx4 v13, s[52:55], s42 offen lds
s_add_u32 m0, s43, 14336
s_nop 0
buffer_load_dwordx4 v14, s[52:55], s42 offen lds
s_add_u32 s42, s42, 229376
s_mov_b32 s68, s6
s_and_b32 s69, s7, 0xffff
s_mov_b32 s70, 0x400000
s_mov_b32 s71, 0x20000
s_add_u32 s60, s6, 0x3c00000
s_addc_u32 s61, s7, 0
s_and_b32 s61, s61, 0xffff
s_mov_b32 s62, 0x2000
s_mov_b32 s63, 0x20000
s_mov_b32 s72, s34
s_and_b32 s73, s35, 0xffff
s_mov_b32 s74, 0x100
s_mov_b32 s75, 0x20000
s_lshr_b32 s36, s47, 1
s_lshl_b32 s36, s36, 15
s_and_b32 s37, s47, 1
s_lshl_b32 s37, s37, 7
s_add_u32 s36, s36, s37
v_lshrrev_b32 v193, 2, v197
v_lshlrev_b32 v193, 10, v193
v_and_b32 v198, 3, v197
v_lshl_add_u32 v193, v198, 8, v193
v_lshl_add_u32 v193, v196, 4, v193
v_add_u32 v193, s36, v193
v_lshrrev_b32 v194, 6, v0
v_lshl_add_u32 v194, v194, 3, v196
v_lshlrev_b32 v194, 2, v194
v_add_u32 v194, 131072, v194
v_lshlrev_b32 v195, 2, v196
v_add_u32 v195, 131072, v195
s_waitcnt vmcnt(10)
v_lshlrev_b32 v80, 16, v64
v_and_b32 v81, 0xffff0000, v64
v_lshlrev_b32 v82, 16, v65
v_and_b32 v83, 0xffff0000, v65
v_lshlrev_b32 v84, 16, v66
v_and_b32 v85, 0xffff0000, v66
v_lshlrev_b32 v86, 16, v67
v_and_b32 v87, 0xffff0000, v67
s_waitcnt vmcnt(9)
v_lshlrev_b32 v88, 16, v68
v_and_b32 v89, 0xffff0000, v68
v_lshlrev_b32 v90, 16, v69
v_and_b32 v91, 0xffff0000, v69
v_lshlrev_b32 v92, 16, v70
v_and_b32 v93, 0xffff0000, v70
v_lshlrev_b32 v94, 16, v71
v_and_b32 v95, 0xffff0000, v71
s_waitcnt vmcnt(8)
v_lshlrev_b32 v96, 16, v72
v_and_b32 v97, 0xffff0000, v72
v_lshlrev_b32 v98, 16, v73
v_and_b32 v99, 0xffff0000, v73
v_lshlrev_b32 v100, 16, v74
v_and_b32 v101, 0xffff0000, v74
v_lshlrev_b32 v102, 16, v75
v_and_b32 v103, 0xffff0000, v75
s_waitcnt vmcnt(7)
v_lshlrev_b32 v104, 16, v76
v_and_b32 v105, 0xffff0000, v76
v_lshlrev_b32 v106, 16, v77
v_and_b32 v107, 0xffff0000, v77
v_lshlrev_b32 v108, 16, v78
v_and_b32 v109, 0xffff0000, v78
v_lshlrev_b32 v110, 16, v79
v_and_b32 v111, 0xffff0000, v79
v_pk_mul_f32 v[144:145], v[80:81], v[80:81]
v_pk_mul_f32 v[146:147], v[82:83], v[82:83]
v_pk_mul_f32 v[148:149], v[84:85], v[84:85]
v_pk_mul_f32 v[150:151], v[86:87], v[86:87]
v_pk_fma_f32 v[144:145], v[88:89], v[88:89], v[144:145]
v_pk_fma_f32 v[146:147], v[90:91], v[90:91], v[146:147]
v_pk_fma_f32 v[148:149], v[92:93], v[92:93], v[148:149]
v_pk_fma_f32 v[150:151], v[94:95], v[94:95], v[150:151]
v_pk_fma_f32 v[144:145], v[96:97], v[96:97], v[144:145]
v_pk_fma_f32 v[146:147], v[98:99], v[98:99], v[146:147]
v_pk_fma_f32 v[148:149], v[100:101], v[100:101], v[148:149]
v_pk_fma_f32 v[150:151], v[102:103], v[102:103], v[150:151]
v_pk_fma_f32 v[144:145], v[104:105], v[104:105], v[144:145]
v_pk_fma_f32 v[146:147], v[106:107], v[106:107], v[146:147]
v_pk_fma_f32 v[148:149], v[108:109], v[108:109], v[148:149]
v_pk_fma_f32 v[150:151], v[110:111], v[110:111], v[150:151]
v_pk_add_f32 v[112:113], v[80:81], v[82:83]
v_pk_add_f32 v[114:115], v[84:85], v[86:87]
v_pk_add_f32 v[116:117], v[88:89], v[90:91]
v_pk_add_f32 v[118:119], v[92:93], v[94:95]
v_pk_add_f32 v[120:121], v[96:97], v[98:99]
v_pk_add_f32 v[122:123], v[100:101], v[102:103]
v_pk_add_f32 v[124:125], v[104:105], v[106:107]
v_pk_add_f32 v[126:127], v[108:109], v[110:111]
v_pk_add_f32 v[128:129], v[112:113], v[114:115]
v_pk_add_f32 v[130:131], v[116:117], v[118:119]
v_pk_add_f32 v[132:133], v[120:121], v[122:123]
v_pk_add_f32 v[134:135], v[124:125], v[126:127]
v_pk_add_f32 v[136:137], v[128:129], v[130:131]
v_pk_add_f32 v[138:139], v[132:133], v[134:135]
v_pk_add_f32 v[140:141], v[136:137], v[138:139]
v_add_f32 v200, v140, v141
v_pk_add_f32 v[152:153], v[144:145], v[146:147]
v_pk_add_f32 v[154:155], v[148:149], v[150:151]
v_pk_add_f32 v[156:157], v[152:153], v[154:155]
v_add_f32 v201, v156, v157
s_nop 1
v_add_f32_dpp v200, v200, v200 row_ror:8 row_mask:0xf bank_mask:0xf
v_add_f32_dpp v201, v201, v201 row_ror:8 row_mask:0xf bank_mask:0xf
v_mov_b32 v208, v200
v_mov_b32 v212, v201
s_nop 1
v_permlane16_swap_b32 v200, v208
v_permlane16_swap_b32 v201, v212
s_nop 1
v_add_f32 v200, v200, v208
v_add_f32 v201, v201, v212
v_mov_b32 v208, v200
v_mov_b32 v212, v201
s_nop 1
v_permlane32_swap_b32 v200, v208
v_permlane32_swap_b32 v201, v212
s_nop 1
v_add_f32 v200, v200, v208
v_add_f32 v201, v201, v212
v_lshlrev_b32 v194, 1, v194
v_subrev_u32 v194, 131072, v194
v_lshlrev_b32 v195, 1, v195
v_subrev_u32 v195, 131072, v195
ds_write_b64 v194, v[200:201]
s_waitcnt lgkmcnt(0)
s_barrier
ds_read_b64 v[112:113], v195 offset:0
ds_read_b64 v[114:115], v195 offset:64
ds_read_b64 v[116:117], v195 offset:128
ds_read_b64 v[118:119], v195 offset:192
s_waitcnt lgkmcnt(0)
v_pk_add_f32 v[112:113], v[112:113], v[114:115]
v_pk_add_f32 v[116:117], v[116:117], v[118:119]
v_pk_add_f32 v[112:113], v[112:113], v[116:117]
v_mul_f32 v112, 0x3a800000, v112
v_mul_f32 v200, 0x3a800000, v113
v_fma_f32 v200, -v112, v112, v200
v_max_f32 v200, 0, v200
v_add_f32 v206, 0x3727c5ac, v200
v_rsq_f32 v206, v206
s_nop 0
v_mul_f32 v210, 0x3f014852, v206
v_mul_f32 v211, -v112, v210
v_pk_fma_f32 v[80:81], v[80:81], v[210:211], v[210:211] op_sel:[0,0,1] op_sel_hi:[1,0,1]
v_pk_fma_f32 v[82:83], v[82:83], v[210:211], v[210:211] op_sel:[0,0,1] op_sel_hi:[1,0,1]
v_pk_fma_f32 v[84:85], v[84:85], v[210:211], v[210:211] op_sel:[0,0,1] op_sel_hi:[1,0,1]
v_pk_fma_f32 v[86:87], v[86:87], v[210:211], v[210:211] op_sel:[0,0,1] op_sel_hi:[1,0,1]
v_pk_fma_f32 v[88:89], v[88:89], v[210:211], v[210:211] op_sel:[0,0,1] op_sel_hi:[1,0,1]
v_pk_fma_f32 v[90:91], v[90:91], v[210:211], v[210:211] op_sel:[0,0,1] op_sel_hi:[1,0,1]
v_pk_fma_f32 v[92:93], v[92:93], v[210:211], v[210:211] op_sel:[0,0,1] op_sel_hi:[1,0,1]
v_pk_fma_f32 v[94:95], v[94:95], v[210:211], v[210:211] op_sel:[0,0,1] op_sel_hi:[1,0,1]
v_pk_fma_f32 v[96:97], v[96:97], v[210:211], v[210:211] op_sel:[0,0,1] op_sel_hi:[1,0,1]
v_pk_fma_f32 v[98:99], v[98:99], v[210:211], v[210:211] op_sel:[0,0,1] op_sel_hi:[1,0,1]
v_pk_fma_f32 v[100:101], v[100:101], v[210:211], v[210:211] op_sel:[0,0,1] op_sel_hi:[1,0,1]
v_pk_fma_f32 v[102:103], v[102:103], v[210:211], v[210:211] op_sel:[0,0,1] op_sel_hi:[1,0,1]
v_pk_fma_f32 v[104:105], v[104:105], v[210:211], v[210:211] op_sel:[0,0,1] op_sel_hi:[1,0,1]
v_pk_fma_f32 v[106:107], v[106:107], v[210:211], v[210:211] op_sel:[0,0,1] op_sel_hi:[1,0,1]
v_pk_fma_f32 v[108:109], v[108:109], v[210:211], v[210:211] op_sel:[0,0,1] op_sel_hi:[1,0,1]
v_pk_fma_f32 v[110:111], v[110:111], v[210:211], v[210:211] op_sel:[0,0,1] op_sel_hi:[1,0,1]
v_cvt_pk_bf16_f32 v64, v80, v81
v_cvt_pk_bf16_f32 v65, v82, v83
v_cvt_pk_bf16_f32 v66, v84, v85
v_cvt_pk_bf16_f32 v67, v86, v87
v_cvt_pk_bf16_f32 v68, v88, v89
v_cvt_pk_bf16_f32 v69, v90, v91
v_cvt_pk_bf16_f32 v70, v92, v93
v_cvt_pk_bf16_f32 v71, v94, v95
v_cvt_pk_bf16_f32 v72, v96, v97
v_cvt_pk_bf16_f32 v73, v98, v99
v_cvt_pk_bf16_f32 v74, v100, v101
v_cvt_pk_bf16_f32 v75, v102, v103
v_cvt_pk_bf16_f32 v76, v104, v105
v_cvt_pk_bf16_f32 v77, v106, v107
v_cvt_pk_bf16_f32 v78, v108, v109
v_cvt_pk_bf16_f32 v79, v110, v111
s_mov_b32 s36, 8192
s_mov_b32 s37, 16384
s_mov_b32 s27, 24576
buffer_store_dwordx4 v[64:67], v193, s[68:71], 0 offen sc1
buffer_store_dwordx4 v[68:71], v193, s[68:71], s36 offen sc1
buffer_store_dwordx4 v[72:75], v193, s[68:71], s37 offen sc1
buffer_store_dwordx4 v[76:79], v193, s[68:71], s27 offen sc1
v_mul_f32 v209, v206, v206
v_mul_f32 v209, v209, v200
v_add_f32 v209, 0x3727c5ac, v209
v_rsq_f32 v209, v209
v_add_u32 v198, s3, v196
v_lshlrev_b32 v198, 2, v198
v_mul_f32 v209, 0x3ffd75e0, v209
buffer_store_dword v209, v198, s[60:63], 0 offen sc1
s_waitcnt vmcnt(0)
s_barrier
s_cmp_lg_u32 s40, 0
s_cbranch_scc1 L_gemm1_kernel_w12_ln_nosig
s_lshr_b32 s36, s47, 5
s_lshl_b32 s37, s36, 5
v_mov_b32 v6, s37
v_mov_b32 v7, 1
s_mov_b64 s[38:39], exec
s_mov_b64 exec, 1
buffer_atomic_add v7, v6, s[72:75], 0 offen sc0 sc1
s_mov_b64 exec, s[38:39]
L_gemm1_kernel_w12_ln_nosig:
s_add_u32 m0, s43, 24576
s_nop 0
buffer_load_dwordx4 v12, s[52:55], s42 offen lds
s_add_u32 m0, s43, 25600
s_nop 0
buffer_load_dwordx4 v13, s[52:55], s42 offen lds
s_add_u32 m0, s43, 26624
s_nop 0
buffer_load_dwordx4 v14, s[52:55], s42 offen lds
s_add_u32 s42, s42, 229376
s_add_u32 m0, s43, 36864
s_nop 0
buffer_load_dwordx4 v12, s[52:55], s42 offen lds
s_add_u32 m0, s43, 37888
s_nop 0
buffer_load_dwordx4 v13, s[52:55], s42 offen lds
s_add_u32 m0, s43, 38912
s_nop 0
buffer_load_dwordx4 v14, s[52:55], s42 offen lds
s_add_u32 s42, s42, 229376
s_add_u32 m0, s43, 49152
s_nop 0
buffer_load_dwordx4 v12, s[52:55], s42 offen lds
s_add_u32 m0, s43, 50176
s_nop 0
buffer_load_dwordx4 v13, s[52:55], s42 offen lds
s_add_u32 m0, s43, 51200
s_nop 0
buffer_load_dwordx4 v14, s[52:55], s42 offen lds
s_add_u32 s42, s42, 229376
s_add_u32 m0, s43, 61440
s_nop 0
buffer_load_dwordx4 v12, s[52:55], s42 offen lds
s_add_u32 m0, s43, 62464
s_nop 0
buffer_load_dwordx4 v13, s[52:55], s42 offen lds
s_add_u32 m0, s43, 63488
s_nop 0
buffer_load_dwordx4 v14, s[52:55], s42 offen lds
s_add_u32 s42, s42, 229376
v_bfe_u32 v3, v0, 2, 4
v_bfe_u32 v4, v3, 1, 2
v_lshlrev_b32 v4, 5, v4
v_mul_u32_u24 v3, 384, v3
v_and_b32 v2, 3, v0
v_lshl_add_u32 v3, v2, 3, v3
v_xor_b32 v2, 0, v4
v_add_u32 v15, v2, v3
v_add_u32 v19, 49152, v15
v_xor_b32 v2, 32, v4
v_add_u32 v16, v2, v3
v_add_u32 v20, 49152, v16
v_xor_b32 v2, 64, v4
v_add_u32 v17, v2, v3
v_add_u32 v21, 49152, v17
v_xor_b32 v2, 96, v4
v_add_u32 v18, v2, v3
v_add_u32 v22, 49152, v18
s_add_u32 s28, s6, 0x3d00000
s_addc_u32 s29, s7, 0
s_and_b32 s29, s29, 0xffff
s_mov_b32 s30, 0x20000
s_mov_b32 s31, 0x20000
s_lshl_b32 s36, s2, 7
s_add_u32 s36, s36, 0x10000
v_and_b32 v5, 31, v0
v_lshlrev_b32 v5, 2, v5
v_add_u32 v5, s36, v5
s_lshl_b32 s36, s2, 6
s_add_u32 s36, s36, 4096
v_mov_b32 v3, s36
v_mov_b32 v2, 0
buffer_store_dword v2, v5, s[28:31], 0 offen
buffer_store_dword v2, v3, s[28:31], 0 offen
s_nop 0
v_mov_b32 v2, 0
v_mov_b32 v3, 0
v_mov_b32 v4, 0
v_mov_b32 v5, 0
s_nop 1
v_mfma_f32_32x32x16_bf16 v[64:79], v[2:5], v[2:5], 0
v_mfma_f32_32x32x16_bf16 v[80:95], v[2:5], v[2:5], 0
v_mfma_f32_32x32x16_bf16 v[96:111], v[2:5], v[2:5], 0
v_mfma_f32_32x32x16_bf16 v[112:127], v[2:5], v[2:5], 0
v_mfma_f32_32x32x16_bf16 v[128:143], v[2:5], v[2:5], 0
v_mfma_f32_32x32x16_bf16 v[144:159], v[2:5], v[2:5], 0
v_mfma_f32_32x32x16_bf16 v[160:175], v[2:5], v[2:5], 0
v_mfma_f32_32x32x16_bf16 v[176:191], v[2:5], v[2:5], 0
v_mfma_f32_32x32x16_bf16 v[192:207], v[2:5], v[2:5], 0
v_mfma_f32_32x32x16_bf16 v[208:223], v[2:5], v[2:5], 0
v_mfma_f32_32x32x16_bf16 v[224:239], v[2:5], v[2:5], 0
v_mfma_f32_32x32x16_bf16 v[240:255], v[2:5], v[2:5], 0
s_cmp_lg_u32 s40, 0
s_cbranch_scc1 L_gemm1_kernel_w12_ln_join
s_waitcnt vmcnt(14)
v_readfirstlane_b32 s37, v7
s_lshr_b32 s36, s47, 5
s_cmp_eq_u32 s37, 31
s_cbranch_scc0 L_gemm1_kernel_w12_ln_wait
s_lshl_b32 s36, s36, 12
s_add_u32 s36, s36, 0x8000
v_lshlrev_b32 v6, 7, v0
v_add_u32 v6, s36, v6
v_mov_b32 v7, 1
s_mov_b32 exec_hi, 0
buffer_store_dword v7, v6, s[76:79], 0 offen sc1
s_mov_b64 exec, s[38:39]
s_branch L_gemm1_kernel_w12_ln_join
L_gemm1_kernel_w12_ln_wait:
s_lshl_b32 s36, s47, 7
s_add_u32 s36, s36, 0x8000
v_mov_b32 v6, s36
s_mov_b32 s37, 0x80000
L_gemm1_kernel_w12_ln_p:
buffer_load_dword v7, v6, s[76:79], 0 offen sc1
s_waitcnt vmcnt(0)
v_readfirstlane_b32 s36, v7
s_sub_u32 s37, s37, 1
s_cbranch_scc1 L_gemm1_kernel_w12_ln_p_out
s_cmp_ge_u32 s36, 1
s_cbranch_scc1 L_gemm1_kernel_w12_ln_p_out
s_branch L_gemm1_kernel_w12_ln_p
L_gemm1_kernel_w12_ln_p_out:
L_gemm1_kernel_w12_ln_join:
s_barrier
buffer_load_dwordx4 a[0:3], v8, s[48:51], s41 offen sc1
buffer_load_dwordx4 a[4:7], v9, s[48:51], s41 offen sc1
buffer_load_dwordx4 a[8:11], v10, s[48:51], s41 offen sc1
buffer_load_dwordx4 a[12:15], v11, s[48:51], s41 offen sc1
s_add_u32 s41, s41, 1024
buffer_load_dwordx4 a[16:19], v8, s[48:51], s41 offen sc1
buffer_load_dwordx4 a[20:23], v9, s[48:51], s41 offen sc1
buffer_load_dwordx4 a[24:27], v10, s[48:51], s41 offen sc1
buffer_load_dwordx4 a[28:31], v11, s[48:51], s41 offen sc1
s_add_u32 s41, s41, 1024
buffer_load_dwordx4 a[32:35], v8, s[48:51], s41 offen sc1
buffer_load_dwordx4 a[36:39], v9, s[48:51], s41 offen sc1
buffer_load_dwordx4 a[40:43], v10, s[48:51], s41 offen sc1
buffer_load_dwordx4 a[44:47], v11, s[48:51], s41 offen sc1
s_add_u32 s41, s41, 1024
buffer_load_dword v56, v60, s[60:63], 0 offen offset:0 sc1
buffer_load_dword v57, v60, s[60:63], 0 offen offset:64 sc1
buffer_load_dword v58, v60, s[60:63], 0 offen offset:128 sc1
buffer_load_dword v59, v60, s[60:63], 0 offen offset:192 sc1
buffer_load_dwordx2 v[32:33], v61, s[64:67], 0 offen offset:0
buffer_load_dwordx2 v[34:35], v61, s[64:67], 0 offen offset:32
buffer_load_dwordx2 v[36:37], v61, s[64:67], 0 offen offset:64
buffer_load_dwordx2 v[38:39], v61, s[64:67], 0 offen offset:96
buffer_load_dwordx2 v[40:41], v61, s[64:67], 0 offen offset:128
buffer_load_dwordx2 v[42:43], v61, s[64:67], 0 offen offset:160
buffer_load_dwordx2 v[44:45], v61, s[64:67], 0 offen offset:192
buffer_load_dwordx2 v[46:47], v61, s[64:67], 0 offen offset:224
buffer_load_dwordx2 v[48:49], v61, s[64:67], 0 offen offset:256
buffer_load_dwordx2 v[50:51], v61, s[64:67], 0 offen offset:288
buffer_load_dwordx2 v[52:53], v61, s[64:67], 0 offen offset:320
buffer_load_dwordx2 v[54:55], v61, s[64:67], 0 offen offset:352
s_waitcnt vmcnt(24)
s_barrier
ds_read_b64_tr_b16 a[64:65], v15 offset:0
ds_read_b64_tr_b16 a[66:67], v15 offset:6144
ds_read_b64_tr_b16 a[68:69], v16 offset:0
ds_read_b64_tr_b16 a[70:71], v16 offset:6144
ds_read_b64_tr_b16 a[72:73], v17 offset:0
ds_read_b64_tr_b16 a[74:75], v17 offset:6144
ds_read_b64_tr_b16 a[76:77], v18 offset:0
ds_read_b64_tr_b16 a[78:79], v18 offset:6144
s_mov_b32 s44, 4
.p2align 4
L_gemm1_kernel_w12_loop0:
s_waitcnt lgkmcnt(6)
v_mfma_f32_16x16x32_bf16 v[64:67], a[64:67], a[0:3], v[64:67]
ds_read_b64_tr_b16 a[80:81], v15 offset:128
v_mfma_f32_16x16x32_bf16 v[68:71], a[64:67], a[4:7], v[68:71]
ds_read_b64_tr_b16 a[82:83], v15 offset:6272
buffer_load_dwordx4 a[48:51], v8, s[48:51], s41 offen sc1
v_mfma_f32_16x16x32_bf16 v[72:75], a[64:67], a[8:11], v[72:75]
v_mfma_f32_16x16x32_bf16 v[76:79], a[64:67], a[12:15], v[76:79]
s_waitcnt lgkmcnt(6)
v_mfma_f32_16x16x32_bf16 v[80:83], a[68:71], a[0:3], v[80:83]
ds_read_b64_tr_b16 a[84:85], v16 offset:128
v_mfma_f32_16x16x32_bf16 v[84:87], a[68:71], a[4:7], v[84:87]
ds_read_b64_tr_b16 a[86:87], v16 offset:6272
v_mfma_f32_16x16x32_bf16 v[88:91], a[68:71], a[8:11], v[88:91]
v_mfma_f32_16x16x32_bf16 v[92:95], a[68:71], a[12:15], v[92:95]
s_add_u32 m0, s43, 73728
s_waitcnt lgkmcnt(6)
v_mfma_f32_16x16x32_bf16 v[96:99], a[72:75], a[0:3], v[96:99]
ds_read_b64_tr_b16 a[88:89], v17 offset:128
buffer_load_dwordx4 v12, s[52:55], s42 offen lds
v_mfma_f32_16x16x32_bf16 v[100:103], a[72:75], a[4:7], v[100:103]
ds_read_b64_tr_b16 a[90:91], v17 offset:6272
v_mfma_f32_16x16x32_bf16 v[104:107], a[72:75], a[8:11], v[104:107]
v_mfma_f32_16x16x32_bf16 v[108:111], a[72:75], a[12:15], v[108:111]
s_waitcnt lgkmcnt(6)
v_mfma_f32_16x16x32_bf16 v[112:115], a[76:79], a[0:3], v[112:115]
ds_read_b64_tr_b16 a[92:93], v18 offset:128
v_mfma_f32_16x16x32_bf16 v[116:119], a[76:79], a[4:7], v[116:119]
ds_read_b64_tr_b16 a[94:95], v18 offset:6272
v_mfma_f32_16x16x32_bf16 v[120:123], a[76:79], a[8:11], v[120:123]
buffer_load_dwordx4 a[52:55], v9, s[48:51], s41 offen sc1
v_mfma_f32_16x16x32_bf16 v[124:127], a[76:79], a[12:15], v[124:127]
s_waitcnt lgkmcnt(6)
v_mfma_f32_16x16x32_bf16 v[128:131], a[80:83], a[0:3], v[128:131]
ds_read_b64_tr_b16 a[64:65], v15 offset:256
v_mfma_f32_16x16x32_bf16 v[132:135], a[80:83], a[4:7], v[132:135]
ds_read_b64_tr_b16 a[66:67], v15 offset:6400
v_mfma_f32_16x16x32_bf16 v[136:139], a[80:83], a[8:11], v[136:139]
v_mfma_f32_16x16x32_bf16 v[140:143], a[80:83], a[12:15], v[140:143]
s_waitcnt lgkmcnt(6)
v_mfma_f32_16x16x32_bf16 v[144:147], a[84:87], a[0:3], v[144:147]
ds_read_b64_tr_b16 a[68:69], v16 offset:256
v_mfma_f32_16x16x32_bf16 v[148:151], a[84:87], a[4:7], v[148:151]
ds_read_b64_tr_b16 a[70:71], v16 offset:6400
s_add_u32 m0, s43, 74752
v_mfma_f32_16x16x32_bf16 v[152:155], a[84:87], a[8:11], v[152:155]
buffer_load_dwordx4 v13, s[52:55], s42 offen lds
v_mfma_f32_16x16x32_bf16 v[156:159], a[84:87], a[12:15], v[156:159]
s_waitcnt lgkmcnt(6)
v_mfma_f32_16x16x32_bf16 v[160:163], a[88:91], a[0:3], v[160:163]
ds_read_b64_tr_b16 a[72:73], v17 offset:256
v_mfma_f32_16x16x32_bf16 v[164:167], a[88:91], a[4:7], v[164:167]
ds_read_b64_tr_b16 a[74:75], v17 offset:6400
v_mfma_f32_16x16x32_bf16 v[168:171], a[88:91], a[8:11], v[168:171]
v_mfma_f32_16x16x32_bf16 v[172:175], a[88:91], a[12:15], v[172:175]
s_waitcnt lgkmcnt(6)
v_mfma_f32_16x16x32_bf16 v[176:179], a[92:95], a[0:3], v[176:179]
ds_read_b64_tr_b16 a[76:77], v18 offset:256
buffer_load_dwordx4 a[56:59], v10, s[48:51], s41 offen sc1
v_mfma_f32_16x16x32_bf16 v[180:183], a[92:95], a[4:7], v[180:183]
ds_read_b64_tr_b16 a[78:79], v18 offset:6400
v_mfma_f32_16x16x32_bf16 v[184:187], a[92:95], a[8:11], v[184:187]
v_mfma_f32_16x16x32_bf16 v[188:191], a[92:95], a[12:15], v[188:191]
s_waitcnt lgkmcnt(6)
v_mfma_f32_16x16x32_bf16 v[192:195], a[64:67], a[0:3], v[192:195]
s_waitcnt vmcnt(12)
s_barrier
ds_read_b64_tr_b16 a[80:81], v15 offset:12288
v_mfma_f32_16x16x32_bf16 v[196:199], a[64:67], a[4:7], v[196:199]
ds_read_b64_tr_b16 a[82:83], v15 offset:18432
v_mfma_f32_16x16x32_bf16 v[200:203], a[64:67], a[8:11], v[200:203]
v_mfma_f32_16x16x32_bf16 v[204:207], a[64:67], a[12:15], v[204:207]
s_add_u32 m0, s43, 75776
s_waitcnt lgkmcnt(6)
v_mfma_f32_16x16x32_bf16 v[208:211], a[68:71], a[0:3], v[208:211]
ds_read_b64_tr_b16 a[84:85], v16 offset:12288
buffer_load_dwordx4 v14, s[52:55], s42 offen lds
s_add_u32 s42, s42, 229376
v_mfma_f32_16x16x32_bf16 v[212:215], a[68:71], a[4:7], v[212:215]
ds_read_b64_tr_b16 a[86:87], v16 offset:18432
v_mfma_f32_16x16x32_bf16 v[216:219], a[68:71], a[8:11], v[216:219]
v_mfma_f32_16x16x32_bf16 v[220:223], a[68:71], a[12:15], v[220:223]
s_waitcnt lgkmcnt(6)
v_mfma_f32_16x16x32_bf16 v[224:227], a[72:75], a[0:3], v[224:227]
ds_read_b64_tr_b16 a[88:89], v17 offset:12288
v_mfma_f32_16x16x32_bf16 v[228:231], a[72:75], a[4:7], v[228:231]
ds_read_b64_tr_b16 a[90:91], v17 offset:18432
v_mfma_f32_16x16x32_bf16 v[232:235], a[72:75], a[8:11], v[232:235]
buffer_load_dwordx4 a[60:63], v11, s[48:51], s41 offen sc1
s_add_u32 s41, s41, 1024
v_mfma_f32_16x16x32_bf16 v[236:239], a[72:75], a[12:15], v[236:239]
s_waitcnt lgkmcnt(6)
v_mfma_f32_16x16x32_bf16 v[240:243], a[76:79], a[0:3], v[240:243]
ds_read_b64_tr_b16 a[92:93], v18 offset:12288
v_mfma_f32_16x16x32_bf16 v[244:247], a[76:79], a[4:7], v[244:247]
ds_read_b64_tr_b16 a[94:95], v18 offset:18432
v_mfma_f32_16x16x32_bf16 v[248:251], a[76:79], a[8:11], v[248:251]
v_mfma_f32_16x16x32_bf16 v[252:255], a[76:79], a[12:15], v[252:255]
s_waitcnt lgkmcnt(6)
v_mfma_f32_16x16x32_bf16 v[64:67], a[80:83], a[16:19], v[64:67]
ds_read_b64_tr_b16 a[64:65], v15 offset:12416
v_mfma_f32_16x16x32_bf16 v[68:71], a[80:83], a[20:23], v[68:71]
ds_read_b64_tr_b16 a[66:67], v15 offset:18560
buffer_load_dwordx4 a[0:3], v8, s[48:51], s41 offen sc1
v_mfma_f32_16x16x32_bf16 v[72:75], a[80:83], a[24:27], v[72:75]
v_mfma_f32_16x16x32_bf16 v[76:79], a[80:83], a[28:31], v[76:79]
s_waitcnt lgkmcnt(6)
v_mfma_f32_16x16x32_bf16 v[80:83], a[84:87], a[16:19], v[80:83]
ds_read_b64_tr_b16 a[68:69], v16 offset:12416
v_mfma_f32_16x16x32_bf16 v[84:87], a[84:87], a[20:23], v[84:87]
ds_read_b64_tr_b16 a[70:71], v16 offset:18560
v_mfma_f32_16x16x32_bf16 v[88:91], a[84:87], a[24:27], v[88:91]
v_mfma_f32_16x16x32_bf16 v[92:95], a[84:87], a[28:31], v[92:95]
s_add_u32 m0, s43, 86016
s_waitcnt lgkmcnt(6)
v_mfma_f32_16x16x32_bf16 v[96:99], a[88:91], a[16:19], v[96:99]
ds_read_b64_tr_b16 a[72:73], v17 offset:12416
buffer_load_dwordx4 v12, s[52:55], s42 offen lds
v_mfma_f32_16x16x32_bf16 v[100:103], a[88:91], a[20:23], v[100:103]
ds_read_b64_tr_b16 a[74:75], v17 offset:18560
v_mfma_f32_16x16x32_bf16 v[104:107], a[88:91], a[24:27], v[104:107]
v_mfma_f32_16x16x32_bf16 v[108:111], a[88:91], a[28:31], v[108:111]
s_waitcnt lgkmcnt(6)
v_mfma_f32_16x16x32_bf16 v[112:115], a[92:95], a[16:19], v[112:115]
ds_read_b64_tr_b16 a[76:77], v18 offset:12416
v_mfma_f32_16x16x32_bf16 v[116:119], a[92:95], a[20:23], v[116:119]
ds_read_b64_tr_b16 a[78:79], v18 offset:18560
v_mfma_f32_16x16x32_bf16 v[120:123], a[92:95], a[24:27], v[120:123]
buffer_load_dwordx4 a[4:7], v9, s[48:51], s41 offen sc1
v_mfma_f32_16x16x32_bf16 v[124:127], a[92:95], a[28:31], v[124:127]
s_waitcnt lgkmcnt(6)
v_mfma_f32_16x16x32_bf16 v[128:131], a[64:67], a[16:19], v[128:131]
ds_read_b64_tr_b16 a[80:81], v15 offset:12544
v_mfma_f32_16x16x32_bf16 v[132:135], a[64:67], a[20:23], v[132:135]
ds_read_b64_tr_b16 a[82:83], v15 offset:18688
v_mfma_f32_16x16x32_bf16 v[136:139], a[64:67], a[24:27], v[136:139]
v_mfma_f32_16x16x32_bf16 v[140:143], a[64:67], a[28:31], v[140:143]
s_waitcnt lgkmcnt(6)
v_mfma_f32_16x16x32_bf16 v[144:147], a[68:71], a[16:19], v[144:147]
ds_read_b64_tr_b16 a[84:85], v16 offset:12544
v_mfma_f32_16x16x32_bf16 v[148:151], a[68:71], a[20:23], v[148:151]
ds_read_b64_tr_b16 a[86:87], v16 offset:18688
s_add_u32 m0, s43, 87040
v_mfma_f32_16x16x32_bf16 v[152:155], a[68:71], a[24:27], v[152:155]
buffer_load_dwordx4 v13, s[52:55], s42 offen lds
v_mfma_f32_16x16x32_bf16 v[156:159], a[68:71], a[28:31], v[156:159]
s_waitcnt lgkmcnt(6)
v_mfma_f32_16x16x32_bf16 v[160:163], a[72:75], a[16:19], v[160:163]
ds_read_b64_tr_b16 a[88:89], v17 offset:12544
v_mfma_f32_16x16x32_bf16 v[164:167], a[72:75], a[20:23], v[164:167]
ds_read_b64_tr_b16 a[90:91], v17 offset:18688
v_mfma_f32_16x16x32_bf16 v[168:171], a[72:75], a[24:27], v[168:171]
v_mfma_f32_16x16x32_bf16 v[172:175], a[72:75], a[28:31], v[172:175]
s_waitcnt lgkmcnt(6)
v_mfma_f32_16x16x32_bf16 v[176:179], a[76:79], a[16:19], v[176:179]
ds_read_b64_tr_b16 a[92:93], v18 offset:12544
buffer_load_dwordx4 a[8:11], v10, s[48:51], s41 offen sc1
v_mfma_f32_16x16x32_bf16 v[180:183], a[76:79], a[20:23], v[180:183]
ds_read_b64_tr_b16 a[94:95], v18 offset:18688
v_mfma_f32_16x16x32_bf16 v[184:187], a[76:79], a[24:27], v[184:187]
v_mfma_f32_16x16x32_bf16 v[188:191], a[76:79], a[28:31], v[188:191]
s_waitcnt lgkmcnt(6)
v_mfma_f32_16x16x32_bf16 v[192:195], a[80:83], a[16:19], v[192:195]
s_waitcnt vmcnt(12)
s_barrier
ds_read_b64_tr_b16 a[64:65], v15 offset:24576
v_mfma_f32_16x16x32_bf16 v[196:199], a[80:83], a[20:23], v[196:199]
ds_read_b64_tr_b16 a[66:67], v15 offset:30720
v_mfma_f32_16x16x32_bf16 v[200:203], a[80:83], a[24:27], v[200:203]
v_mfma_f32_16x16x32_bf16 v[204:207], a[80:83], a[28:31], v[204:207]
s_add_u32 m0, s43, 88064
s_waitcnt lgkmcnt(6)
v_mfma_f32_16x16x32_bf16 v[208:211], a[84:87], a[16:19], v[208:211]
ds_read_b64_tr_b16 a[68:69], v16 offset:24576
buffer_load_dwordx4 v14, s[52:55], s42 offen lds
s_add_u32 s42, s42, 229376
v_mfma_f32_16x16x32_bf16 v[212:215], a[84:87], a[20:23], v[212:215]
ds_read_b64_tr_b16 a[70:71], v16 offset:30720
v_mfma_f32_16x16x32_bf16 v[216:219], a[84:87], a[24:27], v[216:219]
v_mfma_f32_16x16x32_bf16 v[220:223], a[84:87], a[28:31], v[220:223]
s_waitcnt lgkmcnt(6)
v_mfma_f32_16x16x32_bf16 v[224:227], a[88:91], a[16:19], v[224:227]
ds_read_b64_tr_b16 a[72:73], v17 offset:24576
v_mfma_f32_16x16x32_bf16 v[228:231], a[88:91], a[20:23], v[228:231]
ds_read_b64_tr_b16 a[74:75], v17 offset:30720
v_mfma_f32_16x16x32_bf16 v[232:235], a[88:91], a[24:27], v[232:235]
buffer_load_dwordx4 a[12:15], v11, s[48:51], s41 offen sc1
s_add_u32 s41, s41, 1024
v_mfma_f32_16x16x32_bf16 v[236:239], a[88:91], a[28:31], v[236:239]
s_waitcnt lgkmcnt(6)
v_mfma_f32_16x16x32_bf16 v[240:243], a[92:95], a[16:19], v[240:243]
ds_read_b64_tr_b16 a[76:77], v18 offset:24576
v_mfma_f32_16x16x32_bf16 v[244:247], a[92:95], a[20:23], v[244:247]
ds_read_b64_tr_b16 a[78:79], v18 offset:30720
v_mfma_f32_16x16x32_bf16 v[248:251], a[92:95], a[24:27], v[248:251]
v_mfma_f32_16x16x32_bf16 v[252:255], a[92:95], a[28:31], v[252:255]
s_waitcnt lgkmcnt(6)
v_mfma_f32_16x16x32_bf16 v[64:67], a[64:67], a[32:35], v[64:67]
ds_read_b64_tr_b16 a[80:81], v15 offset:24704
v_mfma_f32_16x16x32_bf16 v[68:71], a[64:67], a[36:39], v[68:71]
ds_read_b64_tr_b16 a[82:83], v15 offset:30848
buffer_load_dwordx4 a[16:19], v8, s[48:51], s41 offen sc1
v_mfma_f32_16x16x32_bf16 v[72:75], a[64:67], a[40:43], v[72:75]
v_mfma_f32_16x16x32_bf16 v[76:79], a[64:67], a[44:47], v[76:79]
s_waitcnt lgkmcnt(6)
v_mfma_f32_16x16x32_bf16 v[80:83], a[68:71], a[32:35], v[80:83]
ds_read_b64_tr_b16 a[84:85], v16 offset:24704
v_mfma_f32_16x16x32_bf16 v[84:87], a[68:71], a[36:39], v[84:87]
ds_read_b64_tr_b16 a[86:87], v16 offset:30848
v_mfma_f32_16x16x32_bf16 v[88:91], a[68:71], a[40:43], v[88:91]
v_mfma_f32_16x16x32_bf16 v[92:95], a[68:71], a[44:47], v[92:95]
s_add_u32 m0, s43, 0
s_waitcnt lgkmcnt(6)
v_mfma_f32_16x16x32_bf16 v[96:99], a[72:75], a[32:35], v[96:99]
ds_read_b64_tr_b16 a[88:89], v17 offset:24704
buffer_load_dwordx4 v12, s[52:55], s42 offen lds
v_mfma_f32_16x16x32_bf16 v[100:103], a[72:75], a[36:39], v[100:103]
ds_read_b64_tr_b16 a[90:91], v17 offset:30848
v_mfma_f32_16x16x32_bf16 v[104:107], a[72:75], a[40:43], v[104:107]
v_mfma_f32_16x16x32_bf16 v[108:111], a[72:75], a[44:47], v[108:111]
s_waitcnt lgkmcnt(6)
v_mfma_f32_16x16x32_bf16 v[112:115], a[76:79], a[32:35], v[112:115]
ds_read_b64_tr_b16 a[92:93], v18 offset:24704
v_mfma_f32_16x16x32_bf16 v[116:119], a[76:79], a[36:39], v[116:119]
ds_read_b64_tr_b16 a[94:95], v18 offset:30848
v_mfma_f32_16x16x32_bf16 v[120:123], a[76:79], a[40:43], v[120:123]
buffer_load_dwordx4 a[20:23], v9, s[48:51], s41 offen sc1
v_mfma_f32_16x16x32_bf16 v[124:127], a[76:79], a[44:47], v[124:127]
s_waitcnt lgkmcnt(6)
v_mfma_f32_16x16x32_bf16 v[128:131], a[80:83], a[32:35], v[128:131]
ds_read_b64_tr_b16 a[64:65], v15 offset:24832
v_mfma_f32_16x16x32_bf16 v[132:135], a[80:83], a[36:39], v[132:135]
ds_read_b64_tr_b16 a[66:67], v15 offset:30976
v_mfma_f32_16x16x32_bf16 v[136:139], a[80:83], a[40:43], v[136:139]
v_mfma_f32_16x16x32_bf16 v[140:143], a[80:83], a[44:47], v[140:143]
s_waitcnt lgkmcnt(6)
v_mfma_f32_16x16x32_bf16 v[144:147], a[84:87], a[32:35], v[144:147]
ds_read_b64_tr_b16 a[68:69], v16 offset:24832
v_mfma_f32_16x16x32_bf16 v[148:151], a[84:87], a[36:39], v[148:151]
ds_read_b64_tr_b16 a[70:71], v16 offset:30976
s_add_u32 m0, s43, 1024
v_mfma_f32_16x16x32_bf16 v[152:155], a[84:87], a[40:43], v[152:155]
buffer_load_dwordx4 v13, s[52:55], s42 offen lds
v_mfma_f32_16x16x32_bf16 v[156:159], a[84:87], a[44:47], v[156:159]
s_waitcnt lgkmcnt(6)
v_mfma_f32_16x16x32_bf16 v[160:163], a[88:91], a[32:35], v[160:163]
ds_read_b64_tr_b16 a[72:73], v17 offset:24832
v_mfma_f32_16x16x32_bf16 v[164:167], a[88:91], a[36:39], v[164:167]
ds_read_b64_tr_b16 a[74:75], v17 offset:30976
v_mfma_f32_16x16x32_bf16 v[168:171], a[88:91], a[40:43], v[168:171]
v_mfma_f32_16x16x32_bf16 v[172:175], a[88:91], a[44:47], v[172:175]
s_waitcnt lgkmcnt(6)
v_mfma_f32_16x16x32_bf16 v[176:179], a[92:95], a[32:35], v[176:179]
ds_read_b64_tr_b16 a[76:77], v18 offset:24832
buffer_load_dwordx4 a[24:27], v10, s[48:51], s41 offen sc1
v_mfma_f32_16x16x32_bf16 v[180:183], a[92:95], a[36:39], v[180:183]
ds_read_b64_tr_b16 a[78:79], v18 offset:30976
v_mfma_f32_16x16x32_bf16 v[184:187], a[92:95], a[40:43], v[184:187]
v_mfma_f32_16x16x32_bf16 v[188:191], a[92:95], a[44:47], v[188:191]
s_waitcnt lgkmcnt(6)
v_mfma_f32_16x16x32_bf16 v[192:195], a[64:67], a[32:35], v[192:195]
s_waitcnt vmcnt(12)
s_barrier
ds_read_b64_tr_b16 a[80:81], v15 offset:36864
v_mfma_f32_16x16x32_bf16 v[196:199], a[64:67], a[36:39], v[196:199]
ds_read_b64_tr_b16 a[82:83], v15 offset:43008
v_mfma_f32_16x16x32_bf16 v[200:203], a[64:67], a[40:43], v[200:203]
v_mfma_f32_16x16x32_bf16 v[204:207], a[64:67], a[44:47], v[204:207]
s_add_u32 m0, s43, 2048
s_waitcnt lgkmcnt(6)
v_mfma_f32_16x16x32_bf16 v[208:211], a[68:71], a[32:35], v[208:211]
ds_read_b64_tr_b16 a[84:85], v16 offset:36864
buffer_load_dwordx4 v14, s[52:55], s42 offen lds
s_add_u32 s42, s42, 229376
v_mfma_f32_16x16x32_bf16 v[212:215], a[68:71], a[36:39], v[212:215]
ds_read_b64_tr_b16 a[86:87], v16 offset:43008
v_mfma_f32_16x16x32_bf16 v[216:219], a[68:71], a[40:43], v[216:219]
v_mfma_f32_16x16x32_bf16 v[220:223], a[68:71], a[44:47], v[220:223]
s_waitcnt lgkmcnt(6)
v_mfma_f32_16x16x32_bf16 v[224:227], a[72:75], a[32:35], v[224:227]
ds_read_b64_tr_b16 a[88:89], v17 offset:36864
v_mfma_f32_16x16x32_bf16 v[228:231], a[72:75], a[36:39], v[228:231]
ds_read_b64_tr_b16 a[90:91], v17 offset:43008
v_mfma_f32_16x16x32_bf16 v[232:235], a[72:75], a[40:43], v[232:235]
buffer_load_dwordx4 a[28:31], v11, s[48:51], s41 offen sc1
s_add_u32 s41, s41, 1024
v_mfma_f32_16x16x32_bf16 v[236:239], a[72:75], a[44:47], v[236:239]
s_waitcnt lgkmcnt(6)
v_mfma_f32_16x16x32_bf16 v[240:243], a[76:79], a[32:35], v[240:243]
ds_read_b64_tr_b16 a[92:93], v18 offset:36864
v_mfma_f32_16x16x32_bf16 v[244:247], a[76:79], a[36:39], v[244:247]
ds_read_b64_tr_b16 a[94:95], v18 offset:43008
v_mfma_f32_16x16x32_bf16 v[248:251], a[76:79], a[40:43], v[248:251]
v_mfma_f32_16x16x32_bf16 v[252:255], a[76:79], a[44:47], v[252:255]
s_waitcnt lgkmcnt(6)
v_mfma_f32_16x16x32_bf16 v[64:67], a[80:83], a[48:51], v[64:67]
ds_read_b64_tr_b16 a[64:65], v15 offset:36992
v_mfma_f32_16x16x32_bf16 v[68:71], a[80:83], a[52:55], v[68:71]
ds_read_b64_tr_b16 a[66:67], v15 offset:43136
buffer_load_dwordx4 a[32:35], v8, s[48:51], s41 offen sc1
v_mfma_f32_16x16x32_bf16 v[72:75], a[80:83], a[56:59], v[72:75]
v_mfma_f32_16x16x32_bf16 v[76:79], a[80:83], a[60:63], v[76:79]
s_waitcnt lgkmcnt(6)
v_mfma_f32_16x16x32_bf16 v[80:83], a[84:87], a[48:51], v[80:83]
ds_read_b64_tr_b16 a[68:69], v16 offset:36992
v_mfma_f32_16x16x32_bf16 v[84:87], a[84:87], a[52:55], v[84:87]
ds_read_b64_tr_b16 a[70:71], v16 offset:43136
v_mfma_f32_16x16x32_bf16 v[88:91], a[84:87], a[56:59], v[88:91]
v_mfma_f32_16x16x32_bf16 v[92:95], a[84:87], a[60:63], v[92:95]
s_add_u32 m0, s43, 12288
s_waitcnt lgkmcnt(6)
v_mfma_f32_16x16x32_bf16 v[96:99], a[88:91], a[48:51], v[96:99]
ds_read_b64_tr_b16 a[72:73], v17 offset:36992
buffer_load_dwordx4 v12, s[52:55], s42 offen lds
v_mfma_f32_16x16x32_bf16 v[100:103], a[88:91], a[52:55], v[100:103]
ds_read_b64_tr_b16 a[74:75], v17 offset:43136
v_mfma_f32_16x16x32_bf16 v[104:107], a[88:91], a[56:59], v[104:107]
v_mfma_f32_16x16x32_bf16 v[108:111], a[88:91], a[60:63], v[108:111]
s_waitcnt lgkmcnt(6)
v_mfma_f32_16x16x32_bf16 v[112:115], a[92:95], a[48:51], v[112:115]
ds_read_b64_tr_b16 a[76:77], v18 offset:36992
v_mfma_f32_16x16x32_bf16 v[116:119], a[92:95], a[52:55], v[116:119]
ds_read_b64_tr_b16 a[78:79], v18 offset:43136
v_mfma_f32_16x16x32_bf16 v[120:123], a[92:95], a[56:59], v[120:123]
buffer_load_dwordx4 a[36:39], v9, s[48:51], s41 offen sc1
v_mfma_f32_16x16x32_bf16 v[124:127], a[92:95], a[60:63], v[124:127]
s_waitcnt lgkmcnt(6)
v_mfma_f32_16x16x32_bf16 v[128:131], a[64:67], a[48:51], v[128:131]
ds_read_b64_tr_b16 a[80:81], v15 offset:37120
v_mfma_f32_16x16x32_bf16 v[132:135], a[64:67], a[52:55], v[132:135]
ds_read_b64_tr_b16 a[82:83], v15 offset:43264
v_mfma_f32_16x16x32_bf16 v[136:139], a[64:67], a[56:59], v[136:139]
v_mfma_f32_16x16x32_bf16 v[140:143], a[64:67], a[60:63], v[140:143]
s_waitcnt lgkmcnt(6)
v_mfma_f32_16x16x32_bf16 v[144:147], a[68:71], a[48:51], v[144:147]
ds_read_b64_tr_b16 a[84:85], v16 offset:37120
v_mfma_f32_16x16x32_bf16 v[148:151], a[68:71], a[52:55], v[148:151]
ds_read_b64_tr_b16 a[86:87], v16 offset:43264
s_add_u32 m0, s43, 13312
v_mfma_f32_16x16x32_bf16 v[152:155], a[68:71], a[56:59], v[152:155]
buffer_load_dwordx4 v13, s[52:55], s42 offen lds
v_mfma_f32_16x16x32_bf16 v[156:159], a[68:71], a[60:63], v[156:159]
s_waitcnt lgkmcnt(6)
v_mfma_f32_16x16x32_bf16 v[160:163], a[72:75], a[48:51], v[160:163]
ds_read_b64_tr_b16 a[88:89], v17 offset:37120
v_mfma_f32_16x16x32_bf16 v[164:167], a[72:75], a[52:55], v[164:167]
ds_read_b64_tr_b16 a[90:91], v17 offset:43264
v_mfma_f32_16x16x32_bf16 v[168:171], a[72:75], a[56:59], v[168:171]
v_mfma_f32_16x16x32_bf16 v[172:175], a[72:75], a[60:63], v[172:175]
s_waitcnt lgkmcnt(6)
v_mfma_f32_16x16x32_bf16 v[176:179], a[76:79], a[48:51], v[176:179]
ds_read_b64_tr_b16 a[92:93], v18 offset:37120
buffer_load_dwordx4 a[40:43], v10, s[48:51], s41 offen sc1
v_mfma_f32_16x16x32_bf16 v[180:183], a[76:79], a[52:55], v[180:183]
ds_read_b64_tr_b16 a[94:95], v18 offset:43264
v_mfma_f32_16x16x32_bf16 v[184:187], a[76:79], a[56:59], v[184:187]
v_mfma_f32_16x16x32_bf16 v[188:191], a[76:79], a[60:63], v[188:191]
s_waitcnt lgkmcnt(6)
v_mfma_f32_16x16x32_bf16 v[192:195], a[80:83], a[48:51], v[192:195]
s_waitcnt vmcnt(12)
s_barrier
ds_read_b64_tr_b16 a[64:65], v19 offset:0
v_mfma_f32_16x16x32_bf16 v[196:199], a[80:83], a[52:55], v[196:199]
ds_read_b64_tr_b16 a[66:67], v19 offset:6144
v_mfma_f32_16x16x32_bf16 v[200:203], a[80:83], a[56:59], v[200:203]
v_mfma_f32_16x16x32_bf16 v[204:207], a[80:83], a[60:63], v[204:207]
s_add_u32 m0, s43, 14336
s_waitcnt lgkmcnt(6)
v_mfma_f32_16x16x32_bf16 v[208:211], a[84:87], a[48:51], v[208:211]
ds_read_b64_tr_b16 a[68:69], v20 offset:0
buffer_load_dwordx4 v14, s[52:55], s42 offen lds
s_add_u32 s42, s42, 229376
v_mfma_f32_16x16x32_bf16 v[212:215], a[84:87], a[52:55], v[212:215]
ds_read_b64_tr_b16 a[70:71], v20 offset:6144
v_mfma_f32_16x16x32_bf16 v[216:219], a[84:87], a[56:59], v[216:219]
v_mfma_f32_16x16x32_bf16 v[220:223], a[84:87], a[60:63], v[220:223]
s_waitcnt lgkmcnt(6)
v_mfma_f32_16x16x32_bf16 v[224:227], a[88:91], a[48:51], v[224:227]
ds_read_b64_tr_b16 a[72:73], v21 offset:0
v_mfma_f32_16x16x32_bf16 v[228:231], a[88:91], a[52:55], v[228:231]
ds_read_b64_tr_b16 a[74:75], v21 offset:6144
v_mfma_f32_16x16x32_bf16 v[232:235], a[88:91], a[56:59], v[232:235]
buffer_load_dwordx4 a[44:47], v11, s[48:51], s41 offen sc1
s_add_u32 s41, s41, 1024
v_mfma_f32_16x16x32_bf16 v[236:239], a[88:91], a[60:63], v[236:239]
s_waitcnt lgkmcnt(6)
v_mfma_f32_16x16x32_bf16 v[240:243], a[92:95], a[48:51], v[240:243]
ds_read_b64_tr_b16 a[76:77], v22 offset:0
v_mfma_f32_16x16x32_bf16 v[244:247], a[92:95], a[52:55], v[244:247]
ds_read_b64_tr_b16 a[78:79], v22 offset:6144
v_mfma_f32_16x16x32_bf16 v[248:251], a[92:95], a[56:59], v[248:251]
v_mfma_f32_16x16x32_bf16 v[252:255], a[92:95], a[60:63], v[252:255]
s_waitcnt lgkmcnt(6)
v_mfma_f32_16x16x32_bf16 v[64:67], a[64:67], a[0:3], v[64:67]
ds_read_b64_tr_b16 a[80:81], v19 offset:128
v_mfma_f32_16x16x32_bf16 v[68:71], a[64:67], a[4:7], v[68:71]
ds_read_b64_tr_b16 a[82:83], v19 offset:6272
buffer_load_dwordx4 a[48:51], v8, s[48:51], s41 offen sc1
v_mfma_f32_16x16x32_bf16 v[72:75], a[64:67], a[8:11], v[72:75]
v_mfma_f32_16x16x32_bf16 v[76:79], a[64:67], a[12:15], v[76:79]
s_waitcnt lgkmcnt(6)
v_mfma_f32_16x16x32_bf16 v[80:83], a[68:71], a[0:3], v[80:83]
ds_read_b64_tr_b16 a[84:85], v20 offset:128
v_mfma_f32_16x16x32_bf16 v[84:87], a[68:71], a[4:7], v[84:87]
ds_read_b64_tr_b16 a[86:87], v20 offset:6272
v_mfma_f32_16x16x32_bf16 v[88:91], a[68:71], a[8:11], v[88:91]
v_mfma_f32_16x16x32_bf16 v[92:95], a[68:71], a[12:15], v[92:95]
s_add_u32 m0, s43, 24576
s_waitcnt lgkmcnt(6)
v_mfma_f32_16x16x32_bf16 v[96:99], a[72:75], a[0:3], v[96:99]
ds_read_b64_tr_b16 a[88:89], v21 offset:128
buffer_load_dwordx4 v12, s[52:55], s42 offen lds
v_mfma_f32_16x16x32_bf16 v[100:103], a[72:75], a[4:7], v[100:103]
ds_read_b64_tr_b16 a[90:91], v21 offset:6272
v_mfma_f32_16x16x32_bf16 v[104:107], a[72:75], a[8:11], v[104:107]
v_mfma_f32_16x16x32_bf16 v[108:111], a[72:75], a[12:15], v[108:111]
s_waitcnt lgkmcnt(6)
v_mfma_f32_16x16x32_bf16 v[112:115], a[76:79], a[0:3], v[112:115]
ds_read_b64_tr_b16 a[92:93], v22 offset:128
v_mfma_f32_16x16x32_bf16 v[116:119], a[76:79], a[4:7], v[116:119]
ds_read_b64_tr_b16 a[94:95], v22 offset:6272
v_mfma_f32_16x16x32_bf16 v[120:123], a[76:79], a[8:11], v[120:123]
buffer_load_dwordx4 a[52:55], v9, s[48:51], s41 offen sc1
v_mfma_f32_16x16x32_bf16 v[124:127], a[76:79], a[12:15], v[124:127]
s_waitcnt lgkmcnt(6)
v_mfma_f32_16x16x32_bf16 v[128:131], a[80:83], a[0:3], v[128:131]
ds_read_b64_tr_b16 a[64:65], v19 offset:256
v_mfma_f32_16x16x32_bf16 v[132:135], a[80:83], a[4:7], v[132:135]
ds_read_b64_tr_b16 a[66:67], v19 offset:6400
v_mfma_f32_16x16x32_bf16 v[136:139], a[80:83], a[8:11], v[136:139]
v_mfma_f32_16x16x32_bf16 v[140:143], a[80:83], a[12:15], v[140:143]
s_waitcnt lgkmcnt(6)
v_mfma_f32_16x16x32_bf16 v[144:147], a[84:87], a[0:3], v[144:147]
ds_read_b64_tr_b16 a[68:69], v20 offset:256
v_mfma_f32_16x16x32_bf16 v[148:151], a[84:87], a[4:7], v[148:151]
ds_read_b64_tr_b16 a[70:71], v20 offset:6400
s_add_u32 m0, s43, 25600
v_mfma_f32_16x16x32_bf16 v[152:155], a[84:87], a[8:11], v[152:155]
buffer_load_dwordx4 v13, s[52:55], s42 offen lds
v_mfma_f32_16x16x32_bf16 v[156:159], a[84:87], a[12:15], v[156:159]
s_waitcnt lgkmcnt(6)
v_mfma_f32_16x16x32_bf16 v[160:163], a[88:91], a[0:3], v[160:163]
ds_read_b64_tr_b16 a[72:73], v21 offset:256
v_mfma_f32_16x16x32_bf16 v[164:167], a[88:91], a[4:7], v[164:167]
ds_read_b64_tr_b16 a[74:75], v21 offset:6400
v_mfma_f32_16x16x32_bf16 v[168:171], a[88:91], a[8:11], v[168:171]
v_mfma_f32_16x16x32_bf16 v[172:175], a[88:91], a[12:15], v[172:175]
s_waitcnt lgkmcnt(6)
v_mfma_f32_16x16x32_bf16 v[176:179], a[92:95], a[0:3], v[176:179]
ds_read_b64_tr_b16 a[76:77], v22 offset:256
buffer_load_dwordx4 a[56:59], v10, s[48:51], s41 offen sc1
v_mfma_f32_16x16x32_bf16 v[180:183], a[92:95], a[4:7], v[180:183]
ds_read_b64_tr_b16 a[78:79], v22 offset:6400
v_mfma_f32_16x16x32_bf16 v[184:187], a[92:95], a[8:11], v[184:187]
v_mfma_f32_16x16x32_bf16 v[188:191], a[92:95], a[12:15], v[188:191]
s_waitcnt lgkmcnt(6)
v_mfma_f32_16x16x32_bf16 v[192:195], a[64:67], a[0:3], v[192:195]
s_waitcnt vmcnt(12)
s_barrier
ds_read_b64_tr_b16 a[80:81], v19 offset:12288
v_mfma_f32_16x16x32_bf16 v[196:199], a[64:67], a[4:7], v[196:199]
ds_read_b64_tr_b16 a[82:83], v19 offset:18432
v_mfma_f32_16x16x32_bf16 v[200:203], a[64:67], a[8:11], v[200:203]
v_mfma_f32_16x16x32_bf16 v[204:207], a[64:67], a[12:15], v[204:207]
s_add_u32 m0, s43, 26624
s_waitcnt lgkmcnt(6)
v_mfma_f32_16x16x32_bf16 v[208:211], a[68:71], a[0:3], v[208:211]
ds_read_b64_tr_b16 a[84:85], v20 offset:12288
buffer_load_dwordx4 v14, s[52:55], s42 offen lds
s_add_u32 s42, s42, 229376
v_mfma_f32_16x16x32_bf16 v[212:215], a[68:71], a[4:7], v[212:215]
ds_read_b64_tr_b16 a[86:87], v20 offset:18432
v_mfma_f32_16x16x32_bf16 v[216:219], a[68:71], a[8:11], v[216:219]
v_mfma_f32_16x16x32_bf16 v[220:223], a[68:71], a[12:15], v[220:223]
s_waitcnt lgkmcnt(6)
v_mfma_f32_16x16x32_bf16 v[224:227], a[72:75], a[0:3], v[224:227]
ds_read_b64_tr_b16 a[88:89], v21 offset:12288
v_mfma_f32_16x16x32_bf16 v[228:231], a[72:75], a[4:7], v[228:231]
ds_read_b64_tr_b16 a[90:91], v21 offset:18432
v_mfma_f32_16x16x32_bf16 v[232:235], a[72:75], a[8:11], v[232:235]
buffer_load_dwordx4 a[60:63], v11, s[48:51], s41 offen sc1
s_add_u32 s41, s41, 1024
v_mfma_f32_16x16x32_bf16 v[236:239], a[72:75], a[12:15], v[236:239]
s_waitcnt lgkmcnt(6)
v_mfma_f32_16x16x32_bf16 v[240:243], a[76:79], a[0:3], v[240:243]
ds_read_b64_tr_b16 a[92:93], v22 offset:12288
v_mfma_f32_16x16x32_bf16 v[244:247], a[76:79], a[4:7], v[244:247]
ds_read_b64_tr_b16 a[94:95], v22 offset:18432
v_mfma_f32_16x16x32_bf16 v[248:251], a[76:79], a[8:11], v[248:251]
v_mfma_f32_16x16x32_bf16 v[252:255], a[76:79], a[12:15], v[252:255]
s_waitcnt lgkmcnt(6)
v_mfma_f32_16x16x32_bf16 v[64:67], a[80:83], a[16:19], v[64:67]
ds_read_b64_tr_b16 a[64:65], v19 offset:12416
v_mfma_f32_16x16x32_bf16 v[68:71], a[80:83], a[20:23], v[68:71]
ds_read_b64_tr_b16 a[66:67], v19 offset:18560
buffer_load_dwordx4 a[0:3], v8, s[48:51], s41 offen sc1
v_mfma_f32_16x16x32_bf16 v[72:75], a[80:83], a[24:27], v[72:75]
v_mfma_f32_16x16x32_bf16 v[76:79], a[80:83], a[28:31], v[76:79]
s_waitcnt lgkmcnt(6)
v_mfma_f32_16x16x32_bf16 v[80:83], a[84:87], a[16:19], v[80:83]
ds_read_b64_tr_b16 a[68:69], v20 offset:12416
v_mfma_f32_16x16x32_bf16 v[84:87], a[84:87], a[20:23], v[84:87]
ds_read_b64_tr_b16 a[70:71], v20 offset:18560
v_mfma_f32_16x16x32_bf16 v[88:91], a[84:87], a[24:27], v[88:91]
v_mfma_f32_16x16x32_bf16 v[92:95], a[84:87], a[28:31], v[92:95]
s_add_u32 m0, s43, 36864
s_waitcnt lgkmcnt(6)
v_mfma_f32_16x16x32_bf16 v[96:99], a[88:91], a[16:19], v[96:99]
ds_read_b64_tr_b16 a[72:73], v21 offset:12416
buffer_load_dwordx4 v12, s[52:55], s42 offen lds
v_mfma_f32_16x16x32_bf16 v[100:103], a[88:91], a[20:23], v[100:103]
ds_read_b64_tr_b16 a[74:75], v21 offset:18560
v_mfma_f32_16x16x32_bf16 v[104:107], a[88:91], a[24:27], v[104:107]
v_mfma_f32_16x16x32_bf16 v[108:111], a[88:91], a[28:31], v[108:111]
s_waitcnt lgkmcnt(6)
v_mfma_f32_16x16x32_bf16 v[112:115], a[92:95], a[16:19], v[112:115]
ds_read_b64_tr_b16 a[76:77], v22 offset:12416
v_mfma_f32_16x16x32_bf16 v[116:119], a[92:95], a[20:23], v[116:119]
ds_read_b64_tr_b16 a[78:79], v22 offset:18560
v_mfma_f32_16x16x32_bf16 v[120:123], a[92:95], a[24:27], v[120:123]
buffer_load_dwordx4 a[4:7], v9, s[48:51], s41 offen sc1
v_mfma_f32_16x16x32_bf16 v[124:127], a[92:95], a[28:31], v[124:127]
s_waitcnt lgkmcnt(6)
v_mfma_f32_16x16x32_bf16 v[128:131], a[64:67], a[16:19], v[128:131]
ds_read_b64_tr_b16 a[80:81], v19 offset:12544
v_mfma_f32_16x16x32_bf16 v[132:135], a[64:67], a[20:23], v[132:135]
ds_read_b64_tr_b16 a[82:83], v19 offset:18688
v_mfma_f32_16x16x32_bf16 v[136:139], a[64:67], a[24:27], v[136:139]
v_mfma_f32_16x16x32_bf16 v[140:143], a[64:67], a[28:31], v[140:143]
s_waitcnt lgkmcnt(6)
v_mfma_f32_16x16x32_bf16 v[144:147], a[68:71], a[16:19], v[144:147]
ds_read_b64_tr_b16 a[84:85], v20 offset:12544
v_mfma_f32_16x16x32_bf16 v[148:151], a[68:71], a[20:23], v[148:151]
ds_read_b64_tr_b16 a[86:87], v20 offset:18688
s_add_u32 m0, s43, 37888
v_mfma_f32_16x16x32_bf16 v[152:155], a[68:71], a[24:27], v[152:155]
buffer_load_dwordx4 v13, s[52:55], s42 offen lds
v_mfma_f32_16x16x32_bf16 v[156:159], a[68:71], a[28:31], v[156:159]
s_waitcnt lgkmcnt(6)
v_mfma_f32_16x16x32_bf16 v[160:163], a[72:75], a[16:19], v[160:163]
ds_read_b64_tr_b16 a[88:89], v21 offset:12544
v_mfma_f32_16x16x32_bf16 v[164:167], a[72:75], a[20:23], v[164:167]
ds_read_b64_tr_b16 a[90:91], v21 offset:18688
v_mfma_f32_16x16x32_bf16 v[168:171], a[72:75], a[24:27], v[168:171]
v_mfma_f32_16x16x32_bf16 v[172:175], a[72:75], a[28:31], v[172:175]
s_waitcnt lgkmcnt(6)
v_mfma_f32_16x16x32_bf16 v[176:179], a[76:79], a[16:19], v[176:179]
ds_read_b64_tr_b16 a[92:93], v22 offset:12544
buffer_load_dwordx4 a[8:11], v10, s[48:51], s41 offen sc1
v_mfma_f32_16x16x32_bf16 v[180:183], a[76:79], a[20:23], v[180:183]
ds_read_b64_tr_b16 a[94:95], v22 offset:18688
v_mfma_f32_16x16x32_bf16 v[184:187], a[76:79], a[24:27], v[184:187]
v_mfma_f32_16x16x32_bf16 v[188:191], a[76:79], a[28:31], v[188:191]
s_waitcnt lgkmcnt(6)
v_mfma_f32_16x16x32_bf16 v[192:195], a[80:83], a[16:19], v[192:195]
s_waitcnt vmcnt(12)
s_barrier
ds_read_b64_tr_b16 a[64:65], v19 offset:24576
v_mfma_f32_16x16x32_bf16 v[196:199], a[80:83], a[20:23], v[196:199]
ds_read_b64_tr_b16 a[66:67], v19 offset:30720
v_mfma_f32_16x16x32_bf16 v[200:203], a[80:83], a[24:27], v[200:203]
v_mfma_f32_16x16x32_bf16 v[204:207], a[80:83], a[28:31], v[204:207]
s_add_u32 m0, s43, 38912
s_waitcnt lgkmcnt(6)
v_mfma_f32_16x16x32_bf16 v[208:211], a[84:87], a[16:19], v[208:211]
ds_read_b64_tr_b16 a[68:69], v20 offset:24576
buffer_load_dwordx4 v14, s[52:55], s42 offen lds
s_add_u32 s42, s42, 229376
v_mfma_f32_16x16x32_bf16 v[212:215], a[84:87], a[20:23], v[212:215]
ds_read_b64_tr_b16 a[70:71], v20 offset:30720
v_mfma_f32_16x16x32_bf16 v[216:219], a[84:87], a[24:27], v[216:219]
v_mfma_f32_16x16x32_bf16 v[220:223], a[84:87], a[28:31], v[220:223]
s_waitcnt lgkmcnt(6)
v_mfma_f32_16x16x32_bf16 v[224:227], a[88:91], a[16:19], v[224:227]
ds_read_b64_tr_b16 a[72:73], v21 offset:24576
v_mfma_f32_16x16x32_bf16 v[228:231], a[88:91], a[20:23], v[228:231]
ds_read_b64_tr_b16 a[74:75], v21 offset:30720
v_mfma_f32_16x16x32_bf16 v[232:235], a[88:91], a[24:27], v[232:235]
buffer_load_dwordx4 a[12:15], v11, s[48:51], s41 offen sc1
s_add_u32 s41, s41, 1024
v_mfma_f32_16x16x32_bf16 v[236:239], a[88:91], a[28:31], v[236:239]
s_waitcnt lgkmcnt(6)
v_mfma_f32_16x16x32_bf16 v[240:243], a[92:95], a[16:19], v[240:243]
ds_read_b64_tr_b16 a[76:77], v22 offset:24576
v_mfma_f32_16x16x32_bf16 v[244:247], a[92:95], a[20:23], v[244:247]
ds_read_b64_tr_b16 a[78:79], v22 offset:30720
v_mfma_f32_16x16x32_bf16 v[248:251], a[92:95], a[24:27], v[248:251]
v_mfma_f32_16x16x32_bf16 v[252:255], a[92:95], a[28:31], v[252:255]
s_waitcnt lgkmcnt(6)
v_mfma_f32_16x16x32_bf16 v[64:67], a[64:67], a[32:35], v[64:67]
ds_read_b64_tr_b16 a[80:81], v19 offset:24704
v_mfma_f32_16x16x32_bf16 v[68:71], a[64:67], a[36:39], v[68:71]
ds_read_b64_tr_b16 a[82:83], v19 offset:30848
buffer_load_dwordx4 a[16:19], v8, s[48:51], s41 offen sc1
v_mfma_f32_16x16x32_bf16 v[72:75], a[64:67], a[40:43], v[72:75]
v_mfma_f32_16x16x32_bf16 v[76:79], a[64:67], a[44:47], v[76:79]
s_waitcnt lgkmcnt(6)
v_mfma_f32_16x16x32_bf16 v[80:83], a[68:71], a[32:35], v[80:83]
ds_read_b64_tr_b16 a[84:85], v20 offset:24704
v_mfma_f32_16x16x32_bf16 v[84:87], a[68:71], a[36:39], v[84:87]
ds_read_b64_tr_b16 a[86:87], v20 offset:30848
v_mfma_f32_16x16x32_bf16 v[88:91], a[68:71], a[40:43], v[88:91]
v_mfma_f32_16x16x32_bf16 v[92:95], a[68:71], a[44:47], v[92:95]
s_add_u32 m0, s43, 49152
s_waitcnt lgkmcnt(6)
v_mfma_f32_16x16x32_bf16 v[96:99], a[72:75], a[32:35], v[96:99]
ds_read_b64_tr_b16 a[88:89], v21 offset:24704
buffer_load_dwordx4 v12, s[52:55], s42 offen lds
v_mfma_f32_16x16x32_bf16 v[100:103], a[72:75], a[36:39], v[100:103]
ds_read_b64_tr_b16 a[90:91], v21 offset:30848
v_mfma_f32_16x16x32_bf16 v[104:107], a[72:75], a[40:43], v[104:107]
v_mfma_f32_16x16x32_bf16 v[108:111], a[72:75], a[44:47], v[108:111]
s_waitcnt lgkmcnt(6)
v_mfma_f32_16x16x32_bf16 v[112:115], a[76:79], a[32:35], v[112:115]
ds_read_b64_tr_b16 a[92:93], v22 offset:24704
v_mfma_f32_16x16x32_bf16 v[116:119], a[76:79], a[36:39], v[116:119]
ds_read_b64_tr_b16 a[94:95], v22 offset:30848
v_mfma_f32_16x16x32_bf16 v[120:123], a[76:79], a[40:43], v[120:123]
buffer_load_dwordx4 a[20:23], v9, s[48:51], s41 offen sc1
v_mfma_f32_16x16x32_bf16 v[124:127], a[76:79], a[44:47], v[124:127]
s_waitcnt lgkmcnt(6)
v_mfma_f32_16x16x32_bf16 v[128:131], a[80:83], a[32:35], v[128:131]
ds_read_b64_tr_b16 a[64:65], v19 offset:24832
v_mfma_f32_16x16x32_bf16 v[132:135], a[80:83], a[36:39], v[132:135]
ds_read_b64_tr_b16 a[66:67], v19 offset:30976
v_mfma_f32_16x16x32_bf16 v[136:139], a[80:83], a[40:43], v[136:139]
v_mfma_f32_16x16x32_bf16 v[140:143], a[80:83], a[44:47], v[140:143]
s_waitcnt lgkmcnt(6)
v_mfma_f32_16x16x32_bf16 v[144:147], a[84:87], a[32:35], v[144:147]
ds_read_b64_tr_b16 a[68:69], v20 offset:24832
v_mfma_f32_16x16x32_bf16 v[148:151], a[84:87], a[36:39], v[148:151]
ds_read_b64_tr_b16 a[70:71], v20 offset:30976
s_add_u32 m0, s43, 50176
v_mfma_f32_16x16x32_bf16 v[152:155], a[84:87], a[40:43], v[152:155]
buffer_load_dwordx4 v13, s[52:55], s42 offen lds
v_mfma_f32_16x16x32_bf16 v[156:159], a[84:87], a[44:47], v[156:159]
s_waitcnt lgkmcnt(6)
v_mfma_f32_16x16x32_bf16 v[160:163], a[88:91], a[32:35], v[160:163]
ds_read_b64_tr_b16 a[72:73], v21 offset:24832
v_mfma_f32_16x16x32_bf16 v[164:167], a[88:91], a[36:39], v[164:167]
ds_read_b64_tr_b16 a[74:75], v21 offset:30976
v_mfma_f32_16x16x32_bf16 v[168:171], a[88:91], a[40:43], v[168:171]
v_mfma_f32_16x16x32_bf16 v[172:175], a[88:91], a[44:47], v[172:175]
s_waitcnt lgkmcnt(6)
v_mfma_f32_16x16x32_bf16 v[176:179], a[92:95], a[32:35], v[176:179]
ds_read_b64_tr_b16 a[76:77], v22 offset:24832
buffer_load_dwordx4 a[24:27], v10, s[48:51], s41 offen sc1
v_mfma_f32_16x16x32_bf16 v[180:183], a[92:95], a[36:39], v[180:183]
ds_read_b64_tr_b16 a[78:79], v22 offset:30976
v_mfma_f32_16x16x32_bf16 v[184:187], a[92:95], a[40:43], v[184:187]
v_mfma_f32_16x16x32_bf16 v[188:191], a[92:95], a[44:47], v[188:191]
s_waitcnt lgkmcnt(6)
v_mfma_f32_16x16x32_bf16 v[192:195], a[64:67], a[32:35], v[192:195]
s_waitcnt vmcnt(12)
s_barrier
ds_read_b64_tr_b16 a[80:81], v19 offset:36864
v_mfma_f32_16x16x32_bf16 v[196:199], a[64:67], a[36:39], v[196:199]
ds_read_b64_tr_b16 a[82:83], v19 offset:43008
v_mfma_f32_16x16x32_bf16 v[200:203], a[64:67], a[40:43], v[200:203]
v_mfma_f32_16x16x32_bf16 v[204:207], a[64:67], a[44:47], v[204:207]
s_add_u32 m0, s43, 51200
s_waitcnt lgkmcnt(6)
v_mfma_f32_16x16x32_bf16 v[208:211], a[68:71], a[32:35], v[208:211]
ds_read_b64_tr_b16 a[84:85], v20 offset:36864
buffer_load_dwordx4 v14, s[52:55], s42 offen lds
s_add_u32 s42, s42, 229376
v_mfma_f32_16x16x32_bf16 v[212:215], a[68:71], a[36:39], v[212:215]
ds_read_b64_tr_b16 a[86:87], v20 offset:43008
v_mfma_f32_16x16x32_bf16 v[216:219], a[68:71], a[40:43], v[216:219]
v_mfma_f32_16x16x32_bf16 v[220:223], a[68:71], a[44:47], v[220:223]
s_waitcnt lgkmcnt(6)
v_mfma_f32_16x16x32_bf16 v[224:227], a[72:75], a[32:35], v[224:227]
ds_read_b64_tr_b16 a[88:89], v21 offset:36864
v_mfma_f32_16x16x32_bf16 v[228:231], a[72:75], a[36:39], v[228:231]
ds_read_b64_tr_b16 a[90:91], v21 offset:43008
v_mfma_f32_16x16x32_bf16 v[232:235], a[72:75], a[40:43], v[232:235]
buffer_load_dwordx4 a[28:31], v11, s[48:51], s41 offen sc1
s_add_u32 s41, s41, 1024
v_mfma_f32_16x16x32_bf16 v[236:239], a[72:75], a[44:47], v[236:239]
s_waitcnt lgkmcnt(6)
v_mfma_f32_16x16x32_bf16 v[240:243], a[76:79], a[32:35], v[240:243]
ds_read_b64_tr_b16 a[92:93], v22 offset:36864
v_mfma_f32_16x16x32_bf16 v[244:247], a[76:79], a[36:39], v[244:247]
ds_read_b64_tr_b16 a[94:95], v22 offset:43008
v_mfma_f32_16x16x32_bf16 v[248:251], a[76:79], a[40:43], v[248:251]
v_mfma_f32_16x16x32_bf16 v[252:255], a[76:79], a[44:47], v[252:255]
s_waitcnt lgkmcnt(6)
v_mfma_f32_16x16x32_bf16 v[64:67], a[80:83], a[48:51], v[64:67]
ds_read_b64_tr_b16 a[64:65], v19 offset:36992
v_mfma_f32_16x16x32_bf16 v[68:71], a[80:83], a[52:55], v[68:71]
ds_read_b64_tr_b16 a[66:67], v19 offset:43136
buffer_load_dwordx4 a[32:35], v8, s[48:51], s41 offen sc1
v_mfma_f32_16x16x32_bf16 v[72:75], a[80:83], a[56:59], v[72:75]
v_mfma_f32_16x16x32_bf16 v[76:79], a[80:83], a[60:63], v[76:79]
s_waitcnt lgkmcnt(6)
v_mfma_f32_16x16x32_bf16 v[80:83], a[84:87], a[48:51], v[80:83]
ds_read_b64_tr_b16 a[68:69], v20 offset:36992
v_mfma_f32_16x16x32_bf16 v[84:87], a[84:87], a[52:55], v[84:87]
ds_read_b64_tr_b16 a[70:71], v20 offset:43136
v_mfma_f32_16x16x32_bf16 v[88:91], a[84:87], a[56:59], v[88:91]
v_mfma_f32_16x16x32_bf16 v[92:95], a[84:87], a[60:63], v[92:95]
s_add_u32 m0, s43, 61440
s_waitcnt lgkmcnt(6)
v_mfma_f32_16x16x32_bf16 v[96:99], a[88:91], a[48:51], v[96:99]
ds_read_b64_tr_b16 a[72:73], v21 offset:36992
buffer_load_dwordx4 v12, s[52:55], s42 offen lds
v_mfma_f32_16x16x32_bf16 v[100:103], a[88:91], a[52:55], v[100:103]
ds_read_b64_tr_b16 a[74:75], v21 offset:43136
v_mfma_f32_16x16x32_bf16 v[104:107], a[88:91], a[56:59], v[104:107]
v_mfma_f32_16x16x32_bf16 v[108:111], a[88:91], a[60:63], v[108:111]
s_waitcnt lgkmcnt(6)
v_mfma_f32_16x16x32_bf16 v[112:115], a[92:95], a[48:51], v[112:115]
ds_read_b64_tr_b16 a[76:77], v22 offset:36992
v_mfma_f32_16x16x32_bf16 v[116:119], a[92:95], a[52:55], v[116:119]
ds_read_b64_tr_b16 a[78:79], v22 offset:43136
v_mfma_f32_16x16x32_bf16 v[120:123], a[92:95], a[56:59], v[120:123]
buffer_load_dwordx4 a[36:39], v9, s[48:51], s41 offen sc1
v_mfma_f32_16x16x32_bf16 v[124:127], a[92:95], a[60:63], v[124:127]
s_waitcnt lgkmcnt(6)
v_mfma_f32_16x16x32_bf16 v[128:131], a[64:67], a[48:51], v[128:131]
ds_read_b64_tr_b16 a[80:81], v19 offset:37120
v_mfma_f32_16x16x32_bf16 v[132:135], a[64:67], a[52:55], v[132:135]
ds_read_b64_tr_b16 a[82:83], v19 offset:43264
v_mfma_f32_16x16x32_bf16 v[136:139], a[64:67], a[56:59], v[136:139]
v_mfma_f32_16x16x32_bf16 v[140:143], a[64:67], a[60:63], v[140:143]
s_waitcnt lgkmcnt(6)
v_mfma_f32_16x16x32_bf16 v[144:147], a[68:71], a[48:51], v[144:147]
ds_read_b64_tr_b16 a[84:85], v20 offset:37120
v_mfma_f32_16x16x32_bf16 v[148:151], a[68:71], a[52:55], v[148:151]
ds_read_b64_tr_b16 a[86:87], v20 offset:43264
s_add_u32 m0, s43, 62464
v_mfma_f32_16x16x32_bf16 v[152:155], a[68:71], a[56:59], v[152:155]
buffer_load_dwordx4 v13, s[52:55], s42 offen lds
v_mfma_f32_16x16x32_bf16 v[156:159], a[68:71], a[60:63], v[156:159]
s_waitcnt lgkmcnt(6)
v_mfma_f32_16x16x32_bf16 v[160:163], a[72:75], a[48:51], v[160:163]
ds_read_b64_tr_b16 a[88:89], v21 offset:37120
v_mfma_f32_16x16x32_bf16 v[164:167], a[72:75], a[52:55], v[164:167]
ds_read_b64_tr_b16 a[90:91], v21 offset:43264
v_mfma_f32_16x16x32_bf16 v[168:171], a[72:75], a[56:59], v[168:171]
v_mfma_f32_16x16x32_bf16 v[172:175], a[72:75], a[60:63], v[172:175]
s_waitcnt lgkmcnt(6)
v_mfma_f32_16x16x32_bf16 v[176:179], a[76:79], a[48:51], v[176:179]
ds_read_b64_tr_b16 a[92:93], v22 offset:37120
buffer_load_dwordx4 a[40:43], v10, s[48:51], s41 offen sc1
v_mfma_f32_16x16x32_bf16 v[180:183], a[76:79], a[52:55], v[180:183]
ds_read_b64_tr_b16 a[94:95], v22 offset:43264
v_mfma_f32_16x16x32_bf16 v[184:187], a[76:79], a[56:59], v[184:187]
v_mfma_f32_16x16x32_bf16 v[188:191], a[76:79], a[60:63], v[188:191]
s_waitcnt lgkmcnt(6)
v_mfma_f32_16x16x32_bf16 v[192:195], a[80:83], a[48:51], v[192:195]
s_waitcnt vmcnt(12)
s_barrier
ds_read_b64_tr_b16 a[64:65], v15 offset:0
v_mfma_f32_16x16x32_bf16 v[196:199], a[80:83], a[52:55], v[196:199]
ds_read_b64_tr_b16 a[66:67], v15 offset:6144
v_mfma_f32_16x16x32_bf16 v[200:203], a[80:83], a[56:59], v[200:203]
v_mfma_f32_16x16x32_bf16 v[204:207], a[80:83], a[60:63], v[204:207]
s_add_u32 m0, s43, 63488
s_waitcnt lgkmcnt(6)
v_mfma_f32_16x16x32_bf16 v[208:211], a[84:87], a[48:51], v[208:211]
ds_read_b64_tr_b16 a[68:69], v16 offset:0
buffer_load_dwordx4 v14, s[52:55], s42 offen lds
s_add_u32 s42, s42, 229376
v_mfma_f32_16x16x32_bf16 v[212:215], a[84:87], a[52:55], v[212:215]
ds_read_b64_tr_b16 a[70:71], v16 offset:6144
v_mfma_f32_16x16x32_bf16 v[216:219], a[84:87], a[56:59], v[216:219]
v_mfma_f32_16x16x32_bf16 v[220:223], a[84:87], a[60:63], v[220:223]
s_waitcnt lgkmcnt(6)
v_mfma_f32_16x16x32_bf16 v[224:227], a[88:91], a[48:51], v[224:227]
ds_read_b64_tr_b16 a[72:73], v17 offset:0
v_mfma_f32_16x16x32_bf16 v[228:231], a[88:91], a[52:55], v[228:231]
ds_read_b64_tr_b16 a[74:75], v17 offset:6144
v_mfma_f32_16x16x32_bf16 v[232:235], a[88:91], a[56:59], v[232:235]
buffer_load_dwordx4 a[44:47], v11, s[48:51], s41 offen sc1
s_add_u32 s41, s41, 1024
v_mfma_f32_16x16x32_bf16 v[236:239], a[88:91], a[60:63], v[236:239]
s_waitcnt lgkmcnt(6)
v_mfma_f32_16x16x32_bf16 v[240:243], a[92:95], a[48:51], v[240:243]
ds_read_b64_tr_b16 a[76:77], v18 offset:0
v_mfma_f32_16x16x32_bf16 v[244:247], a[92:95], a[52:55], v[244:247]
ds_read_b64_tr_b16 a[78:79], v18 offset:6144
v_mfma_f32_16x16x32_bf16 v[248:251], a[92:95], a[56:59], v[248:251]
v_mfma_f32_16x16x32_bf16 v[252:255], a[92:95], a[60:63], v[252:255]
s_sub_u32 s44, s44, 1
s_cmp_lg_u32 s44, 0
s_cbranch_scc1 L_gemm1_kernel_w12_loop0
s_add_u32 s56, s6, 0x1400000
s_addc_u32 s57, s7, 0
s_and_b32 s57, s57, 0xffff
s_mov_b32 s58, 0xe00000
s_mov_b32 s59, 0x20000
v_and_b32 v2, 63, v0
v_lshlrev_b32 v5, 4, v2
s_mul_i32 s17, s16, 114688
s_lshl_b32 s27, s26, 5
s_add_u32 s17, s17, s27
v_add_u32 v5, s17, v5
s_mov_b32 s30, 0xbdd2d3e8
s_mov_b32 s31, 0xbdd2d3e8
v_mov_b32 v6, 0xc0135761
v_mov_b32 v7, 0xc0135761
s_waitcnt vmcnt(0)
v_lshlrev_b32 v8, 16, v32
v_and_b32 v9, 0xffff0000, v32
v_lshlrev_b32 v10, 16, v33
v_and_b32 v11, 0xffff0000, v33
v_lshlrev_b32 v12, 16, v34
v_and_b32 v13, 0xffff0000, v34
v_lshlrev_b32 v14, 16, v35
v_and_b32 v15, 0xffff0000, v35
v_pk_fma_f32 v[64:65], v[64:65], v[56:57], v[8:9] op_sel_hi:[1,0,1]
v_pk_fma_f32 v[66:67], v[66:67], v[56:57], v[10:11] op_sel_hi:[1,0,1]
v_pk_fma_f32 v[80:81], v[80:81], v[56:57], v[12:13] op_sel_hi:[1,0,1]
v_pk_fma_f32 v[82:83], v[82:83], v[56:57], v[14:15] op_sel_hi:[1,0,1]
v_pk_mul_f32 v[16:17], v[64:65], v[64:65]
v_pk_mul_f32 v[18:19], v[66:67], v[66:67]
v_pk_mul_f32 v[20:21], v[80:81], v[80:81]
v_pk_mul_f32 v[22:23], v[82:83], v[82:83]
v_pk_fma_f32 v[16:17], v[16:17], s[30:31], v[6:7]
v_pk_fma_f32 v[18:19], v[18:19], s[30:31], v[6:7]
v_pk_fma_f32 v[20:21], v[20:21], s[30:31], v[6:7]
v_pk_fma_f32 v[22:23], v[22:23], s[30:31], v[6:7]
v_pk_mul_f32 v[16:17], v[16:17], v[64:65]
v_pk_mul_f32 v[18:19], v[18:19], v[66:67]
v_pk_mul_f32 v[20:21], v[20:21], v[80:81]
v_pk_mul_f32 v[22:23], v[22:23], v[82:83]
v_exp_f32 v16, v16
v_exp_f32 v17, v17
v_exp_f32 v18, v18
v_exp_f32 v19, v19
v_exp_f32 v20, v20
v_exp_f32 v21, v21
v_exp_f32 v22, v22
v_exp_f32 v23, v23
v_pk_add_f32 v[16:17], v[16:17], 1.0 op_sel_hi:[1,0]
v_pk_add_f32 v[18:19], v[18:19], 1.0 op_sel_hi:[1,0]
v_pk_add_f32 v[20:21], v[20:21], 1.0 op_sel_hi:[1,0]
v_pk_add_f32 v[22:23], v[22:23], 1.0 op_sel_hi:[1,0]
v_rcp_f32 v16, v16
v_rcp_f32 v17, v17
v_rcp_f32 v18, v18
v_rcp_f32 v19, v19
v_rcp_f32 v20, v20
v_rcp_f32 v21, v21
v_rcp_f32 v22, v22
v_rcp_f32 v23, v23
v_pk_mul_f32 v[64:65], v[64:65], v[16:17]
v_pk_mul_f32 v[66:67], v[66:67], v[18:19]
v_pk_mul_f32 v[80:81], v[80:81], v[20:21]
v_pk_mul_f32 v[82:83], v[82:83], v[22:23]
v_cvt_pk_bf16_f32 v24, v64, v65
v_cvt_pk_bf16_f32 v25, v66, v67
v_cvt_pk_bf16_f32 v26, v80, v81
v_cvt_pk_bf16_f32 v27, v82, v83
s_mov_b32 s27, 0
buffer_store_dwordx4 v[24:27], v5, s[56:59], s27 offen
v_pk_fma_f32 v[68:69], v[68:69], v[56:57], v[8:9] op_sel:[0,1,0] op_sel_hi:[1,1,1]
v_pk_fma_f32 v[70:71], v[70:71], v[56:57], v[10:11] op_sel:[0,1,0] op_sel_hi:[1,1,1]
v_pk_fma_f32 v[84:85], v[84:85], v[56:57], v[12:13] op_sel:[0,1,0] op_sel_hi:[1,1,1]
v_pk_fma_f32 v[86:87], v[86:87], v[56:57], v[14:15] op_sel:[0,1,0] op_sel_hi:[1,1,1]
v_pk_mul_f32 v[16:17], v[68:69], v[68:69]
v_pk_mul_f32 v[18:19], v[70:71], v[70:71]
v_pk_mul_f32 v[20:21], v[84:85], v[84:85]
v_pk_mul_f32 v[22:23], v[86:87], v[86:87]
v_pk_fma_f32 v[16:17], v[16:17], s[30:31], v[6:7]
v_pk_fma_f32 v[18:19], v[18:19], s[30:31], v[6:7]
v_pk_fma_f32 v[20:21], v[20:21], s[30:31], v[6:7]
v_pk_fma_f32 v[22:23], v[22:23], s[30:31], v[6:7]
v_pk_mul_f32 v[16:17], v[16:17], v[68:69]
v_pk_mul_f32 v[18:19], v[18:19], v[70:71]
v_pk_mul_f32 v[20:21], v[20:21], v[84:85]
v_pk_mul_f32 v[22:23], v[22:23], v[86:87]
v_exp_f32 v16, v16
v_exp_f32 v17, v17
v_exp_f32 v18, v18
v_exp_f32 v19, v19
v_exp_f32 v20, v20
v_exp_f32 v21, v21
v_exp_f32 v22, v22
v_exp_f32 v23, v23
v_pk_add_f32 v[16:17], v[16:17], 1.0 op_sel_hi:[1,0]
v_pk_add_f32 v[18:19], v[18:19], 1.0 op_sel_hi:[1,0]
v_pk_add_f32 v[20:21], v[20:21], 1.0 op_sel_hi:[1,0]
v_pk_add_f32 v[22:23], v[22:23], 1.0 op_sel_hi:[1,0]
v_rcp_f32 v16, v16
v_rcp_f32 v17, v17
v_rcp_f32 v18, v18
v_rcp_f32 v19, v19
v_rcp_f32 v20, v20
v_rcp_f32 v21, v21
v_rcp_f32 v22, v22
v_rcp_f32 v23, v23
v_pk_mul_f32 v[68:69], v[68:69], v[16:17]
v_pk_mul_f32 v[70:71], v[70:71], v[18:19]
v_pk_mul_f32 v[84:85], v[84:85], v[20:21]
v_pk_mul_f32 v[86:87], v[86:87], v[22:23]
v_cvt_pk_bf16_f32 v28, v68, v69
v_cvt_pk_bf16_f32 v29, v70, v71
v_cvt_pk_bf16_f32 v30, v84, v85
v_cvt_pk_bf16_f32 v31, v86, v87
s_mov_b32 s27, 114688
buffer_store_dwordx4 v[28:31], v5, s[56:59], s27 offen
v_pk_fma_f32 v[72:73], v[72:73], v[58:59], v[8:9] op_sel_hi:[1,0,1]
v_pk_fma_f32 v[74:75], v[74:75], v[58:59], v[10:11] op_sel_hi:[1,0,1]
v_pk_fma_f32 v[88:89], v[88:89], v[58:59], v[12:13] op_sel_hi:[1,0,1]
v_pk_fma_f32 v[90:91], v[90:91], v[58:59], v[14:15] op_sel_hi:[1,0,1]
v_pk_mul_f32 v[16:17], v[72:73], v[72:73]
v_pk_mul_f32 v[18:19], v[74:75], v[74:75]
v_pk_mul_f32 v[20:21], v[88:89], v[88:89]
v_pk_mul_f32 v[22:23], v[90:91], v[90:91]
v_pk_fma_f32 v[16:17], v[16:17], s[30:31], v[6:7]
v_pk_fma_f32 v[18:19], v[18:19], s[30:31], v[6:7]
v_pk_fma_f32 v[20:21], v[20:21], s[30:31], v[6:7]
v_pk_fma_f32 v[22:23], v[22:23], s[30:31], v[6:7]
v_pk_mul_f32 v[16:17], v[16:17], v[72:73]
v_pk_mul_f32 v[18:19], v[18:19], v[74:75]
v_pk_mul_f32 v[20:21], v[20:21], v[88:89]
v_pk_mul_f32 v[22:23], v[22:23], v[90:91]
v_exp_f32 v16, v16
v_exp_f32 v17, v17
v_exp_f32 v18, v18
v_exp_f32 v19, v19
v_exp_f32 v20, v20
v_exp_f32 v21, v21
v_exp_f32 v22, v22
v_exp_f32 v23, v23
v_pk_add_f32 v[16:17], v[16:17], 1.0 op_sel_hi:[1,0]
v_pk_add_f32 v[18:19], v[18:19], 1.0 op_sel_hi:[1,0]
v_pk_add_f32 v[20:21], v[20:21], 1.0 op_sel_hi:[1,0]
v_pk_add_f32 v[22:23], v[22:23], 1.0 op_sel_hi:[1,0]
v_rcp_f32 v16, v16
v_rcp_f32 v17, v17
v_rcp_f32 v18, v18
v_rcp_f32 v19, v19
v_rcp_f32 v20, v20
v_rcp_f32 v21, v21
v_rcp_f32 v22, v22
v_rcp_f32 v23, v23
v_pk_mul_f32 v[72:73], v[72:73], v[16:17]
v_pk_mul_f32 v[74:75], v[74:75], v[18:19]
v_pk_mul_f32 v[88:89], v[88:89], v[20:21]
v_pk_mul_f32 v[90:91], v[90:91], v[22:23]
v_cvt_pk_bf16_f32 v24, v72, v73
v_cvt_pk_bf16_f32 v25, v74, v75
v_cvt_pk_bf16_f32 v26, v88, v89
v_cvt_pk_bf16_f32 v27, v90, v91
s_mov_b32 s27, 229376
buffer_store_dwordx4 v[24:27], v5, s[56:59], s27 offen
v_pk_fma_f32 v[76:77], v[76:77], v[58:59], v[8:9] op_sel:[0,1,0] op_sel_hi:[1,1,1]
v_pk_fma_f32 v[78:79], v[78:79], v[58:59], v[10:11] op_sel:[0,1,0] op_sel_hi:[1,1,1]
v_pk_fma_f32 v[92:93], v[92:93], v[58:59], v[12:13] op_sel:[0,1,0] op_sel_hi:[1,1,1]
v_pk_fma_f32 v[94:95], v[94:95], v[58:59], v[14:15] op_sel:[0,1,0] op_sel_hi:[1,1,1]
v_pk_mul_f32 v[16:17], v[76:77], v[76:77]
v_pk_mul_f32 v[18:19], v[78:79], v[78:79]
v_pk_mul_f32 v[20:21], v[92:93], v[92:93]
v_pk_mul_f32 v[22:23], v[94:95], v[94:95]
v_pk_fma_f32 v[16:17], v[16:17], s[30:31], v[6:7]
v_pk_fma_f32 v[18:19], v[18:19], s[30:31], v[6:7]
v_pk_fma_f32 v[20:21], v[20:21], s[30:31], v[6:7]
v_pk_fma_f32 v[22:23], v[22:23], s[30:31], v[6:7]
v_pk_mul_f32 v[16:17], v[16:17], v[76:77]
v_pk_mul_f32 v[18:19], v[18:19], v[78:79]
v_pk_mul_f32 v[20:21], v[20:21], v[92:93]
v_pk_mul_f32 v[22:23], v[22:23], v[94:95]
v_exp_f32 v16, v16
v_exp_f32 v17, v17
v_exp_f32 v18, v18
v_exp_f32 v19, v19
v_exp_f32 v20, v20
v_exp_f32 v21, v21
v_exp_f32 v22, v22
v_exp_f32 v23, v23
v_pk_add_f32 v[16:17], v[16:17], 1.0 op_sel_hi:[1,0]
v_pk_add_f32 v[18:19], v[18:19], 1.0 op_sel_hi:[1,0]
v_pk_add_f32 v[20:21], v[20:21], 1.0 op_sel_hi:[1,0]
v_pk_add_f32 v[22:23], v[22:23], 1.0 op_sel_hi:[1,0]
v_rcp_f32 v16, v16
v_rcp_f32 v17, v17
v_rcp_f32 v18, v18
v_rcp_f32 v19, v19
v_rcp_f32 v20, v20
v_rcp_f32 v21, v21
v_rcp_f32 v22, v22
v_rcp_f32 v23, v23
v_pk_mul_f32 v[76:77], v[76:77], v[16:17]
v_pk_mul_f32 v[78:79], v[78:79], v[18:19]
v_pk_mul_f32 v[92:93], v[92:93], v[20:21]
v_pk_mul_f32 v[94:95], v[94:95], v[22:23]
v_cvt_pk_bf16_f32 v28, v76, v77
v_cvt_pk_bf16_f32 v29, v78, v79
v_cvt_pk_bf16_f32 v30, v92, v93
v_cvt_pk_bf16_f32 v31, v94, v95
s_mov_b32 s27, 344064
buffer_store_dwordx4 v[28:31], v5, s[56:59], s27 offen
v_lshlrev_b32 v8, 16, v36
v_and_b32 v9, 0xffff0000, v36
v_lshlrev_b32 v10, 16, v37
v_and_b32 v11, 0xffff0000, v37
v_lshlrev_b32 v12, 16, v38
v_and_b32 v13, 0xffff0000, v38
v_lshlrev_b32 v14, 16, v39
v_and_b32 v15, 0xffff0000, v39
v_pk_fma_f32 v[96:97], v[96:97], v[56:57], v[8:9] op_sel_hi:[1,0,1]
v_pk_fma_f32 v[98:99], v[98:99], v[56:57], v[10:11] op_sel_hi:[1,0,1]
v_pk_fma_f32 v[112:113], v[112:113], v[56:57], v[12:13] op_sel_hi:[1,0,1]
v_pk_fma_f32 v[114:115], v[114:115], v[56:57], v[14:15] op_sel_hi:[1,0,1]
v_pk_mul_f32 v[16:17], v[96:97], v[96:97]
v_pk_mul_f32 v[18:19], v[98:99], v[98:99]
v_pk_mul_f32 v[20:21], v[112:113], v[112:113]
v_pk_mul_f32 v[22:23], v[114:115], v[114:115]
v_pk_fma_f32 v[16:17], v[16:17], s[30:31], v[6:7]
v_pk_fma_f32 v[18:19], v[18:19], s[30:31], v[6:7]
v_pk_fma_f32 v[20:21], v[20:21], s[30:31], v[6:7]
v_pk_fma_f32 v[22:23], v[22:23], s[30:31], v[6:7]
v_pk_mul_f32 v[16:17], v[16:17], v[96:97]
v_pk_mul_f32 v[18:19], v[18:19], v[98:99]
v_pk_mul_f32 v[20:21], v[20:21], v[112:113]
v_pk_mul_f32 v[22:23], v[22:23], v[114:115]
v_exp_f32 v16, v16
v_exp_f32 v17, v17
v_exp_f32 v18, v18
v_exp_f32 v19, v19
v_exp_f32 v20, v20
v_exp_f32 v21, v21
v_exp_f32 v22, v22
v_exp_f32 v23, v23
v_pk_add_f32 v[16:17], v[16:17], 1.0 op_sel_hi:[1,0]
v_pk_add_f32 v[18:19], v[18:19], 1.0 op_sel_hi:[1,0]
v_pk_add_f32 v[20:21], v[20:21], 1.0 op_sel_hi:[1,0]
v_pk_add_f32 v[22:23], v[22:23], 1.0 op_sel_hi:[1,0]
v_rcp_f32 v16, v16
v_rcp_f32 v17, v17
v_rcp_f32 v18, v18
v_rcp_f32 v19, v19
v_rcp_f32 v20, v20
v_rcp_f32 v21, v21
v_rcp_f32 v22, v22
v_rcp_f32 v23, v23
v_pk_mul_f32 v[96:97], v[96:97], v[16:17]
v_pk_mul_f32 v[98:99], v[98:99], v[18:19]
v_pk_mul_f32 v[112:113], v[112:113], v[20:21]
v_pk_mul_f32 v[114:115], v[114:115], v[22:23]
v_cvt_pk_bf16_f32 v24, v96, v97
v_cvt_pk_bf16_f32 v25, v98, v99
v_cvt_pk_bf16_f32 v26, v112, v113
v_cvt_pk_bf16_f32 v27, v114, v115
s_mov_b32 s27, 1024
buffer_store_dwordx4 v[24:27], v5, s[56:59], s27 offen
v_pk_fma_f32 v[100:101], v[100:101], v[56:57], v[8:9] op_sel:[0,1,0] op_sel_hi:[1,1,1]
v_pk_fma_f32 v[102:103], v[102:103], v[56:57], v[10:11] op_sel:[0,1,0] op_sel_hi:[1,1,1]
v_pk_fma_f32 v[116:117], v[116:117], v[56:57], v[12:13] op_sel:[0,1,0] op_sel_hi:[1,1,1]
v_pk_fma_f32 v[118:119], v[118:119], v[56:57], v[14:15] op_sel:[0,1,0] op_sel_hi:[1,1,1]
v_pk_mul_f32 v[16:17], v[100:101], v[100:101]
v_pk_mul_f32 v[18:19], v[102:103], v[102:103]
v_pk_mul_f32 v[20:21], v[116:117], v[116:117]
v_pk_mul_f32 v[22:23], v[118:119], v[118:119]
v_pk_fma_f32 v[16:17], v[16:17], s[30:31], v[6:7]
v_pk_fma_f32 v[18:19], v[18:19], s[30:31], v[6:7]
v_pk_fma_f32 v[20:21], v[20:21], s[30:31], v[6:7]
v_pk_fma_f32 v[22:23], v[22:23], s[30:31], v[6:7]
v_pk_mul_f32 v[16:17], v[16:17], v[100:101]
v_pk_mul_f32 v[18:19], v[18:19], v[102:103]
v_pk_mul_f32 v[20:21], v[20:21], v[116:117]
v_pk_mul_f32 v[22:23], v[22:23], v[118:119]
v_exp_f32 v16, v16
v_exp_f32 v17, v17
v_exp_f32 v18, v18
v_exp_f32 v19, v19
v_exp_f32 v20, v20
v_exp_f32 v21, v21
v_exp_f32 v22, v22
v_exp_f32 v23, v23
v_pk_add_f32 v[16:17], v[16:17], 1.0 op_sel_hi:[1,0]
v_pk_add_f32 v[18:19], v[18:19], 1.0 op_sel_hi:[1,0]
v_pk_add_f32 v[20:21], v[20:21], 1.0 op_sel_hi:[1,0]
v_pk_add_f32 v[22:23], v[22:23], 1.0 op_sel_hi:[1,0]
v_rcp_f32 v16, v16
v_rcp_f32 v17, v17
v_rcp_f32 v18, v18
v_rcp_f32 v19, v19
v_rcp_f32 v20, v20
v_rcp_f32 v21, v21
v_rcp_f32 v22, v22
v_rcp_f32 v23, v23
v_pk_mul_f32 v[100:101], v[100:101], v[16:17]
v_pk_mul_f32 v[102:103], v[102:103], v[18:19]
v_pk_mul_f32 v[116:117], v[116:117], v[20:21]
v_pk_mul_f32 v[118:119], v[118:119], v[22:23]
v_cvt_pk_bf16_f32 v28, v100, v101
v_cvt_pk_bf16_f32 v29, v102, v103
v_cvt_pk_bf16_f32 v30, v116, v117
v_cvt_pk_bf16_f32 v31, v118, v119
s_mov_b32 s27, 115712
buffer_store_dwordx4 v[28:31], v5, s[56:59], s27 offen
v_pk_fma_f32 v[104:105], v[104:105], v[58:59], v[8:9] op_sel_hi:[1,0,1]
v_pk_fma_f32 v[106:107], v[106:107], v[58:59], v[10:11] op_sel_hi:[1,0,1]
v_pk_fma_f32 v[120:121], v[120:121], v[58:59], v[12:13] op_sel_hi:[1,0,1]
v_pk_fma_f32 v[122:123], v[122:123], v[58:59], v[14:15] op_sel_hi:[1,0,1]
v_pk_mul_f32 v[16:17], v[104:105], v[104:105]
v_pk_mul_f32 v[18:19], v[106:107], v[106:107]
v_pk_mul_f32 v[20:21], v[120:121], v[120:121]
v_pk_mul_f32 v[22:23], v[122:123], v[122:123]
v_pk_fma_f32 v[16:17], v[16:17], s[30:31], v[6:7]
v_pk_fma_f32 v[18:19], v[18:19], s[30:31], v[6:7]
v_pk_fma_f32 v[20:21], v[20:21], s[30:31], v[6:7]
v_pk_fma_f32 v[22:23], v[22:23], s[30:31], v[6:7]
v_pk_mul_f32 v[16:17], v[16:17], v[104:105]
v_pk_mul_f32 v[18:19], v[18:19], v[106:107]
v_pk_mul_f32 v[20:21], v[20:21], v[120:121]
v_pk_mul_f32 v[22:23], v[22:23], v[122:123]
v_exp_f32 v16, v16
v_exp_f32 v17, v17
v_exp_f32 v18, v18
v_exp_f32 v19, v19
v_exp_f32 v20, v20
v_exp_f32 v21, v21
v_exp_f32 v22, v22
v_exp_f32 v23, v23
v_pk_add_f32 v[16:17], v[16:17], 1.0 op_sel_hi:[1,0]
v_pk_add_f32 v[18:19], v[18:19], 1.0 op_sel_hi:[1,0]
v_pk_add_f32 v[20:21], v[20:21], 1.0 op_sel_hi:[1,0]
v_pk_add_f32 v[22:23], v[22:23], 1.0 op_sel_hi:[1,0]
v_rcp_f32 v16, v16
v_rcp_f32 v17, v17
v_rcp_f32 v18, v18
v_rcp_f32 v19, v19
v_rcp_f32 v20, v20
v_rcp_f32 v21, v21
v_rcp_f32 v22, v22
v_rcp_f32 v23, v23
v_pk_mul_f32 v[104:105], v[104:105], v[16:17]
v_pk_mul_f32 v[106:107], v[106:107], v[18:19]
v_pk_mul_f32 v[120:121], v[120:121], v[20:21]
v_pk_mul_f32 v[122:123], v[122:123], v[22:23]
v_cvt_pk_bf16_f32 v24, v104, v105
v_cvt_pk_bf16_f32 v25, v106, v107
v_cvt_pk_bf16_f32 v26, v120, v121
v_cvt_pk_bf16_f32 v27, v122, v123
s_mov_b32 s27, 230400
buffer_store_dwordx4 v[24:27], v5, s[56:59], s27 offen
v_pk_fma_f32 v[108:109], v[108:109], v[58:59], v[8:9] op_sel:[0,1,0] op_sel_hi:[1,1,1]
v_pk_fma_f32 v[110:111], v[110:111], v[58:59], v[10:11] op_sel:[0,1,0] op_sel_hi:[1,1,1]
v_pk_fma_f32 v[124:125], v[124:125], v[58:59], v[12:13] op_sel:[0,1,0] op_sel_hi:[1,1,1]
v_pk_fma_f32 v[126:127], v[126:127], v[58:59], v[14:15] op_sel:[0,1,0] op_sel_hi:[1,1,1]
v_pk_mul_f32 v[16:17], v[108:109], v[108:109]
v_pk_mul_f32 v[18:19], v[110:111], v[110:111]
v_pk_mul_f32 v[20:21], v[124:125], v[124:125]
v_pk_mul_f32 v[22:23], v[126:127], v[126:127]
v_pk_fma_f32 v[16:17], v[16:17], s[30:31], v[6:7]
v_pk_fma_f32 v[18:19], v[18:19], s[30:31], v[6:7]
v_pk_fma_f32 v[20:21], v[20:21], s[30:31], v[6:7]
v_pk_fma_f32 v[22:23], v[22:23], s[30:31], v[6:7]
v_pk_mul_f32 v[16:17], v[16:17], v[108:109]
v_pk_mul_f32 v[18:19], v[18:19], v[110:111]
v_pk_mul_f32 v[20:21], v[20:21], v[124:125]
v_pk_mul_f32 v[22:23], v[22:23], v[126:127]
v_exp_f32 v16, v16
v_exp_f32 v17, v17
v_exp_f32 v18, v18
v_exp_f32 v19, v19
v_exp_f32 v20, v20
v_exp_f32 v21, v21
v_exp_f32 v22, v22
v_exp_f32 v23, v23
v_pk_add_f32 v[16:17], v[16:17], 1.0 op_sel_hi:[1,0]
v_pk_add_f32 v[18:19], v[18:19], 1.0 op_sel_hi:[1,0]
v_pk_add_f32 v[20:21], v[20:21], 1.0 op_sel_hi:[1,0]
v_pk_add_f32 v[22:23], v[22:23], 1.0 op_sel_hi:[1,0]
v_rcp_f32 v16, v16
v_rcp_f32 v17, v17
v_rcp_f32 v18, v18
v_rcp_f32 v19, v19
v_rcp_f32 v20, v20
v_rcp_f32 v21, v21
v_rcp_f32 v22, v22
v_rcp_f32 v23, v23
v_pk_mul_f32 v[108:109], v[108:109], v[16:17]
v_pk_mul_f32 v[110:111], v[110:111], v[18:19]
v_pk_mul_f32 v[124:125], v[124:125], v[20:21]
v_pk_mul_f32 v[126:127], v[126:127], v[22:23]
v_cvt_pk_bf16_f32 v28, v108, v109
v_cvt_pk_bf16_f32 v29, v110, v111
v_cvt_pk_bf16_f32 v30, v124, v125
v_cvt_pk_bf16_f32 v31, v126, v127
s_mov_b32 s27, 345088
buffer_store_dwordx4 v[28:31], v5, s[56:59], s27 offen
v_lshlrev_b32 v8, 16, v40
v_and_b32 v9, 0xffff0000, v40
v_lshlrev_b32 v10, 16, v41
v_and_b32 v11, 0xffff0000, v41
v_lshlrev_b32 v12, 16, v42
v_and_b32 v13, 0xffff0000, v42
v_lshlrev_b32 v14, 16, v43
v_and_b32 v15, 0xffff0000, v43
v_pk_fma_f32 v[128:129], v[128:129], v[56:57], v[8:9] op_sel_hi:[1,0,1]
v_pk_fma_f32 v[130:131], v[130:131], v[56:57], v[10:11] op_sel_hi:[1,0,1]
v_pk_fma_f32 v[144:145], v[144:145], v[56:57], v[12:13] op_sel_hi:[1,0,1]
v_pk_fma_f32 v[146:147], v[146:147], v[56:57], v[14:15] op_sel_hi:[1,0,1]
v_pk_mul_f32 v[16:17], v[128:129], v[128:129]
v_pk_mul_f32 v[18:19], v[130:131], v[130:131]
v_pk_mul_f32 v[20:21], v[144:145], v[144:145]
v_pk_mul_f32 v[22:23], v[146:147], v[146:147]
v_pk_fma_f32 v[16:17], v[16:17], s[30:31], v[6:7]
v_pk_fma_f32 v[18:19], v[18:19], s[30:31], v[6:7]
v_pk_fma_f32 v[20:21], v[20:21], s[30:31], v[6:7]
v_pk_fma_f32 v[22:23], v[22:23], s[30:31], v[6:7]
v_pk_mul_f32 v[16:17], v[16:17], v[128:129]
v_pk_mul_f32 v[18:19], v[18:19], v[130:131]
v_pk_mul_f32 v[20:21], v[20:21], v[144:145]
v_pk_mul_f32 v[22:23], v[22:23], v[146:147]
v_exp_f32 v16, v16
v_exp_f32 v17, v17
v_exp_f32 v18, v18
v_exp_f32 v19, v19
v_exp_f32 v20, v20
v_exp_f32 v21, v21
v_exp_f32 v22, v22
v_exp_f32 v23, v23
v_pk_add_f32 v[16:17], v[16:17], 1.0 op_sel_hi:[1,0]
v_pk_add_f32 v[18:19], v[18:19], 1.0 op_sel_hi:[1,0]
v_pk_add_f32 v[20:21], v[20:21], 1.0 op_sel_hi:[1,0]
v_pk_add_f32 v[22:23], v[22:23], 1.0 op_sel_hi:[1,0]
v_rcp_f32 v16, v16
v_rcp_f32 v17, v17
v_rcp_f32 v18, v18
v_rcp_f32 v19, v19
v_rcp_f32 v20, v20
v_rcp_f32 v21, v21
v_rcp_f32 v22, v22
v_rcp_f32 v23, v23
v_pk_mul_f32 v[128:129], v[128:129], v[16:17]
v_pk_mul_f32 v[130:131], v[130:131], v[18:19]
v_pk_mul_f32 v[144:145], v[144:145], v[20:21]
v_pk_mul_f32 v[146:147], v[146:147], v[22:23]
v_cvt_pk_bf16_f32 v24, v128, v129
v_cvt_pk_bf16_f32 v25, v130, v131
v_cvt_pk_bf16_f32 v26, v144, v145
v_cvt_pk_bf16_f32 v27, v146, v147
s_mov_b32 s27, 2048
buffer_store_dwordx4 v[24:27], v5, s[56:59], s27 offen
v_pk_fma_f32 v[132:133], v[132:133], v[56:57], v[8:9] op_sel:[0,1,0] op_sel_hi:[1,1,1]
v_pk_fma_f32 v[134:135], v[134:135], v[56:57], v[10:11] op_sel:[0,1,0] op_sel_hi:[1,1,1]
v_pk_fma_f32 v[148:149], v[148:149], v[56:57], v[12:13] op_sel:[0,1,0] op_sel_hi:[1,1,1]
v_pk_fma_f32 v[150:151], v[150:151], v[56:57], v[14:15] op_sel:[0,1,0] op_sel_hi:[1,1,1]
v_pk_mul_f32 v[16:17], v[132:133], v[132:133]
v_pk_mul_f32 v[18:19], v[134:135], v[134:135]
v_pk_mul_f32 v[20:21], v[148:149], v[148:149]
v_pk_mul_f32 v[22:23], v[150:151], v[150:151]
v_pk_fma_f32 v[16:17], v[16:17], s[30:31], v[6:7]
v_pk_fma_f32 v[18:19], v[18:19], s[30:31], v[6:7]
v_pk_fma_f32 v[20:21], v[20:21], s[30:31], v[6:7]
v_pk_fma_f32 v[22:23], v[22:23], s[30:31], v[6:7]
v_pk_mul_f32 v[16:17], v[16:17], v[132:133]
v_pk_mul_f32 v[18:19], v[18:19], v[134:135]
v_pk_mul_f32 v[20:21], v[20:21], v[148:149]
v_pk_mul_f32 v[22:23], v[22:23], v[150:151]
v_exp_f32 v16, v16
v_exp_f32 v17, v17
v_exp_f32 v18, v18
v_exp_f32 v19, v19
v_exp_f32 v20, v20
v_exp_f32 v21, v21
v_exp_f32 v22, v22
v_exp_f32 v23, v23
v_pk_add_f32 v[16:17], v[16:17], 1.0 op_sel_hi:[1,0]
v_pk_add_f32 v[18:19], v[18:19], 1.0 op_sel_hi:[1,0]
v_pk_add_f32 v[20:21], v[20:21], 1.0 op_sel_hi:[1,0]
v_pk_add_f32 v[22:23], v[22:23], 1.0 op_sel_hi:[1,0]
v_rcp_f32 v16, v16
v_rcp_f32 v17, v17
v_rcp_f32 v18, v18
v_rcp_f32 v19, v19
v_rcp_f32 v20, v20
v_rcp_f32 v21, v21
v_rcp_f32 v22, v22
v_rcp_f32 v23, v23
v_pk_mul_f32 v[132:133], v[132:133], v[16:17]
v_pk_mul_f32 v[134:135], v[134:135], v[18:19]
v_pk_mul_f32 v[148:149], v[148:149], v[20:21]
v_pk_mul_f32 v[150:151], v[150:151], v[22:23]
v_cvt_pk_bf16_f32 v28, v132, v133
v_cvt_pk_bf16_f32 v29, v134, v135
v_cvt_pk_bf16_f32 v30, v148, v149
v_cvt_pk_bf16_f32 v31, v150, v151
s_mov_b32 s27, 116736
buffer_store_dwordx4 v[28:31], v5, s[56:59], s27 offen
v_pk_fma_f32 v[136:137], v[136:137], v[58:59], v[8:9] op_sel_hi:[1,0,1]
v_pk_fma_f32 v[138:139], v[138:139], v[58:59], v[10:11] op_sel_hi:[1,0,1]
v_pk_fma_f32 v[152:153], v[152:153], v[58:59], v[12:13] op_sel_hi:[1,0,1]
v_pk_fma_f32 v[154:155], v[154:155], v[58:59], v[14:15] op_sel_hi:[1,0,1]
v_pk_mul_f32 v[16:17], v[136:137], v[136:137]
v_pk_mul_f32 v[18:19], v[138:139], v[138:139]
v_pk_mul_f32 v[20:21], v[152:153], v[152:153]
v_pk_mul_f32 v[22:23], v[154:155], v[154:155]
v_pk_fma_f32 v[16:17], v[16:17], s[30:31], v[6:7]
v_pk_fma_f32 v[18:19], v[18:19], s[30:31], v[6:7]
v_pk_fma_f32 v[20:21], v[20:21], s[30:31], v[6:7]
v_pk_fma_f32 v[22:23], v[22:23], s[30:31], v[6:7]
v_pk_mul_f32 v[16:17], v[16:17], v[136:137]
v_pk_mul_f32 v[18:19], v[18:19], v[138:139]
v_pk_mul_f32 v[20:21], v[20:21], v[152:153]
v_pk_mul_f32 v[22:23], v[22:23], v[154:155]
v_exp_f32 v16, v16
v_exp_f32 v17, v17
v_exp_f32 v18, v18
v_exp_f32 v19, v19
v_exp_f32 v20, v20
v_exp_f32 v21, v21
v_exp_f32 v22, v22
v_exp_f32 v23, v23
v_pk_add_f32 v[16:17], v[16:17], 1.0 op_sel_hi:[1,0]
v_pk_add_f32 v[18:19], v[18:19], 1.0 op_sel_hi:[1,0]
v_pk_add_f32 v[20:21], v[20:21], 1.0 op_sel_hi:[1,0]
v_pk_add_f32 v[22:23], v[22:23], 1.0 op_sel_hi:[1,0]
v_rcp_f32 v16, v16
v_rcp_f32 v17, v17
v_rcp_f32 v18, v18
v_rcp_f32 v19, v19
v_rcp_f32 v20, v20
v_rcp_f32 v21, v21
v_rcp_f32 v22, v22
v_rcp_f32 v23, v23
v_pk_mul_f32 v[136:137], v[136:137], v[16:17]
v_pk_mul_f32 v[138:139], v[138:139], v[18:19]
v_pk_mul_f32 v[152:153], v[152:153], v[20:21]
v_pk_mul_f32 v[154:155], v[154:155], v[22:23]
v_cvt_pk_bf16_f32 v24, v136, v137
v_cvt_pk_bf16_f32 v25, v138, v139
v_cvt_pk_bf16_f32 v26, v152, v153
v_cvt_pk_bf16_f32 v27, v154, v155
s_mov_b32 s27, 231424
buffer_store_dwordx4 v[24:27], v5, s[56:59], s27 offen
v_pk_fma_f32 v[140:141], v[140:141], v[58:59], v[8:9] op_sel:[0,1,0] op_sel_hi:[1,1,1]
v_pk_fma_f32 v[142:143], v[142:143], v[58:59], v[10:11] op_sel:[0,1,0] op_sel_hi:[1,1,1]
v_pk_fma_f32 v[156:157], v[156:157], v[58:59], v[12:13] op_sel:[0,1,0] op_sel_hi:[1,1,1]
v_pk_fma_f32 v[158:159], v[158:159], v[58:59], v[14:15] op_sel:[0,1,0] op_sel_hi:[1,1,1]
v_pk_mul_f32 v[16:17], v[140:141], v[140:141]
v_pk_mul_f32 v[18:19], v[142:143], v[142:143]
v_pk_mul_f32 v[20:21], v[156:157], v[156:157]
v_pk_mul_f32 v[22:23], v[158:159], v[158:159]
v_pk_fma_f32 v[16:17], v[16:17], s[30:31], v[6:7]
v_pk_fma_f32 v[18:19], v[18:19], s[30:31], v[6:7]
v_pk_fma_f32 v[20:21], v[20:21], s[30:31], v[6:7]
v_pk_fma_f32 v[22:23], v[22:23], s[30:31], v[6:7]
v_pk_mul_f32 v[16:17], v[16:17], v[140:141]
v_pk_mul_f32 v[18:19], v[18:19], v[142:143]
v_pk_mul_f32 v[20:21], v[20:21], v[156:157]
v_pk_mul_f32 v[22:23], v[22:23], v[158:159]
v_exp_f32 v16, v16
v_exp_f32 v17, v17
v_exp_f32 v18, v18
v_exp_f32 v19, v19
v_exp_f32 v20, v20
v_exp_f32 v21, v21
v_exp_f32 v22, v22
v_exp_f32 v23, v23
v_pk_add_f32 v[16:17], v[16:17], 1.0 op_sel_hi:[1,0]
v_pk_add_f32 v[18:19], v[18:19], 1.0 op_sel_hi:[1,0]
v_pk_add_f32 v[20:21], v[20:21], 1.0 op_sel_hi:[1,0]
v_pk_add_f32 v[22:23], v[22:23], 1.0 op_sel_hi:[1,0]
v_rcp_f32 v16, v16
v_rcp_f32 v17, v17
v_rcp_f32 v18, v18
v_rcp_f32 v19, v19
v_rcp_f32 v20, v20
v_rcp_f32 v21, v21
v_rcp_f32 v22, v22
v_rcp_f32 v23, v23
v_pk_mul_f32 v[140:141], v[140:141], v[16:17]
v_pk_mul_f32 v[142:143], v[142:143], v[18:19]
v_pk_mul_f32 v[156:157], v[156:157], v[20:21]
v_pk_mul_f32 v[158:159], v[158:159], v[22:23]
v_cvt_pk_bf16_f32 v28, v140, v141
v_cvt_pk_bf16_f32 v29, v142, v143
v_cvt_pk_bf16_f32 v30, v156, v157
v_cvt_pk_bf16_f32 v31, v158, v159
s_mov_b32 s27, 346112
buffer_store_dwordx4 v[28:31], v5, s[56:59], s27 offen
v_lshlrev_b32 v8, 16, v44
v_and_b32 v9, 0xffff0000, v44
v_lshlrev_b32 v10, 16, v45
v_and_b32 v11, 0xffff0000, v45
v_lshlrev_b32 v12, 16, v46
v_and_b32 v13, 0xffff0000, v46
v_lshlrev_b32 v14, 16, v47
v_and_b32 v15, 0xffff0000, v47
v_pk_fma_f32 v[160:161], v[160:161], v[56:57], v[8:9] op_sel_hi:[1,0,1]
v_pk_fma_f32 v[162:163], v[162:163], v[56:57], v[10:11] op_sel_hi:[1,0,1]
v_pk_fma_f32 v[176:177], v[176:177], v[56:57], v[12:13] op_sel_hi:[1,0,1]
v_pk_fma_f32 v[178:179], v[178:179], v[56:57], v[14:15] op_sel_hi:[1,0,1]
v_pk_mul_f32 v[16:17], v[160:161], v[160:161]
v_pk_mul_f32 v[18:19], v[162:163], v[162:163]
v_pk_mul_f32 v[20:21], v[176:177], v[176:177]
v_pk_mul_f32 v[22:23], v[178:179], v[178:179]
v_pk_fma_f32 v[16:17], v[16:17], s[30:31], v[6:7]
v_pk_fma_f32 v[18:19], v[18:19], s[30:31], v[6:7]
v_pk_fma_f32 v[20:21], v[20:21], s[30:31], v[6:7]
v_pk_fma_f32 v[22:23], v[22:23], s[30:31], v[6:7]
v_pk_mul_f32 v[16:17], v[16:17], v[160:161]
v_pk_mul_f32 v[18:19], v[18:19], v[162:163]
v_pk_mul_f32 v[20:21], v[20:21], v[176:177]
v_pk_mul_f32 v[22:23], v[22:23], v[178:179]
v_exp_f32 v16, v16
v_exp_f32 v17, v17
v_exp_f32 v18, v18
v_exp_f32 v19, v19
v_exp_f32 v20, v20
v_exp_f32 v21, v21
v_exp_f32 v22, v22
v_exp_f32 v23, v23
v_pk_add_f32 v[16:17], v[16:17], 1.0 op_sel_hi:[1,0]
v_pk_add_f32 v[18:19], v[18:19], 1.0 op_sel_hi:[1,0]
v_pk_add_f32 v[20:21], v[20:21], 1.0 op_sel_hi:[1,0]
v_pk_add_f32 v[22:23], v[22:23], 1.0 op_sel_hi:[1,0]
v_rcp_f32 v16, v16
v_rcp_f32 v17, v17
v_rcp_f32 v18, v18
v_rcp_f32 v19, v19
v_rcp_f32 v20, v20
v_rcp_f32 v21, v21
v_rcp_f32 v22, v22
v_rcp_f32 v23, v23
v_pk_mul_f32 v[160:161], v[160:161], v[16:17]
v_pk_mul_f32 v[162:163], v[162:163], v[18:19]
v_pk_mul_f32 v[176:177], v[176:177], v[20:21]
v_pk_mul_f32 v[178:179], v[178:179], v[22:23]
v_cvt_pk_bf16_f32 v24, v160, v161
v_cvt_pk_bf16_f32 v25, v162, v163
v_cvt_pk_bf16_f32 v26, v176, v177
v_cvt_pk_bf16_f32 v27, v178, v179
s_mov_b32 s27, 3072
buffer_store_dwordx4 v[24:27], v5, s[56:59], s27 offen
v_pk_fma_f32 v[164:165], v[164:165], v[56:57], v[8:9] op_sel:[0,1,0] op_sel_hi:[1,1,1]
v_pk_fma_f32 v[166:167], v[166:167], v[56:57], v[10:11] op_sel:[0,1,0] op_sel_hi:[1,1,1]
v_pk_fma_f32 v[180:181], v[180:181], v[56:57], v[12:13] op_sel:[0,1,0] op_sel_hi:[1,1,1]
v_pk_fma_f32 v[182:183], v[182:183], v[56:57], v[14:15] op_sel:[0,1,0] op_sel_hi:[1,1,1]
v_pk_mul_f32 v[16:17], v[164:165], v[164:165]
v_pk_mul_f32 v[18:19], v[166:167], v[166:167]
v_pk_mul_f32 v[20:21], v[180:181], v[180:181]
v_pk_mul_f32 v[22:23], v[182:183], v[182:183]
v_pk_fma_f32 v[16:17], v[16:17], s[30:31], v[6:7]
v_pk_fma_f32 v[18:19], v[18:19], s[30:31], v[6:7]
v_pk_fma_f32 v[20:21], v[20:21], s[30:31], v[6:7]
v_pk_fma_f32 v[22:23], v[22:23], s[30:31], v[6:7]
v_pk_mul_f32 v[16:17], v[16:17], v[164:165]
v_pk_mul_f32 v[18:19], v[18:19], v[166:167]
v_pk_mul_f32 v[20:21], v[20:21], v[180:181]
v_pk_mul_f32 v[22:23], v[22:23], v[182:183]
v_exp_f32 v16, v16
v_exp_f32 v17, v17
v_exp_f32 v18, v18
v_exp_f32 v19, v19
v_exp_f32 v20, v20
v_exp_f32 v21, v21
v_exp_f32 v22, v22
v_exp_f32 v23, v23
v_pk_add_f32 v[16:17], v[16:17], 1.0 op_sel_hi:[1,0]
v_pk_add_f32 v[18:19], v[18:19], 1.0 op_sel_hi:[1,0]
v_pk_add_f32 v[20:21], v[20:21], 1.0 op_sel_hi:[1,0]
v_pk_add_f32 v[22:23], v[22:23], 1.0 op_sel_hi:[1,0]
v_rcp_f32 v16, v16
v_rcp_f32 v17, v17
v_rcp_f32 v18, v18
v_rcp_f32 v19, v19
v_rcp_f32 v20, v20
v_rcp_f32 v21, v21
v_rcp_f32 v22, v22
v_rcp_f32 v23, v23
v_pk_mul_f32 v[164:165], v[164:165], v[16:17]
v_pk_mul_f32 v[166:167], v[166:167], v[18:19]
v_pk_mul_f32 v[180:181], v[180:181], v[20:21]
v_pk_mul_f32 v[182:183], v[182:183], v[22:23]
v_cvt_pk_bf16_f32 v28, v164, v165
v_cvt_pk_bf16_f32 v29, v166, v167
v_cvt_pk_bf16_f32 v30, v180, v181
v_cvt_pk_bf16_f32 v31, v182, v183
s_mov_b32 s27, 117760
buffer_store_dwordx4 v[28:31], v5, s[56:59], s27 offen
v_pk_fma_f32 v[168:169], v[168:169], v[58:59], v[8:9] op_sel_hi:[1,0,1]
v_pk_fma_f32 v[170:171], v[170:171], v[58:59], v[10:11] op_sel_hi:[1,0,1]
v_pk_fma_f32 v[184:185], v[184:185], v[58:59], v[12:13] op_sel_hi:[1,0,1]
v_pk_fma_f32 v[186:187], v[186:187], v[58:59], v[14:15] op_sel_hi:[1,0,1]
v_pk_mul_f32 v[16:17], v[168:169], v[168:169]
v_pk_mul_f32 v[18:19], v[170:171], v[170:171]
v_pk_mul_f32 v[20:21], v[184:185], v[184:185]
v_pk_mul_f32 v[22:23], v[186:187], v[186:187]
v_pk_fma_f32 v[16:17], v[16:17], s[30:31], v[6:7]
v_pk_fma_f32 v[18:19], v[18:19], s[30:31], v[6:7]
v_pk_fma_f32 v[20:21], v[20:21], s[30:31], v[6:7]
v_pk_fma_f32 v[22:23], v[22:23], s[30:31], v[6:7]
v_pk_mul_f32 v[16:17], v[16:17], v[168:169]
v_pk_mul_f32 v[18:19], v[18:19], v[170:171]
v_pk_mul_f32 v[20:21], v[20:21], v[184:185]
v_pk_mul_f32 v[22:23], v[22:23], v[186:187]
v_exp_f32 v16, v16
v_exp_f32 v17, v17
v_exp_f32 v18, v18
v_exp_f32 v19, v19
v_exp_f32 v20, v20
v_exp_f32 v21, v21
v_exp_f32 v22, v22
v_exp_f32 v23, v23
v_pk_add_f32 v[16:17], v[16:17], 1.0 op_sel_hi:[1,0]
v_pk_add_f32 v[18:19], v[18:19], 1.0 op_sel_hi:[1,0]
v_pk_add_f32 v[20:21], v[20:21], 1.0 op_sel_hi:[1,0]
v_pk_add_f32 v[22:23], v[22:23], 1.0 op_sel_hi:[1,0]
v_rcp_f32 v16, v16
v_rcp_f32 v17, v17
v_rcp_f32 v18, v18
v_rcp_f32 v19, v19
v_rcp_f32 v20, v20
v_rcp_f32 v21, v21
v_rcp_f32 v22, v22
v_rcp_f32 v23, v23
v_pk_mul_f32 v[168:169], v[168:169], v[16:17]
v_pk_mul_f32 v[170:171], v[170:171], v[18:19]
v_pk_mul_f32 v[184:185], v[184:185], v[20:21]
v_pk_mul_f32 v[186:187], v[186:187], v[22:23]
v_cvt_pk_bf16_f32 v24, v168, v169
v_cvt_pk_bf16_f32 v25, v170, v171
v_cvt_pk_bf16_f32 v26, v184, v185
v_cvt_pk_bf16_f32 v27, v186, v187
s_mov_b32 s27, 232448
buffer_store_dwordx4 v[24:27], v5, s[56:59], s27 offen
v_pk_fma_f32 v[172:173], v[172:173], v[58:59], v[8:9] op_sel:[0,1,0] op_sel_hi:[1,1,1]
v_pk_fma_f32 v[174:175], v[174:175], v[58:59], v[10:11] op_sel:[0,1,0] op_sel_hi:[1,1,1]
v_pk_fma_f32 v[188:189], v[188:189], v[58:59], v[12:13] op_sel:[0,1,0] op_sel_hi:[1,1,1]
v_pk_fma_f32 v[190:191], v[190:191], v[58:59], v[14:15] op_sel:[0,1,0] op_sel_hi:[1,1,1]
v_pk_mul_f32 v[16:17], v[172:173], v[172:173]
v_pk_mul_f32 v[18:19], v[174:175], v[174:175]
v_pk_mul_f32 v[20:21], v[188:189], v[188:189]
v_pk_mul_f32 v[22:23], v[190:191], v[190:191]
v_pk_fma_f32 v[16:17], v[16:17], s[30:31], v[6:7]
v_pk_fma_f32 v[18:19], v[18:19], s[30:31], v[6:7]
v_pk_fma_f32 v[20:21], v[20:21], s[30:31], v[6:7]
v_pk_fma_f32 v[22:23], v[22:23], s[30:31], v[6:7]
v_pk_mul_f32 v[16:17], v[16:17], v[172:173]
v_pk_mul_f32 v[18:19], v[18:19], v[174:175]
v_pk_mul_f32 v[20:21], v[20:21], v[188:189]
v_pk_mul_f32 v[22:23], v[22:23], v[190:191]
v_exp_f32 v16, v16
v_exp_f32 v17, v17
v_exp_f32 v18, v18
v_exp_f32 v19, v19
v_exp_f32 v20, v20
v_exp_f32 v21, v21
v_exp_f32 v22, v22
v_exp_f32 v23, v23
v_pk_add_f32 v[16:17], v[16:17], 1.0 op_sel_hi:[1,0]
v_pk_add_f32 v[18:19], v[18:19], 1.0 op_sel_hi:[1,0]
v_pk_add_f32 v[20:21], v[20:21], 1.0 op_sel_hi:[1,0]
v_pk_add_f32 v[22:23], v[22:23], 1.0 op_sel_hi:[1,0]
v_rcp_f32 v16, v16
v_rcp_f32 v17, v17
v_rcp_f32 v18, v18
v_rcp_f32 v19, v19
v_rcp_f32 v20, v20
v_rcp_f32 v21, v21
v_rcp_f32 v22, v22
v_rcp_f32 v23, v23
v_pk_mul_f32 v[172:173], v[172:173], v[16:17]
v_pk_mul_f32 v[174:175], v[174:175], v[18:19]
v_pk_mul_f32 v[188:189], v[188:189], v[20:21]
v_pk_mul_f32 v[190:191], v[190:191], v[22:23]
v_cvt_pk_bf16_f32 v28, v172, v173
v_cvt_pk_bf16_f32 v29, v174, v175
v_cvt_pk_bf16_f32 v30, v188, v189
v_cvt_pk_bf16_f32 v31, v190, v191
s_mov_b32 s27, 347136
buffer_store_dwordx4 v[28:31], v5, s[56:59], s27 offen
v_lshlrev_b32 v8, 16, v48
v_and_b32 v9, 0xffff0000, v48
v_lshlrev_b32 v10, 16, v49
v_and_b32 v11, 0xffff0000, v49
v_lshlrev_b32 v12, 16, v50
v_and_b32 v13, 0xffff0000, v50
v_lshlrev_b32 v14, 16, v51
v_and_b32 v15, 0xffff0000, v51
v_pk_fma_f32 v[192:193], v[192:193], v[56:57], v[8:9] op_sel_hi:[1,0,1]
v_pk_fma_f32 v[194:195], v[194:195], v[56:57], v[10:11] op_sel_hi:[1,0,1]
v_pk_fma_f32 v[208:209], v[208:209], v[56:57], v[12:13] op_sel_hi:[1,0,1]
v_pk_fma_f32 v[210:211], v[210:211], v[56:57], v[14:15] op_sel_hi:[1,0,1]
v_pk_mul_f32 v[16:17], v[192:193], v[192:193]
v_pk_mul_f32 v[18:19], v[194:195], v[194:195]
v_pk_mul_f32 v[20:21], v[208:209], v[208:209]
v_pk_mul_f32 v[22:23], v[210:211], v[210:211]
v_pk_fma_f32 v[16:17], v[16:17], s[30:31], v[6:7]
v_pk_fma_f32 v[18:19], v[18:19], s[30:31], v[6:7]
v_pk_fma_f32 v[20:21], v[20:21], s[30:31], v[6:7]
v_pk_fma_f32 v[22:23], v[22:23], s[30:31], v[6:7]
v_pk_mul_f32 v[16:17], v[16:17], v[192:193]
v_pk_mul_f32 v[18:19], v[18:19], v[194:195]
v_pk_mul_f32 v[20:21], v[20:21], v[208:209]
v_pk_mul_f32 v[22:23], v[22:23], v[210:211]
v_exp_f32 v16, v16
v_exp_f32 v17, v17
v_exp_f32 v18, v18
v_exp_f32 v19, v19
v_exp_f32 v20, v20
v_exp_f32 v21, v21
v_exp_f32 v22, v22
v_exp_f32 v23, v23
v_pk_add_f32 v[16:17], v[16:17], 1.0 op_sel_hi:[1,0]
v_pk_add_f32 v[18:19], v[18:19], 1.0 op_sel_hi:[1,0]
v_pk_add_f32 v[20:21], v[20:21], 1.0 op_sel_hi:[1,0]
v_pk_add_f32 v[22:23], v[22:23], 1.0 op_sel_hi:[1,0]
v_rcp_f32 v16, v16
v_rcp_f32 v17, v17
v_rcp_f32 v18, v18
v_rcp_f32 v19, v19
v_rcp_f32 v20, v20
v_rcp_f32 v21, v21
v_rcp_f32 v22, v22
v_rcp_f32 v23, v23
v_pk_mul_f32 v[192:193], v[192:193], v[16:17]
v_pk_mul_f32 v[194:195], v[194:195], v[18:19]
v_pk_mul_f32 v[208:209], v[208:209], v[20:21]
v_pk_mul_f32 v[210:211], v[210:211], v[22:23]
v_cvt_pk_bf16_f32 v24, v192, v193
v_cvt_pk_bf16_f32 v25, v194, v195
v_cvt_pk_bf16_f32 v26, v208, v209
v_cvt_pk_bf16_f32 v27, v210, v211
s_mov_b32 s27, 4096
buffer_store_dwordx4 v[24:27], v5, s[56:59], s27 offen
v_pk_fma_f32 v[196:197], v[196:197], v[56:57], v[8:9] op_sel:[0,1,0] op_sel_hi:[1,1,1]
v_pk_fma_f32 v[198:199], v[198:199], v[56:57], v[10:11] op_sel:[0,1,0] op_sel_hi:[1,1,1]
v_pk_fma_f32 v[212:213], v[212:213], v[56:57], v[12:13] op_sel:[0,1,0] op_sel_hi:[1,1,1]
v_pk_fma_f32 v[214:215], v[214:215], v[56:57], v[14:15] op_sel:[0,1,0] op_sel_hi:[1,1,1]
v_pk_mul_f32 v[16:17], v[196:197], v[196:197]
v_pk_mul_f32 v[18:19], v[198:199], v[198:199]
v_pk_mul_f32 v[20:21], v[212:213], v[212:213]
v_pk_mul_f32 v[22:23], v[214:215], v[214:215]
v_pk_fma_f32 v[16:17], v[16:17], s[30:31], v[6:7]
v_pk_fma_f32 v[18:19], v[18:19], s[30:31], v[6:7]
v_pk_fma_f32 v[20:21], v[20:21], s[30:31], v[6:7]
v_pk_fma_f32 v[22:23], v[22:23], s[30:31], v[6:7]
v_pk_mul_f32 v[16:17], v[16:17], v[196:197]
v_pk_mul_f32 v[18:19], v[18:19], v[198:199]
v_pk_mul_f32 v[20:21], v[20:21], v[212:213]
v_pk_mul_f32 v[22:23], v[22:23], v[214:215]
v_exp_f32 v16, v16
v_exp_f32 v17, v17
v_exp_f32 v18, v18
v_exp_f32 v19, v19
v_exp_f32 v20, v20
v_exp_f32 v21, v21
v_exp_f32 v22, v22
v_exp_f32 v23, v23
v_pk_add_f32 v[16:17], v[16:17], 1.0 op_sel_hi:[1,0]
v_pk_add_f32 v[18:19], v[18:19], 1.0 op_sel_hi:[1,0]
v_pk_add_f32 v[20:21], v[20:21], 1.0 op_sel_hi:[1,0]
v_pk_add_f32 v[22:23], v[22:23], 1.0 op_sel_hi:[1,0]
v_rcp_f32 v16, v16
v_rcp_f32 v17, v17
v_rcp_f32 v18, v18
v_rcp_f32 v19, v19
v_rcp_f32 v20, v20
v_rcp_f32 v21, v21
v_rcp_f32 v22, v22
v_rcp_f32 v23, v23
v_pk_mul_f32 v[196:197], v[196:197], v[16:17]
v_pk_mul_f32 v[198:199], v[198:199], v[18:19]
v_pk_mul_f32 v[212:213], v[212:213], v[20:21]
v_pk_mul_f32 v[214:215], v[214:215], v[22:23]
v_cvt_pk_bf16_f32 v28, v196, v197
v_cvt_pk_bf16_f32 v29, v198, v199
v_cvt_pk_bf16_f32 v30, v212, v213
v_cvt_pk_bf16_f32 v31, v214, v215
s_mov_b32 s27, 118784
buffer_store_dwordx4 v[28:31], v5, s[56:59], s27 offen
v_pk_fma_f32 v[200:201], v[200:201], v[58:59], v[8:9] op_sel_hi:[1,0,1]
v_pk_fma_f32 v[202:203], v[202:203], v[58:59], v[10:11] op_sel_hi:[1,0,1]
v_pk_fma_f32 v[216:217], v[216:217], v[58:59], v[12:13] op_sel_hi:[1,0,1]
v_pk_fma_f32 v[218:219], v[218:219], v[58:59], v[14:15] op_sel_hi:[1,0,1]
v_pk_mul_f32 v[16:17], v[200:201], v[200:201]
v_pk_mul_f32 v[18:19], v[202:203], v[202:203]
v_pk_mul_f32 v[20:21], v[216:217], v[216:217]
v_pk_mul_f32 v[22:23], v[218:219], v[218:219]
v_pk_fma_f32 v[16:17], v[16:17], s[30:31], v[6:7]
v_pk_fma_f32 v[18:19], v[18:19], s[30:31], v[6:7]
v_pk_fma_f32 v[20:21], v[20:21], s[30:31], v[6:7]
v_pk_fma_f32 v[22:23], v[22:23], s[30:31], v[6:7]
v_pk_mul_f32 v[16:17], v[16:17], v[200:201]
v_pk_mul_f32 v[18:19], v[18:19], v[202:203]
v_pk_mul_f32 v[20:21], v[20:21], v[216:217]
v_pk_mul_f32 v[22:23], v[22:23], v[218:219]
v_exp_f32 v16, v16
v_exp_f32 v17, v17
v_exp_f32 v18, v18
v_exp_f32 v19, v19
v_exp_f32 v20, v20
v_exp_f32 v21, v21
v_exp_f32 v22, v22
v_exp_f32 v23, v23
v_pk_add_f32 v[16:17], v[16:17], 1.0 op_sel_hi:[1,0]
v_pk_add_f32 v[18:19], v[18:19], 1.0 op_sel_hi:[1,0]
v_pk_add_f32 v[20:21], v[20:21], 1.0 op_sel_hi:[1,0]
v_pk_add_f32 v[22:23], v[22:23], 1.0 op_sel_hi:[1,0]
v_rcp_f32 v16, v16
v_rcp_f32 v17, v17
v_rcp_f32 v18, v18
v_rcp_f32 v19, v19
v_rcp_f32 v20, v20
v_rcp_f32 v21, v21
v_rcp_f32 v22, v22
v_rcp_f32 v23, v23
v_pk_mul_f32 v[200:201], v[200:201], v[16:17]
v_pk_mul_f32 v[202:203], v[202:203], v[18:19]
v_pk_mul_f32 v[216:217], v[216:217], v[20:21]
v_pk_mul_f32 v[218:219], v[218:219], v[22:23]
v_cvt_pk_bf16_f32 v24, v200, v201
v_cvt_pk_bf16_f32 v25, v202, v203
v_cvt_pk_bf16_f32 v26, v216, v217
v_cvt_pk_bf16_f32 v27, v218, v219
s_mov_b32 s27, 233472
buffer_store_dwordx4 v[24:27], v5, s[56:59], s27 offen
v_pk_fma_f32 v[204:205], v[204:205], v[58:59], v[8:9] op_sel:[0,1,0] op_sel_hi:[1,1,1]
v_pk_fma_f32 v[206:207], v[206:207], v[58:59], v[10:11] op_sel:[0,1,0] op_sel_hi:[1,1,1]
v_pk_fma_f32 v[220:221], v[220:221], v[58:59], v[12:13] op_sel:[0,1,0] op_sel_hi:[1,1,1]
v_pk_fma_f32 v[222:223], v[222:223], v[58:59], v[14:15] op_sel:[0,1,0] op_sel_hi:[1,1,1]
v_pk_mul_f32 v[16:17], v[204:205], v[204:205]
v_pk_mul_f32 v[18:19], v[206:207], v[206:207]
v_pk_mul_f32 v[20:21], v[220:221], v[220:221]
v_pk_mul_f32 v[22:23], v[222:223], v[222:223]
v_pk_fma_f32 v[16:17], v[16:17], s[30:31], v[6:7]
v_pk_fma_f32 v[18:19], v[18:19], s[30:31], v[6:7]
v_pk_fma_f32 v[20:21], v[20:21], s[30:31], v[6:7]
v_pk_fma_f32 v[22:23], v[22:23], s[30:31], v[6:7]
v_pk_mul_f32 v[16:17], v[16:17], v[204:205]
v_pk_mul_f32 v[18:19], v[18:19], v[206:207]
v_pk_mul_f32 v[20:21], v[20:21], v[220:221]
v_pk_mul_f32 v[22:23], v[22:23], v[222:223]
v_exp_f32 v16, v16
v_exp_f32 v17, v17
v_exp_f32 v18, v18
v_exp_f32 v19, v19
v_exp_f32 v20, v20
v_exp_f32 v21, v21
v_exp_f32 v22, v22
v_exp_f32 v23, v23
v_pk_add_f32 v[16:17], v[16:17], 1.0 op_sel_hi:[1,0]
v_pk_add_f32 v[18:19], v[18:19], 1.0 op_sel_hi:[1,0]
v_pk_add_f32 v[20:21], v[20:21], 1.0 op_sel_hi:[1,0]
v_pk_add_f32 v[22:23], v[22:23], 1.0 op_sel_hi:[1,0]
v_rcp_f32 v16, v16
v_rcp_f32 v17, v17
v_rcp_f32 v18, v18
v_rcp_f32 v19, v19
v_rcp_f32 v20, v20
v_rcp_f32 v21, v21
v_rcp_f32 v22, v22
v_rcp_f32 v23, v23
v_pk_mul_f32 v[204:205], v[204:205], v[16:17]
v_pk_mul_f32 v[206:207], v[206:207], v[18:19]
v_pk_mul_f32 v[220:221], v[220:221], v[20:21]
v_pk_mul_f32 v[222:223], v[222:223], v[22:23]
v_cvt_pk_bf16_f32 v28, v204, v205
v_cvt_pk_bf16_f32 v29, v206, v207
v_cvt_pk_bf16_f32 v30, v220, v221
v_cvt_pk_bf16_f32 v31, v222, v223
s_mov_b32 s27, 348160
buffer_store_dwordx4 v[28:31], v5, s[56:59], s27 offen
v_lshlrev_b32 v8, 16, v52
v_and_b32 v9, 0xffff0000, v52
v_lshlrev_b32 v10, 16, v53
v_and_b32 v11, 0xffff0000, v53
v_lshlrev_b32 v12, 16, v54
v_and_b32 v13, 0xffff0000, v54
v_lshlrev_b32 v14, 16, v55
v_and_b32 v15, 0xffff0000, v55
v_pk_fma_f32 v[224:225], v[224:225], v[56:57], v[8:9] op_sel_hi:[1,0,1]
v_pk_fma_f32 v[226:227], v[226:227], v[56:57], v[10:11] op_sel_hi:[1,0,1]
v_pk_fma_f32 v[240:241], v[240:241], v[56:57], v[12:13] op_sel_hi:[1,0,1]
v_pk_fma_f32 v[242:243], v[242:243], v[56:57], v[14:15] op_sel_hi:[1,0,1]
v_pk_mul_f32 v[16:17], v[224:225], v[224:225]
v_pk_mul_f32 v[18:19], v[226:227], v[226:227]
v_pk_mul_f32 v[20:21], v[240:241], v[240:241]
v_pk_mul_f32 v[22:23], v[242:243], v[242:243]
v_pk_fma_f32 v[16:17], v[16:17], s[30:31], v[6:7]
v_pk_fma_f32 v[18:19], v[18:19], s[30:31], v[6:7]
v_pk_fma_f32 v[20:21], v[20:21], s[30:31], v[6:7]
v_pk_fma_f32 v[22:23], v[22:23], s[30:31], v[6:7]
v_pk_mul_f32 v[16:17], v[16:17], v[224:225]
v_pk_mul_f32 v[18:19], v[18:19], v[226:227]
v_pk_mul_f32 v[20:21], v[20:21], v[240:241]
v_pk_mul_f32 v[22:23], v[22:23], v[242:243]
v_exp_f32 v16, v16
v_exp_f32 v17, v17
v_exp_f32 v18, v18
v_exp_f32 v19, v19
v_exp_f32 v20, v20
v_exp_f32 v21, v21
v_exp_f32 v22, v22
v_exp_f32 v23, v23
v_pk_add_f32 v[16:17], v[16:17], 1.0 op_sel_hi:[1,0]
v_pk_add_f32 v[18:19], v[18:19], 1.0 op_sel_hi:[1,0]
v_pk_add_f32 v[20:21], v[20:21], 1.0 op_sel_hi:[1,0]
v_pk_add_f32 v[22:23], v[22:23], 1.0 op_sel_hi:[1,0]
v_rcp_f32 v16, v16
v_rcp_f32 v17, v17
v_rcp_f32 v18, v18
v_rcp_f32 v19, v19
v_rcp_f32 v20, v20
v_rcp_f32 v21, v21
v_rcp_f32 v22, v22
v_rcp_f32 v23, v23
v_pk_mul_f32 v[224:225], v[224:225], v[16:17]
v_pk_mul_f32 v[226:227], v[226:227], v[18:19]
v_pk_mul_f32 v[240:241], v[240:241], v[20:21]
v_pk_mul_f32 v[242:243], v[242:243], v[22:23]
v_cvt_pk_bf16_f32 v24, v224, v225
v_cvt_pk_bf16_f32 v25, v226, v227
v_cvt_pk_bf16_f32 v26, v240, v241
v_cvt_pk_bf16_f32 v27, v242, v243
s_mov_b32 s27, 5120
buffer_store_dwordx4 v[24:27], v5, s[56:59], s27 offen
v_pk_fma_f32 v[228:229], v[228:229], v[56:57], v[8:9] op_sel:[0,1,0] op_sel_hi:[1,1,1]
v_pk_fma_f32 v[230:231], v[230:231], v[56:57], v[10:11] op_sel:[0,1,0] op_sel_hi:[1,1,1]
v_pk_fma_f32 v[244:245], v[244:245], v[56:57], v[12:13] op_sel:[0,1,0] op_sel_hi:[1,1,1]
v_pk_fma_f32 v[246:247], v[246:247], v[56:57], v[14:15] op_sel:[0,1,0] op_sel_hi:[1,1,1]
v_pk_mul_f32 v[16:17], v[228:229], v[228:229]
v_pk_mul_f32 v[18:19], v[230:231], v[230:231]
v_pk_mul_f32 v[20:21], v[244:245], v[244:245]
v_pk_mul_f32 v[22:23], v[246:247], v[246:247]
v_pk_fma_f32 v[16:17], v[16:17], s[30:31], v[6:7]
v_pk_fma_f32 v[18:19], v[18:19], s[30:31], v[6:7]
v_pk_fma_f32 v[20:21], v[20:21], s[30:31], v[6:7]
v_pk_fma_f32 v[22:23], v[22:23], s[30:31], v[6:7]
v_pk_mul_f32 v[16:17], v[16:17], v[228:229]
v_pk_mul_f32 v[18:19], v[18:19], v[230:231]
v_pk_mul_f32 v[20:21], v[20:21], v[244:245]
v_pk_mul_f32 v[22:23], v[22:23], v[246:247]
v_exp_f32 v16, v16
v_exp_f32 v17, v17
v_exp_f32 v18, v18
v_exp_f32 v19, v19
v_exp_f32 v20, v20
v_exp_f32 v21, v21
v_exp_f32 v22, v22
v_exp_f32 v23, v23
v_pk_add_f32 v[16:17], v[16:17], 1.0 op_sel_hi:[1,0]
v_pk_add_f32 v[18:19], v[18:19], 1.0 op_sel_hi:[1,0]
v_pk_add_f32 v[20:21], v[20:21], 1.0 op_sel_hi:[1,0]
v_pk_add_f32 v[22:23], v[22:23], 1.0 op_sel_hi:[1,0]
v_rcp_f32 v16, v16
v_rcp_f32 v17, v17
v_rcp_f32 v18, v18
v_rcp_f32 v19, v19
v_rcp_f32 v20, v20
v_rcp_f32 v21, v21
v_rcp_f32 v22, v22
v_rcp_f32 v23, v23
v_pk_mul_f32 v[228:229], v[228:229], v[16:17]
v_pk_mul_f32 v[230:231], v[230:231], v[18:19]
v_pk_mul_f32 v[244:245], v[244:245], v[20:21]
v_pk_mul_f32 v[246:247], v[246:247], v[22:23]
v_cvt_pk_bf16_f32 v28, v228, v229
v_cvt_pk_bf16_f32 v29, v230, v231
v_cvt_pk_bf16_f32 v30, v244, v245
v_cvt_pk_bf16_f32 v31, v246, v247
s_mov_b32 s27, 119808
buffer_store_dwordx4 v[28:31], v5, s[56:59], s27 offen
v_pk_fma_f32 v[232:233], v[232:233], v[58:59], v[8:9] op_sel_hi:[1,0,1]
v_pk_fma_f32 v[234:235], v[234:235], v[58:59], v[10:11] op_sel_hi:[1,0,1]
v_pk_fma_f32 v[248:249], v[248:249], v[58:59], v[12:13] op_sel_hi:[1,0,1]
v_pk_fma_f32 v[250:251], v[250:251], v[58:59], v[14:15] op_sel_hi:[1,0,1]
v_pk_mul_f32 v[16:17], v[232:233], v[232:233]
v_pk_mul_f32 v[18:19], v[234:235], v[234:235]
v_pk_mul_f32 v[20:21], v[248:249], v[248:249]
v_pk_mul_f32 v[22:23], v[250:251], v[250:251]
v_pk_fma_f32 v[16:17], v[16:17], s[30:31], v[6:7]
v_pk_fma_f32 v[18:19], v[18:19], s[30:31], v[6:7]
v_pk_fma_f32 v[20:21], v[20:21], s[30:31], v[6:7]
v_pk_fma_f32 v[22:23], v[22:23], s[30:31], v[6:7]
v_pk_mul_f32 v[16:17], v[16:17], v[232:233]
v_pk_mul_f32 v[18:19], v[18:19], v[234:235]
v_pk_mul_f32 v[20:21], v[20:21], v[248:249]
v_pk_mul_f32 v[22:23], v[22:23], v[250:251]
v_exp_f32 v16, v16
v_exp_f32 v17, v17
v_exp_f32 v18, v18
v_exp_f32 v19, v19
v_exp_f32 v20, v20
v_exp_f32 v21, v21
v_exp_f32 v22, v22
v_exp_f32 v23, v23
v_pk_add_f32 v[16:17], v[16:17], 1.0 op_sel_hi:[1,0]
v_pk_add_f32 v[18:19], v[18:19], 1.0 op_sel_hi:[1,0]
v_pk_add_f32 v[20:21], v[20:21], 1.0 op_sel_hi:[1,0]
v_pk_add_f32 v[22:23], v[22:23], 1.0 op_sel_hi:[1,0]
v_rcp_f32 v16, v16
v_rcp_f32 v17, v17
v_rcp_f32 v18, v18
v_rcp_f32 v19, v19
v_rcp_f32 v20, v20
v_rcp_f32 v21, v21
v_rcp_f32 v22, v22
v_rcp_f32 v23, v23
v_pk_mul_f32 v[232:233], v[232:233], v[16:17]
v_pk_mul_f32 v[234:235], v[234:235], v[18:19]
v_pk_mul_f32 v[248:249], v[248:249], v[20:21]
v_pk_mul_f32 v[250:251], v[250:251], v[22:23]
v_cvt_pk_bf16_f32 v24, v232, v233
v_cvt_pk_bf16_f32 v25, v234, v235
v_cvt_pk_bf16_f32 v26, v248, v249
v_cvt_pk_bf16_f32 v27, v250, v251
s_mov_b32 s27, 234496
buffer_store_dwordx4 v[24:27], v5, s[56:59], s27 offen
v_pk_fma_f32 v[236:237], v[236:237], v[58:59], v[8:9] op_sel:[0,1,0] op_sel_hi:[1,1,1]
v_pk_fma_f32 v[238:239], v[238:239], v[58:59], v[10:11] op_sel:[0,1,0] op_sel_hi:[1,1,1]
v_pk_fma_f32 v[252:253], v[252:253], v[58:59], v[12:13] op_sel:[0,1,0] op_sel_hi:[1,1,1]
v_pk_fma_f32 v[254:255], v[254:255], v[58:59], v[14:15] op_sel:[0,1,0] op_sel_hi:[1,1,1]
v_pk_mul_f32 v[16:17], v[236:237], v[236:237]
v_pk_mul_f32 v[18:19], v[238:239], v[238:239]
v_pk_mul_f32 v[20:21], v[252:253], v[252:253]
v_pk_mul_f32 v[22:23], v[254:255], v[254:255]
v_pk_fma_f32 v[16:17], v[16:17], s[30:31], v[6:7]
v_pk_fma_f32 v[18:19], v[18:19], s[30:31], v[6:7]
v_pk_fma_f32 v[20:21], v[20:21], s[30:31], v[6:7]
v_pk_fma_f32 v[22:23], v[22:23], s[30:31], v[6:7]
v_pk_mul_f32 v[16:17], v[16:17], v[236:237]
v_pk_mul_f32 v[18:19], v[18:19], v[238:239]
v_pk_mul_f32 v[20:21], v[20:21], v[252:253]
v_pk_mul_f32 v[22:23], v[22:23], v[254:255]
v_exp_f32 v16, v16
v_exp_f32 v17, v17
v_exp_f32 v18, v18
v_exp_f32 v19, v19
v_exp_f32 v20, v20
v_exp_f32 v21, v21
v_exp_f32 v22, v22
v_exp_f32 v23, v23
v_pk_add_f32 v[16:17], v[16:17], 1.0 op_sel_hi:[1,0]
v_pk_add_f32 v[18:19], v[18:19], 1.0 op_sel_hi:[1,0]
v_pk_add_f32 v[20:21], v[20:21], 1.0 op_sel_hi:[1,0]
v_pk_add_f32 v[22:23], v[22:23], 1.0 op_sel_hi:[1,0]
v_rcp_f32 v16, v16
v_rcp_f32 v17, v17
v_rcp_f32 v18, v18
v_rcp_f32 v19, v19
v_rcp_f32 v20, v20
v_rcp_f32 v21, v21
v_rcp_f32 v22, v22
v_rcp_f32 v23, v23
v_pk_mul_f32 v[236:237], v[236:237], v[16:17]
v_pk_mul_f32 v[238:239], v[238:239], v[18:19]
v_pk_mul_f32 v[252:253], v[252:253], v[20:21]
v_pk_mul_f32 v[254:255], v[254:255], v[22:23]
v_cvt_pk_bf16_f32 v28, v236, v237
v_cvt_pk_bf16_f32 v29, v238, v239
v_cvt_pk_bf16_f32 v30, v252, v253
v_cvt_pk_bf16_f32 v31, v254, v255
s_mov_b32 s27, 349184
buffer_store_dwordx4 v[28:31], v5, s[56:59], s27 offen
s_endpgm
L_gemm1_kernel_w8:
s_lshl_b32 s26, s12, 7
s_add_u32 s26, s26, 3072
s_lshl_b32 s18, s26, 1
v_and_b32 v2, 63, v0
v_lshlrev_b32 v8, 4, v2
v_add_u32 v9, 32768, v8
v_add_u32 v10, 65536, v8
v_add_u32 v11, 98304, v8
s_mov_b32 s45, 7168
v_and_b32 v2, 63, v0
v_lshrrev_b32 v3, 4, v2
s_mul_i32 s46, s40, 4
v_add_u32 v3, s46, v3
v_and_b32 v2, 15, v2
v_and_b32 v4, 7, v3
v_lshlrev_b32 v4, 1, v4
v_xor_b32 v2, v2, v4
v_lshlrev_b32 v2, 4, v2
v_bfe_u32 v4, v3, 2, 2
v_lshrrev_b32 v5, 4, v3
v_and_b32 v3, 3, v3
v_lshl_add_u32 v3, v4, 3, v3
v_lshl_add_u32 v3, v5, 2, v3
v_mul_lo_u32 v3, v3, s45
v_add_u32 v12, v2, v3
v_add_u32 v13, 28672, v12
s_lshl_b32 s43, s40, 10
s_mov_b32 s41, 0
s_mov_b32 s42, 0
s_waitcnt lgkmcnt(0)
s_add_u32 s52, s8, s18
s_addc_u32 s53, s9, 0
s_and_b32 s53, s53, 0xffff
s_sub_u32 s54, 0x700000, s18
s_mov_b32 s55, 0x20000
s_lshl_b32 s17, s16, 15
s_add_u32 s48, s6, s17
s_addc_u32 s49, s7, 0
s_and_b32 s49, s49, 0xffff
s_mov_b32 s50, 131072
s_mov_b32 s51, 0x20000
s_add_u32 s60, s6, 0x3c00000
s_addc_u32 s61, s7, 0
s_and_b32 s61, s61, 0xffff
s_mov_b32 s62, 0x2000
s_mov_b32 s63, 0x20000
s_mov_b32 s64, s10
s_and_b32 s65, s11, 0xffff
s_mov_b32 s66, 0x1c00
s_mov_b32 s67, 0x20000
v_and_b32 v4, 15, v0
s_lshl_b32 s17, s16, 6
v_lshlrev_b32 v60, 2, v4
v_add_u32 v60, s17, v60
v_bfe_u32 v61, v0, 4, 2
v_lshlrev_b32 v61, 3, v61
v_add_u32 v61, s18, v61
s_add_u32 m0, s43, 0
s_nop 0
buffer_load_dwordx4 v12, s[52:55], s42 offen lds
s_add_u32 m0, s43, 4096
s_nop 0
buffer_load_dwordx4 v13, s[52:55], s42 offen lds
s_add_u32 s42, s42, 229376
s_add_u32 m0, s43, 8192
s_nop 0
buffer_load_dwordx4 v12, s[52:55], s42 offen lds
s_add_u32 m0, s43, 12288
s_nop 0
buffer_load_dwordx4 v13, s[52:55], s42 offen lds
s_add_u32 s42, s42, 229376
s_mov_b32 s68, s6
s_and_b32 s69, s7, 0xffff
s_mov_b32 s70, 0x400000
s_mov_b32 s71, 0x20000
s_add_u32 s60, s6, 0x3c00000
s_addc_u32 s61, s7, 0
s_and_b32 s61, s61, 0xffff
s_mov_b32 s62, 0x2000
s_mov_b32 s63, 0x20000
s_mov_b32 s72, s34
s_and_b32 s73, s35, 0xffff
s_mov_b32 s74, 0x100
s_mov_b32 s75, 0x20000
s_lshr_b32 s36, s47, 1
s_lshl_b32 s36, s36, 15
s_and_b32 s37, s47, 1
s_lshl_b32 s37, s37, 7
s_add_u32 s36, s36, s37
v_lshrrev_b32 v193, 2, v197
v_lshlrev_b32 v193, 10, v193
v_and_b32 v198, 3, v197
v_lshl_add_u32 v193, v198, 8, v193
v_lshl_add_u32 v193, v196, 4, v193
v_add_u32 v193, s36, v193
v_lshrrev_b32 v194, 6, v0
v_lshl_add_u32 v194, v194, 3, v196
v_lshlrev_b32 v194, 2, v194
v_add_u32 v194, 131072, v194
v_lshlrev_b32 v195, 2, v196
v_add_u32 v195, 131072, v195
s_waitcnt vmcnt(8)
v_lshlrev_b32 v80, 16, v64
v_and_b32 v81, 0xffff0000, v64
v_lshlrev_b32 v82, 16, v65
v_and_b32 v83, 0xffff0000, v65
v_lshlrev_b32 v84, 16, v66
v_and_b32 v85, 0xffff0000, v66
v_lshlrev_b32 v86, 16, v67
v_and_b32 v87, 0xffff0000, v67
s_waitcnt vmcnt(7)
v_lshlrev_b32 v88, 16, v68
v_and_b32 v89, 0xffff0000, v68
v_lshlrev_b32 v90, 16, v69
v_and_b32 v91, 0xffff0000, v69
v_lshlrev_b32 v92, 16, v70
v_and_b32 v93, 0xffff0000, v70
v_lshlrev_b32 v94, 16, v71
v_and_b32 v95, 0xffff0000, v71
s_waitcnt vmcnt(6)
v_lshlrev_b32 v96, 16, v72
v_and_b32 v97, 0xffff0000, v72
v_lshlrev_b32 v98, 16, v73
v_and_b32 v99, 0xffff0000, v73
v_lshlrev_b32 v100, 16, v74
v_and_b32 v101, 0xffff0000, v74
v_lshlrev_b32 v102, 16, v75
v_and_b32 v103, 0xffff0000, v75
s_waitcnt vmcnt(5)
v_lshlrev_b32 v104, 16, v76
v_and_b32 v105, 0xffff0000, v76
v_lshlrev_b32 v106, 16, v77
v_and_b32 v107, 0xffff0000, v77
v_lshlrev_b32 v108, 16, v78
v_and_b32 v109, 0xffff0000, v78
v_lshlrev_b32 v110, 16, v79
v_and_b32 v111, 0xffff0000, v79
v_pk_mul_f32 v[144:145], v[80:81], v[80:81]
v_pk_mul_f32 v[146:147], v[82:83], v[82:83]
v_pk_mul_f32 v[148:149], v[84:85], v[84:85]
v_pk_mul_f32 v[150:151], v[86:87], v[86:87]
v_pk_fma_f32 v[144:145], v[88:89], v[88:89], v[144:145]
v_pk_fma_f32 v[146:147], v[90:91], v[90:91], v[146:147]
v_pk_fma_f32 v[148:149], v[92:93], v[92:93], v[148:149]
v_pk_fma_f32 v[150:151], v[94:95], v[94:95], v[150:151]
v_pk_fma_f32 v[144:145], v[96:97], v[96:97], v[144:145]
v_pk_fma_f32 v[146:147], v[98:99], v[98:99], v[146:147]
v_pk_fma_f32 v[148:149], v[100:101], v[100:101], v[148:149]
v_pk_fma_f32 v[150:151], v[102:103], v[102:103], v[150:151]
v_pk_fma_f32 v[144:145], v[104:105], v[104:105], v[144:145]
v_pk_fma_f32 v[146:147], v[106:107], v[106:107], v[146:147]
v_pk_fma_f32 v[148:149], v[108:109], v[108:109], v[148:149]
v_pk_fma_f32 v[150:151], v[110:111], v[110:111], v[150:151]
v_pk_add_f32 v[112:113], v[80:81], v[82:83]
v_pk_add_f32 v[114:115], v[84:85], v[86:87]
v_pk_add_f32 v[116:117], v[88:89], v[90:91]
v_pk_add_f32 v[118:119], v[92:93], v[94:95]
v_pk_add_f32 v[120:121], v[96:97], v[98:99]
v_pk_add_f32 v[122:123], v[100:101], v[102:103]
v_pk_add_f32 v[124:125], v[104:105], v[106:107]
v_pk_add_f32 v[126:127], v[108:109], v[110:111]
v_pk_add_f32 v[128:129], v[112:113], v[114:115]
v_pk_add_f32 v[130:131], v[116:117], v[118:119]
v_pk_add_f32 v[132:133], v[120:121], v[122:123]
v_pk_add_f32 v[134:135], v[124:125], v[126:127]
v_pk_add_f32 v[136:137], v[128:129], v[130:131]
v_pk_add_f32 v[138:139], v[132:133], v[134:135]
v_pk_add_f32 v[140:141], v[136:137], v[138:139]
v_add_f32 v200, v140, v141
v_pk_add_f32 v[152:153], v[144:145], v[146:147]
v_pk_add_f32 v[154:155], v[148:149], v[150:151]
v_pk_add_f32 v[156:157], v[152:153], v[154:155]
v_add_f32 v201, v156, v157
s_nop 1
v_add_f32_dpp v200, v200, v200 row_ror:8 row_mask:0xf bank_mask:0xf
v_add_f32_dpp v201, v201, v201 row_ror:8 row_mask:0xf bank_mask:0xf
v_mov_b32 v208, v200
v_mov_b32 v212, v201
s_nop 1
v_permlane16_swap_b32 v200, v208
v_permlane16_swap_b32 v201, v212
s_nop 1
v_add_f32 v200, v200, v208
v_add_f32 v201, v201, v212
v_mov_b32 v208, v200
v_mov_b32 v212, v201
s_nop 1
v_permlane32_swap_b32 v200, v208
v_permlane32_swap_b32 v201, v212
s_nop 1
v_add_f32 v200, v200, v208
v_add_f32 v201, v201, v212
v_lshlrev_b32 v194, 1, v194
v_subrev_u32 v194, 131072, v194
v_lshlrev_b32 v195, 1, v195
v_subrev_u32 v195, 131072, v195
ds_write_b64 v194, v[200:201]
s_waitcnt lgkmcnt(0)
s_barrier
ds_read_b64 v[112:113], v195 offset:0
ds_read_b64 v[114:115], v195 offset:64
ds_read_b64 v[116:117], v195 offset:128
ds_read_b64 v[118:119], v195 offset:192
s_waitcnt lgkmcnt(0)
v_pk_add_f32 v[112:113], v[112:113], v[114:115]
v_pk_add_f32 v[116:117], v[116:117], v[118:119]
v_pk_add_f32 v[112:113], v[112:113], v[116:117]
v_mul_f32 v112, 0x3a800000, v112
v_mul_f32 v200, 0x3a800000, v113
v_fma_f32 v200, -v112, v112, v200
v_max_f32 v200, 0, v200
v_add_f32 v206, 0x3727c5ac, v200
v_rsq_f32 v206, v206
s_nop 0
v_mul_f32 v210, 0x3f014852, v206
v_mul_f32 v211, -v112, v210
v_pk_fma_f32 v[80:81], v[80:81], v[210:211], v[210:211] op_sel:[0,0,1] op_sel_hi:[1,0,1]
v_pk_fma_f32 v[82:83], v[82:83], v[210:211], v[210:211] op_sel:[0,0,1] op_sel_hi:[1,0,1]
v_pk_fma_f32 v[84:85], v[84:85], v[210:211], v[210:211] op_sel:[0,0,1] op_sel_hi:[1,0,1]
v_pk_fma_f32 v[86:87], v[86:87], v[210:211], v[210:211] op_sel:[0,0,1] op_sel_hi:[1,0,1]
v_pk_fma_f32 v[88:89], v[88:89], v[210:211], v[210:211] op_sel:[0,0,1] op_sel_hi:[1,0,1]
v_pk_fma_f32 v[90:91], v[90:91], v[210:211], v[210:211] op_sel:[0,0,1] op_sel_hi:[1,0,1]
v_pk_fma_f32 v[92:93], v[92:93], v[210:211], v[210:211] op_sel:[0,0,1] op_sel_hi:[1,0,1]
v_pk_fma_f32 v[94:95], v[94:95], v[210:211], v[210:211] op_sel:[0,0,1] op_sel_hi:[1,0,1]
v_pk_fma_f32 v[96:97], v[96:97], v[210:211], v[210:211] op_sel:[0,0,1] op_sel_hi:[1,0,1]
v_pk_fma_f32 v[98:99], v[98:99], v[210:211], v[210:211] op_sel:[0,0,1] op_sel_hi:[1,0,1]
v_pk_fma_f32 v[100:101], v[100:101], v[210:211], v[210:211] op_sel:[0,0,1] op_sel_hi:[1,0,1]
v_pk_fma_f32 v[102:103], v[102:103], v[210:211], v[210:211] op_sel:[0,0,1] op_sel_hi:[1,0,1]
v_pk_fma_f32 v[104:105], v[104:105], v[210:211], v[210:211] op_sel:[0,0,1] op_sel_hi:[1,0,1]
v_pk_fma_f32 v[106:107], v[106:107], v[210:211], v[210:211] op_sel:[0,0,1] op_sel_hi:[1,0,1]
v_pk_fma_f32 v[108:109], v[108:109], v[210:211], v[210:211] op_sel:[0,0,1] op_sel_hi:[1,0,1]
v_pk_fma_f32 v[110:111], v[110:111], v[210:211], v[210:211] op_sel:[0,0,1] op_sel_hi:[1,0,1]
v_cvt_pk_bf16_f32 v64, v80, v81
v_cvt_pk_bf16_f32 v65, v82, v83
v_cvt_pk_bf16_f32 v66, v84, v85
v_cvt_pk_bf16_f32 v67, v86, v87
v_cvt_pk_bf16_f32 v68, v88, v89
v_cvt_pk_bf16_f32 v69, v90, v91
v_cvt_pk_bf16_f32 v70, v92, v93
v_cvt_pk_bf16_f32 v71, v94, v95
v_cvt_pk_bf16_f32 v72, v96, v97
v_cvt_pk_bf16_f32 v73, v98, v99
v_cvt_pk_bf16_f32 v74, v100, v101
v_cvt_pk_bf16_f32 v75, v102, v103
v_cvt_pk_bf16_f32 v76, v104, v105
v_cvt_pk_bf16_f32 v77, v106, v107
v_cvt_pk_bf16_f32 v78, v108, v109
v_cvt_pk_bf16_f32 v79, v110, v111
s_mov_b32 s36, 8192
s_mov_b32 s37, 16384
s_mov_b32 s27, 24576
buffer_store_dwordx4 v[64:67], v193, s[68:71], 0 offen sc1
buffer_store_dwordx4 v[68:71], v193, s[68:71], s36 offen sc1
buffer_store_dwordx4 v[72:75], v193, s[68:71], s37 offen sc1
buffer_store_dwordx4 v[76:79], v193, s[68:71], s27 offen sc1
v_mul_f32 v209, v206, v206
v_mul_f32 v209, v209, v200
v_add_f32 v209, 0x3727c5ac, v209
v_rsq_f32 v209, v209
v_add_u32 v198, s3, v196
v_lshlrev_b32 v198, 2, v198
v_mul_f32 v209, 0x3ffd75e0, v209
buffer_store_dword v209, v198, s[60:63], 0 offen sc1
s_waitcnt vmcnt(0)
s_barrier
s_cmp_lg_u32 s40, 0
s_cbranch_scc1 L_gemm1_kernel_w8_ln_nosig
s_lshr_b32 s36, s47, 5
s_lshl_b32 s37, s36, 5
v_mov_b32 v6, s37
v_mov_b32 v7, 1
s_mov_b64 s[38:39], exec
s_mov_b64 exec, 1
buffer_atomic_add v7, v6, s[72:75], 0 offen sc0 sc1
s_mov_b64 exec, s[38:39]
L_gemm1_kernel_w8_ln_nosig:
s_add_u32 m0, s43, 16384
s_nop 0
buffer_load_dwordx4 v12, s[52:55], s42 offen lds
s_add_u32 m0, s43, 20480
s_nop 0
buffer_load_dwordx4 v13, s[52:55], s42 offen lds
s_add_u32 s42, s42, 229376
s_add_u32 m0, s43, 24576
s_nop 0
buffer_load_dwordx4 v12, s[52:55], s42 offen lds
s_add_u32 m0, s43, 28672
s_nop 0
buffer_load_dwordx4 v13, s[52:55], s42 offen lds
s_add_u32 s42, s42, 229376
s_add_u32 m0, s43, 32768
s_nop 0
buffer_load_dwordx4 v12, s[52:55], s42 offen lds
s_add_u32 m0, s43, 36864
s_nop 0
buffer_load_dwordx4 v13, s[52:55], s42 offen lds
s_add_u32 s42, s42, 229376
s_add_u32 m0, s43, 40960
s_nop 0
buffer_load_dwordx4 v12, s[52:55], s42 offen lds
s_add_u32 m0, s43, 45056
s_nop 0
buffer_load_dwordx4 v13, s[52:55], s42 offen lds
s_add_u32 s42, s42, 229376
v_bfe_u32 v3, v0, 2, 4
v_and_b32 v4, 7, v3
v_lshlrev_b32 v4, 5, v4
v_mul_u32_u24 v3, 256, v3
v_and_b32 v2, 3, v0
v_lshl_add_u32 v3, v2, 3, v3
v_xor_b32 v2, 0, v4
v_add_u32 v14, v2, v3
v_xor_b32 v2, 32, v4
v_add_u32 v15, v2, v3
v_xor_b32 v2, 64, v4
v_add_u32 v16, v2, v3
v_xor_b32 v2, 96, v4
v_add_u32 v17, v2, v3
v_xor_b32 v2, 128, v4
v_add_u32 v18, v2, v3
v_xor_b32 v2, 160, v4
v_add_u32 v19, v2, v3
v_xor_b32 v2, 192, v4
v_add_u32 v20, v2, v3
v_xor_b32 v2, 224, v4
v_add_u32 v21, v2, v3
s_add_u32 s28, s6, 0x3d00000
s_addc_u32 s29, s7, 0
s_and_b32 s29, s29, 0xffff
s_mov_b32 s30, 0x20000
s_mov_b32 s31, 0x20000
s_lshl_b32 s36, s2, 7
s_add_u32 s36, s36, 0x10000
v_and_b32 v5, 31, v0
v_lshlrev_b32 v5, 2, v5
v_add_u32 v5, s36, v5
s_lshl_b32 s36, s2, 6
s_add_u32 s36, s36, 4096
v_mov_b32 v3, s36
v_mov_b32 v2, 0
buffer_store_dword v2, v5, s[28:31], 0 offen
buffer_store_dword v2, v3, s[28:31], 0 offen
s_nop 0
v_mov_b32 v2, 0
v_mov_b32 v3, 0
v_mov_b32 v4, 0
v_mov_b32 v5, 0
s_nop 1
v_mfma_f32_32x32x16_bf16 v[64:79], v[2:5], v[2:5], 0
v_mfma_f32_32x32x16_bf16 v[80:95], v[2:5], v[2:5], 0
v_mfma_f32_32x32x16_bf16 v[96:111], v[2:5], v[2:5], 0
v_mfma_f32_32x32x16_bf16 v[112:127], v[2:5], v[2:5], 0
v_mfma_f32_32x32x16_bf16 v[128:143], v[2:5], v[2:5], 0
v_mfma_f32_32x32x16_bf16 v[144:159], v[2:5], v[2:5], 0
v_mfma_f32_32x32x16_bf16 v[160:175], v[2:5], v[2:5], 0
v_mfma_f32_32x32x16_bf16 v[176:191], v[2:5], v[2:5], 0
s_cmp_lg_u32 s40, 0
s_cbranch_scc1 L_gemm1_kernel_w8_ln_join
s_waitcnt vmcnt(10)
v_readfirstlane_b32 s37, v7
s_lshr_b32 s36, s47, 5
s_cmp_eq_u32 s37, 31
s_cbranch_scc0 L_gemm1_kernel_w8_ln_wait
s_lshl_b32 s36, s36, 12
s_add_u32 s36, s36, 0x8000
v_lshlrev_b32 v6, 7, v0
v_add_u32 v6, s36, v6
v_mov_b32 v7, 1
s_mov_b32 exec_hi, 0
buffer_store_dword v7, v6, s[76:79], 0 offen sc1
s_mov_b64 exec, s[38:39]
s_branch L_gemm1_kernel_w8_ln_join
L_gemm1_kernel_w8_ln_wait:
s_lshl_b32 s36, s47, 7
s_add_u32 s36, s36, 0x8000
v_mov_b32 v6, s36
s_mov_b32 s37, 0x80000
L_gemm1_kernel_w8_ln_p:
buffer_load_dword v7, v6, s[76:79], 0 offen sc1
s_waitcnt vmcnt(0)
v_readfirstlane_b32 s36, v7
s_sub_u32 s37, s37, 1
s_cbranch_scc1 L_gemm1_kernel_w8_ln_p_out
s_cmp_ge_u32 s36, 1
s_cbranch_scc1 L_gemm1_kernel_w8_ln_p_out
s_branch L_gemm1_kernel_w8_ln_p
L_gemm1_kernel_w8_ln_p_out:
L_gemm1_kernel_w8_ln_join:
s_barrier
buffer_load_dwordx4 a[0:3], v8, s[48:51], s41 offen sc1
buffer_load_dwordx4 a[4:7], v9, s[48:51], s41 offen sc1
buffer_load_dwordx4 a[8:11], v10, s[48:51], s41 offen sc1
buffer_load_dwordx4 a[12:15], v11, s[48:51], s41 offen sc1
s_add_u32 s41, s41, 1024
buffer_load_dwordx4 a[16:19], v8, s[48:51], s41 offen sc1
buffer_load_dwordx4 a[20:23], v9, s[48:51], s41 offen sc1
buffer_load_dwordx4 a[24:27], v10, s[48:51], s41 offen sc1
buffer_load_dwordx4 a[28:31], v11, s[48:51], s41 offen sc1
s_add_u32 s41, s41, 1024
buffer_load_dwordx4 a[32:35], v8, s[48:51], s41 offen sc1
buffer_load_dwordx4 a[36:39], v9, s[48:51], s41 offen sc1
buffer_load_dwordx4 a[40:43], v10, s[48:51], s41 offen sc1
buffer_load_dwordx4 a[44:47], v11, s[48:51], s41 offen sc1
s_add_u32 s41, s41, 1024
buffer_load_dword v56, v60, s[60:63], 0 offen offset:0 sc1
buffer_load_dword v57, v60, s[60:63], 0 offen offset:64 sc1
buffer_load_dword v58, v60, s[60:63], 0 offen offset:128 sc1
buffer_load_dword v59, v60, s[60:63], 0 offen offset:192 sc1
buffer_load_dwordx2 v[32:33], v61, s[64:67], 0 offen offset:0
buffer_load_dwordx2 v[34:35], v61, s[64:67], 0 offen offset:32
buffer_load_dwordx2 v[36:37], v61, s[64:67], 0 offen offset:64
buffer_load_dwordx2 v[38:39], v61, s[64:67], 0 offen offset:96
buffer_load_dwordx2 v[40:41], v61, s[64:67], 0 offen offset:128
buffer_load_dwordx2 v[42:43], v61, s[64:67], 0 offen offset:160
buffer_load_dwordx2 v[44:45], v61, s[64:67], 0 offen offset:192
buffer_load_dwordx2 v[46:47], v61, s[64:67], 0 offen offset:224
s_waitcnt vmcnt(20)
s_barrier
ds_read_b64_tr_b16 a[64:65], v14 offset:0
ds_read_b64_tr_b16 a[66:67], v14 offset:4096
ds_read_b64_tr_b16 a[68:69], v15 offset:0
ds_read_b64_tr_b16 a[70:71], v15 offset:4096
ds_read_b64_tr_b16 a[72:73], v16 offset:0
ds_read_b64_tr_b16 a[74:75], v16 offset:4096
ds_read_b64_tr_b16 a[76:77], v17 offset:0
ds_read_b64_tr_b16 a[78:79], v17 offset:4096
s_mov_b32 s44, 4
.p2align 4
L_gemm1_kernel_w8_loop0:
s_waitcnt lgkmcnt(6)
v_mfma_f32_16x16x32_bf16 v[64:67], a[64:67], a[0:3], v[64:67]
ds_read_b64_tr_b16 a[80:81], v18 offset:0
v_mfma_f32_16x16x32_bf16 v[68:71], a[64:67], a[4:7], v[68:71]
ds_read_b64_tr_b16 a[82:83], v18 offset:4096
buffer_load_dwordx4 a[48:51], v8, s[48:51], s41 offen sc1
v_mfma_f32_16x16x32_bf16 v[72:75], a[64:67], a[8:11], v[72:75]
v_mfma_f32_16x16x32_bf16 v[76:79], a[64:67], a[12:15], v[76:79]
s_waitcnt lgkmcnt(6)
v_mfma_f32_16x16x32_bf16 v[80:83], a[68:71], a[0:3], v[80:83]
ds_read_b64_tr_b16 a[84:85], v19 offset:0
v_mfma_f32_16x16x32_bf16 v[84:87], a[68:71], a[4:7], v[84:87]
ds_read_b64_tr_b16 a[86:87], v19 offset:4096
v_mfma_f32_16x16x32_bf16 v[88:91], a[68:71], a[8:11], v[88:91]
s_add_u32 m0, s43, 49152
v_mfma_f32_16x16x32_bf16 v[92:95], a[68:71], a[12:15], v[92:95]
buffer_load_dwordx4 v12, s[52:55], s42 offen lds
s_waitcnt lgkmcnt(6)
v_mfma_f32_16x16x32_bf16 v[96:99], a[72:75], a[0:3], v[96:99]
ds_read_b64_tr_b16 a[88:89], v20 offset:0
v_mfma_f32_16x16x32_bf16 v[100:103], a[72:75], a[4:7], v[100:103]
ds_read_b64_tr_b16 a[90:91], v20 offset:4096
v_mfma_f32_16x16x32_bf16 v[104:107], a[72:75], a[8:11], v[104:107]
v_mfma_f32_16x16x32_bf16 v[108:111], a[72:75], a[12:15], v[108:111]
buffer_load_dwordx4 a[52:55], v9, s[48:51], s41 offen sc1
s_waitcnt lgkmcnt(6)
v_mfma_f32_16x16x32_bf16 v[112:115], a[76:79], a[0:3], v[112:115]
ds_read_b64_tr_b16 a[92:93], v21 offset:0
v_mfma_f32_16x16x32_bf16 v[116:119], a[76:79], a[4:7], v[116:119]
ds_read_b64_tr_b16 a[94:95], v21 offset:4096
v_mfma_f32_16x16x32_bf16 v[120:123], a[76:79], a[8:11], v[120:123]
v_mfma_f32_16x16x32_bf16 v[124:127], a[76:79], a[12:15], v[124:127]
s_waitcnt lgkmcnt(6)
v_mfma_f32_16x16x32_bf16 v[128:131], a[80:83], a[0:3], v[128:131]
s_waitcnt vmcnt(9)
s_barrier
ds_read_b64_tr_b16 a[64:65], v14 offset:8192
v_mfma_f32_16x16x32_bf16 v[132:135], a[80:83], a[4:7], v[132:135]
ds_read_b64_tr_b16 a[66:67], v14 offset:12288
s_add_u32 m0, s43, 53248
v_mfma_f32_16x16x32_bf16 v[136:139], a[80:83], a[8:11], v[136:139]
buffer_load_dwordx4 v13, s[52:55], s42 offen lds
s_add_u32 s42, s42, 229376
v_mfma_f32_16x16x32_bf16 v[140:143], a[80:83], a[12:15], v[140:143]
s_waitcnt lgkmcnt(6)
v_mfma_f32_16x16x32_bf16 v[144:147], a[84:87], a[0:3], v[144:147]
ds_read_b64_tr_b16 a[68:69], v15 offset:8192
v_mfma_f32_16x16x32_bf16 v[148:151], a[84:87], a[4:7], v[148:151]
ds_read_b64_tr_b16 a[70:71], v15 offset:12288
v_mfma_f32_16x16x32_bf16 v[152:155], a[84:87], a[8:11], v[152:155]
buffer_load_dwordx4 a[56:59], v10, s[48:51], s41 offen sc1
v_mfma_f32_16x16x32_bf16 v[156:159], a[84:87], a[12:15], v[156:159]
s_waitcnt lgkmcnt(6)
v_mfma_f32_16x16x32_bf16 v[160:163], a[88:91], a[0:3], v[160:163]
ds_read_b64_tr_b16 a[72:73], v16 offset:8192
v_mfma_f32_16x16x32_bf16 v[164:167], a[88:91], a[4:7], v[164:167]
ds_read_b64_tr_b16 a[74:75], v16 offset:12288
v_mfma_f32_16x16x32_bf16 v[168:171], a[88:91], a[8:11], v[168:171]
v_mfma_f32_16x16x32_bf16 v[172:175], a[88:91], a[12:15], v[172:175]
buffer_load_dwordx4 a[60:63], v11, s[48:51], s41 offen sc1
s_add_u32 s41, s41, 1024
s_waitcnt lgkmcnt(6)
v_mfma_f32_16x16x32_bf16 v[176:179], a[92:95], a[0:3], v[176:179]
ds_read_b64_tr_b16 a[76:77], v17 offset:8192
v_mfma_f32_16x16x32_bf16 v[180:183], a[92:95], a[4:7], v[180:183]
ds_read_b64_tr_b16 a[78:79], v17 offset:12288
v_mfma_f32_16x16x32_bf16 v[184:187], a[92:95], a[8:11], v[184:187]
v_mfma_f32_16x16x32_bf16 v[188:191], a[92:95], a[12:15], v[188:191]
s_waitcnt lgkmcnt(6)
v_mfma_f32_16x16x32_bf16 v[64:67], a[64:67], a[16:19], v[64:67]
ds_read_b64_tr_b16 a[80:81], v18 offset:8192
v_mfma_f32_16x16x32_bf16 v[68:71], a[64:67], a[20:23], v[68:71]
ds_read_b64_tr_b16 a[82:83], v18 offset:12288
buffer_load_dwordx4 a[0:3], v8, s[48:51], s41 offen sc1
v_mfma_f32_16x16x32_bf16 v[72:75], a[64:67], a[24:27], v[72:75]
v_mfma_f32_16x16x32_bf16 v[76:79], a[64:67], a[28:31], v[76:79]
s_waitcnt lgkmcnt(6)
v_mfma_f32_16x16x32_bf16 v[80:83], a[68:71], a[16:19], v[80:83]
ds_read_b64_tr_b16 a[84:85], v19 offset:8192
v_mfma_f32_16x16x32_bf16 v[84:87], a[68:71], a[20:23], v[84:87]
ds_read_b64_tr_b16 a[86:87], v19 offset:12288
v_mfma_f32_16x16x32_bf16 v[88:91], a[68:71], a[24:27], v[88:91]
s_add_u32 m0, s43, 57344
v_mfma_f32_16x16x32_bf16 v[92:95], a[68:71], a[28:31], v[92:95]
buffer_load_dwordx4 v12, s[52:55], s42 offen lds
s_waitcnt lgkmcnt(6)
v_mfma_f32_16x16x32_bf16 v[96:99], a[72:75], a[16:19], v[96:99]
ds_read_b64_tr_b16 a[88:89], v20 offset:8192
v_mfma_f32_16x16x32_bf16 v[100:103], a[72:75], a[20:23], v[100:103]
ds_read_b64_tr_b16 a[90:91], v20 offset:12288
v_mfma_f32_16x16x32_bf16 v[104:107], a[72:75], a[24:27], v[104:107]
v_mfma_f32_16x16x32_bf16 v[108:111], a[72:75], a[28:31], v[108:111]
buffer_load_dwordx4 a[4:7], v9, s[48:51], s41 offen sc1
s_waitcnt lgkmcnt(6)
v_mfma_f32_16x16x32_bf16 v[112:115], a[76:79], a[16:19], v[112:115]
ds_read_b64_tr_b16 a[92:93], v21 offset:8192
v_mfma_f32_16x16x32_bf16 v[116:119], a[76:79], a[20:23], v[116:119]
ds_read_b64_tr_b16 a[94:95], v21 offset:12288
v_mfma_f32_16x16x32_bf16 v[120:123], a[76:79], a[24:27], v[120:123]
v_mfma_f32_16x16x32_bf16 v[124:127], a[76:79], a[28:31], v[124:127]
s_waitcnt lgkmcnt(6)
v_mfma_f32_16x16x32_bf16 v[128:131], a[80:83], a[16:19], v[128:131]
s_waitcnt vmcnt(9)
s_barrier
ds_read_b64_tr_b16 a[64:65], v14 offset:16384
v_mfma_f32_16x16x32_bf16 v[132:135], a[80:83], a[20:23], v[132:135]
ds_read_b64_tr_b16 a[66:67], v14 offset:20480
s_add_u32 m0, s43, 61440
v_mfma_f32_16x16x32_bf16 v[136:139], a[80:83], a[24:27], v[136:139]
buffer_load_dwordx4 v13, s[52:55], s42 offen lds
s_add_u32 s42, s42, 229376
v_mfma_f32_16x16x32_bf16 v[140:143], a[80:83], a[28:31], v[140:143]
s_waitcnt lgkmcnt(6)
v_mfma_f32_16x16x32_bf16 v[144:147], a[84:87], a[16:19], v[144:147]
ds_read_b64_tr_b16 a[68:69], v15 offset:16384
v_mfma_f32_16x16x32_bf16 v[148:151], a[84:87], a[20:23], v[148:151]
ds_read_b64_tr_b16 a[70:71], v15 offset:20480
v_mfma_f32_16x16x32_bf16 v[152:155], a[84:87], a[24:27], v[152:155]
buffer_load_dwordx4 a[8:11], v10, s[48:51], s41 offen sc1
v_mfma_f32_16x16x32_bf16 v[156:159], a[84:87], a[28:31], v[156:159]
s_waitcnt lgkmcnt(6)
v_mfma_f32_16x16x32_bf16 v[160:163], a[88:91], a[16:19], v[160:163]
ds_read_b64_tr_b16 a[72:73], v16 offset:16384
v_mfma_f32_16x16x32_bf16 v[164:167], a[88:91], a[20:23], v[164:167]
ds_read_b64_tr_b16 a[74:75], v16 offset:20480
v_mfma_f32_16x16x32_bf16 v[168:171], a[88:91], a[24:27], v[168:171]
v_mfma_f32_16x16x32_bf16 v[172:175], a[88:91], a[28:31], v[172:175]
buffer_load_dwordx4 a[12:15], v11, s[48:51], s41 offen sc1
s_add_u32 s41, s41, 1024
s_waitcnt lgkmcnt(6)
v_mfma_f32_16x16x32_bf16 v[176:179], a[92:95], a[16:19], v[176:179]
ds_read_b64_tr_b16 a[76:77], v17 offset:16384
v_mfma_f32_16x16x32_bf16 v[180:183], a[92:95], a[20:23], v[180:183]
ds_read_b64_tr_b16 a[78:79], v17 offset:20480
v_mfma_f32_16x16x32_bf16 v[184:187], a[92:95], a[24:27], v[184:187]
v_mfma_f32_16x16x32_bf16 v[188:191], a[92:95], a[28:31], v[188:191]
s_waitcnt lgkmcnt(6)
v_mfma_f32_16x16x32_bf16 v[64:67], a[64:67], a[32:35], v[64:67]
ds_read_b64_tr_b16 a[80:81], v18 offset:16384
v_mfma_f32_16x16x32_bf16 v[68:71], a[64:67], a[36:39], v[68:71]
ds_read_b64_tr_b16 a[82:83], v18 offset:20480
buffer_load_dwordx4 a[16:19], v8, s[48:51], s41 offen sc1
v_mfma_f32_16x16x32_bf16 v[72:75], a[64:67], a[40:43], v[72:75]
v_mfma_f32_16x16x32_bf16 v[76:79], a[64:67], a[44:47], v[76:79]
s_waitcnt lgkmcnt(6)
v_mfma_f32_16x16x32_bf16 v[80:83], a[68:71], a[32:35], v[80:83]
ds_read_b64_tr_b16 a[84:85], v19 offset:16384
v_mfma_f32_16x16x32_bf16 v[84:87], a[68:71], a[36:39], v[84:87]
ds_read_b64_tr_b16 a[86:87], v19 offset:20480
v_mfma_f32_16x16x32_bf16 v[88:91], a[68:71], a[40:43], v[88:91]
s_add_u32 m0, s43, 0
v_mfma_f32_16x16x32_bf16 v[92:95], a[68:71], a[44:47], v[92:95]
buffer_load_dwordx4 v12, s[52:55], s42 offen lds
s_waitcnt lgkmcnt(6)
v_mfma_f32_16x16x32_bf16 v[96:99], a[72:75], a[32:35], v[96:99]
ds_read_b64_tr_b16 a[88:89], v20 offset:16384
v_mfma_f32_16x16x32_bf16 v[100:103], a[72:75], a[36:39], v[100:103]
ds_read_b64_tr_b16 a[90:91], v20 offset:20480
v_mfma_f32_16x16x32_bf16 v[104:107], a[72:75], a[40:43], v[104:107]
v_mfma_f32_16x16x32_bf16 v[108:111], a[72:75], a[44:47], v[108:111]
buffer_load_dwordx4 a[20:23], v9, s[48:51], s41 offen sc1
s_waitcnt lgkmcnt(6)
v_mfma_f32_16x16x32_bf16 v[112:115], a[76:79], a[32:35], v[112:115]
ds_read_b64_tr_b16 a[92:93], v21 offset:16384
v_mfma_f32_16x16x32_bf16 v[116:119], a[76:79], a[36:39], v[116:119]
ds_read_b64_tr_b16 a[94:95], v21 offset:20480
v_mfma_f32_16x16x32_bf16 v[120:123], a[76:79], a[40:43], v[120:123]
v_mfma_f32_16x16x32_bf16 v[124:127], a[76:79], a[44:47], v[124:127]
s_waitcnt lgkmcnt(6)
v_mfma_f32_16x16x32_bf16 v[128:131], a[80:83], a[32:35], v[128:131]
s_waitcnt vmcnt(9)
s_barrier
ds_read_b64_tr_b16 a[64:65], v14 offset:24576
v_mfma_f32_16x16x32_bf16 v[132:135], a[80:83], a[36:39], v[132:135]
ds_read_b64_tr_b16 a[66:67], v14 offset:28672
s_add_u32 m0, s43, 4096
v_mfma_f32_16x16x32_bf16 v[136:139], a[80:83], a[40:43], v[136:139]
buffer_load_dwordx4 v13, s[52:55], s42 offen lds
s_add_u32 s42, s42, 229376
v_mfma_f32_16x16x32_bf16 v[140:143], a[80:83], a[44:47], v[140:143]
s_waitcnt lgkmcnt(6)
v_mfma_f32_16x16x32_bf16 v[144:147], a[84:87], a[32:35], v[144:147]
ds_read_b64_tr_b16 a[68:69], v15 offset:24576
v_mfma_f32_16x16x32_bf16 v[148:151], a[84:87], a[36:39], v[148:151]
ds_read_b64_tr_b16 a[70:71], v15 offset:28672
v_mfma_f32_16x16x32_bf16 v[152:155], a[84:87], a[40:43], v[152:155]
buffer_load_dwordx4 a[24:27], v10, s[48:51], s41 offen sc1
v_mfma_f32_16x16x32_bf16 v[156:159], a[84:87], a[44:47], v[156:159]
s_waitcnt lgkmcnt(6)
v_mfma_f32_16x16x32_bf16 v[160:163], a[88:91], a[32:35], v[160:163]
ds_read_b64_tr_b16 a[72:73], v16 offset:24576
v_mfma_f32_16x16x32_bf16 v[164:167], a[88:91], a[36:39], v[164:167]
ds_read_b64_tr_b16 a[74:75], v16 offset:28672
v_mfma_f32_16x16x32_bf16 v[168:171], a[88:91], a[40:43], v[168:171]
v_mfma_f32_16x16x32_bf16 v[172:175], a[88:91], a[44:47], v[172:175]
buffer_load_dwordx4 a[28:31], v11, s[48:51], s41 offen sc1
s_add_u32 s41, s41, 1024
s_waitcnt lgkmcnt(6)
v_mfma_f32_16x16x32_bf16 v[176:179], a[92:95], a[32:35], v[176:179]
ds_read_b64_tr_b16 a[76:77], v17 offset:24576
v_mfma_f32_16x16x32_bf16 v[180:183], a[92:95], a[36:39], v[180:183]
ds_read_b64_tr_b16 a[78:79], v17 offset:28672
v_mfma_f32_16x16x32_bf16 v[184:187], a[92:95], a[40:43], v[184:187]
v_mfma_f32_16x16x32_bf16 v[188:191], a[92:95], a[44:47], v[188:191]
s_waitcnt lgkmcnt(6)
v_mfma_f32_16x16x32_bf16 v[64:67], a[64:67], a[48:51], v[64:67]
ds_read_b64_tr_b16 a[80:81], v18 offset:24576
v_mfma_f32_16x16x32_bf16 v[68:71], a[64:67], a[52:55], v[68:71]
ds_read_b64_tr_b16 a[82:83], v18 offset:28672
buffer_load_dwordx4 a[32:35], v8, s[48:51], s41 offen sc1
v_mfma_f32_16x16x32_bf16 v[72:75], a[64:67], a[56:59], v[72:75]
v_mfma_f32_16x16x32_bf16 v[76:79], a[64:67], a[60:63], v[76:79]
s_waitcnt lgkmcnt(6)
v_mfma_f32_16x16x32_bf16 v[80:83], a[68:71], a[48:51], v[80:83]
ds_read_b64_tr_b16 a[84:85], v19 offset:24576
v_mfma_f32_16x16x32_bf16 v[84:87], a[68:71], a[52:55], v[84:87]
ds_read_b64_tr_b16 a[86:87], v19 offset:28672
v_mfma_f32_16x16x32_bf16 v[88:91], a[68:71], a[56:59], v[88:91]
s_add_u32 m0, s43, 8192
v_mfma_f32_16x16x32_bf16 v[92:95], a[68:71], a[60:63], v[92:95]
buffer_load_dwordx4 v12, s[52:55], s42 offen lds
s_waitcnt lgkmcnt(6)
v_mfma_f32_16x16x32_bf16 v[96:99], a[72:75], a[48:51], v[96:99]
ds_read_b64_tr_b16 a[88:89], v20 offset:24576
v_mfma_f32_16x16x32_bf16 v[100:103], a[72:75], a[52:55], v[100:103]
ds_read_b64_tr_b16 a[90:91], v20 offset:28672
v_mfma_f32_16x16x32_bf16 v[104:107], a[72:75], a[56:59], v[104:107]
v_mfma_f32_16x16x32_bf16 v[108:111], a[72:75], a[60:63], v[108:111]
buffer_load_dwordx4 a[36:39], v9, s[48:51], s41 offen sc1
s_waitcnt lgkmcnt(6)
v_mfma_f32_16x16x32_bf16 v[112:115], a[76:79], a[48:51], v[112:115]
ds_read_b64_tr_b16 a[92:93], v21 offset:24576
v_mfma_f32_16x16x32_bf16 v[116:119], a[76:79], a[52:55], v[116:119]
ds_read_b64_tr_b16 a[94:95], v21 offset:28672
v_mfma_f32_16x16x32_bf16 v[120:123], a[76:79], a[56:59], v[120:123]
v_mfma_f32_16x16x32_bf16 v[124:127], a[76:79], a[60:63], v[124:127]
s_waitcnt lgkmcnt(6)
v_mfma_f32_16x16x32_bf16 v[128:131], a[80:83], a[48:51], v[128:131]
s_waitcnt vmcnt(9)
s_barrier
ds_read_b64_tr_b16 a[64:65], v14 offset:32768
v_mfma_f32_16x16x32_bf16 v[132:135], a[80:83], a[52:55], v[132:135]
ds_read_b64_tr_b16 a[66:67], v14 offset:36864
s_add_u32 m0, s43, 12288
v_mfma_f32_16x16x32_bf16 v[136:139], a[80:83], a[56:59], v[136:139]
buffer_load_dwordx4 v13, s[52:55], s42 offen lds
s_add_u32 s42, s42, 229376
v_mfma_f32_16x16x32_bf16 v[140:143], a[80:83], a[60:63], v[140:143]
s_waitcnt lgkmcnt(6)
v_mfma_f32_16x16x32_bf16 v[144:147], a[84:87], a[48:51], v[144:147]
ds_read_b64_tr_b16 a[68:69], v15 offset:32768
v_mfma_f32_16x16x32_bf16 v[148:151], a[84:87], a[52:55], v[148:151]
ds_read_b64_tr_b16 a[70:71], v15 offset:36864
v_mfma_f32_16x16x32_bf16 v[152:155], a[84:87], a[56:59], v[152:155]
buffer_load_dwordx4 a[40:43], v10, s[48:51], s41 offen sc1
v_mfma_f32_16x16x32_bf16 v[156:159], a[84:87], a[60:63], v[156:159]
s_waitcnt lgkmcnt(6)
v_mfma_f32_16x16x32_bf16 v[160:163], a[88:91], a[48:51], v[160:163]
ds_read_b64_tr_b16 a[72:73], v16 offset:32768
v_mfma_f32_16x16x32_bf16 v[164:167], a[88:91], a[52:55], v[164:167]
ds_read_b64_tr_b16 a[74:75], v16 offset:36864
v_mfma_f32_16x16x32_bf16 v[168:171], a[88:91], a[56:59], v[168:171]
v_mfma_f32_16x16x32_bf16 v[172:175], a[88:91], a[60:63], v[172:175]
buffer_load_dwordx4 a[44:47], v11, s[48:51], s41 offen sc1
s_add_u32 s41, s41, 1024
s_waitcnt lgkmcnt(6)
v_mfma_f32_16x16x32_bf16 v[176:179], a[92:95], a[48:51], v[176:179]
ds_read_b64_tr_b16 a[76:77], v17 offset:32768
v_mfma_f32_16x16x32_bf16 v[180:183], a[92:95], a[52:55], v[180:183]
ds_read_b64_tr_b16 a[78:79], v17 offset:36864
v_mfma_f32_16x16x32_bf16 v[184:187], a[92:95], a[56:59], v[184:187]
v_mfma_f32_16x16x32_bf16 v[188:191], a[92:95], a[60:63], v[188:191]
s_waitcnt lgkmcnt(6)
v_mfma_f32_16x16x32_bf16 v[64:67], a[64:67], a[0:3], v[64:67]
ds_read_b64_tr_b16 a[80:81], v18 offset:32768
v_mfma_f32_16x16x32_bf16 v[68:71], a[64:67], a[4:7], v[68:71]
ds_read_b64_tr_b16 a[82:83], v18 offset:36864
buffer_load_dwordx4 a[48:51], v8, s[48:51], s41 offen sc1
v_mfma_f32_16x16x32_bf16 v[72:75], a[64:67], a[8:11], v[72:75]
v_mfma_f32_16x16x32_bf16 v[76:79], a[64:67], a[12:15], v[76:79]
s_waitcnt lgkmcnt(6)
v_mfma_f32_16x16x32_bf16 v[80:83], a[68:71], a[0:3], v[80:83]
ds_read_b64_tr_b16 a[84:85], v19 offset:32768
v_mfma_f32_16x16x32_bf16 v[84:87], a[68:71], a[4:7], v[84:87]
ds_read_b64_tr_b16 a[86:87], v19 offset:36864
v_mfma_f32_16x16x32_bf16 v[88:91], a[68:71], a[8:11], v[88:91]
s_add_u32 m0, s43, 16384
v_mfma_f32_16x16x32_bf16 v[92:95], a[68:71], a[12:15], v[92:95]
buffer_load_dwordx4 v12, s[52:55], s42 offen lds
s_waitcnt lgkmcnt(6)
v_mfma_f32_16x16x32_bf16 v[96:99], a[72:75], a[0:3], v[96:99]
ds_read_b64_tr_b16 a[88:89], v20 offset:32768
v_mfma_f32_16x16x32_bf16 v[100:103], a[72:75], a[4:7], v[100:103]
ds_read_b64_tr_b16 a[90:91], v20 offset:36864
v_mfma_f32_16x16x32_bf16 v[104:107], a[72:75], a[8:11], v[104:107]
v_mfma_f32_16x16x32_bf16 v[108:111], a[72:75], a[12:15], v[108:111]
buffer_load_dwordx4 a[52:55], v9, s[48:51], s41 offen sc1
s_waitcnt lgkmcnt(6)
v_mfma_f32_16x16x32_bf16 v[112:115], a[76:79], a[0:3], v[112:115]
ds_read_b64_tr_b16 a[92:93], v21 offset:32768
v_mfma_f32_16x16x32_bf16 v[116:119], a[76:79], a[4:7], v[116:119]
ds_read_b64_tr_b16 a[94:95], v21 offset:36864
v_mfma_f32_16x16x32_bf16 v[120:123], a[76:79], a[8:11], v[120:123]
v_mfma_f32_16x16x32_bf16 v[124:127], a[76:79], a[12:15], v[124:127]
s_waitcnt lgkmcnt(6)
v_mfma_f32_16x16x32_bf16 v[128:131], a[80:83], a[0:3], v[128:131]
s_waitcnt vmcnt(9)
s_barrier
ds_read_b64_tr_b16 a[64:65], v14 offset:40960
v_mfma_f32_16x16x32_bf16 v[132:135], a[80:83], a[4:7], v[132:135]
ds_read_b64_tr_b16 a[66:67], v14 offset:45056
s_add_u32 m0, s43, 20480
v_mfma_f32_16x16x32_bf16 v[136:139], a[80:83], a[8:11], v[136:139]
buffer_load_dwordx4 v13, s[52:55], s42 offen lds
s_add_u32 s42, s42, 229376
v_mfma_f32_16x16x32_bf16 v[140:143], a[80:83], a[12:15], v[140:143]
s_waitcnt lgkmcnt(6)
v_mfma_f32_16x16x32_bf16 v[144:147], a[84:87], a[0:3], v[144:147]
ds_read_b64_tr_b16 a[68:69], v15 offset:40960
v_mfma_f32_16x16x32_bf16 v[148:151], a[84:87], a[4:7], v[148:151]
ds_read_b64_tr_b16 a[70:71], v15 offset:45056
v_mfma_f32_16x16x32_bf16 v[152:155], a[84:87], a[8:11], v[152:155]
buffer_load_dwordx4 a[56:59], v10, s[48:51], s41 offen sc1
v_mfma_f32_16x16x32_bf16 v[156:159], a[84:87], a[12:15], v[156:159]
s_waitcnt lgkmcnt(6)
v_mfma_f32_16x16x32_bf16 v[160:163], a[88:91], a[0:3], v[160:163]
ds_read_b64_tr_b16 a[72:73], v16 offset:40960
v_mfma_f32_16x16x32_bf16 v[164:167], a[88:91], a[4:7], v[164:167]
ds_read_b64_tr_b16 a[74:75], v16 offset:45056
v_mfma_f32_16x16x32_bf16 v[168:171], a[88:91], a[8:11], v[168:171]
v_mfma_f32_16x16x32_bf16 v[172:175], a[88:91], a[12:15], v[172:175]
buffer_load_dwordx4 a[60:63], v11, s[48:51], s41 offen sc1
s_add_u32 s41, s41, 1024
s_waitcnt lgkmcnt(6)
v_mfma_f32_16x16x32_bf16 v[176:179], a[92:95], a[0:3], v[176:179]
ds_read_b64_tr_b16 a[76:77], v17 offset:40960
v_mfma_f32_16x16x32_bf16 v[180:183], a[92:95], a[4:7], v[180:183]
ds_read_b64_tr_b16 a[78:79], v17 offset:45056
v_mfma_f32_16x16x32_bf16 v[184:187], a[92:95], a[8:11], v[184:187]
v_mfma_f32_16x16x32_bf16 v[188:191], a[92:95], a[12:15], v[188:191]
s_waitcnt lgkmcnt(6)
v_mfma_f32_16x16x32_bf16 v[64:67], a[64:67], a[16:19], v[64:67]
ds_read_b64_tr_b16 a[80:81], v18 offset:40960
v_mfma_f32_16x16x32_bf16 v[68:71], a[64:67], a[20:23], v[68:71]
ds_read_b64_tr_b16 a[82:83], v18 offset:45056
buffer_load_dwordx4 a[0:3], v8, s[48:51], s41 offen sc1
v_mfma_f32_16x16x32_bf16 v[72:75], a[64:67], a[24:27], v[72:75]
v_mfma_f32_16x16x32_bf16 v[76:79], a[64:67], a[28:31], v[76:79]
s_waitcnt lgkmcnt(6)
v_mfma_f32_16x16x32_bf16 v[80:83], a[68:71], a[16:19], v[80:83]
ds_read_b64_tr_b16 a[84:85], v19 offset:40960
v_mfma_f32_16x16x32_bf16 v[84:87], a[68:71], a[20:23], v[84:87]
ds_read_b64_tr_b16 a[86:87], v19 offset:45056
v_mfma_f32_16x16x32_bf16 v[88:91], a[68:71], a[24:27], v[88:91]
s_add_u32 m0, s43, 24576
v_mfma_f32_16x16x32_bf16 v[92:95], a[68:71], a[28:31], v[92:95]
buffer_load_dwordx4 v12, s[52:55], s42 offen lds
s_waitcnt lgkmcnt(6)
v_mfma_f32_16x16x32_bf16 v[96:99], a[72:75], a[16:19], v[96:99]
ds_read_b64_tr_b16 a[88:89], v20 offset:40960
v_mfma_f32_16x16x32_bf16 v[100:103], a[72:75], a[20:23], v[100:103]
ds_read_b64_tr_b16 a[90:91], v20 offset:45056
v_mfma_f32_16x16x32_bf16 v[104:107], a[72:75], a[24:27], v[104:107]
v_mfma_f32_16x16x32_bf16 v[108:111], a[72:75], a[28:31], v[108:111]
buffer_load_dwordx4 a[4:7], v9, s[48:51], s41 offen sc1
s_waitcnt lgkmcnt(6)
v_mfma_f32_16x16x32_bf16 v[112:115], a[76:79], a[16:19], v[112:115]
ds_read_b64_tr_b16 a[92:93], v21 offset:40960
v_mfma_f32_16x16x32_bf16 v[116:119], a[76:79], a[20:23], v[116:119]
ds_read_b64_tr_b16 a[94:95], v21 offset:45056
v_mfma_f32_16x16x32_bf16 v[120:123], a[76:79], a[24:27], v[120:123]
v_mfma_f32_16x16x32_bf16 v[124:127], a[76:79], a[28:31], v[124:127]
s_waitcnt lgkmcnt(6)
v_mfma_f32_16x16x32_bf16 v[128:131], a[80:83], a[16:19], v[128:131]
s_waitcnt vmcnt(9)
s_barrier
ds_read_b64_tr_b16 a[64:65], v14 offset:49152
v_mfma_f32_16x16x32_bf16 v[132:135], a[80:83], a[20:23], v[132:135]
ds_read_b64_tr_b16 a[66:67], v14 offset:53248
s_add_u32 m0, s43, 28672
v_mfma_f32_16x16x32_bf16 v[136:139], a[80:83], a[24:27], v[136:139]
buffer_load_dwordx4 v13, s[52:55], s42 offen lds
s_add_u32 s42, s42, 229376
v_mfma_f32_16x16x32_bf16 v[140:143], a[80:83], a[28:31], v[140:143]
s_waitcnt lgkmcnt(6)
v_mfma_f32_16x16x32_bf16 v[144:147], a[84:87], a[16:19], v[144:147]
ds_read_b64_tr_b16 a[68:69], v15 offset:49152
v_mfma_f32_16x16x32_bf16 v[148:151], a[84:87], a[20:23], v[148:151]
ds_read_b64_tr_b16 a[70:71], v15 offset:53248
v_mfma_f32_16x16x32_bf16 v[152:155], a[84:87], a[24:27], v[152:155]
buffer_load_dwordx4 a[8:11], v10, s[48:51], s41 offen sc1
v_mfma_f32_16x16x32_bf16 v[156:159], a[84:87], a[28:31], v[156:159]
s_waitcnt lgkmcnt(6)
v_mfma_f32_16x16x32_bf16 v[160:163], a[88:91], a[16:19], v[160:163]
ds_read_b64_tr_b16 a[72:73], v16 offset:49152
v_mfma_f32_16x16x32_bf16 v[164:167], a[88:91], a[20:23], v[164:167]
ds_read_b64_tr_b16 a[74:75], v16 offset:53248
v_mfma_f32_16x16x32_bf16 v[168:171], a[88:91], a[24:27], v[168:171]
v_mfma_f32_16x16x32_bf16 v[172:175], a[88:91], a[28:31], v[172:175]
buffer_load_dwordx4 a[12:15], v11, s[48:51], s41 offen sc1
s_add_u32 s41, s41, 1024
s_waitcnt lgkmcnt(6)
v_mfma_f32_16x16x32_bf16 v[176:179], a[92:95], a[16:19], v[176:179]
ds_read_b64_tr_b16 a[76:77], v17 offset:49152
v_mfma_f32_16x16x32_bf16 v[180:183], a[92:95], a[20:23], v[180:183]
ds_read_b64_tr_b16 a[78:79], v17 offset:53248
v_mfma_f32_16x16x32_bf16 v[184:187], a[92:95], a[24:27], v[184:187]
v_mfma_f32_16x16x32_bf16 v[188:191], a[92:95], a[28:31], v[188:191]
s_waitcnt lgkmcnt(6)
v_mfma_f32_16x16x32_bf16 v[64:67], a[64:67], a[32:35], v[64:67]
ds_read_b64_tr_b16 a[80:81], v18 offset:49152
v_mfma_f32_16x16x32_bf16 v[68:71], a[64:67], a[36:39], v[68:71]
ds_read_b64_tr_b16 a[82:83], v18 offset:53248
buffer_load_dwordx4 a[16:19], v8, s[48:51], s41 offen sc1
v_mfma_f32_16x16x32_bf16 v[72:75], a[64:67], a[40:43], v[72:75]
v_mfma_f32_16x16x32_bf16 v[76:79], a[64:67], a[44:47], v[76:79]
s_waitcnt lgkmcnt(6)
v_mfma_f32_16x16x32_bf16 v[80:83], a[68:71], a[32:35], v[80:83]
ds_read_b64_tr_b16 a[84:85], v19 offset:49152
v_mfma_f32_16x16x32_bf16 v[84:87], a[68:71], a[36:39], v[84:87]
ds_read_b64_tr_b16 a[86:87], v19 offset:53248
v_mfma_f32_16x16x32_bf16 v[88:91], a[68:71], a[40:43], v[88:91]
s_add_u32 m0, s43, 32768
v_mfma_f32_16x16x32_bf16 v[92:95], a[68:71], a[44:47], v[92:95]
buffer_load_dwordx4 v12, s[52:55], s42 offen lds
s_waitcnt lgkmcnt(6)
v_mfma_f32_16x16x32_bf16 v[96:99], a[72:75], a[32:35], v[96:99]
ds_read_b64_tr_b16 a[88:89], v20 offset:49152
v_mfma_f32_16x16x32_bf16 v[100:103], a[72:75], a[36:39], v[100:103]
ds_read_b64_tr_b16 a[90:91], v20 offset:53248
v_mfma_f32_16x16x32_bf16 v[104:107], a[72:75], a[40:43], v[104:107]
v_mfma_f32_16x16x32_bf16 v[108:111], a[72:75], a[44:47], v[108:111]
buffer_load_dwordx4 a[20:23], v9, s[48:51], s41 offen sc1
s_waitcnt lgkmcnt(6)
v_mfma_f32_16x16x32_bf16 v[112:115], a[76:79], a[32:35], v[112:115]
ds_read_b64_tr_b16 a[92:93], v21 offset:49152
v_mfma_f32_16x16x32_bf16 v[116:119], a[76:79], a[36:39], v[116:119]
ds_read_b64_tr_b16 a[94:95], v21 offset:53248
v_mfma_f32_16x16x32_bf16 v[120:123], a[76:79], a[40:43], v[120:123]
v_mfma_f32_16x16x32_bf16 v[124:127], a[76:79], a[44:47], v[124:127]
s_waitcnt lgkmcnt(6)
v_mfma_f32_16x16x32_bf16 v[128:131], a[80:83], a[32:35], v[128:131]
s_waitcnt vmcnt(9)
s_barrier
ds_read_b64_tr_b16 a[64:65], v14 offset:57344
v_mfma_f32_16x16x32_bf16 v[132:135], a[80:83], a[36:39], v[132:135]
ds_read_b64_tr_b16 a[66:67], v14 offset:61440
s_add_u32 m0, s43, 36864
v_mfma_f32_16x16x32_bf16 v[136:139], a[80:83], a[40:43], v[136:139]
buffer_load_dwordx4 v13, s[52:55], s42 offen lds
s_add_u32 s42, s42, 229376
v_mfma_f32_16x16x32_bf16 v[140:143], a[80:83], a[44:47], v[140:143]
s_waitcnt lgkmcnt(6)
v_mfma_f32_16x16x32_bf16 v[144:147], a[84:87], a[32:35], v[144:147]
ds_read_b64_tr_b16 a[68:69], v15 offset:57344
v_mfma_f32_16x16x32_bf16 v[148:151], a[84:87], a[36:39], v[148:151]
ds_read_b64_tr_b16 a[70:71], v15 offset:61440
v_mfma_f32_16x16x32_bf16 v[152:155], a[84:87], a[40:43], v[152:155]
buffer_load_dwordx4 a[24:27], v10, s[48:51], s41 offen sc1
v_mfma_f32_16x16x32_bf16 v[156:159], a[84:87], a[44:47], v[156:159]
s_waitcnt lgkmcnt(6)
v_mfma_f32_16x16x32_bf16 v[160:163], a[88:91], a[32:35], v[160:163]
ds_read_b64_tr_b16 a[72:73], v16 offset:57344
v_mfma_f32_16x16x32_bf16 v[164:167], a[88:91], a[36:39], v[164:167]
ds_read_b64_tr_b16 a[74:75], v16 offset:61440
v_mfma_f32_16x16x32_bf16 v[168:171], a[88:91], a[40:43], v[168:171]
v_mfma_f32_16x16x32_bf16 v[172:175], a[88:91], a[44:47], v[172:175]
buffer_load_dwordx4 a[28:31], v11, s[48:51], s41 offen sc1
s_add_u32 s41, s41, 1024
s_waitcnt lgkmcnt(6)
v_mfma_f32_16x16x32_bf16 v[176:179], a[92:95], a[32:35], v[176:179]
ds_read_b64_tr_b16 a[76:77], v17 offset:57344
v_mfma_f32_16x16x32_bf16 v[180:183], a[92:95], a[36:39], v[180:183]
ds_read_b64_tr_b16 a[78:79], v17 offset:61440
v_mfma_f32_16x16x32_bf16 v[184:187], a[92:95], a[40:43], v[184:187]
v_mfma_f32_16x16x32_bf16 v[188:191], a[92:95], a[44:47], v[188:191]
s_waitcnt lgkmcnt(6)
v_mfma_f32_16x16x32_bf16 v[64:67], a[64:67], a[48:51], v[64:67]
ds_read_b64_tr_b16 a[80:81], v18 offset:57344
v_mfma_f32_16x16x32_bf16 v[68:71], a[64:67], a[52:55], v[68:71]
ds_read_b64_tr_b16 a[82:83], v18 offset:61440
buffer_load_dwordx4 a[32:35], v8, s[48:51], s41 offen sc1
v_mfma_f32_16x16x32_bf16 v[72:75], a[64:67], a[56:59], v[72:75]
v_mfma_f32_16x16x32_bf16 v[76:79], a[64:67], a[60:63], v[76:79]
s_waitcnt lgkmcnt(6)
v_mfma_f32_16x16x32_bf16 v[80:83], a[68:71], a[48:51], v[80:83]
ds_read_b64_tr_b16 a[84:85], v19 offset:57344
v_mfma_f32_16x16x32_bf16 v[84:87], a[68:71], a[52:55], v[84:87]
ds_read_b64_tr_b16 a[86:87], v19 offset:61440
v_mfma_f32_16x16x32_bf16 v[88:91], a[68:71], a[56:59], v[88:91]
s_add_u32 m0, s43, 40960
v_mfma_f32_16x16x32_bf16 v[92:95], a[68:71], a[60:63], v[92:95]
buffer_load_dwordx4 v12, s[52:55], s42 offen lds
s_waitcnt lgkmcnt(6)
v_mfma_f32_16x16x32_bf16 v[96:99], a[72:75], a[48:51], v[96:99]
ds_read_b64_tr_b16 a[88:89], v20 offset:57344
v_mfma_f32_16x16x32_bf16 v[100:103], a[72:75], a[52:55], v[100:103]
ds_read_b64_tr_b16 a[90:91], v20 offset:61440
v_mfma_f32_16x16x32_bf16 v[104:107], a[72:75], a[56:59], v[104:107]
v_mfma_f32_16x16x32_bf16 v[108:111], a[72:75], a[60:63], v[108:111]
buffer_load_dwordx4 a[36:39], v9, s[48:51], s41 offen sc1
s_waitcnt lgkmcnt(6)
v_mfma_f32_16x16x32_bf16 v[112:115], a[76:79], a[48:51], v[112:115]
ds_read_b64_tr_b16 a[92:93], v21 offset:57344
v_mfma_f32_16x16x32_bf16 v[116:119], a[76:79], a[52:55], v[116:119]
ds_read_b64_tr_b16 a[94:95], v21 offset:61440
v_mfma_f32_16x16x32_bf16 v[120:123], a[76:79], a[56:59], v[120:123]
v_mfma_f32_16x16x32_bf16 v[124:127], a[76:79], a[60:63], v[124:127]
s_waitcnt lgkmcnt(6)
v_mfma_f32_16x16x32_bf16 v[128:131], a[80:83], a[48:51], v[128:131]
s_waitcnt vmcnt(9)
s_barrier
ds_read_b64_tr_b16 a[64:65], v14 offset:0
v_mfma_f32_16x16x32_bf16 v[132:135], a[80:83], a[52:55], v[132:135]
ds_read_b64_tr_b16 a[66:67], v14 offset:4096
s_add_u32 m0, s43, 45056
v_mfma_f32_16x16x32_bf16 v[136:139], a[80:83], a[56:59], v[136:139]
buffer_load_dwordx4 v13, s[52:55], s42 offen lds
s_add_u32 s42, s42, 229376
v_mfma_f32_16x16x32_bf16 v[140:143], a[80:83], a[60:63], v[140:143]
s_waitcnt lgkmcnt(6)
v_mfma_f32_16x16x32_bf16 v[144:147], a[84:87], a[48:51], v[144:147]
ds_read_b64_tr_b16 a[68:69], v15 offset:0
v_mfma_f32_16x16x32_bf16 v[148:151], a[84:87], a[52:55], v[148:151]
ds_read_b64_tr_b16 a[70:71], v15 offset:4096
v_mfma_f32_16x16x32_bf16 v[152:155], a[84:87], a[56:59], v[152:155]
buffer_load_dwordx4 a[40:43], v10, s[48:51], s41 offen sc1
v_mfma_f32_16x16x32_bf16 v[156:159], a[84:87], a[60:63], v[156:159]
s_waitcnt lgkmcnt(6)
v_mfma_f32_16x16x32_bf16 v[160:163], a[88:91], a[48:51], v[160:163]
ds_read_b64_tr_b16 a[72:73], v16 offset:0
v_mfma_f32_16x16x32_bf16 v[164:167], a[88:91], a[52:55], v[164:167]
ds_read_b64_tr_b16 a[74:75], v16 offset:4096
v_mfma_f32_16x16x32_bf16 v[168:171], a[88:91], a[56:59], v[168:171]
v_mfma_f32_16x16x32_bf16 v[172:175], a[88:91], a[60:63], v[172:175]
buffer_load_dwordx4 a[44:47], v11, s[48:51], s41 offen sc1
s_add_u32 s41, s41, 1024
s_waitcnt lgkmcnt(6)
v_mfma_f32_16x16x32_bf16 v[176:179], a[92:95], a[48:51], v[176:179]
ds_read_b64_tr_b16 a[76:77], v17 offset:0
v_mfma_f32_16x16x32_bf16 v[180:183], a[92:95], a[52:55], v[180:183]
ds_read_b64_tr_b16 a[78:79], v17 offset:4096
v_mfma_f32_16x16x32_bf16 v[184:187], a[92:95], a[56:59], v[184:187]
v_mfma_f32_16x16x32_bf16 v[188:191], a[92:95], a[60:63], v[188:191]
s_sub_u32 s44, s44, 1
s_cmp_lg_u32 s44, 0
s_cbranch_scc1 L_gemm1_kernel_w8_loop0
s_add_u32 s68, s6, 0x3d00000
s_addc_u32 s69, s7, 0
s_and_b32 s69, s69, 0xffff
s_mov_b32 s70, 0x20000
s_mov_b32 s71, 0x20000
s_lshl_b32 s72, s2, 7
s_add_u32 s72, s72, 0x10000
v_and_b32 v5, 31, v0
v_lshlrev_b32 v5, 2, v5
v_add_u32 v5, s72, v5
s_lshl_b32 s72, s2, 6
s_add_u32 s72, s72, 4096
s_and_b32 s73, s2, 7
s_lshl_b32 s73, s73, 7
v_mov_b32 v2, 0
v_mov_b32 v3, s72
v_mov_b32 v4, s73
buffer_store_dword v2, v3, s[68:71], 0 offen
buffer_store_dword v2, v4, s[68:71], 0 offen
buffer_store_dword v2, v5, s[68:71], 0 offen
s_load_dwordx2 s[74:75], s[0:1], 48
s_load_dwordx2 s[76:77], s[0:1], 16
s_waitcnt lgkmcnt(0)
s_and_b32 s73, s2, 31
s_mov_b32 s68, s74
s_and_b32 s69, s75, 0xffff
s_mov_b32 s70, 0x700000
s_mov_b32 s71, 0x20000
s_mul_i32 s72, s73, 229376
v_lshrrev_b32 v2, 6, v0
v_mul_u32_u24 v2, 448, v2
v_and_b32 v3, 63, v0
v_add_u32 v2, v2, v3
v_lshlrev_b32 v2, 7, v2
v_add_u32 v2, s72, v2
buffer_load_dword v1, v2, s[68:71], 0 offen
v_add_u32 v2, 8192, v2
buffer_load_dword v1, v2, s[68:71], 0 offen
v_add_u32 v2, 8192, v2
buffer_load_dword v1, v2, s[68:71], 0 offen
v_add_u32 v2, 8192, v2
buffer_load_dword v1, v2, s[68:71], 0 offen
v_add_u32 v2, 8192, v2
buffer_load_dword v1, v2, s[68:71], 0 offen
v_add_u32 v2, 8192, v2
buffer_load_dword v1, v2, s[68:71], 0 offen
v_add_u32 v2, 8192, v2
buffer_load_dword v1, v2, s[68:71], 0 offen
s_mov_b32 s68, s76
s_and_b32 s69, s77, 0xffff
s_mov_b32 s70, 0x200000
s_mov_b32 s71, 0x20000
s_mul_i32 s72, s73, 65536
v_lshrrev_b32 v2, 6, v0
v_mul_u32_u24 v2, 128, v2
v_and_b32 v3, 63, v0
v_add_u32 v2, v2, v3
v_lshlrev_b32 v2, 7, v2
v_add_u32 v2, s72, v2
buffer_load_dword v1, v2, s[68:71], 0 offen
v_add_u32 v2, 8192, v2
buffer_load_dword v1, v2, s[68:71], 0 offen
s_add_u32 s56, s6, 0x1400000
s_addc_u32 s57, s7, 0
s_and_b32 s57, s57, 0xffff
s_mov_b32 s58, 0xe00000
s_mov_b32 s59, 0x20000
v_and_b32 v2, 63, v0
v_lshlrev_b32 v5, 4, v2
s_mul_i32 s17, s16, 114688
s_lshl_b32 s27, s26, 5
s_add_u32 s17, s17, s27
v_add_u32 v5, s17, v5
s_mov_b32 s30, 0xbdd2d3e8
s_mov_b32 s31, 0xbdd2d3e8
v_mov_b32 v6, 0xc0135761
v_mov_b32 v7, 0xc0135761
s_waitcnt vmcnt(0)
v_lshlrev_b32 v8, 16, v32
v_and_b32 v9, 0xffff0000, v32
v_lshlrev_b32 v10, 16, v33
v_and_b32 v11, 0xffff0000, v33
v_lshlrev_b32 v12, 16, v34
v_and_b32 v13, 0xffff0000, v34
v_lshlrev_b32 v14, 16, v35
v_and_b32 v15, 0xffff0000, v35
v_pk_fma_f32 v[64:65], v[64:65], v[56:57], v[8:9] op_sel_hi:[1,0,1]
v_pk_fma_f32 v[66:67], v[66:67], v[56:57], v[10:11] op_sel_hi:[1,0,1]
v_pk_fma_f32 v[80:81], v[80:81], v[56:57], v[12:13] op_sel_hi:[1,0,1]
v_pk_fma_f32 v[82:83], v[82:83], v[56:57], v[14:15] op_sel_hi:[1,0,1]
v_pk_mul_f32 v[16:17], v[64:65], v[64:65]
v_pk_mul_f32 v[18:19], v[66:67], v[66:67]
v_pk_mul_f32 v[20:21], v[80:81], v[80:81]
v_pk_mul_f32 v[22:23], v[82:83], v[82:83]
v_pk_fma_f32 v[16:17], v[16:17], s[30:31], v[6:7]
v_pk_fma_f32 v[18:19], v[18:19], s[30:31], v[6:7]
v_pk_fma_f32 v[20:21], v[20:21], s[30:31], v[6:7]
v_pk_fma_f32 v[22:23], v[22:23], s[30:31], v[6:7]
v_pk_mul_f32 v[16:17], v[16:17], v[64:65]
v_pk_mul_f32 v[18:19], v[18:19], v[66:67]
v_pk_mul_f32 v[20:21], v[20:21], v[80:81]
v_pk_mul_f32 v[22:23], v[22:23], v[82:83]
v_exp_f32 v16, v16
v_exp_f32 v17, v17
v_exp_f32 v18, v18
v_exp_f32 v19, v19
v_exp_f32 v20, v20
v_exp_f32 v21, v21
v_exp_f32 v22, v22
v_exp_f32 v23, v23
v_pk_add_f32 v[16:17], v[16:17], 1.0 op_sel_hi:[1,0]
v_pk_add_f32 v[18:19], v[18:19], 1.0 op_sel_hi:[1,0]
v_pk_add_f32 v[20:21], v[20:21], 1.0 op_sel_hi:[1,0]
v_pk_add_f32 v[22:23], v[22:23], 1.0 op_sel_hi:[1,0]
v_rcp_f32 v16, v16
v_rcp_f32 v17, v17
v_rcp_f32 v18, v18
v_rcp_f32 v19, v19
v_rcp_f32 v20, v20
v_rcp_f32 v21, v21
v_rcp_f32 v22, v22
v_rcp_f32 v23, v23
v_pk_mul_f32 v[64:65], v[64:65], v[16:17]
v_pk_mul_f32 v[66:67], v[66:67], v[18:19]
v_pk_mul_f32 v[80:81], v[80:81], v[20:21]
v_pk_mul_f32 v[82:83], v[82:83], v[22:23]
v_cvt_pk_bf16_f32 v24, v64, v65
v_cvt_pk_bf16_f32 v25, v66, v67
v_cvt_pk_bf16_f32 v26, v80, v81
v_cvt_pk_bf16_f32 v27, v82, v83
s_mov_b32 s27, 0
buffer_store_dwordx4 v[24:27], v5, s[56:59], s27 offen
v_pk_fma_f32 v[68:69], v[68:69], v[56:57], v[8:9] op_sel:[0,1,0] op_sel_hi:[1,1,1]
v_pk_fma_f32 v[70:71], v[70:71], v[56:57], v[10:11] op_sel:[0,1,0] op_sel_hi:[1,1,1]
v_pk_fma_f32 v[84:85], v[84:85], v[56:57], v[12:13] op_sel:[0,1,0] op_sel_hi:[1,1,1]
v_pk_fma_f32 v[86:87], v[86:87], v[56:57], v[14:15] op_sel:[0,1,0] op_sel_hi:[1,1,1]
v_pk_mul_f32 v[16:17], v[68:69], v[68:69]
v_pk_mul_f32 v[18:19], v[70:71], v[70:71]
v_pk_mul_f32 v[20:21], v[84:85], v[84:85]
v_pk_mul_f32 v[22:23], v[86:87], v[86:87]
v_pk_fma_f32 v[16:17], v[16:17], s[30:31], v[6:7]
v_pk_fma_f32 v[18:19], v[18:19], s[30:31], v[6:7]
v_pk_fma_f32 v[20:21], v[20:21], s[30:31], v[6:7]
v_pk_fma_f32 v[22:23], v[22:23], s[30:31], v[6:7]
v_pk_mul_f32 v[16:17], v[16:17], v[68:69]
v_pk_mul_f32 v[18:19], v[18:19], v[70:71]
v_pk_mul_f32 v[20:21], v[20:21], v[84:85]
v_pk_mul_f32 v[22:23], v[22:23], v[86:87]
v_exp_f32 v16, v16
v_exp_f32 v17, v17
v_exp_f32 v18, v18
v_exp_f32 v19, v19
v_exp_f32 v20, v20
v_exp_f32 v21, v21
v_exp_f32 v22, v22
v_exp_f32 v23, v23
v_pk_add_f32 v[16:17], v[16:17], 1.0 op_sel_hi:[1,0]
v_pk_add_f32 v[18:19], v[18:19], 1.0 op_sel_hi:[1,0]
v_pk_add_f32 v[20:21], v[20:21], 1.0 op_sel_hi:[1,0]
v_pk_add_f32 v[22:23], v[22:23], 1.0 op_sel_hi:[1,0]
v_rcp_f32 v16, v16
v_rcp_f32 v17, v17
v_rcp_f32 v18, v18
v_rcp_f32 v19, v19
v_rcp_f32 v20, v20
v_rcp_f32 v21, v21
v_rcp_f32 v22, v22
v_rcp_f32 v23, v23
v_pk_mul_f32 v[68:69], v[68:69], v[16:17]
v_pk_mul_f32 v[70:71], v[70:71], v[18:19]
v_pk_mul_f32 v[84:85], v[84:85], v[20:21]
v_pk_mul_f32 v[86:87], v[86:87], v[22:23]
v_cvt_pk_bf16_f32 v28, v68, v69
v_cvt_pk_bf16_f32 v29, v70, v71
v_cvt_pk_bf16_f32 v30, v84, v85
v_cvt_pk_bf16_f32 v31, v86, v87
s_mov_b32 s27, 114688
buffer_store_dwordx4 v[28:31], v5, s[56:59], s27 offen
v_pk_fma_f32 v[72:73], v[72:73], v[58:59], v[8:9] op_sel_hi:[1,0,1]
v_pk_fma_f32 v[74:75], v[74:75], v[58:59], v[10:11] op_sel_hi:[1,0,1]
v_pk_fma_f32 v[88:89], v[88:89], v[58:59], v[12:13] op_sel_hi:[1,0,1]
v_pk_fma_f32 v[90:91], v[90:91], v[58:59], v[14:15] op_sel_hi:[1,0,1]
v_pk_mul_f32 v[16:17], v[72:73], v[72:73]
v_pk_mul_f32 v[18:19], v[74:75], v[74:75]
v_pk_mul_f32 v[20:21], v[88:89], v[88:89]
v_pk_mul_f32 v[22:23], v[90:91], v[90:91]
v_pk_fma_f32 v[16:17], v[16:17], s[30:31], v[6:7]
v_pk_fma_f32 v[18:19], v[18:19], s[30:31], v[6:7]
v_pk_fma_f32 v[20:21], v[20:21], s[30:31], v[6:7]
v_pk_fma_f32 v[22:23], v[22:23], s[30:31], v[6:7]
v_pk_mul_f32 v[16:17], v[16:17], v[72:73]
v_pk_mul_f32 v[18:19], v[18:19], v[74:75]
v_pk_mul_f32 v[20:21], v[20:21], v[88:89]
v_pk_mul_f32 v[22:23], v[22:23], v[90:91]
v_exp_f32 v16, v16
v_exp_f32 v17, v17
v_exp_f32 v18, v18
v_exp_f32 v19, v19
v_exp_f32 v20, v20
v_exp_f32 v21, v21
v_exp_f32 v22, v22
v_exp_f32 v23, v23
v_pk_add_f32 v[16:17], v[16:17], 1.0 op_sel_hi:[1,0]
v_pk_add_f32 v[18:19], v[18:19], 1.0 op_sel_hi:[1,0]
v_pk_add_f32 v[20:21], v[20:21], 1.0 op_sel_hi:[1,0]
v_pk_add_f32 v[22:23], v[22:23], 1.0 op_sel_hi:[1,0]
v_rcp_f32 v16, v16
v_rcp_f32 v17, v17
v_rcp_f32 v18, v18
v_rcp_f32 v19, v19
v_rcp_f32 v20, v20
v_rcp_f32 v21, v21
v_rcp_f32 v22, v22
v_rcp_f32 v23, v23
v_pk_mul_f32 v[72:73], v[72:73], v[16:17]
v_pk_mul_f32 v[74:75], v[74:75], v[18:19]
v_pk_mul_f32 v[88:89], v[88:89], v[20:21]
v_pk_mul_f32 v[90:91], v[90:91], v[22:23]
v_cvt_pk_bf16_f32 v24, v72, v73
v_cvt_pk_bf16_f32 v25, v74, v75
v_cvt_pk_bf16_f32 v26, v88, v89
v_cvt_pk_bf16_f32 v27, v90, v91
s_mov_b32 s27, 229376
buffer_store_dwordx4 v[24:27], v5, s[56:59], s27 offen
v_pk_fma_f32 v[76:77], v[76:77], v[58:59], v[8:9] op_sel:[0,1,0] op_sel_hi:[1,1,1]
v_pk_fma_f32 v[78:79], v[78:79], v[58:59], v[10:11] op_sel:[0,1,0] op_sel_hi:[1,1,1]
v_pk_fma_f32 v[92:93], v[92:93], v[58:59], v[12:13] op_sel:[0,1,0] op_sel_hi:[1,1,1]
v_pk_fma_f32 v[94:95], v[94:95], v[58:59], v[14:15] op_sel:[0,1,0] op_sel_hi:[1,1,1]
v_pk_mul_f32 v[16:17], v[76:77], v[76:77]
v_pk_mul_f32 v[18:19], v[78:79], v[78:79]
v_pk_mul_f32 v[20:21], v[92:93], v[92:93]
v_pk_mul_f32 v[22:23], v[94:95], v[94:95]
v_pk_fma_f32 v[16:17], v[16:17], s[30:31], v[6:7]
v_pk_fma_f32 v[18:19], v[18:19], s[30:31], v[6:7]
v_pk_fma_f32 v[20:21], v[20:21], s[30:31], v[6:7]
v_pk_fma_f32 v[22:23], v[22:23], s[30:31], v[6:7]
v_pk_mul_f32 v[16:17], v[16:17], v[76:77]
v_pk_mul_f32 v[18:19], v[18:19], v[78:79]
v_pk_mul_f32 v[20:21], v[20:21], v[92:93]
v_pk_mul_f32 v[22:23], v[22:23], v[94:95]
v_exp_f32 v16, v16
v_exp_f32 v17, v17
v_exp_f32 v18, v18
v_exp_f32 v19, v19
v_exp_f32 v20, v20
v_exp_f32 v21, v21
v_exp_f32 v22, v22
v_exp_f32 v23, v23
v_pk_add_f32 v[16:17], v[16:17], 1.0 op_sel_hi:[1,0]
v_pk_add_f32 v[18:19], v[18:19], 1.0 op_sel_hi:[1,0]
v_pk_add_f32 v[20:21], v[20:21], 1.0 op_sel_hi:[1,0]
v_pk_add_f32 v[22:23], v[22:23], 1.0 op_sel_hi:[1,0]
v_rcp_f32 v16, v16
v_rcp_f32 v17, v17
v_rcp_f32 v18, v18
v_rcp_f32 v19, v19
v_rcp_f32 v20, v20
v_rcp_f32 v21, v21
v_rcp_f32 v22, v22
v_rcp_f32 v23, v23
v_pk_mul_f32 v[76:77], v[76:77], v[16:17]
v_pk_mul_f32 v[78:79], v[78:79], v[18:19]
v_pk_mul_f32 v[92:93], v[92:93], v[20:21]
v_pk_mul_f32 v[94:95], v[94:95], v[22:23]
v_cvt_pk_bf16_f32 v28, v76, v77
v_cvt_pk_bf16_f32 v29, v78, v79
v_cvt_pk_bf16_f32 v30, v92, v93
v_cvt_pk_bf16_f32 v31, v94, v95
s_mov_b32 s27, 344064
buffer_store_dwordx4 v[28:31], v5, s[56:59], s27 offen
v_lshlrev_b32 v8, 16, v36
v_and_b32 v9, 0xffff0000, v36
v_lshlrev_b32 v10, 16, v37
v_and_b32 v11, 0xffff0000, v37
v_lshlrev_b32 v12, 16, v38
v_and_b32 v13, 0xffff0000, v38
v_lshlrev_b32 v14, 16, v39
v_and_b32 v15, 0xffff0000, v39
v_pk_fma_f32 v[96:97], v[96:97], v[56:57], v[8:9] op_sel_hi:[1,0,1]
v_pk_fma_f32 v[98:99], v[98:99], v[56:57], v[10:11] op_sel_hi:[1,0,1]
v_pk_fma_f32 v[112:113], v[112:113], v[56:57], v[12:13] op_sel_hi:[1,0,1]
v_pk_fma_f32 v[114:115], v[114:115], v[56:57], v[14:15] op_sel_hi:[1,0,1]
v_pk_mul_f32 v[16:17], v[96:97], v[96:97]
v_pk_mul_f32 v[18:19], v[98:99], v[98:99]
v_pk_mul_f32 v[20:21], v[112:113], v[112:113]
v_pk_mul_f32 v[22:23], v[114:115], v[114:115]
v_pk_fma_f32 v[16:17], v[16:17], s[30:31], v[6:7]
v_pk_fma_f32 v[18:19], v[18:19], s[30:31], v[6:7]
v_pk_fma_f32 v[20:21], v[20:21], s[30:31], v[6:7]
v_pk_fma_f32 v[22:23], v[22:23], s[30:31], v[6:7]
v_pk_mul_f32 v[16:17], v[16:17], v[96:97]
v_pk_mul_f32 v[18:19], v[18:19], v[98:99]
v_pk_mul_f32 v[20:21], v[20:21], v[112:113]
v_pk_mul_f32 v[22:23], v[22:23], v[114:115]
v_exp_f32 v16, v16
v_exp_f32 v17, v17
v_exp_f32 v18, v18
v_exp_f32 v19, v19
v_exp_f32 v20, v20
v_exp_f32 v21, v21
v_exp_f32 v22, v22
v_exp_f32 v23, v23
v_pk_add_f32 v[16:17], v[16:17], 1.0 op_sel_hi:[1,0]
v_pk_add_f32 v[18:19], v[18:19], 1.0 op_sel_hi:[1,0]
v_pk_add_f32 v[20:21], v[20:21], 1.0 op_sel_hi:[1,0]
v_pk_add_f32 v[22:23], v[22:23], 1.0 op_sel_hi:[1,0]
v_rcp_f32 v16, v16
v_rcp_f32 v17, v17
v_rcp_f32 v18, v18
v_rcp_f32 v19, v19
v_rcp_f32 v20, v20
v_rcp_f32 v21, v21
v_rcp_f32 v22, v22
v_rcp_f32 v23, v23
v_pk_mul_f32 v[96:97], v[96:97], v[16:17]
v_pk_mul_f32 v[98:99], v[98:99], v[18:19]
v_pk_mul_f32 v[112:113], v[112:113], v[20:21]
v_pk_mul_f32 v[114:115], v[114:115], v[22:23]
v_cvt_pk_bf16_f32 v24, v96, v97
v_cvt_pk_bf16_f32 v25, v98, v99
v_cvt_pk_bf16_f32 v26, v112, v113
v_cvt_pk_bf16_f32 v27, v114, v115
s_mov_b32 s27, 1024
buffer_store_dwordx4 v[24:27], v5, s[56:59], s27 offen
v_pk_fma_f32 v[100:101], v[100:101], v[56:57], v[8:9] op_sel:[0,1,0] op_sel_hi:[1,1,1]
v_pk_fma_f32 v[102:103], v[102:103], v[56:57], v[10:11] op_sel:[0,1,0] op_sel_hi:[1,1,1]
v_pk_fma_f32 v[116:117], v[116:117], v[56:57], v[12:13] op_sel:[0,1,0] op_sel_hi:[1,1,1]
v_pk_fma_f32 v[118:119], v[118:119], v[56:57], v[14:15] op_sel:[0,1,0] op_sel_hi:[1,1,1]
v_pk_mul_f32 v[16:17], v[100:101], v[100:101]
v_pk_mul_f32 v[18:19], v[102:103], v[102:103]
v_pk_mul_f32 v[20:21], v[116:117], v[116:117]
v_pk_mul_f32 v[22:23], v[118:119], v[118:119]
v_pk_fma_f32 v[16:17], v[16:17], s[30:31], v[6:7]
v_pk_fma_f32 v[18:19], v[18:19], s[30:31], v[6:7]
v_pk_fma_f32 v[20:21], v[20:21], s[30:31], v[6:7]
v_pk_fma_f32 v[22:23], v[22:23], s[30:31], v[6:7]
v_pk_mul_f32 v[16:17], v[16:17], v[100:101]
v_pk_mul_f32 v[18:19], v[18:19], v[102:103]
v_pk_mul_f32 v[20:21], v[20:21], v[116:117]
v_pk_mul_f32 v[22:23], v[22:23], v[118:119]
v_exp_f32 v16, v16
v_exp_f32 v17, v17
v_exp_f32 v18, v18
v_exp_f32 v19, v19
v_exp_f32 v20, v20
v_exp_f32 v21, v21
v_exp_f32 v22, v22
v_exp_f32 v23, v23
v_pk_add_f32 v[16:17], v[16:17], 1.0 op_sel_hi:[1,0]
v_pk_add_f32 v[18:19], v[18:19], 1.0 op_sel_hi:[1,0]
v_pk_add_f32 v[20:21], v[20:21], 1.0 op_sel_hi:[1,0]
v_pk_add_f32 v[22:23], v[22:23], 1.0 op_sel_hi:[1,0]
v_rcp_f32 v16, v16
v_rcp_f32 v17, v17
v_rcp_f32 v18, v18
v_rcp_f32 v19, v19
v_rcp_f32 v20, v20
v_rcp_f32 v21, v21
v_rcp_f32 v22, v22
v_rcp_f32 v23, v23
v_pk_mul_f32 v[100:101], v[100:101], v[16:17]
v_pk_mul_f32 v[102:103], v[102:103], v[18:19]
v_pk_mul_f32 v[116:117], v[116:117], v[20:21]
v_pk_mul_f32 v[118:119], v[118:119], v[22:23]
v_cvt_pk_bf16_f32 v28, v100, v101
v_cvt_pk_bf16_f32 v29, v102, v103
v_cvt_pk_bf16_f32 v30, v116, v117
v_cvt_pk_bf16_f32 v31, v118, v119
s_mov_b32 s27, 115712
buffer_store_dwordx4 v[28:31], v5, s[56:59], s27 offen
v_pk_fma_f32 v[104:105], v[104:105], v[58:59], v[8:9] op_sel_hi:[1,0,1]
v_pk_fma_f32 v[106:107], v[106:107], v[58:59], v[10:11] op_sel_hi:[1,0,1]
v_pk_fma_f32 v[120:121], v[120:121], v[58:59], v[12:13] op_sel_hi:[1,0,1]
v_pk_fma_f32 v[122:123], v[122:123], v[58:59], v[14:15] op_sel_hi:[1,0,1]
v_pk_mul_f32 v[16:17], v[104:105], v[104:105]
v_pk_mul_f32 v[18:19], v[106:107], v[106:107]
v_pk_mul_f32 v[20:21], v[120:121], v[120:121]
v_pk_mul_f32 v[22:23], v[122:123], v[122:123]
v_pk_fma_f32 v[16:17], v[16:17], s[30:31], v[6:7]
v_pk_fma_f32 v[18:19], v[18:19], s[30:31], v[6:7]
v_pk_fma_f32 v[20:21], v[20:21], s[30:31], v[6:7]
v_pk_fma_f32 v[22:23], v[22:23], s[30:31], v[6:7]
v_pk_mul_f32 v[16:17], v[16:17], v[104:105]
v_pk_mul_f32 v[18:19], v[18:19], v[106:107]
v_pk_mul_f32 v[20:21], v[20:21], v[120:121]
v_pk_mul_f32 v[22:23], v[22:23], v[122:123]
v_exp_f32 v16, v16
v_exp_f32 v17, v17
v_exp_f32 v18, v18
v_exp_f32 v19, v19
v_exp_f32 v20, v20
v_exp_f32 v21, v21
v_exp_f32 v22, v22
v_exp_f32 v23, v23
v_pk_add_f32 v[16:17], v[16:17], 1.0 op_sel_hi:[1,0]
v_pk_add_f32 v[18:19], v[18:19], 1.0 op_sel_hi:[1,0]
v_pk_add_f32 v[20:21], v[20:21], 1.0 op_sel_hi:[1,0]
v_pk_add_f32 v[22:23], v[22:23], 1.0 op_sel_hi:[1,0]
v_rcp_f32 v16, v16
v_rcp_f32 v17, v17
v_rcp_f32 v18, v18
v_rcp_f32 v19, v19
v_rcp_f32 v20, v20
v_rcp_f32 v21, v21
v_rcp_f32 v22, v22
v_rcp_f32 v23, v23
v_pk_mul_f32 v[104:105], v[104:105], v[16:17]
v_pk_mul_f32 v[106:107], v[106:107], v[18:19]
v_pk_mul_f32 v[120:121], v[120:121], v[20:21]
v_pk_mul_f32 v[122:123], v[122:123], v[22:23]
v_cvt_pk_bf16_f32 v24, v104, v105
v_cvt_pk_bf16_f32 v25, v106, v107
v_cvt_pk_bf16_f32 v26, v120, v121
v_cvt_pk_bf16_f32 v27, v122, v123
s_mov_b32 s27, 230400
buffer_store_dwordx4 v[24:27], v5, s[56:59], s27 offen
v_pk_fma_f32 v[108:109], v[108:109], v[58:59], v[8:9] op_sel:[0,1,0] op_sel_hi:[1,1,1]
v_pk_fma_f32 v[110:111], v[110:111], v[58:59], v[10:11] op_sel:[0,1,0] op_sel_hi:[1,1,1]
v_pk_fma_f32 v[124:125], v[124:125], v[58:59], v[12:13] op_sel:[0,1,0] op_sel_hi:[1,1,1]
v_pk_fma_f32 v[126:127], v[126:127], v[58:59], v[14:15] op_sel:[0,1,0] op_sel_hi:[1,1,1]
v_pk_mul_f32 v[16:17], v[108:109], v[108:109]
v_pk_mul_f32 v[18:19], v[110:111], v[110:111]
v_pk_mul_f32 v[20:21], v[124:125], v[124:125]
v_pk_mul_f32 v[22:23], v[126:127], v[126:127]
v_pk_fma_f32 v[16:17], v[16:17], s[30:31], v[6:7]
v_pk_fma_f32 v[18:19], v[18:19], s[30:31], v[6:7]
v_pk_fma_f32 v[20:21], v[20:21], s[30:31], v[6:7]
v_pk_fma_f32 v[22:23], v[22:23], s[30:31], v[6:7]
v_pk_mul_f32 v[16:17], v[16:17], v[108:109]
v_pk_mul_f32 v[18:19], v[18:19], v[110:111]
v_pk_mul_f32 v[20:21], v[20:21], v[124:125]
v_pk_mul_f32 v[22:23], v[22:23], v[126:127]
v_exp_f32 v16, v16
v_exp_f32 v17, v17
v_exp_f32 v18, v18
v_exp_f32 v19, v19
v_exp_f32 v20, v20
v_exp_f32 v21, v21
v_exp_f32 v22, v22
v_exp_f32 v23, v23
v_pk_add_f32 v[16:17], v[16:17], 1.0 op_sel_hi:[1,0]
v_pk_add_f32 v[18:19], v[18:19], 1.0 op_sel_hi:[1,0]
v_pk_add_f32 v[20:21], v[20:21], 1.0 op_sel_hi:[1,0]
v_pk_add_f32 v[22:23], v[22:23], 1.0 op_sel_hi:[1,0]
v_rcp_f32 v16, v16
v_rcp_f32 v17, v17
v_rcp_f32 v18, v18
v_rcp_f32 v19, v19
v_rcp_f32 v20, v20
v_rcp_f32 v21, v21
v_rcp_f32 v22, v22
v_rcp_f32 v23, v23
v_pk_mul_f32 v[108:109], v[108:109], v[16:17]
v_pk_mul_f32 v[110:111], v[110:111], v[18:19]
v_pk_mul_f32 v[124:125], v[124:125], v[20:21]
v_pk_mul_f32 v[126:127], v[126:127], v[22:23]
v_cvt_pk_bf16_f32 v28, v108, v109
v_cvt_pk_bf16_f32 v29, v110, v111
v_cvt_pk_bf16_f32 v30, v124, v125
v_cvt_pk_bf16_f32 v31, v126, v127
s_mov_b32 s27, 345088
buffer_store_dwordx4 v[28:31], v5, s[56:59], s27 offen
v_lshlrev_b32 v8, 16, v40
v_and_b32 v9, 0xffff0000, v40
v_lshlrev_b32 v10, 16, v41
v_and_b32 v11, 0xffff0000, v41
v_lshlrev_b32 v12, 16, v42
v_and_b32 v13, 0xffff0000, v42
v_lshlrev_b32 v14, 16, v43
v_and_b32 v15, 0xffff0000, v43
v_pk_fma_f32 v[128:129], v[128:129], v[56:57], v[8:9] op_sel_hi:[1,0,1]
v_pk_fma_f32 v[130:131], v[130:131], v[56:57], v[10:11] op_sel_hi:[1,0,1]
v_pk_fma_f32 v[144:145], v[144:145], v[56:57], v[12:13] op_sel_hi:[1,0,1]
v_pk_fma_f32 v[146:147], v[146:147], v[56:57], v[14:15] op_sel_hi:[1,0,1]
v_pk_mul_f32 v[16:17], v[128:129], v[128:129]
v_pk_mul_f32 v[18:19], v[130:131], v[130:131]
v_pk_mul_f32 v[20:21], v[144:145], v[144:145]
v_pk_mul_f32 v[22:23], v[146:147], v[146:147]
v_pk_fma_f32 v[16:17], v[16:17], s[30:31], v[6:7]
v_pk_fma_f32 v[18:19], v[18:19], s[30:31], v[6:7]
v_pk_fma_f32 v[20:21], v[20:21], s[30:31], v[6:7]
v_pk_fma_f32 v[22:23], v[22:23], s[30:31], v[6:7]
v_pk_mul_f32 v[16:17], v[16:17], v[128:129]
v_pk_mul_f32 v[18:19], v[18:19], v[130:131]
v_pk_mul_f32 v[20:21], v[20:21], v[144:145]
v_pk_mul_f32 v[22:23], v[22:23], v[146:147]
v_exp_f32 v16, v16
v_exp_f32 v17, v17
v_exp_f32 v18, v18
v_exp_f32 v19, v19
v_exp_f32 v20, v20
v_exp_f32 v21, v21
v_exp_f32 v22, v22
v_exp_f32 v23, v23
v_pk_add_f32 v[16:17], v[16:17], 1.0 op_sel_hi:[1,0]
v_pk_add_f32 v[18:19], v[18:19], 1.0 op_sel_hi:[1,0]
v_pk_add_f32 v[20:21], v[20:21], 1.0 op_sel_hi:[1,0]
v_pk_add_f32 v[22:23], v[22:23], 1.0 op_sel_hi:[1,0]
v_rcp_f32 v16, v16
v_rcp_f32 v17, v17
v_rcp_f32 v18, v18
v_rcp_f32 v19, v19
v_rcp_f32 v20, v20
v_rcp_f32 v21, v21
v_rcp_f32 v22, v22
v_rcp_f32 v23, v23
v_pk_mul_f32 v[128:129], v[128:129], v[16:17]
v_pk_mul_f32 v[130:131], v[130:131], v[18:19]
v_pk_mul_f32 v[144:145], v[144:145], v[20:21]
v_pk_mul_f32 v[146:147], v[146:147], v[22:23]
v_cvt_pk_bf16_f32 v24, v128, v129
v_cvt_pk_bf16_f32 v25, v130, v131
v_cvt_pk_bf16_f32 v26, v144, v145
v_cvt_pk_bf16_f32 v27, v146, v147
s_mov_b32 s27, 2048
buffer_store_dwordx4 v[24:27], v5, s[56:59], s27 offen
v_pk_fma_f32 v[132:133], v[132:133], v[56:57], v[8:9] op_sel:[0,1,0] op_sel_hi:[1,1,1]
v_pk_fma_f32 v[134:135], v[134:135], v[56:57], v[10:11] op_sel:[0,1,0] op_sel_hi:[1,1,1]
v_pk_fma_f32 v[148:149], v[148:149], v[56:57], v[12:13] op_sel:[0,1,0] op_sel_hi:[1,1,1]
v_pk_fma_f32 v[150:151], v[150:151], v[56:57], v[14:15] op_sel:[0,1,0] op_sel_hi:[1,1,1]
v_pk_mul_f32 v[16:17], v[132:133], v[132:133]
v_pk_mul_f32 v[18:19], v[134:135], v[134:135]
v_pk_mul_f32 v[20:21], v[148:149], v[148:149]
v_pk_mul_f32 v[22:23], v[150:151], v[150:151]
v_pk_fma_f32 v[16:17], v[16:17], s[30:31], v[6:7]
v_pk_fma_f32 v[18:19], v[18:19], s[30:31], v[6:7]
v_pk_fma_f32 v[20:21], v[20:21], s[30:31], v[6:7]
v_pk_fma_f32 v[22:23], v[22:23], s[30:31], v[6:7]
v_pk_mul_f32 v[16:17], v[16:17], v[132:133]
v_pk_mul_f32 v[18:19], v[18:19], v[134:135]
v_pk_mul_f32 v[20:21], v[20:21], v[148:149]
v_pk_mul_f32 v[22:23], v[22:23], v[150:151]
v_exp_f32 v16, v16
v_exp_f32 v17, v17
v_exp_f32 v18, v18
v_exp_f32 v19, v19
v_exp_f32 v20, v20
v_exp_f32 v21, v21
v_exp_f32 v22, v22
v_exp_f32 v23, v23
v_pk_add_f32 v[16:17], v[16:17], 1.0 op_sel_hi:[1,0]
v_pk_add_f32 v[18:19], v[18:19], 1.0 op_sel_hi:[1,0]
v_pk_add_f32 v[20:21], v[20:21], 1.0 op_sel_hi:[1,0]
v_pk_add_f32 v[22:23], v[22:23], 1.0 op_sel_hi:[1,0]
v_rcp_f32 v16, v16
v_rcp_f32 v17, v17
v_rcp_f32 v18, v18
v_rcp_f32 v19, v19
v_rcp_f32 v20, v20
v_rcp_f32 v21, v21
v_rcp_f32 v22, v22
v_rcp_f32 v23, v23
v_pk_mul_f32 v[132:133], v[132:133], v[16:17]
v_pk_mul_f32 v[134:135], v[134:135], v[18:19]
v_pk_mul_f32 v[148:149], v[148:149], v[20:21]
v_pk_mul_f32 v[150:151], v[150:151], v[22:23]
v_cvt_pk_bf16_f32 v28, v132, v133
v_cvt_pk_bf16_f32 v29, v134, v135
v_cvt_pk_bf16_f32 v30, v148, v149
v_cvt_pk_bf16_f32 v31, v150, v151
s_mov_b32 s27, 116736
buffer_store_dwordx4 v[28:31], v5, s[56:59], s27 offen
v_pk_fma_f32 v[136:137], v[136:137], v[58:59], v[8:9] op_sel_hi:[1,0,1]
v_pk_fma_f32 v[138:139], v[138:139], v[58:59], v[10:11] op_sel_hi:[1,0,1]
v_pk_fma_f32 v[152:153], v[152:153], v[58:59], v[12:13] op_sel_hi:[1,0,1]
v_pk_fma_f32 v[154:155], v[154:155], v[58:59], v[14:15] op_sel_hi:[1,0,1]
v_pk_mul_f32 v[16:17], v[136:137], v[136:137]
v_pk_mul_f32 v[18:19], v[138:139], v[138:139]
v_pk_mul_f32 v[20:21], v[152:153], v[152:153]
v_pk_mul_f32 v[22:23], v[154:155], v[154:155]
v_pk_fma_f32 v[16:17], v[16:17], s[30:31], v[6:7]
v_pk_fma_f32 v[18:19], v[18:19], s[30:31], v[6:7]
v_pk_fma_f32 v[20:21], v[20:21], s[30:31], v[6:7]
v_pk_fma_f32 v[22:23], v[22:23], s[30:31], v[6:7]
v_pk_mul_f32 v[16:17], v[16:17], v[136:137]
v_pk_mul_f32 v[18:19], v[18:19], v[138:139]
v_pk_mul_f32 v[20:21], v[20:21], v[152:153]
v_pk_mul_f32 v[22:23], v[22:23], v[154:155]
v_exp_f32 v16, v16
v_exp_f32 v17, v17
v_exp_f32 v18, v18
v_exp_f32 v19, v19
v_exp_f32 v20, v20
v_exp_f32 v21, v21
v_exp_f32 v22, v22
v_exp_f32 v23, v23
v_pk_add_f32 v[16:17], v[16:17], 1.0 op_sel_hi:[1,0]
v_pk_add_f32 v[18:19], v[18:19], 1.0 op_sel_hi:[1,0]
v_pk_add_f32 v[20:21], v[20:21], 1.0 op_sel_hi:[1,0]
v_pk_add_f32 v[22:23], v[22:23], 1.0 op_sel_hi:[1,0]
v_rcp_f32 v16, v16
v_rcp_f32 v17, v17
v_rcp_f32 v18, v18
v_rcp_f32 v19, v19
v_rcp_f32 v20, v20
v_rcp_f32 v21, v21
v_rcp_f32 v22, v22
v_rcp_f32 v23, v23
v_pk_mul_f32 v[136:137], v[136:137], v[16:17]
v_pk_mul_f32 v[138:139], v[138:139], v[18:19]
v_pk_mul_f32 v[152:153], v[152:153], v[20:21]
v_pk_mul_f32 v[154:155], v[154:155], v[22:23]
v_cvt_pk_bf16_f32 v24, v136, v137
v_cvt_pk_bf16_f32 v25, v138, v139
v_cvt_pk_bf16_f32 v26, v152, v153
v_cvt_pk_bf16_f32 v27, v154, v155
s_mov_b32 s27, 231424
buffer_store_dwordx4 v[24:27], v5, s[56:59], s27 offen
v_pk_fma_f32 v[140:141], v[140:141], v[58:59], v[8:9] op_sel:[0,1,0] op_sel_hi:[1,1,1]
v_pk_fma_f32 v[142:143], v[142:143], v[58:59], v[10:11] op_sel:[0,1,0] op_sel_hi:[1,1,1]
v_pk_fma_f32 v[156:157], v[156:157], v[58:59], v[12:13] op_sel:[0,1,0] op_sel_hi:[1,1,1]
v_pk_fma_f32 v[158:159], v[158:159], v[58:59], v[14:15] op_sel:[0,1,0] op_sel_hi:[1,1,1]
v_pk_mul_f32 v[16:17], v[140:141], v[140:141]
v_pk_mul_f32 v[18:19], v[142:143], v[142:143]
v_pk_mul_f32 v[20:21], v[156:157], v[156:157]
v_pk_mul_f32 v[22:23], v[158:159], v[158:159]
v_pk_fma_f32 v[16:17], v[16:17], s[30:31], v[6:7]
v_pk_fma_f32 v[18:19], v[18:19], s[30:31], v[6:7]
v_pk_fma_f32 v[20:21], v[20:21], s[30:31], v[6:7]
v_pk_fma_f32 v[22:23], v[22:23], s[30:31], v[6:7]
v_pk_mul_f32 v[16:17], v[16:17], v[140:141]
v_pk_mul_f32 v[18:19], v[18:19], v[142:143]
v_pk_mul_f32 v[20:21], v[20:21], v[156:157]
v_pk_mul_f32 v[22:23], v[22:23], v[158:159]
v_exp_f32 v16, v16
v_exp_f32 v17, v17
v_exp_f32 v18, v18
v_exp_f32 v19, v19
v_exp_f32 v20, v20
v_exp_f32 v21, v21
v_exp_f32 v22, v22
v_exp_f32 v23, v23
v_pk_add_f32 v[16:17], v[16:17], 1.0 op_sel_hi:[1,0]
v_pk_add_f32 v[18:19], v[18:19], 1.0 op_sel_hi:[1,0]
v_pk_add_f32 v[20:21], v[20:21], 1.0 op_sel_hi:[1,0]
v_pk_add_f32 v[22:23], v[22:23], 1.0 op_sel_hi:[1,0]
v_rcp_f32 v16, v16
v_rcp_f32 v17, v17
v_rcp_f32 v18, v18
v_rcp_f32 v19, v19
v_rcp_f32 v20, v20
v_rcp_f32 v21, v21
v_rcp_f32 v22, v22
v_rcp_f32 v23, v23
v_pk_mul_f32 v[140:141], v[140:141], v[16:17]
v_pk_mul_f32 v[142:143], v[142:143], v[18:19]
v_pk_mul_f32 v[156:157], v[156:157], v[20:21]
v_pk_mul_f32 v[158:159], v[158:159], v[22:23]
v_cvt_pk_bf16_f32 v28, v140, v141
v_cvt_pk_bf16_f32 v29, v142, v143
v_cvt_pk_bf16_f32 v30, v156, v157
v_cvt_pk_bf16_f32 v31, v158, v159
s_mov_b32 s27, 346112
buffer_store_dwordx4 v[28:31], v5, s[56:59], s27 offen
v_lshlrev_b32 v8, 16, v44
v_and_b32 v9, 0xffff0000, v44
v_lshlrev_b32 v10, 16, v45
v_and_b32 v11, 0xffff0000, v45
v_lshlrev_b32 v12, 16, v46
v_and_b32 v13, 0xffff0000, v46
v_lshlrev_b32 v14, 16, v47
v_and_b32 v15, 0xffff0000, v47
v_pk_fma_f32 v[160:161], v[160:161], v[56:57], v[8:9] op_sel_hi:[1,0,1]
v_pk_fma_f32 v[162:163], v[162:163], v[56:57], v[10:11] op_sel_hi:[1,0,1]
v_pk_fma_f32 v[176:177], v[176:177], v[56:57], v[12:13] op_sel_hi:[1,0,1]
v_pk_fma_f32 v[178:179], v[178:179], v[56:57], v[14:15] op_sel_hi:[1,0,1]
v_pk_mul_f32 v[16:17], v[160:161], v[160:161]
v_pk_mul_f32 v[18:19], v[162:163], v[162:163]
v_pk_mul_f32 v[20:21], v[176:177], v[176:177]
v_pk_mul_f32 v[22:23], v[178:179], v[178:179]
v_pk_fma_f32 v[16:17], v[16:17], s[30:31], v[6:7]
v_pk_fma_f32 v[18:19], v[18:19], s[30:31], v[6:7]
v_pk_fma_f32 v[20:21], v[20:21], s[30:31], v[6:7]
v_pk_fma_f32 v[22:23], v[22:23], s[30:31], v[6:7]
v_pk_mul_f32 v[16:17], v[16:17], v[160:161]
v_pk_mul_f32 v[18:19], v[18:19], v[162:163]
v_pk_mul_f32 v[20:21], v[20:21], v[176:177]
v_pk_mul_f32 v[22:23], v[22:23], v[178:179]
v_exp_f32 v16, v16
v_exp_f32 v17, v17
v_exp_f32 v18, v18
v_exp_f32 v19, v19
v_exp_f32 v20, v20
v_exp_f32 v21, v21
v_exp_f32 v22, v22
v_exp_f32 v23, v23
v_pk_add_f32 v[16:17], v[16:17], 1.0 op_sel_hi:[1,0]
v_pk_add_f32 v[18:19], v[18:19], 1.0 op_sel_hi:[1,0]
v_pk_add_f32 v[20:21], v[20:21], 1.0 op_sel_hi:[1,0]
v_pk_add_f32 v[22:23], v[22:23], 1.0 op_sel_hi:[1,0]
v_rcp_f32 v16, v16
v_rcp_f32 v17, v17
v_rcp_f32 v18, v18
v_rcp_f32 v19, v19
v_rcp_f32 v20, v20
v_rcp_f32 v21, v21
v_rcp_f32 v22, v22
v_rcp_f32 v23, v23
v_pk_mul_f32 v[160:161], v[160:161], v[16:17]
v_pk_mul_f32 v[162:163], v[162:163], v[18:19]
v_pk_mul_f32 v[176:177], v[176:177], v[20:21]
v_pk_mul_f32 v[178:179], v[178:179], v[22:23]
v_cvt_pk_bf16_f32 v24, v160, v161
v_cvt_pk_bf16_f32 v25, v162, v163
v_cvt_pk_bf16_f32 v26, v176, v177
v_cvt_pk_bf16_f32 v27, v178, v179
s_mov_b32 s27, 3072
buffer_store_dwordx4 v[24:27], v5, s[56:59], s27 offen
v_pk_fma_f32 v[164:165], v[164:165], v[56:57], v[8:9] op_sel:[0,1,0] op_sel_hi:[1,1,1]
v_pk_fma_f32 v[166:167], v[166:167], v[56:57], v[10:11] op_sel:[0,1,0] op_sel_hi:[1,1,1]
v_pk_fma_f32 v[180:181], v[180:181], v[56:57], v[12:13] op_sel:[0,1,0] op_sel_hi:[1,1,1]
v_pk_fma_f32 v[182:183], v[182:183], v[56:57], v[14:15] op_sel:[0,1,0] op_sel_hi:[1,1,1]
v_pk_mul_f32 v[16:17], v[164:165], v[164:165]
v_pk_mul_f32 v[18:19], v[166:167], v[166:167]
v_pk_mul_f32 v[20:21], v[180:181], v[180:181]
v_pk_mul_f32 v[22:23], v[182:183], v[182:183]
v_pk_fma_f32 v[16:17], v[16:17], s[30:31], v[6:7]
v_pk_fma_f32 v[18:19], v[18:19], s[30:31], v[6:7]
v_pk_fma_f32 v[20:21], v[20:21], s[30:31], v[6:7]
v_pk_fma_f32 v[22:23], v[22:23], s[30:31], v[6:7]
v_pk_mul_f32 v[16:17], v[16:17], v[164:165]
v_pk_mul_f32 v[18:19], v[18:19], v[166:167]
v_pk_mul_f32 v[20:21], v[20:21], v[180:181]
v_pk_mul_f32 v[22:23], v[22:23], v[182:183]
v_exp_f32 v16, v16
v_exp_f32 v17, v17
v_exp_f32 v18, v18
v_exp_f32 v19, v19
v_exp_f32 v20, v20
v_exp_f32 v21, v21
v_exp_f32 v22, v22
v_exp_f32 v23, v23
v_pk_add_f32 v[16:17], v[16:17], 1.0 op_sel_hi:[1,0]
v_pk_add_f32 v[18:19], v[18:19], 1.0 op_sel_hi:[1,0]
v_pk_add_f32 v[20:21], v[20:21], 1.0 op_sel_hi:[1,0]
v_pk_add_f32 v[22:23], v[22:23], 1.0 op_sel_hi:[1,0]
v_rcp_f32 v16, v16
v_rcp_f32 v17, v17
v_rcp_f32 v18, v18
v_rcp_f32 v19, v19
v_rcp_f32 v20, v20
v_rcp_f32 v21, v21
v_rcp_f32 v22, v22
v_rcp_f32 v23, v23
v_pk_mul_f32 v[164:165], v[164:165], v[16:17]
v_pk_mul_f32 v[166:167], v[166:167], v[18:19]
v_pk_mul_f32 v[180:181], v[180:181], v[20:21]
v_pk_mul_f32 v[182:183], v[182:183], v[22:23]
v_cvt_pk_bf16_f32 v28, v164, v165
v_cvt_pk_bf16_f32 v29, v166, v167
v_cvt_pk_bf16_f32 v30, v180, v181
v_cvt_pk_bf16_f32 v31, v182, v183
s_mov_b32 s27, 117760
buffer_store_dwordx4 v[28:31], v5, s[56:59], s27 offen
v_pk_fma_f32 v[168:169], v[168:169], v[58:59], v[8:9] op_sel_hi:[1,0,1]
v_pk_fma_f32 v[170:171], v[170:171], v[58:59], v[10:11] op_sel_hi:[1,0,1]
v_pk_fma_f32 v[184:185], v[184:185], v[58:59], v[12:13] op_sel_hi:[1,0,1]
v_pk_fma_f32 v[186:187], v[186:187], v[58:59], v[14:15] op_sel_hi:[1,0,1]
v_pk_mul_f32 v[16:17], v[168:169], v[168:169]
v_pk_mul_f32 v[18:19], v[170:171], v[170:171]
v_pk_mul_f32 v[20:21], v[184:185], v[184:185]
v_pk_mul_f32 v[22:23], v[186:187], v[186:187]
v_pk_fma_f32 v[16:17], v[16:17], s[30:31], v[6:7]
v_pk_fma_f32 v[18:19], v[18:19], s[30:31], v[6:7]
v_pk_fma_f32 v[20:21], v[20:21], s[30:31], v[6:7]
v_pk_fma_f32 v[22:23], v[22:23], s[30:31], v[6:7]
v_pk_mul_f32 v[16:17], v[16:17], v[168:169]
v_pk_mul_f32 v[18:19], v[18:19], v[170:171]
v_pk_mul_f32 v[20:21], v[20:21], v[184:185]
v_pk_mul_f32 v[22:23], v[22:23], v[186:187]
v_exp_f32 v16, v16
v_exp_f32 v17, v17
v_exp_f32 v18, v18
v_exp_f32 v19, v19
v_exp_f32 v20, v20
v_exp_f32 v21, v21
v_exp_f32 v22, v22
v_exp_f32 v23, v23
v_pk_add_f32 v[16:17], v[16:17], 1.0 op_sel_hi:[1,0]
v_pk_add_f32 v[18:19], v[18:19], 1.0 op_sel_hi:[1,0]
v_pk_add_f32 v[20:21], v[20:21], 1.0 op_sel_hi:[1,0]
v_pk_add_f32 v[22:23], v[22:23], 1.0 op_sel_hi:[1,0]
v_rcp_f32 v16, v16
v_rcp_f32 v17, v17
v_rcp_f32 v18, v18
v_rcp_f32 v19, v19
v_rcp_f32 v20, v20
v_rcp_f32 v21, v21
v_rcp_f32 v22, v22
v_rcp_f32 v23, v23
v_pk_mul_f32 v[168:169], v[168:169], v[16:17]
v_pk_mul_f32 v[170:171], v[170:171], v[18:19]
v_pk_mul_f32 v[184:185], v[184:185], v[20:21]
v_pk_mul_f32 v[186:187], v[186:187], v[22:23]
v_cvt_pk_bf16_f32 v24, v168, v169
v_cvt_pk_bf16_f32 v25, v170, v171
v_cvt_pk_bf16_f32 v26, v184, v185
v_cvt_pk_bf16_f32 v27, v186, v187
s_mov_b32 s27, 232448
buffer_store_dwordx4 v[24:27], v5, s[56:59], s27 offen
v_pk_fma_f32 v[172:173], v[172:173], v[58:59], v[8:9] op_sel:[0,1,0] op_sel_hi:[1,1,1]
v_pk_fma_f32 v[174:175], v[174:175], v[58:59], v[10:11] op_sel:[0,1,0] op_sel_hi:[1,1,1]
v_pk_fma_f32 v[188:189], v[188:189], v[58:59], v[12:13] op_sel:[0,1,0] op_sel_hi:[1,1,1]
v_pk_fma_f32 v[190:191], v[190:191], v[58:59], v[14:15] op_sel:[0,1,0] op_sel_hi:[1,1,1]
v_pk_mul_f32 v[16:17], v[172:173], v[172:173]
v_pk_mul_f32 v[18:19], v[174:175], v[174:175]
v_pk_mul_f32 v[20:21], v[188:189], v[188:189]
v_pk_mul_f32 v[22:23], v[190:191], v[190:191]
v_pk_fma_f32 v[16:17], v[16:17], s[30:31], v[6:7]
v_pk_fma_f32 v[18:19], v[18:19], s[30:31], v[6:7]
v_pk_fma_f32 v[20:21], v[20:21], s[30:31], v[6:7]
v_pk_fma_f32 v[22:23], v[22:23], s[30:31], v[6:7]
v_pk_mul_f32 v[16:17], v[16:17], v[172:173]
v_pk_mul_f32 v[18:19], v[18:19], v[174:175]
v_pk_mul_f32 v[20:21], v[20:21], v[188:189]
v_pk_mul_f32 v[22:23], v[22:23], v[190:191]
v_exp_f32 v16, v16
v_exp_f32 v17, v17
v_exp_f32 v18, v18
v_exp_f32 v19, v19
v_exp_f32 v20, v20
v_exp_f32 v21, v21
v_exp_f32 v22, v22
v_exp_f32 v23, v23
v_pk_add_f32 v[16:17], v[16:17], 1.0 op_sel_hi:[1,0]
v_pk_add_f32 v[18:19], v[18:19], 1.0 op_sel_hi:[1,0]
v_pk_add_f32 v[20:21], v[20:21], 1.0 op_sel_hi:[1,0]
v_pk_add_f32 v[22:23], v[22:23], 1.0 op_sel_hi:[1,0]
v_rcp_f32 v16, v16
v_rcp_f32 v17, v17
v_rcp_f32 v18, v18
v_rcp_f32 v19, v19
v_rcp_f32 v20, v20
v_rcp_f32 v21, v21
v_rcp_f32 v22, v22
v_rcp_f32 v23, v23
v_pk_mul_f32 v[172:173], v[172:173], v[16:17]
v_pk_mul_f32 v[174:175], v[174:175], v[18:19]
v_pk_mul_f32 v[188:189], v[188:189], v[20:21]
v_pk_mul_f32 v[190:191], v[190:191], v[22:23]
v_cvt_pk_bf16_f32 v28, v172, v173
v_cvt_pk_bf16_f32 v29, v174, v175
v_cvt_pk_bf16_f32 v30, v188, v189
v_cvt_pk_bf16_f32 v31, v190, v191
s_mov_b32 s27, 347136
buffer_store_dwordx4 v[28:31], v5, s[56:59], s27 offen
s_endpgm
L_gemm1_kernel_end:
s_endpgm
.section .rodata,"a"
.p2align 6
.amdhsa_kernel gemm1_kernel
.amdhsa_next_free_vgpr 384
.amdhsa_next_free_sgpr 102
.amdhsa_accum_offset 256
.amdhsa_group_segment_fixed_size 0
.amdhsa_kernarg_size 88
.amdhsa_user_sgpr_count 2
.amdhsa_user_sgpr_kernarg_segment_ptr 1
.amdhsa_system_sgpr_workgroup_id_x 1
.amdhsa_float_denorm_mode_32 3
.end_amdhsa_kernel
.text
.globl mid_kernel
.p2align 8
.type mid_kernel,@function
mid_kernel:
s_cmp_ge_u32 s2, 512
s_cbranch_scc1 L_mid_kernel_end
s_load_dwordx2 s[4:5], s[0:1], 80
s_load_dwordx2 s[6:7], s[0:1], 48
s_load_dwordx2 s[60:61], s[0:1], 16
s_load_dwordx2 s[62:63], s[0:1], 0
s_load_dwordx4 s[64:67], s[0:1], 56
s_getpc_b64 s[98:99]
L_pc_mid_kernel:
s_sub_u32 s98, s98, L_pc_mid_kernel - mid_kernel
s_subb_u32 s99, s99, 0
s_lshr_b32 s97, s2, 3
s_and_b32 s97, s97, 31
s_lshl_b32 s97, s97, 15
v_lshlrev_b32 v6, 7, v0
v_add_u32 v6, s97, v6
s_mov_b32 s97, L_mid_kernel_end - mid_kernel - 4
v_min_u32 v6, s97, v6
v_and_b32 v6, -4, v6
global_load_dword v7, v6, s[98:99]
s_and_b32 s28, s2, 255
s_cmp_ge_u32 s2, 256
s_waitcnt lgkmcnt(0)
s_cbranch_scc1 L_mid_kernel_gemm
s_and_b32 s29, s28, 7
s_lshr_b32 s30, s28, 3
s_lshr_b32 s31, s30, 3
s_lshl_b32 s29, s29, 2
s_add_u32 s29, s29, s31
s_and_b32 s30, s30, 7
v_lshrrev_b32 v4, 6, v0
v_and_b32 v5, 63, v0
v_readfirstlane_b32 s24, v4
v_lshlrev_b32 v1, 4, v5
s_lshl_b32 s31, s29, 17
s_add_u32 s8, s4, 0x800000
s_addc_u32 s9, s5, 0
s_add_u32 s8, s8, s31
s_addc_u32 s9, s9, 0
s_and_b32 s9, s9, 0xffff
s_mov_b32 s10, 0x20000
s_mov_b32 s11, 0x20000
s_add_u32 s12, s4, 0xc00000
s_addc_u32 s13, s5, 0
s_add_u32 s12, s12, s31
s_addc_u32 s13, s13, 0
s_and_b32 s13, s13, 0xffff
s_mov_b32 s14, 0x20000
s_mov_b32 s15, 0x20000
s_add_u32 s16, s4, 0x400000
s_addc_u32 s17, s5, 0
s_add_u32 s16, s16, s31
s_addc_u32 s17, s17, 0
s_and_b32 s17, s17, 0xffff
s_mov_b32 s18, 0x20000
s_mov_b32 s19, 0x20000
s_lshl_b32 s32, s30, 4
s_lshl_b32 s33, s24, 2
s_add_u32 s32, s32, s33
s_lshl_b32 s33, s32, 10
buffer_load_dwordx4 v[8:11], v1, s[16:19], s33 offen offset:0
buffer_load_dwordx4 v[12:15], v1, s[16:19], s33 offen offset:1024
buffer_load_dwordx4 v[16:19], v1, s[16:19], s33 offen offset:2048
buffer_load_dwordx4 v[20:23], v1, s[16:19], s33 offen offset:3072
s_lshl_b32 s34, s24, 11
v_add_u32 v3, s34, v1
s_mov_b32 s25, 0
s_mov_b32 s26, 0
s_add_u32 m0, s34, s26
s_nop 0
buffer_load_dwordx4 v3, s[8:11], s25 offen lds
buffer_load_dwordx4 v3, s[8:11], s25 offen offset:1024 lds
s_add_u32 m0, m0, 8192
s_nop 0
buffer_load_dwordx4 v3, s[12:15], s25 offen lds
buffer_load_dwordx4 v3, s[12:15], s25 offen offset:1024 lds
s_add_u32 s26, s26, 16384
s_and_b32 s26, s26, 0xffff
s_add_u32 s25, s25, 8192
s_add_u32 m0, s34, s26
s_nop 0
buffer_load_dwordx4 v3, s[8:11], s25 offen lds
buffer_load_dwordx4 v3, s[8:11], s25 offen offset:1024 lds
s_add_u32 m0, m0, 8192
s_nop 0
buffer_load_dwordx4 v3, s[12:15], s25 offen lds
buffer_load_dwordx4 v3, s[12:15], s25 offen offset:1024 lds
s_add_u32 s26, s26, 16384
s_and_b32 s26, s26, 0xffff
s_add_u32 s25, s25, 8192
s_add_u32 m0, s34, s26
s_nop 0
buffer_load_dwordx4 v3, s[8:11], s25 offen lds
v_add_u32 v2, 16384, v1
v_mov_b32 v56, 0x3f803f80
v_mov_b32 v57, 0x3f803f80
v_mov_b32 v58, 0x3f803f80
v_mov_b32 v59, 0x3f803f80
v_mov_b32 v60, 0
v_mov_b32 v61, 0
v_mov_b32 v62, 0
v_mov_b32 v63, 0
v_mov_b32 v64, 0
v_mov_b32 v65, 0
v_mov_b32 v66, 0
v_mov_b32 v67, 0
v_mov_b32 v68, 0
v_mov_b32 v69, 0
v_mov_b32 v70, 0
v_mov_b32 v71, 0
v_mov_b32 v72, 0
v_mov_b32 v73, 0
v_mov_b32 v74, 0
v_mov_b32 v75, 0
v_mov_b32 v76, 0
v_mov_b32 v77, 0
v_mov_b32 v78, 0
v_mov_b32 v79, 0
v_mov_b32 v80, 0
v_mov_b32 v81, 0
v_mov_b32 v82, 0
v_mov_b32 v83, 0
v_mov_b32 v84, 0
v_mov_b32 v85, 0
v_mov_b32 v86, 0
v_mov_b32 v87, 0
v_mov_b32 v88, 0
v_mov_b32 v89, 0
v_mov_b32 v90, 0
v_mov_b32 v91, 0
v_mov_b32 v92, 0
v_mov_b32 v93, 0
v_mov_b32 v94, 0
v_mov_b32 v95, 0
v_mov_b32 v96, 0
v_mov_b32 v97, 0
v_mov_b32 v98, 0
v_mov_b32 v99, 0
v_mov_b32 v100, 0
v_mov_b32 v101, 0
v_mov_b32 v102, 0
v_mov_b32 v103, 0
v_mov_b32 v104, 0
v_mov_b32 v105, 0
v_mov_b32 v106, 0
v_mov_b32 v107, 0
v_mov_b32 v140, 0
v_mov_b32 v141, 0
v_mov_b32 v142, 0
v_mov_b32 v143, 0
v_mov_b32 v144, 0
v_mov_b32 v145, 0
v_mov_b32 v146, 0
v_mov_b32 v147, 0
v_mov_b32 v48, 0
v_mov_b32 v49, 0
v_mov_b32 v50, 0
v_mov_b32 v51, 0
v_mov_b32 v52, 0
v_mov_b32 v53, 0
v_mov_b32 v54, 0
v_mov_b32 v55, 0
v_and_b32 v159, 63, v0
v_lshlrev_b32 v159, 4, v159
s_lshl_b32 s56, s32, 15
s_lshl_b32 s57, s29, 10
s_add_u32 s56, s56, s57
s_add_u32 s20, s4, 0x1000000
s_addc_u32 s21, s5, 0
s_and_b32 s21, s21, 0xffff
s_mov_b32 s22, 0x400000
s_mov_b32 s23, 0x20000
s_add_u32 s52, s4, 0x3d00000
s_addc_u32 s53, s5, 0
s_and_b32 s53, s53, 0xffff
s_mov_b32 s54, 0x20000
s_mov_b32 s55, 0x20000
v_and_b32 v156, 1, v0
v_bfe_u32 v157, v0, 1, 1
v_bfe_u32 v158, v0, 2, 3
v_lshl_add_u32 v157, v158, 2, v157
v_lshl_add_u32 v156, v157, 3, v156
s_lshr_b32 s36, s30, 1
s_lshl_b32 s36, s36, 1
s_and_b32 s37, s30, 1
s_lshl_b32 s37, s37, 4
s_add_u32 s36, s36, s37
v_add_u32 v156, s36, v156
v_lshlrev_b32 v156, 7, v156
s_lshl_b32 s36, s29, 2
s_add_u32 s36, s36, 0x10000
v_add_u32 v156, s36, v156
v_mov_b32 v157, 1
s_waitcnt vmcnt(5)
s_barrier
ds_read_b128 v[24:27], v1
ds_read_b128 v[28:31], v1 offset:1024
ds_read_b128 v[40:43], v1 offset:8192
ds_read_b128 v[44:47], v1 offset:9216
s_waitcnt lgkmcnt(0)
v_mfma_f32_16x16x32_bf16 v[108:111], v[24:27], v[8:11], 0
v_mfma_f32_16x16x32_bf16 v[112:115], v[28:31], v[8:11], 0
v_mfma_f32_16x16x32_bf16 v[116:119], v[24:27], v[12:15], 0
v_mfma_f32_16x16x32_bf16 v[120:123], v[28:31], v[12:15], 0
s_nop 7
s_mov_b32 s27, 16
.p2align 4
L_mid_kernel_a_loop:
v_mfma_f32_16x16x32_bf16 v[124:127], v[24:27], v[16:19], 0
ds_read_b128 v[32:35], v1 offset:2048
ds_read_b128 v[36:39], v1 offset:3072
v_exp_f32 v108, v108
v_exp_f32 v109, v109
v_mfma_f32_16x16x32_bf16 v[128:131], v[28:31], v[16:19], 0
v_exp_f32 v110, v110
v_exp_f32 v111, v111
v_cvt_pk_bf16_f32 v140, v108, v109
v_mfma_f32_16x16x32_bf16 v[100:103], v[48:51], v[144:147], v[100:103]
v_exp_f32 v112, v112
v_exp_f32 v113, v113
v_cvt_pk_bf16_f32 v141, v110, v111
v_mfma_f32_16x16x32_bf16 v[104:107], v[52:55], v[144:147], v[104:107]
buffer_load_dwordx4 v3, s[8:11], s25 offen offset:1024 lds
v_exp_f32 v114, v114
v_exp_f32 v115, v115
v_mfma_f32_16x16x32_bf16 v[72:75], v[56:59], v[144:147], v[72:75]
v_cvt_pk_bf16_f32 v142, v112, v113
v_cvt_pk_bf16_f32 v143, v114, v115
s_waitcnt lgkmcnt(2)
v_mfma_f32_16x16x32_bf16 v[132:135], v[24:27], v[20:23], 0
v_exp_f32 v116, v116
v_exp_f32 v117, v117
v_mfma_f32_16x16x32_bf16 v[136:139], v[28:31], v[20:23], 0
v_exp_f32 v118, v118
v_exp_f32 v119, v119
v_cvt_pk_bf16_f32 v144, v116, v117
v_mfma_f32_16x16x32_bf16 v[76:79], v[40:43], v[140:143], v[76:79]
v_exp_f32 v120, v120
v_exp_f32 v121, v121
v_cvt_pk_bf16_f32 v145, v118, v119
v_mfma_f32_16x16x32_bf16 v[80:83], v[44:47], v[140:143], v[80:83]
v_exp_f32 v122, v122
v_exp_f32 v123, v123
v_mfma_f32_16x16x32_bf16 v[60:63], v[56:59], v[140:143], v[60:63]
v_cvt_pk_bf16_f32 v146, v120, v121
v_cvt_pk_bf16_f32 v147, v122, v123
s_waitcnt lgkmcnt(0)
v_mfma_f32_16x16x32_bf16 v[108:111], v[32:35], v[8:11], 0
ds_read_b128 v[48:51], v1 offset:10240
ds_read_b128 v[52:55], v1 offset:11264
v_exp_f32 v124, v124
v_exp_f32 v125, v125
v_mfma_f32_16x16x32_bf16 v[112:115], v[36:39], v[8:11], 0
v_exp_f32 v126, v126
v_exp_f32 v127, v127
v_cvt_pk_bf16_f32 v140, v124, v125
v_mfma_f32_16x16x32_bf16 v[84:87], v[40:43], v[144:147], v[84:87]
v_exp_f32 v128, v128
v_exp_f32 v129, v129
v_cvt_pk_bf16_f32 v141, v126, v127
v_mfma_f32_16x16x32_bf16 v[88:91], v[44:47], v[144:147], v[88:91]
v_exp_f32 v130, v130
v_exp_f32 v131, v131
v_mfma_f32_16x16x32_bf16 v[64:67], v[56:59], v[144:147], v[64:67]
v_cvt_pk_bf16_f32 v142, v128, v129
v_cvt_pk_bf16_f32 v143, v130, v131
v_mfma_f32_16x16x32_bf16 v[116:119], v[32:35], v[12:15], 0
v_exp_f32 v132, v132
v_exp_f32 v133, v133
v_mfma_f32_16x16x32_bf16 v[120:123], v[36:39], v[12:15], 0
v_exp_f32 v134, v134
v_exp_f32 v135, v135
v_cvt_pk_bf16_f32 v144, v132, v133
v_mfma_f32_16x16x32_bf16 v[92:95], v[40:43], v[140:143], v[92:95]
v_exp_f32 v136, v136
v_exp_f32 v137, v137
v_cvt_pk_bf16_f32 v145, v134, v135
v_mfma_f32_16x16x32_bf16 v[96:99], v[44:47], v[140:143], v[96:99]
v_exp_f32 v138, v138
v_exp_f32 v139, v139
v_mfma_f32_16x16x32_bf16 v[68:71], v[56:59], v[140:143], v[68:71]
v_cvt_pk_bf16_f32 v146, v136, v137
v_cvt_pk_bf16_f32 v147, v138, v139
v_mfma_f32_16x16x32_bf16 v[124:127], v[32:35], v[16:19], 0
ds_read_b128 v[24:27], v1 offset:4096
ds_read_b128 v[28:31], v1 offset:5120
v_exp_f32 v108, v108
v_exp_f32 v109, v109
v_mfma_f32_16x16x32_bf16 v[128:131], v[36:39], v[16:19], 0
s_add_u32 m0, m0, 8192
v_exp_f32 v110, v110
v_exp_f32 v111, v111
v_cvt_pk_bf16_f32 v140, v108, v109
v_mfma_f32_16x16x32_bf16 v[100:103], v[40:43], v[144:147], v[100:103]
v_exp_f32 v112, v112
v_exp_f32 v113, v113
v_cvt_pk_bf16_f32 v141, v110, v111
v_mfma_f32_16x16x32_bf16 v[104:107], v[44:47], v[144:147], v[104:107]
buffer_load_dwordx4 v3, s[12:15], s25 offen lds
v_exp_f32 v114, v114
v_exp_f32 v115, v115
v_mfma_f32_16x16x32_bf16 v[72:75], v[56:59], v[144:147], v[72:75]
v_cvt_pk_bf16_f32 v142, v112, v113
v_cvt_pk_bf16_f32 v143, v114, v115
s_waitcnt lgkmcnt(2)
v_mfma_f32_16x16x32_bf16 v[132:135], v[32:35], v[20:23], 0
v_exp_f32 v116, v116
v_exp_f32 v117, v117
v_mfma_f32_16x16x32_bf16 v[136:139], v[36:39], v[20:23], 0
v_exp_f32 v118, v118
v_exp_f32 v119, v119
v_cvt_pk_bf16_f32 v144, v116, v117
v_mfma_f32_16x16x32_bf16 v[76:79], v[48:51], v[140:143], v[76:79]
v_exp_f32 v120, v120
v_exp_f32 v121, v121
v_cvt_pk_bf16_f32 v145, v118, v119
v_mfma_f32_16x16x32_bf16 v[80:83], v[52:55], v[140:143], v[80:83]
v_exp_f32 v122, v122
v_exp_f32 v123, v123
v_mfma_f32_16x16x32_bf16 v[60:63], v[56:59], v[140:143], v[60:63]
v_cvt_pk_bf16_f32 v146, v120, v121
v_cvt_pk_bf16_f32 v147, v122, v123
s_waitcnt lgkmcnt(0)
v_mfma_f32_16x16x32_bf16 v[108:111], v[24:27], v[8:11], 0
ds_read_b128 v[40:43], v1 offset:12288
ds_read_b128 v[44:47], v1 offset:13312
v_exp_f32 v124, v124
v_exp_f32 v125, v125
v_mfma_f32_16x16x32_bf16 v[112:115], v[28:31], v[8:11], 0
v_exp_f32 v126, v126
v_exp_f32 v127, v127
v_cvt_pk_bf16_f32 v140, v124, v125
v_mfma_f32_16x16x32_bf16 v[84:87], v[48:51], v[144:147], v[84:87]
v_exp_f32 v128, v128
v_exp_f32 v129, v129
v_cvt_pk_bf16_f32 v141, v126, v127
v_mfma_f32_16x16x32_bf16 v[88:91], v[52:55], v[144:147], v[88:91]
v_exp_f32 v130, v130
v_exp_f32 v131, v131
v_mfma_f32_16x16x32_bf16 v[64:67], v[56:59], v[144:147], v[64:67]
v_cvt_pk_bf16_f32 v142, v128, v129
v_cvt_pk_bf16_f32 v143, v130, v131
v_mfma_f32_16x16x32_bf16 v[116:119], v[24:27], v[12:15], 0
v_exp_f32 v132, v132
v_exp_f32 v133, v133
v_mfma_f32_16x16x32_bf16 v[120:123], v[28:31], v[12:15], 0
v_exp_f32 v134, v134
v_exp_f32 v135, v135
v_cvt_pk_bf16_f32 v144, v132, v133
v_mfma_f32_16x16x32_bf16 v[92:95], v[48:51], v[140:143], v[92:95]
v_exp_f32 v136, v136
v_exp_f32 v137, v137
v_cvt_pk_bf16_f32 v145, v134, v135
v_mfma_f32_16x16x32_bf16 v[96:99], v[52:55], v[140:143], v[96:99]
v_exp_f32 v138, v138
v_exp_f32 v139, v139
v_mfma_f32_16x16x32_bf16 v[68:71], v[56:59], v[140:143], v[68:71]
v_cvt_pk_bf16_f32 v146, v136, v137
v_cvt_pk_bf16_f32 v147, v138, v139
v_mfma_f32_16x16x32_bf16 v[124:127], v[24:27], v[16:19], 0
ds_read_b128 v[32:35], v1 offset:6144
ds_read_b128 v[36:39], v1 offset:7168
v_exp_f32 v108, v108
v_exp_f32 v109, v109
v_mfma_f32_16x16x32_bf16 v[128:131], v[28:31], v[16:19], 0
v_exp_f32 v110, v110
v_exp_f32 v111, v111
v_cvt_pk_bf16_f32 v140, v108, v109
v_mfma_f32_16x16x32_bf16 v[100:103], v[48:51], v[144:147], v[100:103]
v_exp_f32 v112, v112
v_exp_f32 v113, v113
v_cvt_pk_bf16_f32 v141, v110, v111
v_mfma_f32_16x16x32_bf16 v[104:107], v[52:55], v[144:147], v[104:107]
buffer_load_dwordx4 v3, s[12:15], s25 offen offset:1024 lds
s_add_u32 s26, s26, 16384
s_and_b32 s26, s26, 0xffff
s_add_u32 s25, s25, 8192
v_exp_f32 v114, v114
v_exp_f32 v115, v115
v_mfma_f32_16x16x32_bf16 v[72:75], v[56:59], v[144:147], v[72:75]
v_cvt_pk_bf16_f32 v142, v112, v113
v_cvt_pk_bf16_f32 v143, v114, v115
s_waitcnt lgkmcnt(2)
v_mfma_f32_16x16x32_bf16 v[132:135], v[24:27], v[20:23], 0
v_exp_f32 v116, v116
v_exp_f32 v117, v117
v_mfma_f32_16x16x32_bf16 v[136:139], v[28:31], v[20:23], 0
v_exp_f32 v118, v118
v_exp_f32 v119, v119
v_cvt_pk_bf16_f32 v144, v116, v117
v_mfma_f32_16x16x32_bf16 v[76:79], v[40:43], v[140:143], v[76:79]
v_exp_f32 v120, v120
v_exp_f32 v121, v121
v_cvt_pk_bf16_f32 v145, v118, v119
v_mfma_f32_16x16x32_bf16 v[80:83], v[44:47], v[140:143], v[80:83]
v_exp_f32 v122, v122
v_exp_f32 v123, v123
v_mfma_f32_16x16x32_bf16 v[60:63], v[56:59], v[140:143], v[60:63]
v_cvt_pk_bf16_f32 v146, v120, v121
v_cvt_pk_bf16_f32 v147, v122, v123
s_waitcnt lgkmcnt(0)
v_mfma_f32_16x16x32_bf16 v[108:111], v[32:35], v[8:11], 0
ds_read_b128 v[48:51], v1 offset:14336
ds_read_b128 v[52:55], v1 offset:15360
v_exp_f32 v124, v124
v_exp_f32 v125, v125
v_mfma_f32_16x16x32_bf16 v[112:115], v[36:39], v[8:11], 0
v_exp_f32 v126, v126
v_exp_f32 v127, v127
v_cvt_pk_bf16_f32 v140, v124, v125
v_mfma_f32_16x16x32_bf16 v[84:87], v[40:43], v[144:147], v[84:87]
v_exp_f32 v128, v128
v_exp_f32 v129, v129
v_cvt_pk_bf16_f32 v141, v126, v127
v_mfma_f32_16x16x32_bf16 v[88:91], v[44:47], v[144:147], v[88:91]
v_exp_f32 v130, v130
v_exp_f32 v131, v131
v_mfma_f32_16x16x32_bf16 v[64:67], v[56:59], v[144:147], v[64:67]
v_cvt_pk_bf16_f32 v142, v128, v129
v_cvt_pk_bf16_f32 v143, v130, v131
v_mfma_f32_16x16x32_bf16 v[116:119], v[32:35], v[12:15], 0
v_exp_f32 v132, v132
v_exp_f32 v133, v133
v_mfma_f32_16x16x32_bf16 v[120:123], v[36:39], v[12:15], 0
v_exp_f32 v134, v134
v_exp_f32 v135, v135
v_cvt_pk_bf16_f32 v144, v132, v133
v_mfma_f32_16x16x32_bf16 v[92:95], v[40:43], v[140:143], v[92:95]
v_exp_f32 v136, v136
v_exp_f32 v137, v137
v_cvt_pk_bf16_f32 v145, v134, v135
v_mfma_f32_16x16x32_bf16 v[96:99], v[44:47], v[140:143], v[96:99]
v_exp_f32 v138, v138
v_exp_f32 v139, v139
v_mfma_f32_16x16x32_bf16 v[68:71], v[56:59], v[140:143], v[68:71]
v_cvt_pk_bf16_f32 v146, v136, v137
v_cvt_pk_bf16_f32 v147, v138, v139
v_mfma_f32_16x16x32_bf16 v[124:127], v[32:35], v[16:19], 0
s_waitcnt vmcnt(4)
s_barrier
ds_read_b128 v[24:27], v2
ds_read_b128 v[28:31], v2 offset:1024
v_exp_f32 v108, v108
v_exp_f32 v109, v109
v_mfma_f32_16x16x32_bf16 v[128:131], v[36:39], v[16:19], 0
s_add_u32 m0, s34, s26
v_exp_f32 v110, v110
v_exp_f32 v111, v111
v_cvt_pk_bf16_f32 v140, v108, v109
v_mfma_f32_16x16x32_bf16 v[100:103], v[40:43], v[144:147], v[100:103]
v_exp_f32 v112, v112
v_exp_f32 v113, v113
v_cvt_pk_bf16_f32 v141, v110, v111
v_mfma_f32_16x16x32_bf16 v[104:107], v[44:47], v[144:147], v[104:107]
buffer_load_dwordx4 v3, s[8:11], s25 offen lds
v_exp_f32 v114, v114
v_exp_f32 v115, v115
v_mfma_f32_16x16x32_bf16 v[72:75], v[56:59], v[144:147], v[72:75]
v_cvt_pk_bf16_f32 v142, v112, v113
v_cvt_pk_bf16_f32 v143, v114, v115
s_waitcnt lgkmcnt(2)
v_mfma_f32_16x16x32_bf16 v[132:135], v[32:35], v[20:23], 0
v_exp_f32 v116, v116
v_exp_f32 v117, v117
v_mfma_f32_16x16x32_bf16 v[136:139], v[36:39], v[20:23], 0
v_exp_f32 v118, v118
v_exp_f32 v119, v119
v_cvt_pk_bf16_f32 v144, v116, v117
v_mfma_f32_16x16x32_bf16 v[76:79], v[48:51], v[140:143], v[76:79]
v_exp_f32 v120, v120
v_exp_f32 v121, v121
v_cvt_pk_bf16_f32 v145, v118, v119
v_mfma_f32_16x16x32_bf16 v[80:83], v[52:55], v[140:143], v[80:83]
v_exp_f32 v122, v122
v_exp_f32 v123, v123
v_mfma_f32_16x16x32_bf16 v[60:63], v[56:59], v[140:143], v[60:63]
v_cvt_pk_bf16_f32 v146, v120, v121
v_cvt_pk_bf16_f32 v147, v122, v123
s_waitcnt lgkmcnt(0)
v_mfma_f32_16x16x32_bf16 v[108:111], v[24:27], v[8:11], 0
ds_read_b128 v[40:43], v2 offset:8192
ds_read_b128 v[44:47], v2 offset:9216
v_exp_f32 v124, v124
v_exp_f32 v125, v125
v_mfma_f32_16x16x32_bf16 v[112:115], v[28:31], v[8:11], 0
v_mov_b32 v1, v2
v_add_u32 v2, 16384, v2
v_and_b32 v2, 0xffff, v2
v_exp_f32 v126, v126
v_exp_f32 v127, v127
v_cvt_pk_bf16_f32 v140, v124, v125
v_mfma_f32_16x16x32_bf16 v[84:87], v[48:51], v[144:147], v[84:87]
v_exp_f32 v128, v128
v_exp_f32 v129, v129
v_cvt_pk_bf16_f32 v141, v126, v127
v_mfma_f32_16x16x32_bf16 v[88:91], v[52:55], v[144:147], v[88:91]
v_exp_f32 v130, v130
v_exp_f32 v131, v131
v_mfma_f32_16x16x32_bf16 v[64:67], v[56:59], v[144:147], v[64:67]
v_cvt_pk_bf16_f32 v142, v128, v129
v_cvt_pk_bf16_f32 v143, v130, v131
v_mfma_f32_16x16x32_bf16 v[116:119], v[24:27], v[12:15], 0
v_exp_f32 v132, v132
v_exp_f32 v133, v133
v_mfma_f32_16x16x32_bf16 v[120:123], v[28:31], v[12:15], 0
v_exp_f32 v134, v134
v_exp_f32 v135, v135
v_cvt_pk_bf16_f32 v144, v132, v133
v_mfma_f32_16x16x32_bf16 v[92:95], v[48:51], v[140:143], v[92:95]
v_exp_f32 v136, v136
v_exp_f32 v137, v137
v_cvt_pk_bf16_f32 v145, v134, v135
v_mfma_f32_16x16x32_bf16 v[96:99], v[52:55], v[140:143], v[96:99]
v_exp_f32 v138, v138
v_exp_f32 v139, v139
v_mfma_f32_16x16x32_bf16 v[68:71], v[56:59], v[140:143], v[68:71]
v_cvt_pk_bf16_f32 v146, v136, v137
v_cvt_pk_bf16_f32 v147, v138, v139
s_sub_u32 s27, s27, 1
s_cmp_lg_u32 s27, 0
s_cbranch_scc1 L_mid_kernel_a_loop
s_nop 1
v_mfma_f32_16x16x32_bf16 v[100:103], v[48:51], v[144:147], v[100:103]
v_mfma_f32_16x16x32_bf16 v[104:107], v[52:55], v[144:147], v[104:107]
v_mfma_f32_16x16x32_bf16 v[72:75], v[56:59], v[144:147], v[72:75]
s_waitcnt vmcnt(0) lgkmcnt(0)
s_mov_b32 s58, 0
s_nop 7
L_mid_kernel_a_epi:
s_mov_b32 s38, 0x35800000
s_mov_b32 s39, 0x71800000
v_min_f32 v5, v60, v64
v_min3_f32 v5, v68, v72, v5
v_cmp_le_f32 s[42:43], s38, v5
v_cmp_ge_f32 s[44:45], s39, v60
v_cmp_ge_f32 s[46:47], s39, v64
v_cmp_ge_f32 s[48:49], s39, v68
v_cmp_ge_f32 s[50:51], s39, v72
v_mul_f32 v60, 0x3f014852, v60
v_mul_f32 v64, 0x3f014852, v64
v_mul_f32 v68, 0x3f014852, v68
v_mul_f32 v72, 0x3f014852, v72
v_rcp_f32 v60, v60
v_rcp_f32 v64, v64
v_rcp_f32 v68, v68
v_rcp_f32 v72, v72
s_mov_b32 s33, s56
v_pk_mul_f32 v[76:77], v[76:77], v[60:61] op_sel_hi:[1,0]
v_pk_mul_f32 v[78:79], v[78:79], v[60:61] op_sel_hi:[1,0]
v_pk_mul_f32 v[80:81], v[80:81], v[60:61] op_sel_hi:[1,0]
v_pk_mul_f32 v[82:83], v[82:83], v[60:61] op_sel_hi:[1,0]
v_cvt_pk_bf16_f32 v108, v76, v77
v_cvt_pk_bf16_f32 v109, v78, v79
v_cvt_pk_bf16_f32 v110, v80, v81
v_cvt_pk_bf16_f32 v111, v82, v83
buffer_store_dwordx4 v[108:111], v159, s[20:23], s33 offen sc1
s_add_u32 s33, s33, 32768
v_pk_mul_f32 v[84:85], v[84:85], v[64:65] op_sel_hi:[1,0]
v_pk_mul_f32 v[86:87], v[86:87], v[64:65] op_sel_hi:[1,0]
v_pk_mul_f32 v[88:89], v[88:89], v[64:65] op_sel_hi:[1,0]
v_pk_mul_f32 v[90:91], v[90:91], v[64:65] op_sel_hi:[1,0]
v_cvt_pk_bf16_f32 v112, v84, v85
v_cvt_pk_bf16_f32 v113, v86, v87
v_cvt_pk_bf16_f32 v114, v88, v89
v_cvt_pk_bf16_f32 v115, v90, v91
buffer_store_dwordx4 v[112:115], v159, s[20:23], s33 offen sc1
s_add_u32 s33, s33, 32768
v_pk_mul_f32 v[92:93], v[92:93], v[68:69] op_sel_hi:[1,0]
v_pk_mul_f32 v[94:95], v[94:95], v[68:69] op_sel_hi:[1,0]
v_pk_mul_f32 v[96:97], v[96:97], v[68:69] op_sel_hi:[1,0]
v_pk_mul_f32 v[98:99], v[98:99], v[68:69] op_sel_hi:[1,0]
v_cvt_pk_bf16_f32 v116, v92, v93
v_cvt_pk_bf16_f32 v117, v94, v95
v_cvt_pk_bf16_f32 v118, v96, v97
v_cvt_pk_bf16_f32 v119, v98, v99
buffer_store_dwordx4 v[116:119], v159, s[20:23], s33 offen sc1
s_add_u32 s33, s33, 32768
v_pk_mul_f32 v[100:101], v[100:101], v[72:73] op_sel_hi:[1,0]
v_pk_mul_f32 v[102:103], v[102:103], v[72:73] op_sel_hi:[1,0]
v_pk_mul_f32 v[104:105], v[104:105], v[72:73] op_sel_hi:[1,0]
v_pk_mul_f32 v[106:107], v[106:107], v[72:73] op_sel_hi:[1,0]
v_cvt_pk_bf16_f32 v120, v100, v101
v_cvt_pk_bf16_f32 v121, v102, v103
v_cvt_pk_bf16_f32 v122, v104, v105
v_cvt_pk_bf16_f32 v123, v106, v107
buffer_store_dwordx4 v[120:123], v159, s[20:23], s33 offen sc1
s_cmp_lg_u32 s58, 0
s_cbranch_scc1 L_mid_kernel_a_checked
v_mul_f32 v24, 0, v76
v_mul_f32 v25, 0, v77
v_mul_f32 v26, 0, v78
v_mul_f32 v27, 0, v79
v_fma_f32 v24, v80, 0, v24
v_fma_f32 v25, v81, 0, v25
v_fma_f32 v26, v82, 0, v26
v_fma_f32 v27, v83, 0, v27
v_fma_f32 v24, v84, 0, v24
v_fma_f32 v25, v85, 0, v25
v_fma_f32 v26, v86, 0, v26
v_fma_f32 v27, v87, 0, v27
v_fma_f32 v24, v88, 0, v24
v_fma_f32 v25, v89, 0, v25
v_fma_f32 v26, v90, 0, v26
v_fma_f32 v27, v91, 0, v27
v_fma_f32 v24, v92, 0, v24
v_fma_f32 v25, v93, 0, v25
v_fma_f32 v26, v94, 0, v26
v_fma_f32 v27, v95, 0, v27
v_fma_f32 v24, v96, 0, v24
v_fma_f32 v25, v97, 0, v25
v_fma_f32 v26, v98, 0, v26
v_fma_f32 v27, v99, 0, v27
v_fma_f32 v24, v100, 0, v24
v_fma_f32 v25, v101, 0, v25
v_fma_f32 v26, v102, 0, v26
v_fma_f32 v27, v103, 0, v27
v_fma_f32 v24, v104, 0, v24
v_fma_f32 v25, v105, 0, v25
v_fma_f32 v26, v106, 0, v26
v_fma_f32 v27, v107, 0, v27
v_add_f32 v24, v24, v25
v_add_f32 v26, v26, v27
v_add_f32 v24, v24, v26
s_nop 0
v_cmp_eq_f32 s[40:41], 0, v24
s_nop 3
s_and_b64 s[40:41], s[40:41], s[42:43]
s_and_b64 s[40:41], s[40:41], s[44:45]
s_and_b64 s[40:41], s[40:41], s[46:47]
s_and_b64 s[40:41], s[40:41], s[48:49]
s_and_b64 s[40:41], s[40:41], s[50:51]
s_cmp_eq_u64 s[40:41], -1
s_cselect_b32 s38, 0, 1
s_lshl_b32 s39, s24, 2
s_add_u32 s39, s39, 65536
v_mov_b32 v5, s39
v_mov_b32 v6, s38
ds_write_b32 v5, v6
v_mov_b32 v5, 65536
s_waitcnt lgkmcnt(0)
s_barrier
ds_read_b128 v[24:27], v5
s_waitcnt lgkmcnt(0)
v_or_b32 v24, v24, v25
v_or_b32 v26, v26, v27
v_or_b32 v24, v24, v26
s_nop 0
v_readfirstlane_b32 s38, v24
s_nop 1
s_cmp_lg_u32 s38, 0
s_cbranch_scc1 L_mid_kernel_a_safe
L_mid_kernel_a_checked:
s_waitcnt vmcnt(0)
s_barrier
s_cmp_lg_u32 s24, 0
s_cbranch_scc1 L_attn_pub_done
s_mov_b32 exec_hi, 0
buffer_store_dword v157, v156, s[52:55], 0 offen sc1
s_mov_b64 exec, -1
L_attn_pub_done:
s_branch L_mid_kernel_end
L_mid_kernel_a_safe:
s_waitcnt vmcnt(0)
s_mov_b32 s58, 1
v_mov_b32 v60, 0
v_mov_b32 v61, 0
v_mov_b32 v62, 0
v_mov_b32 v63, 0
v_mov_b32 v64, 0
v_mov_b32 v65, 0
v_mov_b32 v66, 0
v_mov_b32 v67, 0
v_mov_b32 v68, 0
v_mov_b32 v69, 0
v_mov_b32 v70, 0
v_mov_b32 v71, 0
v_mov_b32 v72, 0
v_mov_b32 v73, 0
v_mov_b32 v74, 0
v_mov_b32 v75, 0
v_mov_b32 v76, 0
v_mov_b32 v77, 0
v_mov_b32 v78, 0
v_mov_b32 v79, 0
v_mov_b32 v80, 0
v_mov_b32 v81, 0
v_mov_b32 v82, 0
v_mov_b32 v83, 0
v_mov_b32 v84, 0
v_mov_b32 v85, 0
v_mov_b32 v86, 0
v_mov_b32 v87, 0
v_mov_b32 v88, 0
v_mov_b32 v89, 0
v_mov_b32 v90, 0
v_mov_b32 v91, 0
v_mov_b32 v92, 0
v_mov_b32 v93, 0
v_mov_b32 v94, 0
v_mov_b32 v95, 0
v_mov_b32 v96, 0
v_mov_b32 v97, 0
v_mov_b32 v98, 0
v_mov_b32 v99, 0
v_mov_b32 v100, 0
v_mov_b32 v101, 0
v_mov_b32 v102, 0
v_mov_b32 v103, 0
v_mov_b32 v104, 0
v_mov_b32 v105, 0
v_mov_b32 v106, 0
v_mov_b32 v107, 0
v_mov_b32 v148, 0xff800000
v_mov_b32 v149, 0xff800000
v_mov_b32 v150, 0xff800000
v_mov_b32 v151, 0xff800000
s_mov_b32 s25, 0
L_mid_kernel_a_sstage:
s_barrier
s_mov_b32 m0, s34
s_nop 0
buffer_load_dwordx4 v3, s[8:11], s25 offen lds
buffer_load_dwordx4 v3, s[8:11], s25 offen offset:1024 lds
s_add_u32 m0, s34, 8192
s_nop 0
buffer_load_dwordx4 v3, s[12:15], s25 offen lds
buffer_load_dwordx4 v3, s[12:15], s25 offen offset:1024 lds
s_waitcnt vmcnt(0)
s_barrier
v_and_b32 v1, 63, v0
v_lshlrev_b32 v1, 4, v1
s_mov_b32 s27, 4
L_mid_kernel_a_sblk:
ds_read_b128 v[24:27], v1
ds_read_b128 v[28:31], v1 offset:1024
ds_read_b128 v[40:43], v1 offset:8192
ds_read_b128 v[44:47], v1 offset:9216
s_waitcnt lgkmcnt(0)
v_mfma_f32_16x16x32_bf16 v[108:111], v[24:27], v[8:11], 0
v_mfma_f32_16x16x32_bf16 v[112:115], v[28:31], v[8:11], 0
s_nop 15
v_max_f32 v152, v108, v109
v_max3_f32 v152, v110, v111, v152
v_max3_f32 v152, v112, v113, v152
v_max3_f32 v152, v114, v115, v152
v_mov_b32 v153, v152
s_nop 1
v_permlane16_swap_b32 v152, v153
s_nop 1
v_max_f32 v152, v152, v153
v_mov_b32 v153, v152
s_nop 1
v_permlane32_swap_b32 v152, v153
s_nop 1
v_max_f32 v152, v152, v153
v_max_f32 v152, v152, v148
v_sub_f32 v153, v148, v152
v_exp_f32 v153, v153
v_mov_b32 v148, v152
v_sub_f32 v108, v108, v152
v_sub_f32 v109, v109, v152
v_sub_f32 v110, v110, v152
v_sub_f32 v111, v111, v152
v_sub_f32 v112, v112, v152
v_sub_f32 v113, v113, v152
v_sub_f32 v114, v114, v152
v_sub_f32 v115, v115, v152
v_exp_f32 v108, v108
v_exp_f32 v109, v109
v_exp_f32 v110, v110
v_exp_f32 v111, v111
v_exp_f32 v112, v112
v_exp_f32 v113, v113
v_exp_f32 v114, v114
v_exp_f32 v115, v115
v_mul_f32 v76, v76, v153
v_mul_f32 v77, v77, v153
v_mul_f32 v78, v78, v153
v_mul_f32 v79, v79, v153
v_mul_f32 v80, v80, v153
v_mul_f32 v81, v81, v153
v_mul_f32 v82, v82, v153
v_mul_f32 v83, v83, v153
v_mul_f32 v60, v60, v153
v_mul_f32 v61, v61, v153
v_mul_f32 v62, v62, v153
v_mul_f32 v63, v63, v153
v_cvt_pk_bf16_f32 v140, v108, v109
v_cvt_pk_bf16_f32 v141, v110, v111
v_cvt_pk_bf16_f32 v142, v112, v113
v_cvt_pk_bf16_f32 v143, v114, v115
s_nop 1
v_mfma_f32_16x16x32_bf16 v[76:79], v[40:43], v[140:143], v[76:79]
v_mfma_f32_16x16x32_bf16 v[80:83], v[44:47], v[140:143], v[80:83]
v_mfma_f32_16x16x32_bf16 v[60:63], v[56:59], v[140:143], v[60:63]
s_nop 15
v_mfma_f32_16x16x32_bf16 v[108:111], v[24:27], v[12:15], 0
v_mfma_f32_16x16x32_bf16 v[112:115], v[28:31], v[12:15], 0
s_nop 15
v_max_f32 v152, v108, v109
v_max3_f32 v152, v110, v111, v152
v_max3_f32 v152, v112, v113, v152
v_max3_f32 v152, v114, v115, v152
v_mov_b32 v153, v152
s_nop 1
v_permlane16_swap_b32 v152, v153
s_nop 1
v_max_f32 v152, v152, v153
v_mov_b32 v153, v152
s_nop 1
v_permlane32_swap_b32 v152, v153
s_nop 1
v_max_f32 v152, v152, v153
v_max_f32 v152, v152, v149
v_sub_f32 v153, v149, v152
v_exp_f32 v153, v153
v_mov_b32 v149, v152
v_sub_f32 v108, v108, v152
v_sub_f32 v109, v109, v152
v_sub_f32 v110, v110, v152
v_sub_f32 v111, v111, v152
v_sub_f32 v112, v112, v152
v_sub_f32 v113, v113, v152
v_sub_f32 v114, v114, v152
v_sub_f32 v115, v115, v152
v_exp_f32 v108, v108
v_exp_f32 v109, v109
v_exp_f32 v110, v110
v_exp_f32 v111, v111
v_exp_f32 v112, v112
v_exp_f32 v113, v113
v_exp_f32 v114, v114
v_exp_f32 v115, v115
v_mul_f32 v84, v84, v153
v_mul_f32 v85, v85, v153
v_mul_f32 v86, v86, v153
v_mul_f32 v87, v87, v153
v_mul_f32 v88, v88, v153
v_mul_f32 v89, v89, v153
v_mul_f32 v90, v90, v153
v_mul_f32 v91, v91, v153
v_mul_f32 v64, v64, v153
v_mul_f32 v65, v65, v153
v_mul_f32 v66, v66, v153
v_mul_f32 v67, v67, v153
v_cvt_pk_bf16_f32 v140, v108, v109
v_cvt_pk_bf16_f32 v141, v110, v111
v_cvt_pk_bf16_f32 v142, v112, v113
v_cvt_pk_bf16_f32 v143, v114, v115
s_nop 1
v_mfma_f32_16x16x32_bf16 v[84:87], v[40:43], v[140:143], v[84:87]
v_mfma_f32_16x16x32_bf16 v[88:91], v[44:47], v[140:143], v[88:91]
v_mfma_f32_16x16x32_bf16 v[64:67], v[56:59], v[140:143], v[64:67]
s_nop 15
v_mfma_f32_16x16x32_bf16 v[108:111], v[24:27], v[16:19], 0
v_mfma_f32_16x16x32_bf16 v[112:115], v[28:31], v[16:19], 0
s_nop 15
v_max_f32 v152, v108, v109
v_max3_f32 v152, v110, v111, v152
v_max3_f32 v152, v112, v113, v152
v_max3_f32 v152, v114, v115, v152
v_mov_b32 v153, v152
s_nop 1
v_permlane16_swap_b32 v152, v153
s_nop 1
v_max_f32 v152, v152, v153
v_mov_b32 v153, v152
s_nop 1
v_permlane32_swap_b32 v152, v153
s_nop 1
v_max_f32 v152, v152, v153
v_max_f32 v152, v152, v150
v_sub_f32 v153, v150, v152
v_exp_f32 v153, v153
v_mov_b32 v150, v152
v_sub_f32 v108, v108, v152
v_sub_f32 v109, v109, v152
v_sub_f32 v110, v110, v152
v_sub_f32 v111, v111, v152
v_sub_f32 v112, v112, v152
v_sub_f32 v113, v113, v152
v_sub_f32 v114, v114, v152
v_sub_f32 v115, v115, v152
v_exp_f32 v108, v108
v_exp_f32 v109, v109
v_exp_f32 v110, v110
v_exp_f32 v111, v111
v_exp_f32 v112, v112
v_exp_f32 v113, v113
v_exp_f32 v114, v114
v_exp_f32 v115, v115
v_mul_f32 v92, v92, v153
v_mul_f32 v93, v93, v153
v_mul_f32 v94, v94, v153
v_mul_f32 v95, v95, v153
v_mul_f32 v96, v96, v153
v_mul_f32 v97, v97, v153
v_mul_f32 v98, v98, v153
v_mul_f32 v99, v99, v153
v_mul_f32 v68, v68, v153
v_mul_f32 v69, v69, v153
v_mul_f32 v70, v70, v153
v_mul_f32 v71, v71, v153
v_cvt_pk_bf16_f32 v140, v108, v109
v_cvt_pk_bf16_f32 v141, v110, v111
v_cvt_pk_bf16_f32 v142, v112, v113
v_cvt_pk_bf16_f32 v143, v114, v115
s_nop 1
v_mfma_f32_16x16x32_bf16 v[92:95], v[40:43], v[140:143], v[92:95]
v_mfma_f32_16x16x32_bf16 v[96:99], v[44:47], v[140:143], v[96:99]
v_mfma_f32_16x16x32_bf16 v[68:71], v[56:59], v[140:143], v[68:71]
s_nop 15
v_mfma_f32_16x16x32_bf16 v[108:111], v[24:27], v[20:23], 0
v_mfma_f32_16x16x32_bf16 v[112:115], v[28:31], v[20:23], 0
s_nop 15
v_max_f32 v152, v108, v109
v_max3_f32 v152, v110, v111, v152
v_max3_f32 v152, v112, v113, v152
v_max3_f32 v152, v114, v115, v152
v_mov_b32 v153, v152
s_nop 1
v_permlane16_swap_b32 v152, v153
s_nop 1
v_max_f32 v152, v152, v153
v_mov_b32 v153, v152
s_nop 1
v_permlane32_swap_b32 v152, v153
s_nop 1
v_max_f32 v152, v152, v153
v_max_f32 v152, v152, v151
v_sub_f32 v153, v151, v152
v_exp_f32 v153, v153
v_mov_b32 v151, v152
v_sub_f32 v108, v108, v152
v_sub_f32 v109, v109, v152
v_sub_f32 v110, v110, v152
v_sub_f32 v111, v111, v152
v_sub_f32 v112, v112, v152
v_sub_f32 v113, v113, v152
v_sub_f32 v114, v114, v152
v_sub_f32 v115, v115, v152
v_exp_f32 v108, v108
v_exp_f32 v109, v109
v_exp_f32 v110, v110
v_exp_f32 v111, v111
v_exp_f32 v112, v112
v_exp_f32 v113, v113
v_exp_f32 v114, v114
v_exp_f32 v115, v115
v_mul_f32 v100, v100, v153
v_mul_f32 v101, v101, v153
v_mul_f32 v102, v102, v153
v_mul_f32 v103, v103, v153
v_mul_f32 v104, v104, v153
v_mul_f32 v105, v105, v153
v_mul_f32 v106, v106, v153
v_mul_f32 v107, v107, v153
v_mul_f32 v72, v72, v153
v_mul_f32 v73, v73, v153
v_mul_f32 v74, v74, v153
v_mul_f32 v75, v75, v153
v_cvt_pk_bf16_f32 v140, v108, v109
v_cvt_pk_bf16_f32 v141, v110, v111
v_cvt_pk_bf16_f32 v142, v112, v113
v_cvt_pk_bf16_f32 v143, v114, v115
s_nop 1
v_mfma_f32_16x16x32_bf16 v[100:103], v[40:43], v[140:143], v[100:103]
v_mfma_f32_16x16x32_bf16 v[104:107], v[44:47], v[140:143], v[104:107]
v_mfma_f32_16x16x32_bf16 v[72:75], v[56:59], v[140:143], v[72:75]
s_nop 15
v_add_u32 v1, 2048, v1
s_sub_u32 s27, s27, 1
s_cmp_lg_u32 s27, 0
s_cbranch_scc1 L_mid_kernel_a_sblk
s_add_u32 s25, s25, 8192
s_cmp_lt_u32 s25, 0x20000
s_cbranch_scc1 L_mid_kernel_a_sstage
s_branch L_mid_kernel_a_epi
L_mid_kernel_gemm:
s_and_b32 s12, s28, 7
s_lshr_b32 s13, s28, 3
s_and_b32 s14, s12, 1
s_lshr_b32 s12, s12, 1
s_lshl_b32 s12, s12, 2
s_and_b32 s15, s13, 3
s_add_u32 s12, s12, s15
s_lshr_b32 s13, s13, 2
v_lshrrev_b32 v1, 6, v0
s_nop 0
v_readfirstlane_b32 s40, v1
s_add_u32 s48, s4, 0x1400000
s_addc_u32 s49, s5, 0
s_and_b32 s49, s49, 0xffff
s_mov_b32 s50, 0xe00000
s_mov_b32 s51, 0x20000
s_mul_i32 s18, s14, 3670016
s_lshl_b32 s19, s13, 8
s_add_u32 s18, s18, s19
s_add_u32 s52, s6, s18
s_addc_u32 s53, s7, 0
s_and_b32 s53, s53, 0xffff
s_sub_u32 s54, 0x380000, s19
s_mov_b32 s55, 0x20000
s_lshl_b32 s16, s12, 3
s_lshl_b32 s17, s40, 1
s_add_u32 s16, s16, s17
v_and_b32 v2, 63, v0
v_lshlrev_b32 v2, 4, v2
s_mul_i32 s19, s14, 57344
s_mul_i32 s17, s16, 114688
s_add_u32 s17, s17, s19
v_add_u32 v8, s17, v2
v_add_u32 v9, 114688, v8
s_mov_b32 s45, 2048
v_and_b32 v2, 63, v0
v_lshrrev_b32 v3, 4, v2
s_mul_i32 s46, s40, 4
v_add_u32 v3, s46, v3
v_and_b32 v2, 15, v2
v_and_b32 v4, 7, v3
v_lshlrev_b32 v4, 1, v4
v_xor_b32 v2, v2, v4
v_lshlrev_b32 v2, 4, v2
v_mul_lo_u32 v3, v3, s45
v_add_u32 v10, v2, v3
v_add_u32 v11, 32768, v10
s_lshl_b32 s43, s40, 10
s_mov_b32 s41, 0
s_mov_b32 s42, 0
s_lshl_b32 s19, s14, 7
v_xor_b32 v10, s19, v10
v_xor_b32 v11, s19, v11
s_lshl_b32 s23, s13, 1
s_add_u32 s23, s23, s14
s_lshl_b32 s18, s23, 7
s_mov_b32 s72, s62
s_and_b32 s73, s63, 0xffff
s_mov_b32 s74, 0x400000
s_mov_b32 s75, 0x20000
s_mov_b32 s76, s64
s_and_b32 s77, s65, 0xffff
s_mov_b32 s78, 0x800
s_mov_b32 s79, 0x20000
v_and_b32 v3, 15, v0
v_lshlrev_b32 v3, 11, v3
v_bfe_u32 v4, v0, 4, 2
v_lshl_add_u32 v3, v4, 3, v3
s_lshl_b32 s17, s16, 15
s_add_u32 s17, s17, s18
v_add_u32 v25, s17, v3
v_add_u32 v26, 32768, v25
v_lshlrev_b32 v4, 3, v4
v_add_u32 v29, s18, v4
s_add_u32 m0, s43, 0
s_nop 0
buffer_load_dwordx4 v10, s[52:55], s42 offen lds
s_add_u32 m0, s43, 4096
s_nop 0
buffer_load_dwordx4 v11, s[52:55], s42 offen lds
s_add_u32 s42, s42, 65536
buffer_load_dwordx4 v[128:131], v8, s[48:51], s41 offen
buffer_load_dwordx4 v[132:135], v9, s[48:51], s41 offen
s_add_u32 s41, s41, 1024
s_add_u32 m0, s43, 8192
s_nop 0
buffer_load_dwordx4 v10, s[52:55], s42 offen lds
s_add_u32 m0, s43, 12288
s_nop 0
buffer_load_dwordx4 v11, s[52:55], s42 offen lds
s_add_u32 s42, s42, 65536
buffer_load_dwordx4 v[136:139], v8, s[48:51], s41 offen
buffer_load_dwordx4 v[140:143], v9, s[48:51], s41 offen
s_add_u32 s41, s41, 1024
buffer_load_dwordx2 v[232:233], v25, s[72:75], 0 offen offset:0
buffer_load_dwordx2 v[234:235], v26, s[72:75], 0 offen offset:0
buffer_load_dwordx2 v[236:237], v25, s[72:75], 0 offen offset:32
buffer_load_dwordx2 v[238:239], v26, s[72:75], 0 offen offset:32
buffer_load_dwordx2 v[240:241], v25, s[72:75], 0 offen offset:64
buffer_load_dwordx2 v[242:243], v26, s[72:75], 0 offen offset:64
buffer_load_dwordx2 v[244:245], v25, s[72:75], 0 offen offset:96
buffer_load_dwordx2 v[246:247], v26, s[72:75], 0 offen offset:96
buffer_load_dwordx2 v[248:249], v29, s[76:79], 0 offen offset:0
buffer_load_dwordx2 v[250:251], v29, s[76:79], 0 offen offset:32
buffer_load_dwordx2 v[252:253], v29, s[76:79], 0 offen offset:64
buffer_load_dwordx2 v[254:255], v29, s[76:79], 0 offen offset:96
v_bfe_u32 v3, v0, 2, 4
v_and_b32 v4, 7, v3
v_lshlrev_b32 v4, 5, v4
v_mul_u32_u24 v3, 256, v3
v_and_b32 v2, 3, v0
v_lshl_add_u32 v3, v2, 3, v3
v_xor_b32 v2, 0, v4
v_add_u32 v12, v2, v3
v_xor_b32 v2, 32, v4
v_add_u32 v13, v2, v3
v_xor_b32 v2, 64, v4
v_add_u32 v14, v2, v3
v_xor_b32 v2, 96, v4
v_add_u32 v15, v2, v3
v_xor_b32 v2, 128, v4
v_add_u32 v16, v2, v3
v_xor_b32 v2, 160, v4
v_add_u32 v17, v2, v3
v_xor_b32 v2, 192, v4
v_add_u32 v18, v2, v3
v_xor_b32 v2, 224, v4
v_add_u32 v19, v2, v3
v_mov_b32 v64, 0
v_mov_b32 v65, 0
v_mov_b32 v66, 0
v_mov_b32 v67, 0
v_mov_b32 v68, 0
v_mov_b32 v69, 0
v_mov_b32 v70, 0
v_mov_b32 v71, 0
v_mov_b32 v72, 0
v_mov_b32 v73, 0
v_mov_b32 v74, 0
v_mov_b32 v75, 0
v_mov_b32 v76, 0
v_mov_b32 v77, 0
v_mov_b32 v78, 0
v_mov_b32 v79, 0
v_mov_b32 v80, 0
v_mov_b32 v81, 0
v_mov_b32 v82, 0
v_mov_b32 v83, 0
v_mov_b32 v84, 0
v_mov_b32 v85, 0
v_mov_b32 v86, 0
v_mov_b32 v87, 0
v_mov_b32 v88, 0
v_mov_b32 v89, 0
v_mov_b32 v90, 0
v_mov_b32 v91, 0
v_mov_b32 v92, 0
v_mov_b32 v93, 0
v_mov_b32 v94, 0
v_mov_b32 v95, 0
v_mov_b32 v96, 0
v_mov_b32 v97, 0
v_mov_b32 v98, 0
v_mov_b32 v99, 0
v_mov_b32 v100, 0
v_mov_b32 v101, 0
v_mov_b32 v102, 0
v_mov_b32 v103, 0
v_mov_b32 v104, 0
v_mov_b32 v105, 0
v_mov_b32 v106, 0
v_mov_b32 v107, 0
v_mov_b32 v108, 0
v_mov_b32 v109, 0
v_mov_b32 v110, 0
v_mov_b32 v111, 0
v_mov_b32 v112, 0
v_mov_b32 v113, 0
v_mov_b32 v114, 0
v_mov_b32 v115, 0
v_mov_b32 v116, 0
v_mov_b32 v117, 0
v_mov_b32 v118, 0
v_mov_b32 v119, 0
v_mov_b32 v120, 0
v_mov_b32 v121, 0
v_mov_b32 v122, 0
v_mov_b32 v123, 0
v_mov_b32 v124, 0
v_mov_b32 v125, 0
v_mov_b32 v126, 0
v_mov_b32 v127, 0
s_waitcnt vmcnt(16)
s_barrier
ds_read_b64_tr_b16 v[160:161], v12 offset:0
ds_read_b64_tr_b16 v[162:163], v12 offset:4096
ds_read_b64_tr_b16 v[164:165], v13 offset:0
ds_read_b64_tr_b16 v[166:167], v13 offset:4096
ds_read_b64_tr_b16 v[168:169], v14 offset:0
ds_read_b64_tr_b16 v[170:171], v14 offset:4096
ds_read_b64_tr_b16 v[172:173], v15 offset:0
ds_read_b64_tr_b16 v[174:175], v15 offset:4096
s_waitcnt lgkmcnt(6)
v_mfma_f32_16x16x32_bf16 v[64:67], v[160:163], v[128:131], v[64:67]
ds_read_b64_tr_b16 v[176:177], v16 offset:0
buffer_load_dwordx4 v[144:147], v8, s[48:51], s41 offen
v_mfma_f32_16x16x32_bf16 v[68:71], v[160:163], v[132:135], v[68:71]
ds_read_b64_tr_b16 v[178:179], v16 offset:4096
s_waitcnt lgkmcnt(6)
v_mfma_f32_16x16x32_bf16 v[72:75], v[164:167], v[128:131], v[72:75]
ds_read_b64_tr_b16 v[180:181], v17 offset:0
s_add_u32 m0, s43, 16384
v_mfma_f32_16x16x32_bf16 v[76:79], v[164:167], v[132:135], v[76:79]
ds_read_b64_tr_b16 v[182:183], v17 offset:4096
buffer_load_dwordx4 v10, s[52:55], s42 offen lds
s_waitcnt lgkmcnt(6)
v_mfma_f32_16x16x32_bf16 v[80:83], v[168:171], v[128:131], v[80:83]
ds_read_b64_tr_b16 v[184:185], v18 offset:0
buffer_load_dwordx4 v[148:151], v9, s[48:51], s41 offen
s_add_u32 s41, s41, 1024
v_mfma_f32_16x16x32_bf16 v[84:87], v[168:171], v[132:135], v[84:87]
ds_read_b64_tr_b16 v[186:187], v18 offset:4096
s_waitcnt lgkmcnt(6)
v_mfma_f32_16x16x32_bf16 v[88:91], v[172:175], v[128:131], v[88:91]
ds_read_b64_tr_b16 v[188:189], v19 offset:0
s_add_u32 m0, s43, 20480
v_mfma_f32_16x16x32_bf16 v[92:95], v[172:175], v[132:135], v[92:95]
ds_read_b64_tr_b16 v[190:191], v19 offset:4096
buffer_load_dwordx4 v11, s[52:55], s42 offen lds
s_add_u32 s42, s42, 65536
s_waitcnt lgkmcnt(6)
v_mfma_f32_16x16x32_bf16 v[96:99], v[176:179], v[128:131], v[96:99]
s_waitcnt vmcnt(16)
s_barrier
ds_read_b64_tr_b16 v[160:161], v12 offset:8192
buffer_load_dwordx4 v[152:155], v8, s[48:51], s41 offen
v_mfma_f32_16x16x32_bf16 v[100:103], v[176:179], v[132:135], v[100:103]
ds_read_b64_tr_b16 v[162:163], v12 offset:12288
s_waitcnt lgkmcnt(6)
v_mfma_f32_16x16x32_bf16 v[104:107], v[180:183], v[128:131], v[104:107]
ds_read_b64_tr_b16 v[164:165], v13 offset:8192
s_add_u32 m0, s43, 24576
v_mfma_f32_16x16x32_bf16 v[108:111], v[180:183], v[132:135], v[108:111]
ds_read_b64_tr_b16 v[166:167], v13 offset:12288
buffer_load_dwordx4 v10, s[52:55], s42 offen lds
s_waitcnt lgkmcnt(6)
v_mfma_f32_16x16x32_bf16 v[112:115], v[184:187], v[128:131], v[112:115]
ds_read_b64_tr_b16 v[168:169], v14 offset:8192
buffer_load_dwordx4 v[156:159], v9, s[48:51], s41 offen
s_add_u32 s41, s41, 1024
v_mfma_f32_16x16x32_bf16 v[116:119], v[184:187], v[132:135], v[116:119]
ds_read_b64_tr_b16 v[170:171], v14 offset:12288
s_waitcnt lgkmcnt(6)
v_mfma_f32_16x16x32_bf16 v[120:123], v[188:191], v[128:131], v[120:123]
ds_read_b64_tr_b16 v[172:173], v15 offset:8192
s_add_u32 m0, s43, 28672
v_mfma_f32_16x16x32_bf16 v[124:127], v[188:191], v[132:135], v[124:127]
ds_read_b64_tr_b16 v[174:175], v15 offset:12288
buffer_load_dwordx4 v11, s[52:55], s42 offen lds
s_add_u32 s42, s42, 65536
s_waitcnt lgkmcnt(6)
v_mfma_f32_16x16x32_bf16 v[64:67], v[160:163], v[136:139], v[64:67]
ds_read_b64_tr_b16 v[176:177], v16 offset:8192
buffer_load_dwordx4 v[128:131], v8, s[48:51], s41 offen
v_mfma_f32_16x16x32_bf16 v[68:71], v[160:163], v[140:143], v[68:71]
ds_read_b64_tr_b16 v[178:179], v16 offset:12288
s_waitcnt lgkmcnt(6)
v_mfma_f32_16x16x32_bf16 v[72:75], v[164:167], v[136:139], v[72:75]
ds_read_b64_tr_b16 v[180:181], v17 offset:8192
s_add_u32 m0, s43, 32768
v_mfma_f32_16x16x32_bf16 v[76:79], v[164:167], v[140:143], v[76:79]
ds_read_b64_tr_b16 v[182:183], v17 offset:12288
buffer_load_dwordx4 v10, s[52:55], s42 offen lds
s_waitcnt lgkmcnt(6)
v_mfma_f32_16x16x32_bf16 v[80:83], v[168:171], v[136:139], v[80:83]
ds_read_b64_tr_b16 v[184:185], v18 offset:8192
v_mfma_f32_16x16x32_bf16 v[84:87], v[168:171], v[140:143], v[84:87]
ds_read_b64_tr_b16 v[186:187], v18 offset:12288
buffer_load_dwordx4 v[132:135], v9, s[48:51], s41 offen
s_add_u32 s41, s41, 1024
s_waitcnt lgkmcnt(6)
v_mfma_f32_16x16x32_bf16 v[88:91], v[172:175], v[136:139], v[88:91]
ds_read_b64_tr_b16 v[188:189], v19 offset:8192
v_mfma_f32_16x16x32_bf16 v[92:95], v[172:175], v[140:143], v[92:95]
ds_read_b64_tr_b16 v[190:191], v19 offset:12288
s_waitcnt lgkmcnt(6)
v_mfma_f32_16x16x32_bf16 v[96:99], v[176:179], v[136:139], v[96:99]
s_waitcnt vmcnt(7)
s_barrier
ds_read_b64_tr_b16 v[160:161], v12 offset:16384
s_add_u32 m0, s43, 36864
v_mfma_f32_16x16x32_bf16 v[100:103], v[176:179], v[140:143], v[100:103]
ds_read_b64_tr_b16 v[162:163], v12 offset:20480
buffer_load_dwordx4 v11, s[52:55], s42 offen lds
s_add_u32 s42, s42, 65536
s_waitcnt lgkmcnt(6)
v_mfma_f32_16x16x32_bf16 v[104:107], v[180:183], v[136:139], v[104:107]
ds_read_b64_tr_b16 v[164:165], v13 offset:16384
s_add_u32 m0, s43, 40960
v_mfma_f32_16x16x32_bf16 v[108:111], v[180:183], v[140:143], v[108:111]
ds_read_b64_tr_b16 v[166:167], v13 offset:20480
buffer_load_dwordx4 v10, s[52:55], s42 offen lds
s_waitcnt lgkmcnt(6)
v_mfma_f32_16x16x32_bf16 v[112:115], v[184:187], v[136:139], v[112:115]
ds_read_b64_tr_b16 v[168:169], v14 offset:16384
v_mfma_f32_16x16x32_bf16 v[116:119], v[184:187], v[140:143], v[116:119]
ds_read_b64_tr_b16 v[170:171], v14 offset:20480
s_add_u32 m0, s43, 45056
s_waitcnt lgkmcnt(6)
v_mfma_f32_16x16x32_bf16 v[120:123], v[188:191], v[136:139], v[120:123]
ds_read_b64_tr_b16 v[172:173], v15 offset:16384
buffer_load_dwordx4 v11, s[52:55], s42 offen lds
s_add_u32 s42, s42, 65536
v_mfma_f32_16x16x32_bf16 v[124:127], v[188:191], v[140:143], v[124:127]
ds_read_b64_tr_b16 v[174:175], v15 offset:20480
s_waitcnt lgkmcnt(6)
v_mfma_f32_16x16x32_bf16 v[64:67], v[160:163], v[144:147], v[64:67]
ds_read_b64_tr_b16 v[176:177], v16 offset:16384
buffer_load_dwordx4 v[136:139], v8, s[48:51], s41 offen
v_mfma_f32_16x16x32_bf16 v[68:71], v[160:163], v[148:151], v[68:71]
ds_read_b64_tr_b16 v[178:179], v16 offset:20480
s_add_u32 m0, s43, 49152
s_waitcnt lgkmcnt(6)
v_mfma_f32_16x16x32_bf16 v[72:75], v[164:167], v[144:147], v[72:75]
ds_read_b64_tr_b16 v[180:181], v17 offset:16384
buffer_load_dwordx4 v10, s[52:55], s42 offen lds
v_mfma_f32_16x16x32_bf16 v[76:79], v[164:167], v[148:151], v[76:79]
ds_read_b64_tr_b16 v[182:183], v17 offset:20480
buffer_load_dwordx4 v[140:143], v9, s[48:51], s41 offen
s_add_u32 s41, s41, 1024
s_waitcnt lgkmcnt(6)
v_mfma_f32_16x16x32_bf16 v[80:83], v[168:171], v[144:147], v[80:83]
ds_read_b64_tr_b16 v[184:185], v18 offset:16384
s_add_u32 m0, s43, 53248
v_mfma_f32_16x16x32_bf16 v[84:87], v[168:171], v[148:151], v[84:87]
ds_read_b64_tr_b16 v[186:187], v18 offset:20480
buffer_load_dwordx4 v11, s[52:55], s42 offen lds
s_add_u32 s42, s42, 65536
s_waitcnt lgkmcnt(6)
v_mfma_f32_16x16x32_bf16 v[88:91], v[172:175], v[144:147], v[88:91]
ds_read_b64_tr_b16 v[188:189], v19 offset:16384
s_add_u32 m0, s43, 57344
v_mfma_f32_16x16x32_bf16 v[92:95], v[172:175], v[148:151], v[92:95]
ds_read_b64_tr_b16 v[190:191], v19 offset:20480
buffer_load_dwordx4 v10, s[52:55], s42 offen lds
s_waitcnt lgkmcnt(6)
v_mfma_f32_16x16x32_bf16 v[96:99], v[176:179], v[144:147], v[96:99]
s_waitcnt vmcnt(11)
s_barrier
ds_read_b64_tr_b16 v[160:161], v12 offset:24576
s_add_u32 m0, s43, 61440
v_mfma_f32_16x16x32_bf16 v[100:103], v[176:179], v[148:151], v[100:103]
ds_read_b64_tr_b16 v[162:163], v12 offset:28672
buffer_load_dwordx4 v11, s[52:55], s42 offen lds
s_add_u32 s42, s42, 65536
v_mov_b32 v32, 0
v_mov_b32 v33, 0
v_mov_b32 v34, 0
v_mov_b32 v35, 0
v_mov_b32 v36, 0
v_mov_b32 v37, 0
s_waitcnt lgkmcnt(6)
v_mfma_f32_16x16x32_bf16 v[104:107], v[180:183], v[144:147], v[104:107]
ds_read_b64_tr_b16 v[164:165], v13 offset:24576
v_mfma_f32_16x16x32_bf16 v[108:111], v[180:183], v[148:151], v[108:111]
ds_read_b64_tr_b16 v[166:167], v13 offset:28672
v_mov_b32 v38, 0
v_mov_b32 v39, 0
v_mov_b32 v40, 0
v_mov_b32 v41, 0
v_mov_b32 v42, 0
v_mov_b32 v43, 0
s_waitcnt lgkmcnt(6)
v_mfma_f32_16x16x32_bf16 v[112:115], v[184:187], v[144:147], v[112:115]
ds_read_b64_tr_b16 v[168:169], v14 offset:24576
v_mov_b32 v44, 0
v_mov_b32 v45, 0
v_mov_b32 v46, 0
v_mov_b32 v47, 0
v_mov_b32 v48, 0
v_mov_b32 v49, 0
v_mfma_f32_16x16x32_bf16 v[116:119], v[184:187], v[148:151], v[116:119]
ds_read_b64_tr_b16 v[170:171], v14 offset:28672
s_waitcnt lgkmcnt(6)
v_mfma_f32_16x16x32_bf16 v[120:123], v[188:191], v[144:147], v[120:123]
ds_read_b64_tr_b16 v[172:173], v15 offset:24576
v_mov_b32 v50, 0
v_mov_b32 v51, 0
v_mov_b32 v52, 0
v_mov_b32 v53, 0
v_mov_b32 v54, 0
v_mov_b32 v55, 0
v_mfma_f32_16x16x32_bf16 v[124:127], v[188:191], v[148:151], v[124:127]
ds_read_b64_tr_b16 v[174:175], v15 offset:28672
s_waitcnt lgkmcnt(6)
v_mfma_f32_16x16x32_bf16 v[64:67], v[160:163], v[152:155], v[64:67]
ds_read_b64_tr_b16 v[176:177], v16 offset:24576
buffer_load_dwordx4 v[144:147], v8, s[48:51], s41 offen
v_mfma_f32_16x16x32_bf16 v[68:71], v[160:163], v[156:159], v[68:71]
ds_read_b64_tr_b16 v[178:179], v16 offset:28672
s_add_u32 m0, s43, 0
s_waitcnt lgkmcnt(6)
v_mfma_f32_16x16x32_bf16 v[72:75], v[164:167], v[152:155], v[72:75]
ds_read_b64_tr_b16 v[180:181], v17 offset:24576
buffer_load_dwordx4 v10, s[52:55], s42 offen lds
v_mfma_f32_16x16x32_bf16 v[76:79], v[164:167], v[156:159], v[76:79]
ds_read_b64_tr_b16 v[182:183], v17 offset:28672
buffer_load_dwordx4 v[148:151], v9, s[48:51], s41 offen
s_add_u32 s41, s41, 1024
s_waitcnt lgkmcnt(6)
v_mfma_f32_16x16x32_bf16 v[80:83], v[168:171], v[152:155], v[80:83]
ds_read_b64_tr_b16 v[184:185], v18 offset:24576
s_add_u32 m0, s43, 4096
v_mfma_f32_16x16x32_bf16 v[84:87], v[168:171], v[156:159], v[84:87]
ds_read_b64_tr_b16 v[186:187], v18 offset:28672
buffer_load_dwordx4 v11, s[52:55], s42 offen lds
s_add_u32 s42, s42, 65536
s_waitcnt lgkmcnt(6)
v_mfma_f32_16x16x32_bf16 v[88:91], v[172:175], v[152:155], v[88:91]
ds_read_b64_tr_b16 v[188:189], v19 offset:24576
s_add_u32 m0, s43, 8192
v_mfma_f32_16x16x32_bf16 v[92:95], v[172:175], v[156:159], v[92:95]
ds_read_b64_tr_b16 v[190:191], v19 offset:28672
buffer_load_dwordx4 v10, s[52:55], s42 offen lds
s_waitcnt lgkmcnt(6)
v_mfma_f32_16x16x32_bf16 v[96:99], v[176:179], v[152:155], v[96:99]
s_waitcnt vmcnt(13)
s_barrier
ds_read_b64_tr_b16 v[160:161], v12 offset:32768
s_add_u32 m0, s43, 12288
v_mfma_f32_16x16x32_bf16 v[100:103], v[176:179], v[156:159], v[100:103]
ds_read_b64_tr_b16 v[162:163], v12 offset:36864
buffer_load_dwordx4 v11, s[52:55], s42 offen lds
s_add_u32 s42, s42, 65536
v_mov_b32 v56, 0
v_mov_b32 v57, 0
v_mov_b32 v58, 0
v_mov_b32 v59, 0
v_mov_b32 v60, 0
v_mov_b32 v61, 0
s_waitcnt lgkmcnt(6)
v_mfma_f32_16x16x32_bf16 v[104:107], v[180:183], v[152:155], v[104:107]
ds_read_b64_tr_b16 v[164:165], v13 offset:32768
v_mfma_f32_16x16x32_bf16 v[108:111], v[180:183], v[156:159], v[108:111]
ds_read_b64_tr_b16 v[166:167], v13 offset:36864
v_mov_b32 v62, 0
v_mov_b32 v63, 0
s_add_u32 s56, s4, 0x2400000
s_addc_u32 s57, s5, 0
s_and_b32 s57, s57, 0xffff
s_mov_b32 s58, 0x800000
s_waitcnt lgkmcnt(6)
v_mfma_f32_16x16x32_bf16 v[112:115], v[184:187], v[152:155], v[112:115]
ds_read_b64_tr_b16 v[168:169], v14 offset:32768
s_mov_b32 s59, 0x20000
s_add_u32 s68, s4, 0x3d00000
s_addc_u32 s69, s5, 0
s_and_b32 s69, s69, 0xffff
s_mov_b32 s70, 0x20000
s_mov_b32 s71, 0x20000
v_mfma_f32_16x16x32_bf16 v[116:119], v[184:187], v[156:159], v[116:119]
ds_read_b64_tr_b16 v[170:171], v14 offset:36864
s_waitcnt lgkmcnt(6)
v_mfma_f32_16x16x32_bf16 v[120:123], v[188:191], v[152:155], v[120:123]
ds_read_b64_tr_b16 v[172:173], v15 offset:32768
s_mov_b32 s32, s66
s_and_b32 s33, s67, 0xffff
s_mov_b32 s34, 0x400000
s_mov_b32 s35, 0x20000
s_lshl_b32 s17, s28, 15
s_lshl_b32 s19, s40, 13
v_mfma_f32_16x16x32_bf16 v[124:127], v[188:191], v[156:159], v[124:127]
ds_read_b64_tr_b16 v[174:175], v15 offset:36864
s_waitcnt lgkmcnt(6)
v_mfma_f32_16x16x32_bf16 v[64:67], v[160:163], v[128:131], v[64:67]
ds_read_b64_tr_b16 v[176:177], v16 offset:32768
buffer_load_dwordx4 v[152:155], v8, s[48:51], s41 offen
v_mfma_f32_16x16x32_bf16 v[68:71], v[160:163], v[132:135], v[68:71]
ds_read_b64_tr_b16 v[178:179], v16 offset:36864
s_waitcnt lgkmcnt(6)
v_mfma_f32_16x16x32_bf16 v[72:75], v[164:167], v[128:131], v[72:75]
ds_read_b64_tr_b16 v[180:181], v17 offset:32768
s_add_u32 m0, s43, 16384
v_mfma_f32_16x16x32_bf16 v[76:79], v[164:167], v[132:135], v[76:79]
ds_read_b64_tr_b16 v[182:183], v17 offset:36864
buffer_load_dwordx4 v10, s[52:55], s42 offen lds
s_waitcnt lgkmcnt(6)
v_mfma_f32_16x16x32_bf16 v[80:83], v[168:171], v[128:131], v[80:83]
ds_read_b64_tr_b16 v[184:185], v18 offset:32768
buffer_load_dwordx4 v[156:159], v9, s[48:51], s41 offen
s_add_u32 s41, s41, 1024
v_mfma_f32_16x16x32_bf16 v[84:87], v[168:171], v[132:135], v[84:87]
ds_read_b64_tr_b16 v[186:187], v18 offset:36864
s_waitcnt lgkmcnt(6)
v_mfma_f32_16x16x32_bf16 v[88:91], v[172:175], v[128:131], v[88:91]
ds_read_b64_tr_b16 v[188:189], v19 offset:32768
s_add_u32 m0, s43, 20480
v_mfma_f32_16x16x32_bf16 v[92:95], v[172:175], v[132:135], v[92:95]
ds_read_b64_tr_b16 v[190:191], v19 offset:36864
buffer_load_dwordx4 v11, s[52:55], s42 offen lds
s_add_u32 s42, s42, 65536
s_waitcnt lgkmcnt(6)
v_mfma_f32_16x16x32_bf16 v[96:99], v[176:179], v[128:131], v[96:99]
s_waitcnt vmcnt(13)
s_barrier
ds_read_b64_tr_b16 v[160:161], v12 offset:40960
v_mfma_f32_16x16x32_bf16 v[100:103], v[176:179], v[132:135], v[100:103]
ds_read_b64_tr_b16 v[162:163], v12 offset:45056
s_add_u32 s20, s17, s19
s_xor_b32 s21, s20, 0x8000
v_and_b32 v2, 63, v0
v_lshlrev_b32 v2, 4, v2
v_add_u32 v20, s20, v2
v_add_u32 v21, s21, v2
s_waitcnt lgkmcnt(6)
v_mfma_f32_16x16x32_bf16 v[104:107], v[180:183], v[128:131], v[104:107]
ds_read_b64_tr_b16 v[164:165], v13 offset:40960
v_mfma_f32_16x16x32_bf16 v[108:111], v[180:183], v[132:135], v[108:111]
ds_read_b64_tr_b16 v[166:167], v13 offset:45056
s_mov_b32 s22, 4096
s_lshl_b32 s17, s28, 6
s_add_u32 s17, s17, 4096
v_mov_b32 v22, s17
s_xor_b32 s17, s17, 64
v_mov_b32 v23, s17
s_waitcnt lgkmcnt(6)
v_mfma_f32_16x16x32_bf16 v[112:115], v[184:187], v[128:131], v[112:115]
ds_read_b64_tr_b16 v[168:169], v14 offset:40960
v_mfma_f32_16x16x32_bf16 v[116:119], v[184:187], v[132:135], v[116:119]
ds_read_b64_tr_b16 v[170:171], v14 offset:45056
s_lshl_b32 s17, s28, 7
s_add_u32 s17, s17, 0x10000
v_and_b32 v24, 31, v0
v_lshlrev_b32 v24, 2, v24
v_add_u32 v24, s17, v24
v_mov_b32 v28, 1
s_waitcnt lgkmcnt(6)
v_mfma_f32_16x16x32_bf16 v[120:123], v[188:191], v[128:131], v[120:123]
ds_read_b64_tr_b16 v[172:173], v15 offset:40960
v_mfma_f32_16x16x32_bf16 v[124:127], v[188:191], v[132:135], v[124:127]
ds_read_b64_tr_b16 v[174:175], v15 offset:45056
s_waitcnt lgkmcnt(6)
v_mfma_f32_16x16x32_bf16 v[64:67], v[160:163], v[136:139], v[64:67]
ds_read_b64_tr_b16 v[176:177], v16 offset:40960
buffer_load_dwordx4 v[128:131], v8, s[48:51], s41 offen
v_mfma_f32_16x16x32_bf16 v[68:71], v[160:163], v[140:143], v[68:71]
ds_read_b64_tr_b16 v[178:179], v16 offset:45056
s_waitcnt lgkmcnt(6)
v_mfma_f32_16x16x32_bf16 v[72:75], v[164:167], v[136:139], v[72:75]
ds_read_b64_tr_b16 v[180:181], v17 offset:40960
s_add_u32 m0, s43, 24576
v_mfma_f32_16x16x32_bf16 v[76:79], v[164:167], v[140:143], v[76:79]
ds_read_b64_tr_b16 v[182:183], v17 offset:45056
buffer_load_dwordx4 v10, s[52:55], s42 offen lds
s_waitcnt lgkmcnt(6)
v_mfma_f32_16x16x32_bf16 v[80:83], v[168:171], v[136:139], v[80:83]
ds_read_b64_tr_b16 v[184:185], v18 offset:40960
buffer_load_dwordx4 v[132:135], v9, s[48:51], s41 offen
s_add_u32 s41, s41, 1024
v_mfma_f32_16x16x32_bf16 v[84:87], v[168:171], v[140:143], v[84:87]
ds_read_b64_tr_b16 v[186:187], v18 offset:45056
s_waitcnt lgkmcnt(6)
v_mfma_f32_16x16x32_bf16 v[88:91], v[172:175], v[136:139], v[88:91]
ds_read_b64_tr_b16 v[188:189], v19 offset:40960
s_add_u32 m0, s43, 28672
v_mfma_f32_16x16x32_bf16 v[92:95], v[172:175], v[140:143], v[92:95]
ds_read_b64_tr_b16 v[190:191], v19 offset:45056
buffer_load_dwordx4 v11, s[52:55], s42 offen lds
s_add_u32 s42, s42, 65536
s_waitcnt lgkmcnt(6)
v_mfma_f32_16x16x32_bf16 v[96:99], v[176:179], v[136:139], v[96:99]
s_waitcnt vmcnt(11)
s_barrier
ds_read_b64_tr_b16 v[160:161], v12 offset:49152
s_add_u32 s72, s4, 0x1000000
s_addc_u32 s73, s5, 0
s_and_b32 s73, s73, 0xffff
s_mov_b32 s74, 0x400000
s_mov_b32 s75, 0x20000
s_add_u32 s76, s60, s18
s_addc_u32 s77, s61, 0
v_mfma_f32_16x16x32_bf16 v[100:103], v[176:179], v[140:143], v[100:103]
ds_read_b64_tr_b16 v[162:163], v12 offset:53248
s_waitcnt lgkmcnt(6)
v_mfma_f32_16x16x32_bf16 v[104:107], v[180:183], v[136:139], v[104:107]
ds_read_b64_tr_b16 v[164:165], v13 offset:49152
s_and_b32 s77, s77, 0xffff
s_sub_u32 s78, 0x200000, s18
s_mov_b32 s79, 0x20000
s_lshl_b32 s17, s16, 15
v_add_u32 v224, s17, v2
v_add_u32 v225, 32768, v224
v_mfma_f32_16x16x32_bf16 v[108:111], v[180:183], v[140:143], v[108:111]
ds_read_b64_tr_b16 v[166:167], v13 offset:53248
s_waitcnt lgkmcnt(6)
v_mfma_f32_16x16x32_bf16 v[112:115], v[184:187], v[136:139], v[112:115]
ds_read_b64_tr_b16 v[168:169], v14 offset:49152
s_mov_b32 s45, 2048
v_and_b32 v2, 63, v0
v_lshrrev_b32 v3, 3, v2
s_mul_i32 s46, s40, 8
v_add_u32 v3, s46, v3
v_and_b32 v2, 7, v2
v_mfma_f32_16x16x32_bf16 v[116:119], v[184:187], v[140:143], v[116:119]
ds_read_b64_tr_b16 v[170:171], v14 offset:53248
s_waitcnt lgkmcnt(6)
v_mfma_f32_16x16x32_bf16 v[120:123], v[188:191], v[136:139], v[120:123]
ds_read_b64_tr_b16 v[172:173], v15 offset:49152
v_bfe_u32 v4, v3, 1, 2
v_lshlrev_b32 v4, 1, v4
v_xor_b32 v2, v2, v4
v_lshlrev_b32 v2, 4, v2
v_mul_lo_u32 v3, v3, s45
v_add_u32 v226, v2, v3
v_mfma_f32_16x16x32_bf16 v[124:127], v[188:191], v[140:143], v[124:127]
ds_read_b64_tr_b16 v[174:175], v15 offset:53248
s_waitcnt lgkmcnt(6)
v_mfma_f32_16x16x32_bf16 v[64:67], v[160:163], v[144:147], v[64:67]
ds_read_b64_tr_b16 v[176:177], v16 offset:49152
buffer_load_dwordx4 v[136:139], v8, s[48:51], s41 offen
v_mfma_f32_16x16x32_bf16 v[68:71], v[160:163], v[148:151], v[68:71]
ds_read_b64_tr_b16 v[178:179], v16 offset:53248
s_waitcnt lgkmcnt(6)
v_mfma_f32_16x16x32_bf16 v[72:75], v[164:167], v[144:147], v[72:75]
ds_read_b64_tr_b16 v[180:181], v17 offset:49152
s_add_u32 m0, s43, 32768
v_mfma_f32_16x16x32_bf16 v[76:79], v[164:167], v[148:151], v[76:79]
ds_read_b64_tr_b16 v[182:183], v17 offset:53248
buffer_load_dwordx4 v10, s[52:55], s42 offen lds
s_waitcnt lgkmcnt(6)
v_mfma_f32_16x16x32_bf16 v[80:83], v[168:171], v[144:147], v[80:83]
ds_read_b64_tr_b16 v[184:185], v18 offset:49152
buffer_load_dwordx4 v[140:143], v9, s[48:51], s41 offen
s_add_u32 s41, s41, 1024
v_mfma_f32_16x16x32_bf16 v[84:87], v[168:171], v[148:151], v[84:87]
ds_read_b64_tr_b16 v[186:187], v18 offset:53248
s_waitcnt lgkmcnt(6)
v_mfma_f32_16x16x32_bf16 v[88:91], v[172:175], v[144:147], v[88:91]
ds_read_b64_tr_b16 v[188:189], v19 offset:49152
s_add_u32 m0, s43, 36864
v_mfma_f32_16x16x32_bf16 v[92:95], v[172:175], v[148:151], v[92:95]
ds_read_b64_tr_b16 v[190:191], v19 offset:53248
buffer_load_dwordx4 v11, s[52:55], s42 offen lds
s_add_u32 s42, s42, 65536
s_waitcnt lgkmcnt(6)
v_mfma_f32_16x16x32_bf16 v[96:99], v[176:179], v[144:147], v[96:99]
s_waitcnt vmcnt(9)
s_barrier
ds_read_b64_tr_b16 v[160:161], v12 offset:57344
v_mfma_f32_16x16x32_bf16 v[100:103], v[176:179], v[148:151], v[100:103]
ds_read_b64_tr_b16 v[162:163], v12 offset:61440
s_lshl_b32 s27, s40, 10
s_mov_b32 s25, 0
s_mov_b32 s26, 0
v_bfe_u32 v3, v0, 2, 4
v_bfe_u32 v4, v3, 1, 2
v_lshlrev_b32 v4, 5, v4
s_waitcnt lgkmcnt(6)
v_mfma_f32_16x16x32_bf16 v[104:107], v[180:183], v[144:147], v[104:107]
ds_read_b64_tr_b16 v[164:165], v13 offset:57344
v_mfma_f32_16x16x32_bf16 v[108:111], v[180:183], v[148:151], v[108:111]
ds_read_b64_tr_b16 v[166:167], v13 offset:61440
v_mul_u32_u24 v3, 128, v3
v_and_b32 v2, 3, v0
v_lshl_add_u32 v3, v2, 3, v3
v_xor_b32 v2, 0, v4
v_add_u32 v227, v2, v3
v_xor_b32 v2, 32, v4
s_waitcnt lgkmcnt(6)
v_mfma_f32_16x16x32_bf16 v[112:115], v[184:187], v[144:147], v[112:115]
ds_read_b64_tr_b16 v[168:169], v14 offset:57344
v_mfma_f32_16x16x32_bf16 v[116:119], v[184:187], v[148:151], v[116:119]
ds_read_b64_tr_b16 v[170:171], v14 offset:61440
v_add_u32 v228, v2, v3
v_xor_b32 v2, 64, v4
v_add_u32 v229, v2, v3
v_xor_b32 v2, 96, v4
v_add_u32 v230, v2, v3
s_waitcnt lgkmcnt(6)
v_mfma_f32_16x16x32_bf16 v[120:123], v[188:191], v[144:147], v[120:123]
ds_read_b64_tr_b16 v[172:173], v15 offset:57344
v_mfma_f32_16x16x32_bf16 v[124:127], v[188:191], v[148:151], v[124:127]
ds_read_b64_tr_b16 v[174:175], v15 offset:61440
s_waitcnt lgkmcnt(6)
v_mfma_f32_16x16x32_bf16 v[64:67], v[160:163], v[152:155], v[64:67]
ds_read_b64_tr_b16 v[176:177], v16 offset:57344
v_mfma_f32_16x16x32_bf16 v[68:71], v[160:163], v[156:159], v[68:71]
ds_read_b64_tr_b16 v[178:179], v16 offset:61440
buffer_load_dwordx4 v[144:147], v8, s[48:51], s41 offen
s_waitcnt lgkmcnt(6)
v_mfma_f32_16x16x32_bf16 v[72:75], v[164:167], v[152:155], v[72:75]
ds_read_b64_tr_b16 v[180:181], v17 offset:57344
v_mfma_f32_16x16x32_bf16 v[76:79], v[164:167], v[156:159], v[76:79]
ds_read_b64_tr_b16 v[182:183], v17 offset:61440
s_waitcnt lgkmcnt(6)
v_mfma_f32_16x16x32_bf16 v[80:83], v[168:171], v[152:155], v[80:83]
ds_read_b64_tr_b16 v[184:185], v18 offset:57344
v_mfma_f32_16x16x32_bf16 v[84:87], v[168:171], v[156:159], v[84:87]
ds_read_b64_tr_b16 v[186:187], v18 offset:61440
s_add_u32 m0, s43, 40960
s_waitcnt lgkmcnt(6)
v_mfma_f32_16x16x32_bf16 v[88:91], v[172:175], v[152:155], v[88:91]
ds_read_b64_tr_b16 v[188:189], v19 offset:57344
buffer_load_dwordx4 v10, s[52:55], s42 offen lds
v_mfma_f32_16x16x32_bf16 v[92:95], v[172:175], v[156:159], v[92:95]
ds_read_b64_tr_b16 v[190:191], v19 offset:61440
s_waitcnt lgkmcnt(6)
v_mfma_f32_16x16x32_bf16 v[96:99], v[176:179], v[152:155], v[96:99]
s_waitcnt vmcnt(7)
s_barrier
ds_read_b64_tr_b16 v[160:161], v12 offset:0
v_mfma_f32_16x16x32_bf16 v[100:103], v[176:179], v[156:159], v[100:103]
ds_read_b64_tr_b16 v[162:163], v12 offset:4096
buffer_load_dwordx4 v[148:151], v9, s[48:51], s41 offen
s_add_u32 s41, s41, 1024
s_waitcnt lgkmcnt(6)
v_mfma_f32_16x16x32_bf16 v[104:107], v[180:183], v[152:155], v[104:107]
ds_read_b64_tr_b16 v[164:165], v13 offset:0
v_mfma_f32_16x16x32_bf16 v[108:111], v[180:183], v[156:159], v[108:111]
ds_read_b64_tr_b16 v[166:167], v13 offset:4096
s_waitcnt lgkmcnt(6)
v_mfma_f32_16x16x32_bf16 v[112:115], v[184:187], v[152:155], v[112:115]
ds_read_b64_tr_b16 v[168:169], v14 offset:0
v_mfma_f32_16x16x32_bf16 v[116:119], v[184:187], v[156:159], v[116:119]
ds_read_b64_tr_b16 v[170:171], v14 offset:4096
s_add_u32 m0, s43, 45056
s_waitcnt lgkmcnt(6)
v_mfma_f32_16x16x32_bf16 v[120:123], v[188:191], v[152:155], v[120:123]
ds_read_b64_tr_b16 v[172:173], v15 offset:0
buffer_load_dwordx4 v11, s[52:55], s42 offen lds
s_add_u32 s42, s42, 65536
v_mfma_f32_16x16x32_bf16 v[124:127], v[188:191], v[156:159], v[124:127]
ds_read_b64_tr_b16 v[174:175], v15 offset:4096
s_mov_b32 s44, 5
.p2align 4
L_mid_kernel_g_loop0:
s_waitcnt lgkmcnt(6)
v_mfma_f32_16x16x32_bf16 v[64:67], v[160:163], v[128:131], v[64:67]
ds_read_b64_tr_b16 v[176:177], v16 offset:0
v_mfma_f32_16x16x32_bf16 v[68:71], v[160:163], v[132:135], v[68:71]
ds_read_b64_tr_b16 v[178:179], v16 offset:4096
buffer_load_dwordx4 v[152:155], v8, s[48:51], s41 offen
s_waitcnt lgkmcnt(6)
v_mfma_f32_16x16x32_bf16 v[72:75], v[164:167], v[128:131], v[72:75]
ds_read_b64_tr_b16 v[180:181], v17 offset:0
v_mfma_f32_16x16x32_bf16 v[76:79], v[164:167], v[132:135], v[76:79]
ds_read_b64_tr_b16 v[182:183], v17 offset:4096
s_waitcnt lgkmcnt(6)
v_mfma_f32_16x16x32_bf16 v[80:83], v[168:171], v[128:131], v[80:83]
ds_read_b64_tr_b16 v[184:185], v18 offset:0
v_mfma_f32_16x16x32_bf16 v[84:87], v[168:171], v[132:135], v[84:87]
ds_read_b64_tr_b16 v[186:187], v18 offset:4096
s_add_u32 m0, s43, 49152
s_waitcnt lgkmcnt(6)
v_mfma_f32_16x16x32_bf16 v[88:91], v[172:175], v[128:131], v[88:91]
ds_read_b64_tr_b16 v[188:189], v19 offset:0
buffer_load_dwordx4 v10, s[52:55], s42 offen lds
v_mfma_f32_16x16x32_bf16 v[92:95], v[172:175], v[132:135], v[92:95]
ds_read_b64_tr_b16 v[190:191], v19 offset:4096
s_waitcnt lgkmcnt(6)
v_mfma_f32_16x16x32_bf16 v[96:99], v[176:179], v[128:131], v[96:99]
s_waitcnt vmcnt(7)
s_barrier
ds_read_b64_tr_b16 v[160:161], v12 offset:8192
v_mfma_f32_16x16x32_bf16 v[100:103], v[176:179], v[132:135], v[100:103]
ds_read_b64_tr_b16 v[162:163], v12 offset:12288
buffer_load_dwordx4 v[156:159], v9, s[48:51], s41 offen
s_add_u32 s41, s41, 1024
s_waitcnt lgkmcnt(6)
v_mfma_f32_16x16x32_bf16 v[104:107], v[180:183], v[128:131], v[104:107]
ds_read_b64_tr_b16 v[164:165], v13 offset:8192
v_mfma_f32_16x16x32_bf16 v[108:111], v[180:183], v[132:135], v[108:111]
ds_read_b64_tr_b16 v[166:167], v13 offset:12288
s_waitcnt lgkmcnt(6)
v_mfma_f32_16x16x32_bf16 v[112:115], v[184:187], v[128:131], v[112:115]
ds_read_b64_tr_b16 v[168:169], v14 offset:8192
v_mfma_f32_16x16x32_bf16 v[116:119], v[184:187], v[132:135], v[116:119]
ds_read_b64_tr_b16 v[170:171], v14 offset:12288
s_add_u32 m0, s43, 53248
s_waitcnt lgkmcnt(6)
v_mfma_f32_16x16x32_bf16 v[120:123], v[188:191], v[128:131], v[120:123]
ds_read_b64_tr_b16 v[172:173], v15 offset:8192
buffer_load_dwordx4 v11, s[52:55], s42 offen lds
s_add_u32 s42, s42, 65536
v_mfma_f32_16x16x32_bf16 v[124:127], v[188:191], v[132:135], v[124:127]
ds_read_b64_tr_b16 v[174:175], v15 offset:12288
s_waitcnt lgkmcnt(6)
v_mfma_f32_16x16x32_bf16 v[64:67], v[160:163], v[136:139], v[64:67]
ds_read_b64_tr_b16 v[176:177], v16 offset:8192
v_mfma_f32_16x16x32_bf16 v[68:71], v[160:163], v[140:143], v[68:71]
ds_read_b64_tr_b16 v[178:179], v16 offset:12288
buffer_load_dwordx4 v[128:131], v8, s[48:51], s41 offen
s_waitcnt lgkmcnt(6)
v_mfma_f32_16x16x32_bf16 v[72:75], v[164:167], v[136:139], v[72:75]
ds_read_b64_tr_b16 v[180:181], v17 offset:8192
v_mfma_f32_16x16x32_bf16 v[76:79], v[164:167], v[140:143], v[76:79]
ds_read_b64_tr_b16 v[182:183], v17 offset:12288
s_waitcnt lgkmcnt(6)
v_mfma_f32_16x16x32_bf16 v[80:83], v[168:171], v[136:139], v[80:83]
ds_read_b64_tr_b16 v[184:185], v18 offset:8192
v_mfma_f32_16x16x32_bf16 v[84:87], v[168:171], v[140:143], v[84:87]
ds_read_b64_tr_b16 v[186:187], v18 offset:12288
s_add_u32 m0, s43, 57344
s_waitcnt lgkmcnt(6)
v_mfma_f32_16x16x32_bf16 v[88:91], v[172:175], v[136:139], v[88:91]
ds_read_b64_tr_b16 v[188:189], v19 offset:8192
buffer_load_dwordx4 v10, s[52:55], s42 offen lds
v_mfma_f32_16x16x32_bf16 v[92:95], v[172:175], v[140:143], v[92:95]
ds_read_b64_tr_b16 v[190:191], v19 offset:12288
s_waitcnt lgkmcnt(6)
v_mfma_f32_16x16x32_bf16 v[96:99], v[176:179], v[136:139], v[96:99]
s_waitcnt vmcnt(7)
s_barrier
ds_read_b64_tr_b16 v[160:161], v12 offset:16384
v_mfma_f32_16x16x32_bf16 v[100:103], v[176:179], v[140:143], v[100:103]
ds_read_b64_tr_b16 v[162:163], v12 offset:20480
buffer_load_dwordx4 v[132:135], v9, s[48:51], s41 offen
s_add_u32 s41, s41, 1024
s_waitcnt lgkmcnt(6)
v_mfma_f32_16x16x32_bf16 v[104:107], v[180:183], v[136:139], v[104:107]
ds_read_b64_tr_b16 v[164:165], v13 offset:16384
v_mfma_f32_16x16x32_bf16 v[108:111], v[180:183], v[140:143], v[108:111]
ds_read_b64_tr_b16 v[166:167], v13 offset:20480
s_waitcnt lgkmcnt(6)
v_mfma_f32_16x16x32_bf16 v[112:115], v[184:187], v[136:139], v[112:115]
ds_read_b64_tr_b16 v[168:169], v14 offset:16384
v_mfma_f32_16x16x32_bf16 v[116:119], v[184:187], v[140:143], v[116:119]
ds_read_b64_tr_b16 v[170:171], v14 offset:20480
s_add_u32 m0, s43, 61440
s_waitcnt lgkmcnt(6)
v_mfma_f32_16x16x32_bf16 v[120:123], v[188:191], v[136:139], v[120:123]
ds_read_b64_tr_b16 v[172:173], v15 offset:16384
buffer_load_dwordx4 v11, s[52:55], s42 offen lds
s_add_u32 s42, s42, 65536
v_mfma_f32_16x16x32_bf16 v[124:127], v[188:191], v[140:143], v[124:127]
ds_read_b64_tr_b16 v[174:175], v15 offset:20480
s_waitcnt lgkmcnt(6)
v_mfma_f32_16x16x32_bf16 v[64:67], v[160:163], v[144:147], v[64:67]
ds_read_b64_tr_b16 v[176:177], v16 offset:16384
v_mfma_f32_16x16x32_bf16 v[68:71], v[160:163], v[148:151], v[68:71]
ds_read_b64_tr_b16 v[178:179], v16 offset:20480
buffer_load_dwordx4 v[136:139], v8, s[48:51], s41 offen
s_waitcnt lgkmcnt(6)
v_mfma_f32_16x16x32_bf16 v[72:75], v[164:167], v[144:147], v[72:75]
ds_read_b64_tr_b16 v[180:181], v17 offset:16384
v_mfma_f32_16x16x32_bf16 v[76:79], v[164:167], v[148:151], v[76:79]
ds_read_b64_tr_b16 v[182:183], v17 offset:20480
s_waitcnt lgkmcnt(6)
v_mfma_f32_16x16x32_bf16 v[80:83], v[168:171], v[144:147], v[80:83]
ds_read_b64_tr_b16 v[184:185], v18 offset:16384
v_mfma_f32_16x16x32_bf16 v[84:87], v[168:171], v[148:151], v[84:87]
ds_read_b64_tr_b16 v[186:187], v18 offset:20480
s_add_u32 m0, s43, 0
s_waitcnt lgkmcnt(6)
v_mfma_f32_16x16x32_bf16 v[88:91], v[172:175], v[144:147], v[88:91]
ds_read_b64_tr_b16 v[188:189], v19 offset:16384
buffer_load_dwordx4 v10, s[52:55], s42 offen lds
v_mfma_f32_16x16x32_bf16 v[92:95], v[172:175], v[148:151], v[92:95]
ds_read_b64_tr_b16 v[190:191], v19 offset:20480
s_waitcnt lgkmcnt(6)
v_mfma_f32_16x16x32_bf16 v[96:99], v[176:179], v[144:147], v[96:99]
s_waitcnt vmcnt(7)
s_barrier
ds_read_b64_tr_b16 v[160:161], v12 offset:24576
v_mfma_f32_16x16x32_bf16 v[100:103], v[176:179], v[148:151], v[100:103]
ds_read_b64_tr_b16 v[162:163], v12 offset:28672
buffer_load_dwordx4 v[140:143], v9, s[48:51], s41 offen
s_add_u32 s41, s41, 1024
s_waitcnt lgkmcnt(6)
v_mfma_f32_16x16x32_bf16 v[104:107], v[180:183], v[144:147], v[104:107]
ds_read_b64_tr_b16 v[164:165], v13 offset:24576
v_mfma_f32_16x16x32_bf16 v[108:111], v[180:183], v[148:151], v[108:111]
ds_read_b64_tr_b16 v[166:167], v13 offset:28672
s_waitcnt lgkmcnt(6)
v_mfma_f32_16x16x32_bf16 v[112:115], v[184:187], v[144:147], v[112:115]
ds_read_b64_tr_b16 v[168:169], v14 offset:24576
v_mfma_f32_16x16x32_bf16 v[116:119], v[184:187], v[148:151], v[116:119]
ds_read_b64_tr_b16 v[170:171], v14 offset:28672
s_add_u32 m0, s43, 4096
s_waitcnt lgkmcnt(6)
v_mfma_f32_16x16x32_bf16 v[120:123], v[188:191], v[144:147], v[120:123]
ds_read_b64_tr_b16 v[172:173], v15 offset:24576
buffer_load_dwordx4 v11, s[52:55], s42 offen lds
s_add_u32 s42, s42, 65536
v_mfma_f32_16x16x32_bf16 v[124:127], v[188:191], v[148:151], v[124:127]
ds_read_b64_tr_b16 v[174:175], v15 offset:28672
s_waitcnt lgkmcnt(6)
v_mfma_f32_16x16x32_bf16 v[64:67], v[160:163], v[152:155], v[64:67]
ds_read_b64_tr_b16 v[176:177], v16 offset:24576
v_mfma_f32_16x16x32_bf16 v[68:71], v[160:163], v[156:159], v[68:71]
ds_read_b64_tr_b16 v[178:179], v16 offset:28672
buffer_load_dwordx4 v[144:147], v8, s[48:51], s41 offen
s_waitcnt lgkmcnt(6)
v_mfma_f32_16x16x32_bf16 v[72:75], v[164:167], v[152:155], v[72:75]
ds_read_b64_tr_b16 v[180:181], v17 offset:24576
v_mfma_f32_16x16x32_bf16 v[76:79], v[164:167], v[156:159], v[76:79]
ds_read_b64_tr_b16 v[182:183], v17 offset:28672
s_waitcnt lgkmcnt(6)
v_mfma_f32_16x16x32_bf16 v[80:83], v[168:171], v[152:155], v[80:83]
ds_read_b64_tr_b16 v[184:185], v18 offset:24576
v_mfma_f32_16x16x32_bf16 v[84:87], v[168:171], v[156:159], v[84:87]
ds_read_b64_tr_b16 v[186:187], v18 offset:28672
s_add_u32 m0, s43, 8192
s_waitcnt lgkmcnt(6)
v_mfma_f32_16x16x32_bf16 v[88:91], v[172:175], v[152:155], v[88:91]
ds_read_b64_tr_b16 v[188:189], v19 offset:24576
buffer_load_dwordx4 v10, s[52:55], s42 offen lds
v_mfma_f32_16x16x32_bf16 v[92:95], v[172:175], v[156:159], v[92:95]
ds_read_b64_tr_b16 v[190:191], v19 offset:28672
s_waitcnt lgkmcnt(6)
v_mfma_f32_16x16x32_bf16 v[96:99], v[176:179], v[152:155], v[96:99]
s_waitcnt vmcnt(7)
s_barrier
ds_read_b64_tr_b16 v[160:161], v12 offset:32768
v_mfma_f32_16x16x32_bf16 v[100:103], v[176:179], v[156:159], v[100:103]
ds_read_b64_tr_b16 v[162:163], v12 offset:36864
buffer_load_dwordx4 v[148:151], v9, s[48:51], s41 offen
s_add_u32 s41, s41, 1024
s_waitcnt lgkmcnt(6)
v_mfma_f32_16x16x32_bf16 v[104:107], v[180:183], v[152:155], v[104:107]
ds_read_b64_tr_b16 v[164:165], v13 offset:32768
v_mfma_f32_16x16x32_bf16 v[108:111], v[180:183], v[156:159], v[108:111]
ds_read_b64_tr_b16 v[166:167], v13 offset:36864
s_waitcnt lgkmcnt(6)
v_mfma_f32_16x16x32_bf16 v[112:115], v[184:187], v[152:155], v[112:115]
ds_read_b64_tr_b16 v[168:169], v14 offset:32768
v_mfma_f32_16x16x32_bf16 v[116:119], v[184:187], v[156:159], v[116:119]
ds_read_b64_tr_b16 v[170:171], v14 offset:36864
s_add_u32 m0, s43, 12288
s_waitcnt lgkmcnt(6)
v_mfma_f32_16x16x32_bf16 v[120:123], v[188:191], v[152:155], v[120:123]
ds_read_b64_tr_b16 v[172:173], v15 offset:32768
buffer_load_dwordx4 v11, s[52:55], s42 offen lds
s_add_u32 s42, s42, 65536
v_mfma_f32_16x16x32_bf16 v[124:127], v[188:191], v[156:159], v[124:127]
ds_read_b64_tr_b16 v[174:175], v15 offset:36864
s_waitcnt lgkmcnt(6)
v_mfma_f32_16x16x32_bf16 v[64:67], v[160:163], v[128:131], v[64:67]
ds_read_b64_tr_b16 v[176:177], v16 offset:32768
v_mfma_f32_16x16x32_bf16 v[68:71], v[160:163], v[132:135], v[68:71]
ds_read_b64_tr_b16 v[178:179], v16 offset:36864
buffer_load_dwordx4 v[152:155], v8, s[48:51], s41 offen
s_waitcnt lgkmcnt(6)
v_mfma_f32_16x16x32_bf16 v[72:75], v[164:167], v[128:131], v[72:75]
ds_read_b64_tr_b16 v[180:181], v17 offset:32768
v_mfma_f32_16x16x32_bf16 v[76:79], v[164:167], v[132:135], v[76:79]
ds_read_b64_tr_b16 v[182:183], v17 offset:36864
s_waitcnt lgkmcnt(6)
v_mfma_f32_16x16x32_bf16 v[80:83], v[168:171], v[128:131], v[80:83]
ds_read_b64_tr_b16 v[184:185], v18 offset:32768
v_mfma_f32_16x16x32_bf16 v[84:87], v[168:171], v[132:135], v[84:87]
ds_read_b64_tr_b16 v[186:187], v18 offset:36864
s_add_u32 m0, s43, 16384
s_waitcnt lgkmcnt(6)
v_mfma_f32_16x16x32_bf16 v[88:91], v[172:175], v[128:131], v[88:91]
ds_read_b64_tr_b16 v[188:189], v19 offset:32768
buffer_load_dwordx4 v10, s[52:55], s42 offen lds
v_mfma_f32_16x16x32_bf16 v[92:95], v[172:175], v[132:135], v[92:95]
ds_read_b64_tr_b16 v[190:191], v19 offset:36864
s_waitcnt lgkmcnt(6)
v_mfma_f32_16x16x32_bf16 v[96:99], v[176:179], v[128:131], v[96:99]
s_waitcnt vmcnt(7)
s_barrier
ds_read_b64_tr_b16 v[160:161], v12 offset:40960
v_mfma_f32_16x16x32_bf16 v[100:103], v[176:179], v[132:135], v[100:103]
ds_read_b64_tr_b16 v[162:163], v12 offset:45056
buffer_load_dwordx4 v[156:159], v9, s[48:51], s41 offen
s_add_u32 s41, s41, 1024
s_waitcnt lgkmcnt(6)
v_mfma_f32_16x16x32_bf16 v[104:107], v[180:183], v[128:131], v[104:107]
ds_read_b64_tr_b16 v[164:165], v13 offset:40960
v_mfma_f32_16x16x32_bf16 v[108:111], v[180:183], v[132:135], v[108:111]
ds_read_b64_tr_b16 v[166:167], v13 offset:45056
s_waitcnt lgkmcnt(6)
v_mfma_f32_16x16x32_bf16 v[112:115], v[184:187], v[128:131], v[112:115]
ds_read_b64_tr_b16 v[168:169], v14 offset:40960
v_mfma_f32_16x16x32_bf16 v[116:119], v[184:187], v[132:135], v[116:119]
ds_read_b64_tr_b16 v[170:171], v14 offset:45056
s_add_u32 m0, s43, 20480
s_waitcnt lgkmcnt(6)
v_mfma_f32_16x16x32_bf16 v[120:123], v[188:191], v[128:131], v[120:123]
ds_read_b64_tr_b16 v[172:173], v15 offset:40960
buffer_load_dwordx4 v11, s[52:55], s42 offen lds
s_add_u32 s42, s42, 65536
v_mfma_f32_16x16x32_bf16 v[124:127], v[188:191], v[132:135], v[124:127]
ds_read_b64_tr_b16 v[174:175], v15 offset:45056
s_waitcnt lgkmcnt(6)
v_mfma_f32_16x16x32_bf16 v[64:67], v[160:163], v[136:139], v[64:67]
ds_read_b64_tr_b16 v[176:177], v16 offset:40960
v_mfma_f32_16x16x32_bf16 v[68:71], v[160:163], v[140:143], v[68:71]
ds_read_b64_tr_b16 v[178:179], v16 offset:45056
buffer_load_dwordx4 v[128:131], v8, s[48:51], s41 offen
s_waitcnt lgkmcnt(6)
v_mfma_f32_16x16x32_bf16 v[72:75], v[164:167], v[136:139], v[72:75]
ds_read_b64_tr_b16 v[180:181], v17 offset:40960
v_mfma_f32_16x16x32_bf16 v[76:79], v[164:167], v[140:143], v[76:79]
ds_read_b64_tr_b16 v[182:183], v17 offset:45056
s_waitcnt lgkmcnt(6)
v_mfma_f32_16x16x32_bf16 v[80:83], v[168:171], v[136:139], v[80:83]
ds_read_b64_tr_b16 v[184:185], v18 offset:40960
v_mfma_f32_16x16x32_bf16 v[84:87], v[168:171], v[140:143], v[84:87]
ds_read_b64_tr_b16 v[186:187], v18 offset:45056
s_add_u32 m0, s43, 24576
s_waitcnt lgkmcnt(6)
v_mfma_f32_16x16x32_bf16 v[88:91], v[172:175], v[136:139], v[88:91]
ds_read_b64_tr_b16 v[188:189], v19 offset:40960
buffer_load_dwordx4 v10, s[52:55], s42 offen lds
v_mfma_f32_16x16x32_bf16 v[92:95], v[172:175], v[140:143], v[92:95]
ds_read_b64_tr_b16 v[190:191], v19 offset:45056
s_waitcnt lgkmcnt(6)
v_mfma_f32_16x16x32_bf16 v[96:99], v[176:179], v[136:139], v[96:99]
s_waitcnt vmcnt(7)
s_barrier
ds_read_b64_tr_b16 v[160:161], v12 offset:49152
v_mfma_f32_16x16x32_bf16 v[100:103], v[176:179], v[140:143], v[100:103]
ds_read_b64_tr_b16 v[162:163], v12 offset:53248
buffer_load_dwordx4 v[132:135], v9, s[48:51], s41 offen
s_add_u32 s41, s41, 1024
s_waitcnt lgkmcnt(6)
v_mfma_f32_16x16x32_bf16 v[104:107], v[180:183], v[136:139], v[104:107]
ds_read_b64_tr_b16 v[164:165], v13 offset:49152
v_mfma_f32_16x16x32_bf16 v[108:111], v[180:183], v[140:143], v[108:111]
ds_read_b64_tr_b16 v[166:167], v13 offset:53248
s_waitcnt lgkmcnt(6)
v_mfma_f32_16x16x32_bf16 v[112:115], v[184:187], v[136:139], v[112:115]
ds_read_b64_tr_b16 v[168:169], v14 offset:49152
v_mfma_f32_16x16x32_bf16 v[116:119], v[184:187], v[140:143], v[116:119]
ds_read_b64_tr_b16 v[170:171], v14 offset:53248
s_add_u32 m0, s43, 28672
s_waitcnt lgkmcnt(6)
v_mfma_f32_16x16x32_bf16 v[120:123], v[188:191], v[136:139], v[120:123]
ds_read_b64_tr_b16 v[172:173], v15 offset:49152
buffer_load_dwordx4 v11, s[52:55], s42 offen lds
s_add_u32 s42, s42, 65536
v_mfma_f32_16x16x32_bf16 v[124:127], v[188:191], v[140:143], v[124:127]
ds_read_b64_tr_b16 v[174:175], v15 offset:53248
s_waitcnt lgkmcnt(6)
v_mfma_f32_16x16x32_bf16 v[64:67], v[160:163], v[144:147], v[64:67]
ds_read_b64_tr_b16 v[176:177], v16 offset:49152
v_mfma_f32_16x16x32_bf16 v[68:71], v[160:163], v[148:151], v[68:71]
ds_read_b64_tr_b16 v[178:179], v16 offset:53248
buffer_load_dwordx4 v[136:139], v8, s[48:51], s41 offen
s_waitcnt lgkmcnt(6)
v_mfma_f32_16x16x32_bf16 v[72:75], v[164:167], v[144:147], v[72:75]
ds_read_b64_tr_b16 v[180:181], v17 offset:49152
v_mfma_f32_16x16x32_bf16 v[76:79], v[164:167], v[148:151], v[76:79]
ds_read_b64_tr_b16 v[182:183], v17 offset:53248
s_waitcnt lgkmcnt(6)
v_mfma_f32_16x16x32_bf16 v[80:83], v[168:171], v[144:147], v[80:83]
ds_read_b64_tr_b16 v[184:185], v18 offset:49152
v_mfma_f32_16x16x32_bf16 v[84:87], v[168:171], v[148:151], v[84:87]
ds_read_b64_tr_b16 v[186:187], v18 offset:53248
s_add_u32 m0, s43, 32768
s_waitcnt lgkmcnt(6)
v_mfma_f32_16x16x32_bf16 v[88:91], v[172:175], v[144:147], v[88:91]
ds_read_b64_tr_b16 v[188:189], v19 offset:49152
buffer_load_dwordx4 v10, s[52:55], s42 offen lds
v_mfma_f32_16x16x32_bf16 v[92:95], v[172:175], v[148:151], v[92:95]
ds_read_b64_tr_b16 v[190:191], v19 offset:53248
s_waitcnt lgkmcnt(6)
v_mfma_f32_16x16x32_bf16 v[96:99], v[176:179], v[144:147], v[96:99]
s_waitcnt vmcnt(7)
s_barrier
ds_read_b64_tr_b16 v[160:161], v12 offset:57344
v_mfma_f32_16x16x32_bf16 v[100:103], v[176:179], v[148:151], v[100:103]
ds_read_b64_tr_b16 v[162:163], v12 offset:61440
buffer_load_dwordx4 v[140:143], v9, s[48:51], s41 offen
s_add_u32 s41, s41, 1024
s_waitcnt lgkmcnt(6)
v_mfma_f32_16x16x32_bf16 v[104:107], v[180:183], v[144:147], v[104:107]
ds_read_b64_tr_b16 v[164:165], v13 offset:57344
v_mfma_f32_16x16x32_bf16 v[108:111], v[180:183], v[148:151], v[108:111]
ds_read_b64_tr_b16 v[166:167], v13 offset:61440
s_waitcnt lgkmcnt(6)
v_mfma_f32_16x16x32_bf16 v[112:115], v[184:187], v[144:147], v[112:115]
ds_read_b64_tr_b16 v[168:169], v14 offset:57344
v_mfma_f32_16x16x32_bf16 v[116:119], v[184:187], v[148:151], v[116:119]
ds_read_b64_tr_b16 v[170:171], v14 offset:61440
s_add_u32 m0, s43, 36864
s_waitcnt lgkmcnt(6)
v_mfma_f32_16x16x32_bf16 v[120:123], v[188:191], v[144:147], v[120:123]
ds_read_b64_tr_b16 v[172:173], v15 offset:57344
buffer_load_dwordx4 v11, s[52:55], s42 offen lds
s_add_u32 s42, s42, 65536
v_mfma_f32_16x16x32_bf16 v[124:127], v[188:191], v[148:151], v[124:127]
ds_read_b64_tr_b16 v[174:175], v15 offset:61440
s_waitcnt lgkmcnt(6)
v_mfma_f32_16x16x32_bf16 v[64:67], v[160:163], v[152:155], v[64:67]
ds_read_b64_tr_b16 v[176:177], v16 offset:57344
v_mfma_f32_16x16x32_bf16 v[68:71], v[160:163], v[156:159], v[68:71]
ds_read_b64_tr_b16 v[178:179], v16 offset:61440
buffer_load_dwordx4 v[144:147], v8, s[48:51], s41 offen
s_waitcnt lgkmcnt(6)
v_mfma_f32_16x16x32_bf16 v[72:75], v[164:167], v[152:155], v[72:75]
ds_read_b64_tr_b16 v[180:181], v17 offset:57344
v_mfma_f32_16x16x32_bf16 v[76:79], v[164:167], v[156:159], v[76:79]
ds_read_b64_tr_b16 v[182:183], v17 offset:61440
s_waitcnt lgkmcnt(6)
v_mfma_f32_16x16x32_bf16 v[80:83], v[168:171], v[152:155], v[80:83]
ds_read_b64_tr_b16 v[184:185], v18 offset:57344
v_mfma_f32_16x16x32_bf16 v[84:87], v[168:171], v[156:159], v[84:87]
ds_read_b64_tr_b16 v[186:187], v18 offset:61440
s_add_u32 m0, s43, 40960
s_waitcnt lgkmcnt(6)
v_mfma_f32_16x16x32_bf16 v[88:91], v[172:175], v[152:155], v[88:91]
ds_read_b64_tr_b16 v[188:189], v19 offset:57344
buffer_load_dwordx4 v10, s[52:55], s42 offen lds
v_mfma_f32_16x16x32_bf16 v[92:95], v[172:175], v[156:159], v[92:95]
ds_read_b64_tr_b16 v[190:191], v19 offset:61440
s_waitcnt lgkmcnt(6)
v_mfma_f32_16x16x32_bf16 v[96:99], v[176:179], v[152:155], v[96:99]
s_waitcnt vmcnt(7)
s_barrier
ds_read_b64_tr_b16 v[160:161], v12 offset:0
v_mfma_f32_16x16x32_bf16 v[100:103], v[176:179], v[156:159], v[100:103]
ds_read_b64_tr_b16 v[162:163], v12 offset:4096
buffer_load_dwordx4 v[148:151], v9, s[48:51], s41 offen
s_add_u32 s41, s41, 1024
s_waitcnt lgkmcnt(6)
v_mfma_f32_16x16x32_bf16 v[104:107], v[180:183], v[152:155], v[104:107]
ds_read_b64_tr_b16 v[164:165], v13 offset:0
v_mfma_f32_16x16x32_bf16 v[108:111], v[180:183], v[156:159], v[108:111]
ds_read_b64_tr_b16 v[166:167], v13 offset:4096
s_waitcnt lgkmcnt(6)
v_mfma_f32_16x16x32_bf16 v[112:115], v[184:187], v[152:155], v[112:115]
ds_read_b64_tr_b16 v[168:169], v14 offset:0
v_mfma_f32_16x16x32_bf16 v[116:119], v[184:187], v[156:159], v[116:119]
ds_read_b64_tr_b16 v[170:171], v14 offset:4096
s_add_u32 m0, s43, 45056
s_waitcnt lgkmcnt(6)
v_mfma_f32_16x16x32_bf16 v[120:123], v[188:191], v[152:155], v[120:123]
ds_read_b64_tr_b16 v[172:173], v15 offset:0
buffer_load_dwordx4 v11, s[52:55], s42 offen lds
s_add_u32 s42, s42, 65536
v_mfma_f32_16x16x32_bf16 v[124:127], v[188:191], v[156:159], v[124:127]
ds_read_b64_tr_b16 v[174:175], v15 offset:4096
s_sub_u32 s44, s44, 1
s_cmp_lg_u32 s44, 0
s_cbranch_scc1 L_mid_kernel_g_loop0
s_waitcnt lgkmcnt(6)
v_mfma_f32_16x16x32_bf16 v[64:67], v[160:163], v[128:131], v[64:67]
ds_read_b64_tr_b16 v[176:177], v16 offset:0
v_mfma_f32_16x16x32_bf16 v[68:71], v[160:163], v[132:135], v[68:71]
ds_read_b64_tr_b16 v[178:179], v16 offset:4096
buffer_load_dwordx4 v[152:155], v8, s[48:51], s41 offen
s_waitcnt lgkmcnt(6)
v_mfma_f32_16x16x32_bf16 v[72:75], v[164:167], v[128:131], v[72:75]
ds_read_b64_tr_b16 v[180:181], v17 offset:0
v_mfma_f32_16x16x32_bf16 v[76:79], v[164:167], v[132:135], v[76:79]
ds_read_b64_tr_b16 v[182:183], v17 offset:4096
s_waitcnt lgkmcnt(6)
v_mfma_f32_16x16x32_bf16 v[80:83], v[168:171], v[128:131], v[80:83]
ds_read_b64_tr_b16 v[184:185], v18 offset:0
v_mfma_f32_16x16x32_bf16 v[84:87], v[168:171], v[132:135], v[84:87]
ds_read_b64_tr_b16 v[186:187], v18 offset:4096
s_add_u32 m0, s43, 49152
s_waitcnt lgkmcnt(6)
v_mfma_f32_16x16x32_bf16 v[88:91], v[172:175], v[128:131], v[88:91]
ds_read_b64_tr_b16 v[188:189], v19 offset:0
buffer_load_dwordx4 v10, s[52:55], s42 offen lds
v_mfma_f32_16x16x32_bf16 v[92:95], v[172:175], v[132:135], v[92:95]
ds_read_b64_tr_b16 v[190:191], v19 offset:4096
s_waitcnt lgkmcnt(6)
v_mfma_f32_16x16x32_bf16 v[96:99], v[176:179], v[128:131], v[96:99]
s_waitcnt vmcnt(7)
s_barrier
ds_read_b64_tr_b16 v[160:161], v12 offset:8192
v_mfma_f32_16x16x32_bf16 v[100:103], v[176:179], v[132:135], v[100:103]
ds_read_b64_tr_b16 v[162:163], v12 offset:12288
buffer_load_dwordx4 v[156:159], v9, s[48:51], s41 offen
s_add_u32 s41, s41, 1024
s_waitcnt lgkmcnt(6)
v_mfma_f32_16x16x32_bf16 v[104:107], v[180:183], v[128:131], v[104:107]
ds_read_b64_tr_b16 v[164:165], v13 offset:8192
v_mfma_f32_16x16x32_bf16 v[108:111], v[180:183], v[132:135], v[108:111]
ds_read_b64_tr_b16 v[166:167], v13 offset:12288
s_waitcnt lgkmcnt(6)
v_mfma_f32_16x16x32_bf16 v[112:115], v[184:187], v[128:131], v[112:115]
ds_read_b64_tr_b16 v[168:169], v14 offset:8192
v_mfma_f32_16x16x32_bf16 v[116:119], v[184:187], v[132:135], v[116:119]
ds_read_b64_tr_b16 v[170:171], v14 offset:12288
s_add_u32 m0, s43, 53248
s_waitcnt lgkmcnt(6)
v_mfma_f32_16x16x32_bf16 v[120:123], v[188:191], v[128:131], v[120:123]
ds_read_b64_tr_b16 v[172:173], v15 offset:8192
buffer_load_dwordx4 v11, s[52:55], s42 offen lds
s_add_u32 s42, s42, 65536
v_mfma_f32_16x16x32_bf16 v[124:127], v[188:191], v[132:135], v[124:127]
ds_read_b64_tr_b16 v[174:175], v15 offset:12288
s_waitcnt lgkmcnt(6)
v_mfma_f32_16x16x32_bf16 v[64:67], v[160:163], v[136:139], v[64:67]
ds_read_b64_tr_b16 v[176:177], v16 offset:8192
v_mfma_f32_16x16x32_bf16 v[68:71], v[160:163], v[140:143], v[68:71]
ds_read_b64_tr_b16 v[178:179], v16 offset:12288
buffer_load_dwordx4 v[128:131], v8, s[48:51], s41 offen
s_waitcnt lgkmcnt(6)
v_mfma_f32_16x16x32_bf16 v[72:75], v[164:167], v[136:139], v[72:75]
ds_read_b64_tr_b16 v[180:181], v17 offset:8192
v_mfma_f32_16x16x32_bf16 v[76:79], v[164:167], v[140:143], v[76:79]
ds_read_b64_tr_b16 v[182:183], v17 offset:12288
s_waitcnt lgkmcnt(6)
v_mfma_f32_16x16x32_bf16 v[80:83], v[168:171], v[136:139], v[80:83]
ds_read_b64_tr_b16 v[184:185], v18 offset:8192
v_mfma_f32_16x16x32_bf16 v[84:87], v[168:171], v[140:143], v[84:87]
ds_read_b64_tr_b16 v[186:187], v18 offset:12288
s_add_u32 m0, s43, 57344
s_waitcnt lgkmcnt(6)
v_mfma_f32_16x16x32_bf16 v[88:91], v[172:175], v[136:139], v[88:91]
ds_read_b64_tr_b16 v[188:189], v19 offset:8192
buffer_load_dwordx4 v10, s[52:55], s42 offen lds
v_mfma_f32_16x16x32_bf16 v[92:95], v[172:175], v[140:143], v[92:95]
ds_read_b64_tr_b16 v[190:191], v19 offset:12288
s_waitcnt lgkmcnt(6)
v_mfma_f32_16x16x32_bf16 v[96:99], v[176:179], v[136:139], v[96:99]
s_waitcnt vmcnt(7)
s_barrier
ds_read_b64_tr_b16 v[160:161], v12 offset:16384
v_mfma_f32_16x16x32_bf16 v[100:103], v[176:179], v[140:143], v[100:103]
ds_read_b64_tr_b16 v[162:163], v12 offset:20480
buffer_load_dwordx4 v[132:135], v9, s[48:51], s41 offen
s_add_u32 s41, s41, 1024
s_waitcnt lgkmcnt(6)
v_mfma_f32_16x16x32_bf16 v[104:107], v[180:183], v[136:139], v[104:107]
ds_read_b64_tr_b16 v[164:165], v13 offset:16384
v_mfma_f32_16x16x32_bf16 v[108:111], v[180:183], v[140:143], v[108:111]
ds_read_b64_tr_b16 v[166:167], v13 offset:20480
s_waitcnt lgkmcnt(6)
v_mfma_f32_16x16x32_bf16 v[112:115], v[184:187], v[136:139], v[112:115]
ds_read_b64_tr_b16 v[168:169], v14 offset:16384
v_mfma_f32_16x16x32_bf16 v[116:119], v[184:187], v[140:143], v[116:119]
ds_read_b64_tr_b16 v[170:171], v14 offset:20480
s_add_u32 m0, s43, 61440
s_waitcnt lgkmcnt(6)
v_mfma_f32_16x16x32_bf16 v[120:123], v[188:191], v[136:139], v[120:123]
ds_read_b64_tr_b16 v[172:173], v15 offset:16384
buffer_load_dwordx4 v11, s[52:55], s42 offen lds
s_add_u32 s42, s42, 65536
v_mfma_f32_16x16x32_bf16 v[124:127], v[188:191], v[140:143], v[124:127]
ds_read_b64_tr_b16 v[174:175], v15 offset:20480
s_waitcnt lgkmcnt(6)
v_mfma_f32_16x16x32_bf16 v[64:67], v[160:163], v[144:147], v[64:67]
ds_read_b64_tr_b16 v[176:177], v16 offset:16384
v_mfma_f32_16x16x32_bf16 v[68:71], v[160:163], v[148:151], v[68:71]
ds_read_b64_tr_b16 v[178:179], v16 offset:20480
buffer_load_dwordx4 v[136:139], v8, s[48:51], s41 offen
s_waitcnt lgkmcnt(6)
v_mfma_f32_16x16x32_bf16 v[72:75], v[164:167], v[144:147], v[72:75]
ds_read_b64_tr_b16 v[180:181], v17 offset:16384
v_mfma_f32_16x16x32_bf16 v[76:79], v[164:167], v[148:151], v[76:79]
ds_read_b64_tr_b16 v[182:183], v17 offset:20480
s_waitcnt lgkmcnt(6)
v_mfma_f32_16x16x32_bf16 v[80:83], v[168:171], v[144:147], v[80:83]
ds_read_b64_tr_b16 v[184:185], v18 offset:16384
v_mfma_f32_16x16x32_bf16 v[84:87], v[168:171], v[148:151], v[84:87]
ds_read_b64_tr_b16 v[186:187], v18 offset:20480
s_waitcnt lgkmcnt(6)
v_mfma_f32_16x16x32_bf16 v[88:91], v[172:175], v[144:147], v[88:91]
ds_read_b64_tr_b16 v[188:189], v19 offset:16384
v_mfma_f32_16x16x32_bf16 v[92:95], v[172:175], v[148:151], v[92:95]
ds_read_b64_tr_b16 v[190:191], v19 offset:20480
s_waitcnt lgkmcnt(6)
v_mfma_f32_16x16x32_bf16 v[96:99], v[176:179], v[144:147], v[96:99]
s_waitcnt vmcnt(6)
s_barrier
ds_read_b64_tr_b16 v[160:161], v12 offset:24576
v_mfma_f32_16x16x32_bf16 v[100:103], v[176:179], v[148:151], v[100:103]
ds_read_b64_tr_b16 v[162:163], v12 offset:28672
buffer_load_dwordx4 v[140:143], v9, s[48:51], s41 offen
s_add_u32 s41, s41, 1024
s_waitcnt lgkmcnt(6)
v_mfma_f32_16x16x32_bf16 v[104:107], v[180:183], v[144:147], v[104:107]
ds_read_b64_tr_b16 v[164:165], v13 offset:24576
v_mfma_f32_16x16x32_bf16 v[108:111], v[180:183], v[148:151], v[108:111]
ds_read_b64_tr_b16 v[166:167], v13 offset:28672
s_waitcnt lgkmcnt(6)
v_mfma_f32_16x16x32_bf16 v[112:115], v[184:187], v[144:147], v[112:115]
ds_read_b64_tr_b16 v[168:169], v14 offset:24576
v_mfma_f32_16x16x32_bf16 v[116:119], v[184:187], v[148:151], v[116:119]
ds_read_b64_tr_b16 v[170:171], v14 offset:28672
s_waitcnt lgkmcnt(6)
v_mfma_f32_16x16x32_bf16 v[120:123], v[188:191], v[144:147], v[120:123]
ds_read_b64_tr_b16 v[172:173], v15 offset:24576
v_mfma_f32_16x16x32_bf16 v[124:127], v[188:191], v[148:151], v[124:127]
ds_read_b64_tr_b16 v[174:175], v15 offset:28672
s_waitcnt lgkmcnt(6)
v_mfma_f32_16x16x32_bf16 v[64:67], v[160:163], v[152:155], v[64:67]
ds_read_b64_tr_b16 v[176:177], v16 offset:24576
v_mfma_f32_16x16x32_bf16 v[68:71], v[160:163], v[156:159], v[68:71]
ds_read_b64_tr_b16 v[178:179], v16 offset:28672
buffer_load_dwordx4 v[144:147], v8, s[48:51], s41 offen
s_waitcnt lgkmcnt(6)
v_mfma_f32_16x16x32_bf16 v[72:75], v[164:167], v[152:155], v[72:75]
ds_read_b64_tr_b16 v[180:181], v17 offset:24576
v_mfma_f32_16x16x32_bf16 v[76:79], v[164:167], v[156:159], v[76:79]
ds_read_b64_tr_b16 v[182:183], v17 offset:28672
s_waitcnt lgkmcnt(6)
v_mfma_f32_16x16x32_bf16 v[80:83], v[168:171], v[152:155], v[80:83]
ds_read_b64_tr_b16 v[184:185], v18 offset:24576
v_mfma_f32_16x16x32_bf16 v[84:87], v[168:171], v[156:159], v[84:87]
ds_read_b64_tr_b16 v[186:187], v18 offset:28672
s_waitcnt lgkmcnt(6)
v_mfma_f32_16x16x32_bf16 v[88:91], v[172:175], v[152:155], v[88:91]
ds_read_b64_tr_b16 v[188:189], v19 offset:24576
v_mfma_f32_16x16x32_bf16 v[92:95], v[172:175], v[156:159], v[92:95]
ds_read_b64_tr_b16 v[190:191], v19 offset:28672
s_waitcnt lgkmcnt(6)
v_mfma_f32_16x16x32_bf16 v[96:99], v[176:179], v[152:155], v[96:99]
s_waitcnt vmcnt(4)
s_barrier
ds_read_b64_tr_b16 v[160:161], v12 offset:32768
v_mfma_f32_16x16x32_bf16 v[100:103], v[176:179], v[156:159], v[100:103]
ds_read_b64_tr_b16 v[162:163], v12 offset:36864
buffer_load_dwordx4 v[148:151], v9, s[48:51], s41 offen
s_add_u32 s41, s41, 1024
s_waitcnt lgkmcnt(6)
v_mfma_f32_16x16x32_bf16 v[104:107], v[180:183], v[152:155], v[104:107]
ds_read_b64_tr_b16 v[164:165], v13 offset:32768
v_mfma_f32_16x16x32_bf16 v[108:111], v[180:183], v[156:159], v[108:111]
ds_read_b64_tr_b16 v[166:167], v13 offset:36864
s_waitcnt lgkmcnt(6)
v_mfma_f32_16x16x32_bf16 v[112:115], v[184:187], v[152:155], v[112:115]
ds_read_b64_tr_b16 v[168:169], v14 offset:32768
v_mfma_f32_16x16x32_bf16 v[116:119], v[184:187], v[156:159], v[116:119]
ds_read_b64_tr_b16 v[170:171], v14 offset:36864
s_waitcnt lgkmcnt(6)
v_mfma_f32_16x16x32_bf16 v[120:123], v[188:191], v[152:155], v[120:123]
ds_read_b64_tr_b16 v[172:173], v15 offset:32768
v_mfma_f32_16x16x32_bf16 v[124:127], v[188:191], v[156:159], v[124:127]
ds_read_b64_tr_b16 v[174:175], v15 offset:36864
s_waitcnt lgkmcnt(6)
v_mfma_f32_16x16x32_bf16 v[64:67], v[160:163], v[128:131], v[64:67]
ds_read_b64_tr_b16 v[176:177], v16 offset:32768
v_mfma_f32_16x16x32_bf16 v[68:71], v[160:163], v[132:135], v[68:71]
ds_read_b64_tr_b16 v[178:179], v16 offset:36864
buffer_load_dwordx4 v[152:155], v8, s[48:51], s41 offen
s_waitcnt lgkmcnt(6)
v_mfma_f32_16x16x32_bf16 v[72:75], v[164:167], v[128:131], v[72:75]
ds_read_b64_tr_b16 v[180:181], v17 offset:32768
v_mfma_f32_16x16x32_bf16 v[76:79], v[164:167], v[132:135], v[76:79]
ds_read_b64_tr_b16 v[182:183], v17 offset:36864
s_waitcnt lgkmcnt(6)
v_mfma_f32_16x16x32_bf16 v[80:83], v[168:171], v[128:131], v[80:83]
ds_read_b64_tr_b16 v[184:185], v18 offset:32768
v_mfma_f32_16x16x32_bf16 v[84:87], v[168:171], v[132:135], v[84:87]
ds_read_b64_tr_b16 v[186:187], v18 offset:36864
s_waitcnt lgkmcnt(6)
v_mfma_f32_16x16x32_bf16 v[88:91], v[172:175], v[128:131], v[88:91]
ds_read_b64_tr_b16 v[188:189], v19 offset:32768
v_mfma_f32_16x16x32_bf16 v[92:95], v[172:175], v[132:135], v[92:95]
ds_read_b64_tr_b16 v[190:191], v19 offset:36864
s_waitcnt lgkmcnt(6)
v_mfma_f32_16x16x32_bf16 v[96:99], v[176:179], v[128:131], v[96:99]
s_waitcnt vmcnt(3)
s_barrier
ds_read_b64_tr_b16 v[160:161], v12 offset:40960
v_mfma_f32_16x16x32_bf16 v[100:103], v[176:179], v[132:135], v[100:103]
ds_read_b64_tr_b16 v[162:163], v12 offset:45056
buffer_load_dwordx4 v[156:159], v9, s[48:51], s41 offen
s_add_u32 s41, s41, 1024
s_waitcnt lgkmcnt(6)
v_mfma_f32_16x16x32_bf16 v[104:107], v[180:183], v[128:131], v[104:107]
ds_read_b64_tr_b16 v[164:165], v13 offset:40960
v_mfma_f32_16x16x32_bf16 v[108:111], v[180:183], v[132:135], v[108:111]
ds_read_b64_tr_b16 v[166:167], v13 offset:45056
s_waitcnt lgkmcnt(6)
v_mfma_f32_16x16x32_bf16 v[112:115], v[184:187], v[128:131], v[112:115]
ds_read_b64_tr_b16 v[168:169], v14 offset:40960
v_mfma_f32_16x16x32_bf16 v[116:119], v[184:187], v[132:135], v[116:119]
ds_read_b64_tr_b16 v[170:171], v14 offset:45056
s_waitcnt lgkmcnt(6)
v_mfma_f32_16x16x32_bf16 v[120:123], v[188:191], v[128:131], v[120:123]
ds_read_b64_tr_b16 v[172:173], v15 offset:40960
v_mfma_f32_16x16x32_bf16 v[124:127], v[188:191], v[132:135], v[124:127]
ds_read_b64_tr_b16 v[174:175], v15 offset:45056
s_waitcnt lgkmcnt(6)
v_mfma_f32_16x16x32_bf16 v[64:67], v[160:163], v[136:139], v[64:67]
ds_read_b64_tr_b16 v[176:177], v16 offset:40960
v_mfma_f32_16x16x32_bf16 v[68:71], v[160:163], v[140:143], v[68:71]
ds_read_b64_tr_b16 v[178:179], v16 offset:45056
s_waitcnt lgkmcnt(6)
v_mfma_f32_16x16x32_bf16 v[72:75], v[164:167], v[136:139], v[72:75]
ds_read_b64_tr_b16 v[180:181], v17 offset:40960
v_mfma_f32_16x16x32_bf16 v[76:79], v[164:167], v[140:143], v[76:79]
ds_read_b64_tr_b16 v[182:183], v17 offset:45056
s_waitcnt lgkmcnt(6)
v_mfma_f32_16x16x32_bf16 v[80:83], v[168:171], v[136:139], v[80:83]
ds_read_b64_tr_b16 v[184:185], v18 offset:40960
v_mfma_f32_16x16x32_bf16 v[84:87], v[168:171], v[140:143], v[84:87]
ds_read_b64_tr_b16 v[186:187], v18 offset:45056
s_waitcnt lgkmcnt(6)
v_mfma_f32_16x16x32_bf16 v[88:91], v[172:175], v[136:139], v[88:91]
ds_read_b64_tr_b16 v[188:189], v19 offset:40960
v_mfma_f32_16x16x32_bf16 v[92:95], v[172:175], v[140:143], v[92:95]
ds_read_b64_tr_b16 v[190:191], v19 offset:45056
s_waitcnt lgkmcnt(6)
v_mfma_f32_16x16x32_bf16 v[96:99], v[176:179], v[136:139], v[96:99]
s_waitcnt vmcnt(2)
s_barrier
ds_read_b64_tr_b16 v[160:161], v12 offset:49152
v_mfma_f32_16x16x32_bf16 v[100:103], v[176:179], v[140:143], v[100:103]
ds_read_b64_tr_b16 v[162:163], v12 offset:53248
s_waitcnt lgkmcnt(6)
v_mfma_f32_16x16x32_bf16 v[104:107], v[180:183], v[136:139], v[104:107]
ds_read_b64_tr_b16 v[164:165], v13 offset:49152
v_mfma_f32_16x16x32_bf16 v[108:111], v[180:183], v[140:143], v[108:111]
ds_read_b64_tr_b16 v[166:167], v13 offset:53248
s_waitcnt lgkmcnt(6)
v_mfma_f32_16x16x32_bf16 v[112:115], v[184:187], v[136:139], v[112:115]
ds_read_b64_tr_b16 v[168:169], v14 offset:49152
v_mfma_f32_16x16x32_bf16 v[116:119], v[184:187], v[140:143], v[116:119]
ds_read_b64_tr_b16 v[170:171], v14 offset:53248
s_waitcnt lgkmcnt(6)
v_mfma_f32_16x16x32_bf16 v[120:123], v[188:191], v[136:139], v[120:123]
ds_read_b64_tr_b16 v[172:173], v15 offset:49152
v_mfma_f32_16x16x32_bf16 v[124:127], v[188:191], v[140:143], v[124:127]
ds_read_b64_tr_b16 v[174:175], v15 offset:53248
s_waitcnt lgkmcnt(6)
v_mfma_f32_16x16x32_bf16 v[64:67], v[160:163], v[144:147], v[64:67]
ds_read_b64_tr_b16 v[176:177], v16 offset:49152
v_mfma_f32_16x16x32_bf16 v[68:71], v[160:163], v[148:151], v[68:71]
ds_read_b64_tr_b16 v[178:179], v16 offset:53248
s_waitcnt lgkmcnt(6)
v_mfma_f32_16x16x32_bf16 v[72:75], v[164:167], v[144:147], v[72:75]
ds_read_b64_tr_b16 v[180:181], v17 offset:49152
v_mfma_f32_16x16x32_bf16 v[76:79], v[164:167], v[148:151], v[76:79]
ds_read_b64_tr_b16 v[182:183], v17 offset:53248
s_waitcnt lgkmcnt(6)
v_mfma_f32_16x16x32_bf16 v[80:83], v[168:171], v[144:147], v[80:83]
ds_read_b64_tr_b16 v[184:185], v18 offset:49152
v_mfma_f32_16x16x32_bf16 v[84:87], v[168:171], v[148:151], v[84:87]
ds_read_b64_tr_b16 v[186:187], v18 offset:53248
s_waitcnt lgkmcnt(6)
v_mfma_f32_16x16x32_bf16 v[88:91], v[172:175], v[144:147], v[88:91]
ds_read_b64_tr_b16 v[188:189], v19 offset:49152
v_mfma_f32_16x16x32_bf16 v[92:95], v[172:175], v[148:151], v[92:95]
ds_read_b64_tr_b16 v[190:191], v19 offset:53248
s_waitcnt lgkmcnt(6)
v_mfma_f32_16x16x32_bf16 v[96:99], v[176:179], v[144:147], v[96:99]
s_waitcnt vmcnt(0)
s_barrier
ds_read_b64_tr_b16 v[160:161], v12 offset:57344
v_mfma_f32_16x16x32_bf16 v[100:103], v[176:179], v[148:151], v[100:103]
ds_read_b64_tr_b16 v[162:163], v12 offset:61440
s_waitcnt lgkmcnt(6)
v_mfma_f32_16x16x32_bf16 v[104:107], v[180:183], v[144:147], v[104:107]
ds_read_b64_tr_b16 v[164:165], v13 offset:57344
v_mfma_f32_16x16x32_bf16 v[108:111], v[180:183], v[148:151], v[108:111]
ds_read_b64_tr_b16 v[166:167], v13 offset:61440
s_waitcnt lgkmcnt(6)
v_mfma_f32_16x16x32_bf16 v[112:115], v[184:187], v[144:147], v[112:115]
ds_read_b64_tr_b16 v[168:169], v14 offset:57344
v_mfma_f32_16x16x32_bf16 v[116:119], v[184:187], v[148:151], v[116:119]
ds_read_b64_tr_b16 v[170:171], v14 offset:61440
s_waitcnt lgkmcnt(6)
v_mfma_f32_16x16x32_bf16 v[120:123], v[188:191], v[144:147], v[120:123]
ds_read_b64_tr_b16 v[172:173], v15 offset:57344
v_mfma_f32_16x16x32_bf16 v[124:127], v[188:191], v[148:151], v[124:127]
ds_read_b64_tr_b16 v[174:175], v15 offset:61440
s_waitcnt lgkmcnt(6)
v_mfma_f32_16x16x32_bf16 v[64:67], v[160:163], v[152:155], v[64:67]
ds_read_b64_tr_b16 v[176:177], v16 offset:57344
v_mfma_f32_16x16x32_bf16 v[68:71], v[160:163], v[156:159], v[68:71]
ds_read_b64_tr_b16 v[178:179], v16 offset:61440
s_waitcnt lgkmcnt(6)
v_mfma_f32_16x16x32_bf16 v[72:75], v[164:167], v[152:155], v[72:75]
ds_read_b64_tr_b16 v[180:181], v17 offset:57344
v_mfma_f32_16x16x32_bf16 v[76:79], v[164:167], v[156:159], v[76:79]
ds_read_b64_tr_b16 v[182:183], v17 offset:61440
s_waitcnt lgkmcnt(6)
v_mfma_f32_16x16x32_bf16 v[80:83], v[168:171], v[152:155], v[80:83]
ds_read_b64_tr_b16 v[184:185], v18 offset:57344
v_mfma_f32_16x16x32_bf16 v[84:87], v[168:171], v[156:159], v[84:87]
ds_read_b64_tr_b16 v[186:187], v18 offset:61440
s_waitcnt lgkmcnt(6)
v_mfma_f32_16x16x32_bf16 v[88:91], v[172:175], v[152:155], v[88:91]
ds_read_b64_tr_b16 v[188:189], v19 offset:57344
v_mfma_f32_16x16x32_bf16 v[92:95], v[172:175], v[156:159], v[92:95]
ds_read_b64_tr_b16 v[190:191], v19 offset:61440
s_waitcnt lgkmcnt(6)
v_mfma_f32_16x16x32_bf16 v[96:99], v[176:179], v[152:155], v[96:99]
v_mfma_f32_16x16x32_bf16 v[100:103], v[176:179], v[156:159], v[100:103]
s_waitcnt lgkmcnt(4)
v_mfma_f32_16x16x32_bf16 v[104:107], v[180:183], v[152:155], v[104:107]
v_mfma_f32_16x16x32_bf16 v[108:111], v[180:183], v[156:159], v[108:111]
s_waitcnt lgkmcnt(2)
v_mfma_f32_16x16x32_bf16 v[112:115], v[184:187], v[152:155], v[112:115]
v_mfma_f32_16x16x32_bf16 v[116:119], v[184:187], v[156:159], v[116:119]
s_waitcnt lgkmcnt(0)
v_mfma_f32_16x16x32_bf16 v[120:123], v[188:191], v[152:155], v[120:123]
v_mfma_f32_16x16x32_bf16 v[124:127], v[188:191], v[156:159], v[124:127]
s_waitcnt vmcnt(0)
s_barrier
s_nop 7
buffer_store_dwordx4 v[96:99], v20, s[56:59], 0 offen offset:0 sc1
buffer_store_dwordx4 v[100:103], v20, s[56:59], 0 offen offset:1024 sc1
buffer_store_dwordx4 v[104:107], v20, s[56:59], 0 offen offset:2048 sc1
buffer_store_dwordx4 v[108:111], v20, s[56:59], 0 offen offset:3072 sc1
buffer_store_dwordx4 v[112:115], v20, s[56:59], s22 offen offset:0 sc1
buffer_store_dwordx4 v[116:119], v20, s[56:59], s22 offen offset:1024 sc1
buffer_store_dwordx4 v[120:123], v20, s[56:59], s22 offen offset:2048 sc1
buffer_store_dwordx4 v[124:127], v20, s[56:59], s22 offen offset:3072 sc1
s_add_u32 m0, s27, 0
s_nop 0
buffer_load_dwordx4 v226, s[76:79], s26 offen lds
s_add_u32 s26, s26, 65536
s_add_u32 m0, s27, 4096
s_nop 0
buffer_load_dwordx4 v226, s[76:79], s26 offen lds
s_add_u32 s26, s26, 65536
s_add_u32 m0, s27, 8192
s_nop 0
buffer_load_dwordx4 v226, s[76:79], s26 offen lds
s_add_u32 s26, s26, 65536
s_add_u32 m0, s27, 12288
s_nop 0
buffer_load_dwordx4 v226, s[76:79], s26 offen lds
s_add_u32 s26, s26, 65536
s_add_u32 m0, s27, 16384
s_nop 0
buffer_load_dwordx4 v226, s[76:79], s26 offen lds
s_add_u32 s26, s26, 65536
s_add_u32 m0, s27, 20480
s_nop 0
buffer_load_dwordx4 v226, s[76:79], s26 offen lds
s_add_u32 s26, s26, 65536
s_add_u32 m0, s27, 24576
s_nop 0
buffer_load_dwordx4 v226, s[76:79], s26 offen lds
s_add_u32 s26, s26, 65536
s_add_u32 m0, s27, 28672
s_nop 0
buffer_load_dwordx4 v226, s[76:79], s26 offen lds
s_add_u32 s26, s26, 65536
s_add_u32 m0, s27, 32768
s_nop 0
buffer_load_dwordx4 v226, s[76:79], s26 offen lds
s_add_u32 s26, s26, 65536
s_add_u32 m0, s27, 36864
s_nop 0
buffer_load_dwordx4 v226, s[76:79], s26 offen lds
s_add_u32 s26, s26, 65536
s_add_u32 m0, s27, 40960
s_nop 0
buffer_load_dwordx4 v226, s[76:79], s26 offen lds
s_add_u32 s26, s26, 65536
s_add_u32 m0, s27, 45056
s_nop 0
buffer_load_dwordx4 v226, s[76:79], s26 offen lds
s_add_u32 s26, s26, 65536
s_add_u32 m0, s27, 49152
s_nop 0
buffer_load_dwordx4 v226, s[76:79], s26 offen lds
s_add_u32 s26, s26, 65536
s_add_u32 m0, s27, 53248
s_nop 0
buffer_load_dwordx4 v226, s[76:79], s26 offen lds
s_add_u32 s26, s26, 65536
s_waitcnt vmcnt(14)
s_barrier
s_cmp_lg_u32 s40, 0
s_cbranch_scc1 L_mid_kernel_g_noflag
s_mov_b64 exec, 1
buffer_store_dword v28, v22, s[68:71], 0 offen sc1
s_mov_b64 exec, -1
L_mid_kernel_g_noflag:
s_mov_b32 s19, 0x80000
L_mid_kernel_g_pp:
buffer_load_dword v27, v23, s[68:71], 0 offen sc1
s_waitcnt vmcnt(0)
v_readfirstlane_b32 s17, v27
s_sub_u32 s19, s19, 1
s_cbranch_scc1 L_mid_kernel_g_pp_out
s_cmp_ge_u32 s17, 1
s_cbranch_scc1 L_mid_kernel_g_pp_out
s_branch L_mid_kernel_g_pp
L_mid_kernel_g_pp_out:
buffer_load_dwordx4 v[96:99], v21, s[56:59], 0 offen offset:0 sc1
buffer_load_dwordx4 v[100:103], v21, s[56:59], 0 offen offset:1024 sc1
buffer_load_dwordx4 v[104:107], v21, s[56:59], 0 offen offset:2048 sc1
buffer_load_dwordx4 v[108:111], v21, s[56:59], 0 offen offset:3072 sc1
buffer_load_dwordx4 v[112:115], v21, s[56:59], s22 offen offset:0 sc1
buffer_load_dwordx4 v[116:119], v21, s[56:59], s22 offen offset:1024 sc1
buffer_load_dwordx4 v[120:123], v21, s[56:59], s22 offen offset:2048 sc1
buffer_load_dwordx4 v[124:127], v21, s[56:59], s22 offen offset:3072 sc1
s_mov_b32 s24, 0xbfb8aa3b
s_waitcnt vmcnt(0)
v_lshlrev_b32 v2, 16, v248
v_and_b32 v3, 0xffff0000, v248
v_lshlrev_b32 v4, 16, v249
v_and_b32 v5, 0xffff0000, v249
v_pk_add_f32 v[64:65], v[64:65], v[96:97]
v_pk_add_f32 v[66:67], v[66:67], v[98:99]
v_pk_add_f32 v[64:65], v[64:65], v[2:3]
v_pk_add_f32 v[66:67], v[66:67], v[4:5]
v_pk_mul_f32 v[96:97], v[64:65], s[24:25] op_sel_hi:[1,0]
v_pk_mul_f32 v[98:99], v[66:67], s[24:25] op_sel_hi:[1,0]
v_exp_f32 v96, v96
v_exp_f32 v97, v97
v_exp_f32 v98, v98
v_exp_f32 v99, v99
s_nop 0
v_pk_add_f32 v[96:97], v[96:97], 1.0 op_sel_hi:[1,0]
v_pk_add_f32 v[98:99], v[98:99], 1.0 op_sel_hi:[1,0]
v_rcp_f32 v96, v96
v_rcp_f32 v97, v97
v_rcp_f32 v98, v98
v_rcp_f32 v99, v99
s_nop 0
v_pk_mul_f32 v[64:65], v[64:65], v[96:97]
v_pk_mul_f32 v[66:67], v[66:67], v[98:99]
v_pk_add_f32 v[68:69], v[68:69], v[100:101]
v_pk_add_f32 v[70:71], v[70:71], v[102:103]
v_pk_add_f32 v[68:69], v[68:69], v[2:3]
v_pk_add_f32 v[70:71], v[70:71], v[4:5]
v_pk_mul_f32 v[100:101], v[68:69], s[24:25] op_sel_hi:[1,0]
v_pk_mul_f32 v[102:103], v[70:71], s[24:25] op_sel_hi:[1,0]
v_exp_f32 v100, v100
v_exp_f32 v101, v101
v_exp_f32 v102, v102
v_exp_f32 v103, v103
s_nop 0
v_pk_add_f32 v[100:101], v[100:101], 1.0 op_sel_hi:[1,0]
v_pk_add_f32 v[102:103], v[102:103], 1.0 op_sel_hi:[1,0]
v_rcp_f32 v100, v100
v_rcp_f32 v101, v101
v_rcp_f32 v102, v102
v_rcp_f32 v103, v103
s_nop 0
v_pk_mul_f32 v[68:69], v[68:69], v[100:101]
v_pk_mul_f32 v[70:71], v[70:71], v[102:103]
v_lshlrev_b32 v2, 16, v250
v_and_b32 v3, 0xffff0000, v250
v_lshlrev_b32 v4, 16, v251
v_and_b32 v5, 0xffff0000, v251
v_pk_add_f32 v[72:73], v[72:73], v[104:105]
v_pk_add_f32 v[74:75], v[74:75], v[106:107]
v_pk_add_f32 v[72:73], v[72:73], v[2:3]
v_pk_add_f32 v[74:75], v[74:75], v[4:5]
v_pk_mul_f32 v[104:105], v[72:73], s[24:25] op_sel_hi:[1,0]
v_pk_mul_f32 v[106:107], v[74:75], s[24:25] op_sel_hi:[1,0]
v_exp_f32 v104, v104
v_exp_f32 v105, v105
v_exp_f32 v106, v106
v_exp_f32 v107, v107
s_nop 0
v_pk_add_f32 v[104:105], v[104:105], 1.0 op_sel_hi:[1,0]
v_pk_add_f32 v[106:107], v[106:107], 1.0 op_sel_hi:[1,0]
v_rcp_f32 v104, v104
v_rcp_f32 v105, v105
v_rcp_f32 v106, v106
v_rcp_f32 v107, v107
s_nop 0
v_pk_mul_f32 v[72:73], v[72:73], v[104:105]
v_pk_mul_f32 v[74:75], v[74:75], v[106:107]
v_pk_add_f32 v[76:77], v[76:77], v[108:109]
v_pk_add_f32 v[78:79], v[78:79], v[110:111]
v_pk_add_f32 v[76:77], v[76:77], v[2:3]
v_pk_add_f32 v[78:79], v[78:79], v[4:5]
v_pk_mul_f32 v[108:109], v[76:77], s[24:25] op_sel_hi:[1,0]
v_pk_mul_f32 v[110:111], v[78:79], s[24:25] op_sel_hi:[1,0]
v_exp_f32 v108, v108
v_exp_f32 v109, v109
v_exp_f32 v110, v110
v_exp_f32 v111, v111
s_nop 0
v_pk_add_f32 v[108:109], v[108:109], 1.0 op_sel_hi:[1,0]
v_pk_add_f32 v[110:111], v[110:111], 1.0 op_sel_hi:[1,0]
v_rcp_f32 v108, v108
v_rcp_f32 v109, v109
v_rcp_f32 v110, v110
v_rcp_f32 v111, v111
s_nop 0
v_pk_mul_f32 v[76:77], v[76:77], v[108:109]
v_pk_mul_f32 v[78:79], v[78:79], v[110:111]
v_lshlrev_b32 v2, 16, v252
v_and_b32 v3, 0xffff0000, v252
v_lshlrev_b32 v4, 16, v253
v_and_b32 v5, 0xffff0000, v253
v_pk_add_f32 v[80:81], v[80:81], v[112:113]
v_pk_add_f32 v[82:83], v[82:83], v[114:115]
v_pk_add_f32 v[80:81], v[80:81], v[2:3]
v_pk_add_f32 v[82:83], v[82:83], v[4:5]
v_pk_mul_f32 v[112:113], v[80:81], s[24:25] op_sel_hi:[1,0]
v_pk_mul_f32 v[114:115], v[82:83], s[24:25] op_sel_hi:[1,0]
v_exp_f32 v112, v112
v_exp_f32 v113, v113
v_exp_f32 v114, v114
v_exp_f32 v115, v115
s_nop 0
v_pk_add_f32 v[112:113], v[112:113], 1.0 op_sel_hi:[1,0]
v_pk_add_f32 v[114:115], v[114:115], 1.0 op_sel_hi:[1,0]
v_rcp_f32 v112, v112
v_rcp_f32 v113, v113
v_rcp_f32 v114, v114
v_rcp_f32 v115, v115
s_nop 0
v_pk_mul_f32 v[80:81], v[80:81], v[112:113]
v_pk_mul_f32 v[82:83], v[82:83], v[114:115]
v_pk_add_f32 v[84:85], v[84:85], v[116:117]
v_pk_add_f32 v[86:87], v[86:87], v[118:119]
v_pk_add_f32 v[84:85], v[84:85], v[2:3]
v_pk_add_f32 v[86:87], v[86:87], v[4:5]
v_pk_mul_f32 v[116:117], v[84:85], s[24:25] op_sel_hi:[1,0]
v_pk_mul_f32 v[118:119], v[86:87], s[24:25] op_sel_hi:[1,0]
v_exp_f32 v116, v116
v_exp_f32 v117, v117
v_exp_f32 v118, v118
v_exp_f32 v119, v119
s_nop 0
v_pk_add_f32 v[116:117], v[116:117], 1.0 op_sel_hi:[1,0]
v_pk_add_f32 v[118:119], v[118:119], 1.0 op_sel_hi:[1,0]
v_rcp_f32 v116, v116
v_rcp_f32 v117, v117
v_rcp_f32 v118, v118
v_rcp_f32 v119, v119
s_nop 0
v_pk_mul_f32 v[84:85], v[84:85], v[116:117]
v_pk_mul_f32 v[86:87], v[86:87], v[118:119]
v_lshlrev_b32 v2, 16, v254
v_and_b32 v3, 0xffff0000, v254
v_lshlrev_b32 v4, 16, v255
v_and_b32 v5, 0xffff0000, v255
v_pk_add_f32 v[88:89], v[88:89], v[120:121]
v_pk_add_f32 v[90:91], v[90:91], v[122:123]
v_pk_add_f32 v[88:89], v[88:89], v[2:3]
v_pk_add_f32 v[90:91], v[90:91], v[4:5]
v_pk_mul_f32 v[120:121], v[88:89], s[24:25] op_sel_hi:[1,0]
v_pk_mul_f32 v[122:123], v[90:91], s[24:25] op_sel_hi:[1,0]
v_exp_f32 v120, v120
v_exp_f32 v121, v121
v_exp_f32 v122, v122
v_exp_f32 v123, v123
s_nop 0
v_pk_add_f32 v[120:121], v[120:121], 1.0 op_sel_hi:[1,0]
v_pk_add_f32 v[122:123], v[122:123], 1.0 op_sel_hi:[1,0]
v_rcp_f32 v120, v120
v_rcp_f32 v121, v121
v_rcp_f32 v122, v122
v_rcp_f32 v123, v123
s_nop 0
v_pk_mul_f32 v[88:89], v[88:89], v[120:121]
v_pk_mul_f32 v[90:91], v[90:91], v[122:123]
v_pk_add_f32 v[92:93], v[92:93], v[124:125]
v_pk_add_f32 v[94:95], v[94:95], v[126:127]
v_pk_add_f32 v[92:93], v[92:93], v[2:3]
v_pk_add_f32 v[94:95], v[94:95], v[4:5]
v_pk_mul_f32 v[124:125], v[92:93], s[24:25] op_sel_hi:[1,0]
v_pk_mul_f32 v[126:127], v[94:95], s[24:25] op_sel_hi:[1,0]
v_exp_f32 v124, v124
v_exp_f32 v125, v125
v_exp_f32 v126, v126
v_exp_f32 v127, v127
s_nop 0
v_pk_add_f32 v[124:125], v[124:125], 1.0 op_sel_hi:[1,0]
v_pk_add_f32 v[126:127], v[126:127], 1.0 op_sel_hi:[1,0]
v_rcp_f32 v124, v124
v_rcp_f32 v125, v125
v_rcp_f32 v126, v126
v_rcp_f32 v127, v127
s_nop 0
v_pk_mul_f32 v[92:93], v[92:93], v[124:125]
v_pk_mul_f32 v[94:95], v[94:95], v[126:127]
v_lshlrev_b32 v96, 16, v232
v_and_b32 v97, 0xffff0000, v232
v_lshlrev_b32 v98, 16, v233
v_and_b32 v99, 0xffff0000, v233
v_lshlrev_b32 v100, 16, v234
v_and_b32 v101, 0xffff0000, v234
v_lshlrev_b32 v102, 16, v235
v_and_b32 v103, 0xffff0000, v235
v_lshlrev_b32 v104, 16, v236
v_and_b32 v105, 0xffff0000, v236
v_lshlrev_b32 v106, 16, v237
v_and_b32 v107, 0xffff0000, v237
v_lshlrev_b32 v108, 16, v238
v_and_b32 v109, 0xffff0000, v238
v_lshlrev_b32 v110, 16, v239
v_and_b32 v111, 0xffff0000, v239
v_lshlrev_b32 v112, 16, v240
v_and_b32 v113, 0xffff0000, v240
v_lshlrev_b32 v114, 16, v241
v_and_b32 v115, 0xffff0000, v241
v_lshlrev_b32 v116, 16, v242
v_and_b32 v117, 0xffff0000, v242
v_lshlrev_b32 v118, 16, v243
v_and_b32 v119, 0xffff0000, v243
v_lshlrev_b32 v120, 16, v244
v_and_b32 v121, 0xffff0000, v244
v_lshlrev_b32 v122, 16, v245
v_and_b32 v123, 0xffff0000, v245
v_lshlrev_b32 v124, 16, v246
v_and_b32 v125, 0xffff0000, v246
v_lshlrev_b32 v126, 16, v247
v_and_b32 v127, 0xffff0000, v247
s_cmp_lg_u32 s40, 0
s_cbranch_scc1 L_mid_kernel_g_rel
s_mov_b32 s19, 0x80000
L_mid_kernel_g_pa:
buffer_load_dword v27, v24, s[68:71], 0 offen sc1
s_waitcnt vmcnt(0)
v_cmp_ne_u32 vcc, 0, v27
s_sub_u32 s19, s19, 1
s_cbranch_scc1 L_mid_kernel_g_pa_out
s_cmp_eq_u64 vcc, -1
s_cbranch_scc1 L_mid_kernel_g_pa_out
s_branch L_mid_kernel_g_pa
L_mid_kernel_g_pa_out:
L_mid_kernel_g_rel:
s_barrier
buffer_load_dwordx4 v[160:163], v224, s[72:75], s25 offen sc1
buffer_load_dwordx4 v[164:167], v225, s[72:75], s25 offen sc1
s_add_u32 s25, s25, 1024
buffer_load_dwordx4 v[168:171], v224, s[72:75], s25 offen sc1
buffer_load_dwordx4 v[172:175], v225, s[72:75], s25 offen sc1
s_add_u32 s25, s25, 1024
buffer_load_dwordx4 v[176:179], v224, s[72:75], s25 offen sc1
buffer_load_dwordx4 v[180:183], v225, s[72:75], s25 offen sc1
s_add_u32 s25, s25, 1024
buffer_load_dwordx4 v[184:187], v224, s[72:75], s25 offen sc1
buffer_load_dwordx4 v[188:191], v225, s[72:75], s25 offen sc1
s_add_u32 s25, s25, 1024
buffer_load_dwordx4 v[192:195], v224, s[72:75], s25 offen sc1
buffer_load_dwordx4 v[196:199], v225, s[72:75], s25 offen sc1
s_add_u32 s25, s25, 1024
buffer_load_dwordx4 v[200:203], v224, s[72:75], s25 offen sc1
buffer_load_dwordx4 v[204:207], v225, s[72:75], s25 offen sc1
s_add_u32 s25, s25, 1024
buffer_load_dwordx4 v[208:211], v224, s[72:75], s25 offen sc1
buffer_load_dwordx4 v[212:215], v225, s[72:75], s25 offen sc1
s_add_u32 s25, s25, 1024
s_waitcnt vmcnt(12)
s_barrier
ds_read_b64_tr_b16 v[128:129], v227 offset:0
ds_read_b64_tr_b16 v[130:131], v227 offset:2048
ds_read_b64_tr_b16 v[132:133], v228 offset:0
ds_read_b64_tr_b16 v[134:135], v228 offset:2048
ds_read_b64_tr_b16 v[136:137], v229 offset:0
ds_read_b64_tr_b16 v[138:139], v229 offset:2048
ds_read_b64_tr_b16 v[140:141], v230 offset:0
ds_read_b64_tr_b16 v[142:143], v230 offset:2048
s_waitcnt lgkmcnt(6)
v_mfma_f32_16x16x32_bf16 v[32:35], v[128:131], v[160:163], v[32:35]
s_waitcnt vmcnt(10)
s_barrier
ds_read_b64_tr_b16 v[144:145], v227 offset:4096
buffer_load_dwordx4 v[216:219], v224, s[72:75], s25 offen sc1
v_mfma_f32_16x16x32_bf16 v[36:39], v[128:131], v[164:167], v[36:39]
ds_read_b64_tr_b16 v[146:147], v227 offset:6144
s_waitcnt lgkmcnt(6)
v_mfma_f32_16x16x32_bf16 v[40:43], v[132:135], v[160:163], v[40:43]
ds_read_b64_tr_b16 v[148:149], v228 offset:4096
s_add_u32 m0, s27, 57344
v_mfma_f32_16x16x32_bf16 v[44:47], v[132:135], v[164:167], v[44:47]
ds_read_b64_tr_b16 v[150:151], v228 offset:6144
buffer_load_dwordx4 v226, s[76:79], s26 offen lds
s_add_u32 s26, s26, 65536
s_waitcnt lgkmcnt(6)
v_mfma_f32_16x16x32_bf16 v[48:51], v[136:139], v[160:163], v[48:51]
ds_read_b64_tr_b16 v[152:153], v229 offset:4096
v_mfma_f32_16x16x32_bf16 v[52:55], v[136:139], v[164:167], v[52:55]
ds_read_b64_tr_b16 v[154:155], v229 offset:6144
buffer_load_dwordx4 v[220:223], v225, s[72:75], s25 offen sc1
s_add_u32 s25, s25, 1024
s_waitcnt lgkmcnt(6)
v_mfma_f32_16x16x32_bf16 v[56:59], v[140:143], v[160:163], v[56:59]
ds_read_b64_tr_b16 v[156:157], v230 offset:4096
v_mfma_f32_16x16x32_bf16 v[60:63], v[140:143], v[164:167], v[60:63]
ds_read_b64_tr_b16 v[158:159], v230 offset:6144
s_waitcnt lgkmcnt(6)
v_mfma_f32_16x16x32_bf16 v[32:35], v[144:147], v[168:171], v[32:35]
s_waitcnt vmcnt(11)
s_barrier
ds_read_b64_tr_b16 v[128:129], v227 offset:8192
buffer_load_dwordx4 v[160:163], v224, s[72:75], s25 offen sc1
v_mfma_f32_16x16x32_bf16 v[36:39], v[144:147], v[172:175], v[36:39]
ds_read_b64_tr_b16 v[130:131], v227 offset:10240
s_waitcnt lgkmcnt(6)
v_mfma_f32_16x16x32_bf16 v[40:43], v[148:151], v[168:171], v[40:43]
ds_read_b64_tr_b16 v[132:133], v228 offset:8192
s_add_u32 m0, s27, 61440
v_mfma_f32_16x16x32_bf16 v[44:47], v[148:151], v[172:175], v[44:47]
ds_read_b64_tr_b16 v[134:135], v228 offset:10240
buffer_load_dwordx4 v226, s[76:79], s26 offen lds
s_add_u32 s26, s26, 65536
s_waitcnt lgkmcnt(6)
v_mfma_f32_16x16x32_bf16 v[48:51], v[152:155], v[168:171], v[48:51]
ds_read_b64_tr_b16 v[136:137], v229 offset:8192
v_mfma_f32_16x16x32_bf16 v[52:55], v[152:155], v[172:175], v[52:55]
ds_read_b64_tr_b16 v[138:139], v229 offset:10240
buffer_load_dwordx4 v[164:167], v225, s[72:75], s25 offen sc1
s_add_u32 s25, s25, 1024
s_waitcnt lgkmcnt(6)
v_mfma_f32_16x16x32_bf16 v[56:59], v[156:159], v[168:171], v[56:59]
ds_read_b64_tr_b16 v[140:141], v230 offset:8192
v_mfma_f32_16x16x32_bf16 v[60:63], v[156:159], v[172:175], v[60:63]
ds_read_b64_tr_b16 v[142:143], v230 offset:10240
s_waitcnt lgkmcnt(6)
v_mfma_f32_16x16x32_bf16 v[32:35], v[128:131], v[176:179], v[32:35]
s_waitcnt vmcnt(12)
s_barrier
ds_read_b64_tr_b16 v[144:145], v227 offset:12288
buffer_load_dwordx4 v[168:171], v224, s[72:75], s25 offen sc1
v_mfma_f32_16x16x32_bf16 v[36:39], v[128:131], v[180:183], v[36:39]
ds_read_b64_tr_b16 v[146:147], v227 offset:14336
s_waitcnt lgkmcnt(6)
v_mfma_f32_16x16x32_bf16 v[40:43], v[132:135], v[176:179], v[40:43]
ds_read_b64_tr_b16 v[148:149], v228 offset:12288
s_add_u32 m0, s27, 0
v_mfma_f32_16x16x32_bf16 v[44:47], v[132:135], v[180:183], v[44:47]
ds_read_b64_tr_b16 v[150:151], v228 offset:14336
buffer_load_dwordx4 v226, s[76:79], s26 offen lds
s_add_u32 s26, s26, 65536
s_waitcnt lgkmcnt(6)
v_mfma_f32_16x16x32_bf16 v[48:51], v[136:139], v[176:179], v[48:51]
ds_read_b64_tr_b16 v[152:153], v229 offset:12288
v_mfma_f32_16x16x32_bf16 v[52:55], v[136:139], v[180:183], v[52:55]
ds_read_b64_tr_b16 v[154:155], v229 offset:14336
buffer_load_dwordx4 v[172:175], v225, s[72:75], s25 offen sc1
s_add_u32 s25, s25, 1024
s_waitcnt lgkmcnt(6)
v_mfma_f32_16x16x32_bf16 v[56:59], v[140:143], v[176:179], v[56:59]
ds_read_b64_tr_b16 v[156:157], v230 offset:12288
v_mfma_f32_16x16x32_bf16 v[60:63], v[140:143], v[180:183], v[60:63]
ds_read_b64_tr_b16 v[158:159], v230 offset:14336
s_waitcnt lgkmcnt(6)
v_mfma_f32_16x16x32_bf16 v[32:35], v[144:147], v[184:187], v[32:35]
s_waitcnt vmcnt(13)
s_barrier
ds_read_b64_tr_b16 v[128:129], v227 offset:16384
buffer_load_dwordx4 v[176:179], v224, s[72:75], s25 offen sc1
v_mfma_f32_16x16x32_bf16 v[36:39], v[144:147], v[188:191], v[36:39]
ds_read_b64_tr_b16 v[130:131], v227 offset:18432
s_waitcnt lgkmcnt(6)
v_mfma_f32_16x16x32_bf16 v[40:43], v[148:151], v[184:187], v[40:43]
ds_read_b64_tr_b16 v[132:133], v228 offset:16384
s_add_u32 m0, s27, 4096
v_mfma_f32_16x16x32_bf16 v[44:47], v[148:151], v[188:191], v[44:47]
ds_read_b64_tr_b16 v[134:135], v228 offset:18432
buffer_load_dwordx4 v226, s[76:79], s26 offen lds
s_add_u32 s26, s26, 65536
s_waitcnt lgkmcnt(6)
v_mfma_f32_16x16x32_bf16 v[48:51], v[152:155], v[184:187], v[48:51]
ds_read_b64_tr_b16 v[136:137], v229 offset:16384
v_mfma_f32_16x16x32_bf16 v[52:55], v[152:155], v[188:191], v[52:55]
ds_read_b64_tr_b16 v[138:139], v229 offset:18432
buffer_load_dwordx4 v[180:183], v225, s[72:75], s25 offen sc1
s_add_u32 s25, s25, 1024
s_waitcnt lgkmcnt(6)
v_mfma_f32_16x16x32_bf16 v[56:59], v[156:159], v[184:187], v[56:59]
ds_read_b64_tr_b16 v[140:141], v230 offset:16384
v_mfma_f32_16x16x32_bf16 v[60:63], v[156:159], v[188:191], v[60:63]
ds_read_b64_tr_b16 v[142:143], v230 offset:18432
s_waitcnt lgkmcnt(6)
v_mfma_f32_16x16x32_bf16 v[32:35], v[128:131], v[192:195], v[32:35]
s_waitcnt vmcnt(14)
s_barrier
ds_read_b64_tr_b16 v[144:145], v227 offset:20480
buffer_load_dwordx4 v[184:187], v224, s[72:75], s25 offen sc1
v_mfma_f32_16x16x32_bf16 v[36:39], v[128:131], v[196:199], v[36:39]
ds_read_b64_tr_b16 v[146:147], v227 offset:22528
s_waitcnt lgkmcnt(6)
v_mfma_f32_16x16x32_bf16 v[40:43], v[132:135], v[192:195], v[40:43]
ds_read_b64_tr_b16 v[148:149], v228 offset:20480
s_add_u32 m0, s27, 8192
v_mfma_f32_16x16x32_bf16 v[44:47], v[132:135], v[196:199], v[44:47]
ds_read_b64_tr_b16 v[150:151], v228 offset:22528
buffer_load_dwordx4 v226, s[76:79], s26 offen lds
s_add_u32 s26, s26, 65536
s_waitcnt lgkmcnt(6)
v_mfma_f32_16x16x32_bf16 v[48:51], v[136:139], v[192:195], v[48:51]
ds_read_b64_tr_b16 v[152:153], v229 offset:20480
v_mfma_f32_16x16x32_bf16 v[52:55], v[136:139], v[196:199], v[52:55]
ds_read_b64_tr_b16 v[154:155], v229 offset:22528
buffer_load_dwordx4 v[188:191], v225, s[72:75], s25 offen sc1
s_add_u32 s25, s25, 1024
s_waitcnt lgkmcnt(6)
v_mfma_f32_16x16x32_bf16 v[56:59], v[140:143], v[192:195], v[56:59]
ds_read_b64_tr_b16 v[156:157], v230 offset:20480
v_mfma_f32_16x16x32_bf16 v[60:63], v[140:143], v[196:199], v[60:63]
ds_read_b64_tr_b16 v[158:159], v230 offset:22528
s_waitcnt lgkmcnt(6)
v_mfma_f32_16x16x32_bf16 v[32:35], v[144:147], v[200:203], v[32:35]
s_waitcnt vmcnt(15)
s_barrier
ds_read_b64_tr_b16 v[128:129], v227 offset:24576
buffer_load_dwordx4 v[192:195], v224, s[72:75], s25 offen sc1
v_mfma_f32_16x16x32_bf16 v[36:39], v[144:147], v[204:207], v[36:39]
ds_read_b64_tr_b16 v[130:131], v227 offset:26624
s_waitcnt lgkmcnt(6)
v_mfma_f32_16x16x32_bf16 v[40:43], v[148:151], v[200:203], v[40:43]
ds_read_b64_tr_b16 v[132:133], v228 offset:24576
s_add_u32 m0, s27, 12288
v_mfma_f32_16x16x32_bf16 v[44:47], v[148:151], v[204:207], v[44:47]
ds_read_b64_tr_b16 v[134:135], v228 offset:26624
buffer_load_dwordx4 v226, s[76:79], s26 offen lds
s_add_u32 s26, s26, 65536
s_waitcnt lgkmcnt(6)
v_mfma_f32_16x16x32_bf16 v[48:51], v[152:155], v[200:203], v[48:51]
ds_read_b64_tr_b16 v[136:137], v229 offset:24576
v_mfma_f32_16x16x32_bf16 v[52:55], v[152:155], v[204:207], v[52:55]
ds_read_b64_tr_b16 v[138:139], v229 offset:26624
buffer_load_dwordx4 v[196:199], v225, s[72:75], s25 offen sc1
s_add_u32 s25, s25, 1024
s_waitcnt lgkmcnt(6)
v_mfma_f32_16x16x32_bf16 v[56:59], v[156:159], v[200:203], v[56:59]
ds_read_b64_tr_b16 v[140:141], v230 offset:24576
v_mfma_f32_16x16x32_bf16 v[60:63], v[156:159], v[204:207], v[60:63]
ds_read_b64_tr_b16 v[142:143], v230 offset:26624
s_waitcnt lgkmcnt(6)
v_mfma_f32_16x16x32_bf16 v[32:35], v[128:131], v[208:211], v[32:35]
s_waitcnt vmcnt(15)
s_barrier
ds_read_b64_tr_b16 v[144:145], v227 offset:28672
buffer_load_dwordx4 v[200:203], v224, s[72:75], s25 offen sc1
v_mfma_f32_16x16x32_bf16 v[36:39], v[128:131], v[212:215], v[36:39]
ds_read_b64_tr_b16 v[146:147], v227 offset:30720
s_waitcnt lgkmcnt(6)
v_mfma_f32_16x16x32_bf16 v[40:43], v[132:135], v[208:211], v[40:43]
ds_read_b64_tr_b16 v[148:149], v228 offset:28672
s_add_u32 m0, s27, 16384
v_mfma_f32_16x16x32_bf16 v[44:47], v[132:135], v[212:215], v[44:47]
ds_read_b64_tr_b16 v[150:151], v228 offset:30720
buffer_load_dwordx4 v226, s[76:79], s26 offen lds
s_add_u32 s26, s26, 65536
s_waitcnt lgkmcnt(6)
v_mfma_f32_16x16x32_bf16 v[48:51], v[136:139], v[208:211], v[48:51]
ds_read_b64_tr_b16 v[152:153], v229 offset:28672
v_mfma_f32_16x16x32_bf16 v[52:55], v[136:139], v[212:215], v[52:55]
ds_read_b64_tr_b16 v[154:155], v229 offset:30720
buffer_load_dwordx4 v[204:207], v225, s[72:75], s25 offen sc1
s_add_u32 s25, s25, 1024
s_waitcnt lgkmcnt(6)
v_mfma_f32_16x16x32_bf16 v[56:59], v[140:143], v[208:211], v[56:59]
ds_read_b64_tr_b16 v[156:157], v230 offset:28672
v_mfma_f32_16x16x32_bf16 v[60:63], v[140:143], v[212:215], v[60:63]
ds_read_b64_tr_b16 v[158:159], v230 offset:30720
s_waitcnt lgkmcnt(6)
v_mfma_f32_16x16x32_bf16 v[32:35], v[144:147], v[216:219], v[32:35]
s_waitcnt vmcnt(15)
s_barrier
ds_read_b64_tr_b16 v[128:129], v227 offset:32768
buffer_load_dwordx4 v[208:211], v224, s[72:75], s25 offen sc1
v_mfma_f32_16x16x32_bf16 v[36:39], v[144:147], v[220:223], v[36:39]
ds_read_b64_tr_b16 v[130:131], v227 offset:34816
s_waitcnt lgkmcnt(6)
v_mfma_f32_16x16x32_bf16 v[40:43], v[148:151], v[216:219], v[40:43]
ds_read_b64_tr_b16 v[132:133], v228 offset:32768
s_add_u32 m0, s27, 20480
v_mfma_f32_16x16x32_bf16 v[44:47], v[148:151], v[220:223], v[44:47]
ds_read_b64_tr_b16 v[134:135], v228 offset:34816
buffer_load_dwordx4 v226, s[76:79], s26 offen lds
s_add_u32 s26, s26, 65536
s_waitcnt lgkmcnt(6)
v_mfma_f32_16x16x32_bf16 v[48:51], v[152:155], v[216:219], v[48:51]
ds_read_b64_tr_b16 v[136:137], v229 offset:32768
v_mfma_f32_16x16x32_bf16 v[52:55], v[152:155], v[220:223], v[52:55]
ds_read_b64_tr_b16 v[138:139], v229 offset:34816
buffer_load_dwordx4 v[212:215], v225, s[72:75], s25 offen sc1
s_add_u32 s25, s25, 1024
s_waitcnt lgkmcnt(6)
v_mfma_f32_16x16x32_bf16 v[56:59], v[156:159], v[216:219], v[56:59]
ds_read_b64_tr_b16 v[140:141], v230 offset:32768
v_mfma_f32_16x16x32_bf16 v[60:63], v[156:159], v[220:223], v[60:63]
ds_read_b64_tr_b16 v[142:143], v230 offset:34816
s_waitcnt lgkmcnt(6)
v_mfma_f32_16x16x32_bf16 v[32:35], v[128:131], v[160:163], v[32:35]
s_waitcnt vmcnt(15)
s_barrier
ds_read_b64_tr_b16 v[144:145], v227 offset:36864
buffer_load_dwordx4 v[216:219], v224, s[72:75], s25 offen sc1
v_mfma_f32_16x16x32_bf16 v[36:39], v[128:131], v[164:167], v[36:39]
ds_read_b64_tr_b16 v[146:147], v227 offset:38912
s_waitcnt lgkmcnt(6)
v_mfma_f32_16x16x32_bf16 v[40:43], v[132:135], v[160:163], v[40:43]
ds_read_b64_tr_b16 v[148:149], v228 offset:36864
s_add_u32 m0, s27, 24576
v_mfma_f32_16x16x32_bf16 v[44:47], v[132:135], v[164:167], v[44:47]
ds_read_b64_tr_b16 v[150:151], v228 offset:38912
buffer_load_dwordx4 v226, s[76:79], s26 offen lds
s_add_u32 s26, s26, 65536
s_waitcnt lgkmcnt(6)
v_mfma_f32_16x16x32_bf16 v[48:51], v[136:139], v[160:163], v[48:51]
ds_read_b64_tr_b16 v[152:153], v229 offset:36864
v_mfma_f32_16x16x32_bf16 v[52:55], v[136:139], v[164:167], v[52:55]
ds_read_b64_tr_b16 v[154:155], v229 offset:38912
buffer_load_dwordx4 v[220:223], v225, s[72:75], s25 offen sc1
s_add_u32 s25, s25, 1024
s_waitcnt lgkmcnt(6)
v_mfma_f32_16x16x32_bf16 v[56:59], v[140:143], v[160:163], v[56:59]
ds_read_b64_tr_b16 v[156:157], v230 offset:36864
v_mfma_f32_16x16x32_bf16 v[60:63], v[140:143], v[164:167], v[60:63]
ds_read_b64_tr_b16 v[158:159], v230 offset:38912
s_waitcnt lgkmcnt(6)
v_mfma_f32_16x16x32_bf16 v[32:35], v[144:147], v[168:171], v[32:35]
s_waitcnt vmcnt(15)
s_barrier
ds_read_b64_tr_b16 v[128:129], v227 offset:40960
buffer_load_dwordx4 v[160:163], v224, s[72:75], s25 offen sc1
v_mfma_f32_16x16x32_bf16 v[36:39], v[144:147], v[172:175], v[36:39]
ds_read_b64_tr_b16 v[130:131], v227 offset:43008
s_waitcnt lgkmcnt(6)
v_mfma_f32_16x16x32_bf16 v[40:43], v[148:151], v[168:171], v[40:43]
ds_read_b64_tr_b16 v[132:133], v228 offset:40960
s_add_u32 m0, s27, 28672
v_mfma_f32_16x16x32_bf16 v[44:47], v[148:151], v[172:175], v[44:47]
ds_read_b64_tr_b16 v[134:135], v228 offset:43008
buffer_load_dwordx4 v226, s[76:79], s26 offen lds
s_add_u32 s26, s26, 65536
s_waitcnt lgkmcnt(6)
v_mfma_f32_16x16x32_bf16 v[48:51], v[152:155], v[168:171], v[48:51]
ds_read_b64_tr_b16 v[136:137], v229 offset:40960
v_mfma_f32_16x16x32_bf16 v[52:55], v[152:155], v[172:175], v[52:55]
ds_read_b64_tr_b16 v[138:139], v229 offset:43008
buffer_load_dwordx4 v[164:167], v225, s[72:75], s25 offen sc1
s_add_u32 s25, s25, 1024
s_waitcnt lgkmcnt(6)
v_mfma_f32_16x16x32_bf16 v[56:59], v[156:159], v[168:171], v[56:59]
ds_read_b64_tr_b16 v[140:141], v230 offset:40960
v_mfma_f32_16x16x32_bf16 v[60:63], v[156:159], v[172:175], v[60:63]
ds_read_b64_tr_b16 v[142:143], v230 offset:43008
s_waitcnt lgkmcnt(6)
v_mfma_f32_16x16x32_bf16 v[32:35], v[128:131], v[176:179], v[32:35]
s_waitcnt vmcnt(15)
s_barrier
ds_read_b64_tr_b16 v[144:145], v227 offset:45056
buffer_load_dwordx4 v[168:171], v224, s[72:75], s25 offen sc1
v_mfma_f32_16x16x32_bf16 v[36:39], v[128:131], v[180:183], v[36:39]
ds_read_b64_tr_b16 v[146:147], v227 offset:47104
s_waitcnt lgkmcnt(6)
v_mfma_f32_16x16x32_bf16 v[40:43], v[132:135], v[176:179], v[40:43]
ds_read_b64_tr_b16 v[148:149], v228 offset:45056
s_add_u32 m0, s27, 32768
v_mfma_f32_16x16x32_bf16 v[44:47], v[132:135], v[180:183], v[44:47]
ds_read_b64_tr_b16 v[150:151], v228 offset:47104
buffer_load_dwordx4 v226, s[76:79], s26 offen lds
s_add_u32 s26, s26, 65536
s_waitcnt lgkmcnt(6)
v_mfma_f32_16x16x32_bf16 v[48:51], v[136:139], v[176:179], v[48:51]
ds_read_b64_tr_b16 v[152:153], v229 offset:45056
v_mfma_f32_16x16x32_bf16 v[52:55], v[136:139], v[180:183], v[52:55]
ds_read_b64_tr_b16 v[154:155], v229 offset:47104
buffer_load_dwordx4 v[172:175], v225, s[72:75], s25 offen sc1
s_add_u32 s25, s25, 1024
s_waitcnt lgkmcnt(6)
v_mfma_f32_16x16x32_bf16 v[56:59], v[140:143], v[176:179], v[56:59]
ds_read_b64_tr_b16 v[156:157], v230 offset:45056
v_mfma_f32_16x16x32_bf16 v[60:63], v[140:143], v[180:183], v[60:63]
ds_read_b64_tr_b16 v[158:159], v230 offset:47104
s_waitcnt lgkmcnt(6)
v_mfma_f32_16x16x32_bf16 v[32:35], v[144:147], v[184:187], v[32:35]
s_waitcnt vmcnt(15)
s_barrier
ds_read_b64_tr_b16 v[128:129], v227 offset:49152
buffer_load_dwordx4 v[176:179], v224, s[72:75], s25 offen sc1
v_mfma_f32_16x16x32_bf16 v[36:39], v[144:147], v[188:191], v[36:39]
ds_read_b64_tr_b16 v[130:131], v227 offset:51200
s_waitcnt lgkmcnt(6)
v_mfma_f32_16x16x32_bf16 v[40:43], v[148:151], v[184:187], v[40:43]
ds_read_b64_tr_b16 v[132:133], v228 offset:49152
s_add_u32 m0, s27, 36864
v_mfma_f32_16x16x32_bf16 v[44:47], v[148:151], v[188:191], v[44:47]
ds_read_b64_tr_b16 v[134:135], v228 offset:51200
buffer_load_dwordx4 v226, s[76:79], s26 offen lds
s_add_u32 s26, s26, 65536
s_waitcnt lgkmcnt(6)
v_mfma_f32_16x16x32_bf16 v[48:51], v[152:155], v[184:187], v[48:51]
ds_read_b64_tr_b16 v[136:137], v229 offset:49152
v_mfma_f32_16x16x32_bf16 v[52:55], v[152:155], v[188:191], v[52:55]
ds_read_b64_tr_b16 v[138:139], v229 offset:51200
buffer_load_dwordx4 v[180:183], v225, s[72:75], s25 offen sc1
s_add_u32 s25, s25, 1024
s_waitcnt lgkmcnt(6)
v_mfma_f32_16x16x32_bf16 v[56:59], v[156:159], v[184:187], v[56:59]
ds_read_b64_tr_b16 v[140:141], v230 offset:49152
v_mfma_f32_16x16x32_bf16 v[60:63], v[156:159], v[188:191], v[60:63]
ds_read_b64_tr_b16 v[142:143], v230 offset:51200
s_waitcnt lgkmcnt(6)
v_mfma_f32_16x16x32_bf16 v[32:35], v[128:131], v[192:195], v[32:35]
s_waitcnt vmcnt(15)
s_barrier
ds_read_b64_tr_b16 v[144:145], v227 offset:53248
buffer_load_dwordx4 v[184:187], v224, s[72:75], s25 offen sc1
v_mfma_f32_16x16x32_bf16 v[36:39], v[128:131], v[196:199], v[36:39]
ds_read_b64_tr_b16 v[146:147], v227 offset:55296
s_waitcnt lgkmcnt(6)
v_mfma_f32_16x16x32_bf16 v[40:43], v[132:135], v[192:195], v[40:43]
ds_read_b64_tr_b16 v[148:149], v228 offset:53248
s_add_u32 m0, s27, 40960
v_mfma_f32_16x16x32_bf16 v[44:47], v[132:135], v[196:199], v[44:47]
ds_read_b64_tr_b16 v[150:151], v228 offset:55296
buffer_load_dwordx4 v226, s[76:79], s26 offen lds
s_add_u32 s26, s26, 65536
s_waitcnt lgkmcnt(6)
v_mfma_f32_16x16x32_bf16 v[48:51], v[136:139], v[192:195], v[48:51]
ds_read_b64_tr_b16 v[152:153], v229 offset:53248
v_mfma_f32_16x16x32_bf16 v[52:55], v[136:139], v[196:199], v[52:55]
ds_read_b64_tr_b16 v[154:155], v229 offset:55296
buffer_load_dwordx4 v[188:191], v225, s[72:75], s25 offen sc1
s_add_u32 s25, s25, 1024
s_waitcnt lgkmcnt(6)
v_mfma_f32_16x16x32_bf16 v[56:59], v[140:143], v[192:195], v[56:59]
ds_read_b64_tr_b16 v[156:157], v230 offset:53248
v_mfma_f32_16x16x32_bf16 v[60:63], v[140:143], v[196:199], v[60:63]
ds_read_b64_tr_b16 v[158:159], v230 offset:55296
s_waitcnt lgkmcnt(6)
v_mfma_f32_16x16x32_bf16 v[32:35], v[144:147], v[200:203], v[32:35]
s_waitcnt vmcnt(15)
s_barrier
ds_read_b64_tr_b16 v[128:129], v227 offset:57344
buffer_load_dwordx4 v[192:195], v224, s[72:75], s25 offen sc1
v_mfma_f32_16x16x32_bf16 v[36:39], v[144:147], v[204:207], v[36:39]
ds_read_b64_tr_b16 v[130:131], v227 offset:59392
s_waitcnt lgkmcnt(6)
v_mfma_f32_16x16x32_bf16 v[40:43], v[148:151], v[200:203], v[40:43]
ds_read_b64_tr_b16 v[132:133], v228 offset:57344
s_add_u32 m0, s27, 45056
v_mfma_f32_16x16x32_bf16 v[44:47], v[148:151], v[204:207], v[44:47]
ds_read_b64_tr_b16 v[134:135], v228 offset:59392
buffer_load_dwordx4 v226, s[76:79], s26 offen lds
s_add_u32 s26, s26, 65536
s_waitcnt lgkmcnt(6)
v_mfma_f32_16x16x32_bf16 v[48:51], v[152:155], v[200:203], v[48:51]
ds_read_b64_tr_b16 v[136:137], v229 offset:57344
v_mfma_f32_16x16x32_bf16 v[52:55], v[152:155], v[204:207], v[52:55]
ds_read_b64_tr_b16 v[138:139], v229 offset:59392
buffer_load_dwordx4 v[196:199], v225, s[72:75], s25 offen sc1
s_add_u32 s25, s25, 1024
s_waitcnt lgkmcnt(6)
v_mfma_f32_16x16x32_bf16 v[56:59], v[156:159], v[200:203], v[56:59]
ds_read_b64_tr_b16 v[140:141], v230 offset:57344
v_mfma_f32_16x16x32_bf16 v[60:63], v[156:159], v[204:207], v[60:63]
ds_read_b64_tr_b16 v[142:143], v230 offset:59392
s_waitcnt lgkmcnt(6)
v_mfma_f32_16x16x32_bf16 v[32:35], v[128:131], v[208:211], v[32:35]
s_waitcnt vmcnt(15)
s_barrier
ds_read_b64_tr_b16 v[144:145], v227 offset:61440
buffer_load_dwordx4 v[200:203], v224, s[72:75], s25 offen sc1
v_mfma_f32_16x16x32_bf16 v[36:39], v[128:131], v[212:215], v[36:39]
ds_read_b64_tr_b16 v[146:147], v227 offset:63488
s_waitcnt lgkmcnt(6)
v_mfma_f32_16x16x32_bf16 v[40:43], v[132:135], v[208:211], v[40:43]
ds_read_b64_tr_b16 v[148:149], v228 offset:61440
s_add_u32 m0, s27, 49152
v_mfma_f32_16x16x32_bf16 v[44:47], v[132:135], v[212:215], v[44:47]
ds_read_b64_tr_b16 v[150:151], v228 offset:63488
buffer_load_dwordx4 v226, s[76:79], s26 offen lds
s_add_u32 s26, s26, 65536
s_waitcnt lgkmcnt(6)
v_mfma_f32_16x16x32_bf16 v[48:51], v[136:139], v[208:211], v[48:51]
ds_read_b64_tr_b16 v[152:153], v229 offset:61440
v_mfma_f32_16x16x32_bf16 v[52:55], v[136:139], v[212:215], v[52:55]
ds_read_b64_tr_b16 v[154:155], v229 offset:63488
buffer_load_dwordx4 v[204:207], v225, s[72:75], s25 offen sc1
s_add_u32 s25, s25, 1024
s_waitcnt lgkmcnt(6)
v_mfma_f32_16x16x32_bf16 v[56:59], v[140:143], v[208:211], v[56:59]
ds_read_b64_tr_b16 v[156:157], v230 offset:61440
v_mfma_f32_16x16x32_bf16 v[60:63], v[140:143], v[212:215], v[60:63]
ds_read_b64_tr_b16 v[158:159], v230 offset:63488
s_waitcnt lgkmcnt(6)
v_mfma_f32_16x16x32_bf16 v[32:35], v[144:147], v[216:219], v[32:35]
s_waitcnt vmcnt(15)
s_barrier
ds_read_b64_tr_b16 v[128:129], v227 offset:0
buffer_load_dwordx4 v[208:211], v224, s[72:75], s25 offen sc1
v_mfma_f32_16x16x32_bf16 v[36:39], v[144:147], v[220:223], v[36:39]
ds_read_b64_tr_b16 v[130:131], v227 offset:2048
s_waitcnt lgkmcnt(6)
v_mfma_f32_16x16x32_bf16 v[40:43], v[148:151], v[216:219], v[40:43]
ds_read_b64_tr_b16 v[132:133], v228 offset:0
s_add_u32 m0, s27, 53248
v_mfma_f32_16x16x32_bf16 v[44:47], v[148:151], v[220:223], v[44:47]
ds_read_b64_tr_b16 v[134:135], v228 offset:2048
buffer_load_dwordx4 v226, s[76:79], s26 offen lds
s_add_u32 s26, s26, 65536
s_waitcnt lgkmcnt(6)
v_mfma_f32_16x16x32_bf16 v[48:51], v[152:155], v[216:219], v[48:51]
ds_read_b64_tr_b16 v[136:137], v229 offset:0
v_mfma_f32_16x16x32_bf16 v[52:55], v[152:155], v[220:223], v[52:55]
ds_read_b64_tr_b16 v[138:139], v229 offset:2048
buffer_load_dwordx4 v[212:215], v225, s[72:75], s25 offen sc1
s_add_u32 s25, s25, 1024
s_waitcnt lgkmcnt(6)
v_mfma_f32_16x16x32_bf16 v[56:59], v[156:159], v[216:219], v[56:59]
ds_read_b64_tr_b16 v[140:141], v230 offset:0
v_mfma_f32_16x16x32_bf16 v[60:63], v[156:159], v[220:223], v[60:63]
ds_read_b64_tr_b16 v[142:143], v230 offset:2048
s_waitcnt lgkmcnt(6)
v_mfma_f32_16x16x32_bf16 v[32:35], v[128:131], v[160:163], v[32:35]
s_waitcnt vmcnt(15)
s_barrier
ds_read_b64_tr_b16 v[144:145], v227 offset:4096
buffer_load_dwordx4 v[216:219], v224, s[72:75], s25 offen sc1
v_mfma_f32_16x16x32_bf16 v[36:39], v[128:131], v[164:167], v[36:39]
ds_read_b64_tr_b16 v[146:147], v227 offset:6144
s_waitcnt lgkmcnt(6)
v_mfma_f32_16x16x32_bf16 v[40:43], v[132:135], v[160:163], v[40:43]
ds_read_b64_tr_b16 v[148:149], v228 offset:4096
s_add_u32 m0, s27, 57344
v_mfma_f32_16x16x32_bf16 v[44:47], v[132:135], v[164:167], v[44:47]
ds_read_b64_tr_b16 v[150:151], v228 offset:6144
buffer_load_dwordx4 v226, s[76:79], s26 offen lds
s_add_u32 s26, s26, 65536
s_waitcnt lgkmcnt(6)
v_mfma_f32_16x16x32_bf16 v[48:51], v[136:139], v[160:163], v[48:51]
ds_read_b64_tr_b16 v[152:153], v229 offset:4096
v_mfma_f32_16x16x32_bf16 v[52:55], v[136:139], v[164:167], v[52:55]
ds_read_b64_tr_b16 v[154:155], v229 offset:6144
buffer_load_dwordx4 v[220:223], v225, s[72:75], s25 offen sc1
s_add_u32 s25, s25, 1024
s_waitcnt lgkmcnt(6)
v_mfma_f32_16x16x32_bf16 v[56:59], v[140:143], v[160:163], v[56:59]
ds_read_b64_tr_b16 v[156:157], v230 offset:4096
v_mfma_f32_16x16x32_bf16 v[60:63], v[140:143], v[164:167], v[60:63]
ds_read_b64_tr_b16 v[158:159], v230 offset:6144
s_waitcnt lgkmcnt(6)
v_mfma_f32_16x16x32_bf16 v[32:35], v[144:147], v[168:171], v[32:35]
s_waitcnt vmcnt(15)
s_barrier
ds_read_b64_tr_b16 v[128:129], v227 offset:8192
buffer_load_dwordx4 v[160:163], v224, s[72:75], s25 offen sc1
v_mfma_f32_16x16x32_bf16 v[36:39], v[144:147], v[172:175], v[36:39]
ds_read_b64_tr_b16 v[130:131], v227 offset:10240
s_waitcnt lgkmcnt(6)
v_mfma_f32_16x16x32_bf16 v[40:43], v[148:151], v[168:171], v[40:43]
ds_read_b64_tr_b16 v[132:133], v228 offset:8192
s_add_u32 m0, s27, 61440
v_mfma_f32_16x16x32_bf16 v[44:47], v[148:151], v[172:175], v[44:47]
ds_read_b64_tr_b16 v[134:135], v228 offset:10240
buffer_load_dwordx4 v226, s[76:79], s26 offen lds
s_add_u32 s26, s26, 65536
s_waitcnt lgkmcnt(6)
v_mfma_f32_16x16x32_bf16 v[48:51], v[152:155], v[168:171], v[48:51]
ds_read_b64_tr_b16 v[136:137], v229 offset:8192
v_mfma_f32_16x16x32_bf16 v[52:55], v[152:155], v[172:175], v[52:55]
ds_read_b64_tr_b16 v[138:139], v229 offset:10240
buffer_load_dwordx4 v[164:167], v225, s[72:75], s25 offen sc1
s_add_u32 s25, s25, 1024
s_waitcnt lgkmcnt(6)
v_mfma_f32_16x16x32_bf16 v[56:59], v[156:159], v[168:171], v[56:59]
ds_read_b64_tr_b16 v[140:141], v230 offset:8192
v_mfma_f32_16x16x32_bf16 v[60:63], v[156:159], v[172:175], v[60:63]
ds_read_b64_tr_b16 v[142:143], v230 offset:10240
s_waitcnt lgkmcnt(6)
v_mfma_f32_16x16x32_bf16 v[32:35], v[128:131], v[176:179], v[32:35]
s_waitcnt vmcnt(15)
s_barrier
ds_read_b64_tr_b16 v[144:145], v227 offset:12288
v_mfma_f32_16x16x32_bf16 v[36:39], v[128:131], v[180:183], v[36:39]
ds_read_b64_tr_b16 v[146:147], v227 offset:14336
buffer_load_dwordx4 v[168:171], v224, s[72:75], s25 offen sc1
s_waitcnt lgkmcnt(6)
v_mfma_f32_16x16x32_bf16 v[40:43], v[132:135], v[176:179], v[40:43]
ds_read_b64_tr_b16 v[148:149], v228 offset:12288
v_mfma_f32_16x16x32_bf16 v[44:47], v[132:135], v[180:183], v[44:47]
ds_read_b64_tr_b16 v[150:151], v228 offset:14336
s_waitcnt lgkmcnt(6)
v_mfma_f32_16x16x32_bf16 v[48:51], v[136:139], v[176:179], v[48:51]
ds_read_b64_tr_b16 v[152:153], v229 offset:12288
v_mfma_f32_16x16x32_bf16 v[52:55], v[136:139], v[180:183], v[52:55]
ds_read_b64_tr_b16 v[154:155], v229 offset:14336
buffer_load_dwordx4 v[172:175], v225, s[72:75], s25 offen sc1
s_add_u32 s25, s25, 1024
s_waitcnt lgkmcnt(6)
v_mfma_f32_16x16x32_bf16 v[56:59], v[140:143], v[176:179], v[56:59]
ds_read_b64_tr_b16 v[156:157], v230 offset:12288
v_mfma_f32_16x16x32_bf16 v[60:63], v[140:143], v[180:183], v[60:63]
ds_read_b64_tr_b16 v[158:159], v230 offset:14336
s_waitcnt lgkmcnt(6)
v_mfma_f32_16x16x32_bf16 v[32:35], v[144:147], v[184:187], v[32:35]
s_waitcnt vmcnt(14)
s_barrier
ds_read_b64_tr_b16 v[128:129], v227 offset:16384
v_mfma_f32_16x16x32_bf16 v[36:39], v[144:147], v[188:191], v[36:39]
ds_read_b64_tr_b16 v[130:131], v227 offset:18432
buffer_load_dwordx4 v[176:179], v224, s[72:75], s25 offen sc1
s_waitcnt lgkmcnt(6)
v_mfma_f32_16x16x32_bf16 v[40:43], v[148:151], v[184:187], v[40:43]
ds_read_b64_tr_b16 v[132:133], v228 offset:16384
v_mfma_f32_16x16x32_bf16 v[44:47], v[148:151], v[188:191], v[44:47]
ds_read_b64_tr_b16 v[134:135], v228 offset:18432
s_waitcnt lgkmcnt(6)
v_mfma_f32_16x16x32_bf16 v[48:51], v[152:155], v[184:187], v[48:51]
ds_read_b64_tr_b16 v[136:137], v229 offset:16384
v_mfma_f32_16x16x32_bf16 v[52:55], v[152:155], v[188:191], v[52:55]
ds_read_b64_tr_b16 v[138:139], v229 offset:18432
buffer_load_dwordx4 v[180:183], v225, s[72:75], s25 offen sc1
s_add_u32 s25, s25, 1024
s_waitcnt lgkmcnt(6)
v_mfma_f32_16x16x32_bf16 v[56:59], v[156:159], v[184:187], v[56:59]
ds_read_b64_tr_b16 v[140:141], v230 offset:16384
v_mfma_f32_16x16x32_bf16 v[60:63], v[156:159], v[188:191], v[60:63]
ds_read_b64_tr_b16 v[142:143], v230 offset:18432
s_waitcnt lgkmcnt(6)
v_mfma_f32_16x16x32_bf16 v[32:35], v[128:131], v[192:195], v[32:35]
s_waitcnt vmcnt(13)
s_barrier
ds_read_b64_tr_b16 v[144:145], v227 offset:20480
v_mfma_f32_16x16x32_bf16 v[36:39], v[128:131], v[196:199], v[36:39]
ds_read_b64_tr_b16 v[146:147], v227 offset:22528
buffer_load_dwordx4 v[184:187], v224, s[72:75], s25 offen sc1
s_waitcnt lgkmcnt(6)
v_mfma_f32_16x16x32_bf16 v[40:43], v[132:135], v[192:195], v[40:43]
ds_read_b64_tr_b16 v[148:149], v228 offset:20480
v_mfma_f32_16x16x32_bf16 v[44:47], v[132:135], v[196:199], v[44:47]
ds_read_b64_tr_b16 v[150:151], v228 offset:22528
s_waitcnt lgkmcnt(6)
v_mfma_f32_16x16x32_bf16 v[48:51], v[136:139], v[192:195], v[48:51]
ds_read_b64_tr_b16 v[152:153], v229 offset:20480
v_mfma_f32_16x16x32_bf16 v[52:55], v[136:139], v[196:199], v[52:55]
ds_read_b64_tr_b16 v[154:155], v229 offset:22528
buffer_load_dwordx4 v[188:191], v225, s[72:75], s25 offen sc1
s_add_u32 s25, s25, 1024
s_waitcnt lgkmcnt(6)
v_mfma_f32_16x16x32_bf16 v[56:59], v[140:143], v[192:195], v[56:59]
ds_read_b64_tr_b16 v[156:157], v230 offset:20480
v_mfma_f32_16x16x32_bf16 v[60:63], v[140:143], v[196:199], v[60:63]
ds_read_b64_tr_b16 v[158:159], v230 offset:22528
s_waitcnt lgkmcnt(6)
v_mfma_f32_16x16x32_bf16 v[32:35], v[144:147], v[200:203], v[32:35]
s_waitcnt vmcnt(12)
s_barrier
ds_read_b64_tr_b16 v[128:129], v227 offset:24576
v_mfma_f32_16x16x32_bf16 v[36:39], v[144:147], v[204:207], v[36:39]
ds_read_b64_tr_b16 v[130:131], v227 offset:26624
buffer_load_dwordx4 v[192:195], v224, s[72:75], s25 offen sc1
s_waitcnt lgkmcnt(6)
v_mfma_f32_16x16x32_bf16 v[40:43], v[148:151], v[200:203], v[40:43]
ds_read_b64_tr_b16 v[132:133], v228 offset:24576
v_mfma_f32_16x16x32_bf16 v[44:47], v[148:151], v[204:207], v[44:47]
ds_read_b64_tr_b16 v[134:135], v228 offset:26624
s_waitcnt lgkmcnt(6)
v_mfma_f32_16x16x32_bf16 v[48:51], v[152:155], v[200:203], v[48:51]
ds_read_b64_tr_b16 v[136:137], v229 offset:24576
v_mfma_f32_16x16x32_bf16 v[52:55], v[152:155], v[204:207], v[52:55]
ds_read_b64_tr_b16 v[138:139], v229 offset:26624
buffer_load_dwordx4 v[196:199], v225, s[72:75], s25 offen sc1
s_add_u32 s25, s25, 1024
s_waitcnt lgkmcnt(6)
v_mfma_f32_16x16x32_bf16 v[56:59], v[156:159], v[200:203], v[56:59]
ds_read_b64_tr_b16 v[140:141], v230 offset:24576
v_mfma_f32_16x16x32_bf16 v[60:63], v[156:159], v[204:207], v[60:63]
ds_read_b64_tr_b16 v[142:143], v230 offset:26624
s_waitcnt lgkmcnt(6)
v_mfma_f32_16x16x32_bf16 v[32:35], v[128:131], v[208:211], v[32:35]
s_waitcnt vmcnt(11)
s_barrier
ds_read_b64_tr_b16 v[144:145], v227 offset:28672
v_mfma_f32_16x16x32_bf16 v[36:39], v[128:131], v[212:215], v[36:39]
ds_read_b64_tr_b16 v[146:147], v227 offset:30720
buffer_load_dwordx4 v[200:203], v224, s[72:75], s25 offen sc1
s_waitcnt lgkmcnt(6)
v_mfma_f32_16x16x32_bf16 v[40:43], v[132:135], v[208:211], v[40:43]
ds_read_b64_tr_b16 v[148:149], v228 offset:28672
v_mfma_f32_16x16x32_bf16 v[44:47], v[132:135], v[212:215], v[44:47]
ds_read_b64_tr_b16 v[150:151], v228 offset:30720
s_waitcnt lgkmcnt(6)
v_mfma_f32_16x16x32_bf16 v[48:51], v[136:139], v[208:211], v[48:51]
ds_read_b64_tr_b16 v[152:153], v229 offset:28672
v_mfma_f32_16x16x32_bf16 v[52:55], v[136:139], v[212:215], v[52:55]
ds_read_b64_tr_b16 v[154:155], v229 offset:30720
buffer_load_dwordx4 v[204:207], v225, s[72:75], s25 offen sc1
s_add_u32 s25, s25, 1024
s_waitcnt lgkmcnt(6)
v_mfma_f32_16x16x32_bf16 v[56:59], v[140:143], v[208:211], v[56:59]
ds_read_b64_tr_b16 v[156:157], v230 offset:28672
v_mfma_f32_16x16x32_bf16 v[60:63], v[140:143], v[212:215], v[60:63]
ds_read_b64_tr_b16 v[158:159], v230 offset:30720
s_waitcnt lgkmcnt(6)
v_mfma_f32_16x16x32_bf16 v[32:35], v[144:147], v[216:219], v[32:35]
s_waitcnt vmcnt(10)
s_barrier
ds_read_b64_tr_b16 v[128:129], v227 offset:32768
v_mfma_f32_16x16x32_bf16 v[36:39], v[144:147], v[220:223], v[36:39]
ds_read_b64_tr_b16 v[130:131], v227 offset:34816
buffer_load_dwordx4 v[208:211], v224, s[72:75], s25 offen sc1
s_waitcnt lgkmcnt(6)
v_mfma_f32_16x16x32_bf16 v[40:43], v[148:151], v[216:219], v[40:43]
ds_read_b64_tr_b16 v[132:133], v228 offset:32768
v_mfma_f32_16x16x32_bf16 v[44:47], v[148:151], v[220:223], v[44:47]
ds_read_b64_tr_b16 v[134:135], v228 offset:34816
s_waitcnt lgkmcnt(6)
v_mfma_f32_16x16x32_bf16 v[48:51], v[152:155], v[216:219], v[48:51]
ds_read_b64_tr_b16 v[136:137], v229 offset:32768
v_mfma_f32_16x16x32_bf16 v[52:55], v[152:155], v[220:223], v[52:55]
ds_read_b64_tr_b16 v[138:139], v229 offset:34816
buffer_load_dwordx4 v[212:215], v225, s[72:75], s25 offen sc1
s_add_u32 s25, s25, 1024
s_waitcnt lgkmcnt(6)
v_mfma_f32_16x16x32_bf16 v[56:59], v[156:159], v[216:219], v[56:59]
ds_read_b64_tr_b16 v[140:141], v230 offset:32768
v_mfma_f32_16x16x32_bf16 v[60:63], v[156:159], v[220:223], v[60:63]
ds_read_b64_tr_b16 v[142:143], v230 offset:34816
s_waitcnt lgkmcnt(6)
v_mfma_f32_16x16x32_bf16 v[32:35], v[128:131], v[160:163], v[32:35]
s_waitcnt vmcnt(10)
s_barrier
ds_read_b64_tr_b16 v[144:145], v227 offset:36864
v_mfma_f32_16x16x32_bf16 v[36:39], v[128:131], v[164:167], v[36:39]
ds_read_b64_tr_b16 v[146:147], v227 offset:38912
buffer_load_dwordx4 v[216:219], v224, s[72:75], s25 offen sc1
s_waitcnt lgkmcnt(6)
v_mfma_f32_16x16x32_bf16 v[40:43], v[132:135], v[160:163], v[40:43]
ds_read_b64_tr_b16 v[148:149], v228 offset:36864
v_mfma_f32_16x16x32_bf16 v[44:47], v[132:135], v[164:167], v[44:47]
ds_read_b64_tr_b16 v[150:151], v228 offset:38912
s_waitcnt lgkmcnt(6)
v_mfma_f32_16x16x32_bf16 v[48:51], v[136:139], v[160:163], v[48:51]
ds_read_b64_tr_b16 v[152:153], v229 offset:36864
v_mfma_f32_16x16x32_bf16 v[52:55], v[136:139], v[164:167], v[52:55]
ds_read_b64_tr_b16 v[154:155], v229 offset:38912
buffer_load_dwordx4 v[220:223], v225, s[72:75], s25 offen sc1
s_add_u32 s25, s25, 1024
s_waitcnt lgkmcnt(6)
v_mfma_f32_16x16x32_bf16 v[56:59], v[140:143], v[160:163], v[56:59]
ds_read_b64_tr_b16 v[156:157], v230 offset:36864
v_mfma_f32_16x16x32_bf16 v[60:63], v[140:143], v[164:167], v[60:63]
ds_read_b64_tr_b16 v[158:159], v230 offset:38912
s_waitcnt lgkmcnt(6)
v_mfma_f32_16x16x32_bf16 v[32:35], v[144:147], v[168:171], v[32:35]
s_waitcnt vmcnt(10)
s_barrier
ds_read_b64_tr_b16 v[128:129], v227 offset:40960
v_mfma_f32_16x16x32_bf16 v[36:39], v[144:147], v[172:175], v[36:39]
ds_read_b64_tr_b16 v[130:131], v227 offset:43008
s_waitcnt lgkmcnt(6)
v_mfma_f32_16x16x32_bf16 v[40:43], v[148:151], v[168:171], v[40:43]
ds_read_b64_tr_b16 v[132:133], v228 offset:40960
v_mfma_f32_16x16x32_bf16 v[44:47], v[148:151], v[172:175], v[44:47]
ds_read_b64_tr_b16 v[134:135], v228 offset:43008
s_waitcnt lgkmcnt(6)
v_mfma_f32_16x16x32_bf16 v[48:51], v[152:155], v[168:171], v[48:51]
ds_read_b64_tr_b16 v[136:137], v229 offset:40960
v_mfma_f32_16x16x32_bf16 v[52:55], v[152:155], v[172:175], v[52:55]
ds_read_b64_tr_b16 v[138:139], v229 offset:43008
s_waitcnt lgkmcnt(6)
v_mfma_f32_16x16x32_bf16 v[56:59], v[156:159], v[168:171], v[56:59]
ds_read_b64_tr_b16 v[140:141], v230 offset:40960
v_mfma_f32_16x16x32_bf16 v[60:63], v[156:159], v[172:175], v[60:63]
ds_read_b64_tr_b16 v[142:143], v230 offset:43008
s_waitcnt lgkmcnt(6)
v_mfma_f32_16x16x32_bf16 v[32:35], v[128:131], v[176:179], v[32:35]
s_waitcnt vmcnt(8)
s_barrier
ds_read_b64_tr_b16 v[144:145], v227 offset:45056
v_mfma_f32_16x16x32_bf16 v[36:39], v[128:131], v[180:183], v[36:39]
ds_read_b64_tr_b16 v[146:147], v227 offset:47104
s_waitcnt lgkmcnt(6)
v_mfma_f32_16x16x32_bf16 v[40:43], v[132:135], v[176:179], v[40:43]
ds_read_b64_tr_b16 v[148:149], v228 offset:45056
v_mfma_f32_16x16x32_bf16 v[44:47], v[132:135], v[180:183], v[44:47]
ds_read_b64_tr_b16 v[150:151], v228 offset:47104
s_waitcnt lgkmcnt(6)
v_mfma_f32_16x16x32_bf16 v[48:51], v[136:139], v[176:179], v[48:51]
ds_read_b64_tr_b16 v[152:153], v229 offset:45056
v_mfma_f32_16x16x32_bf16 v[52:55], v[136:139], v[180:183], v[52:55]
ds_read_b64_tr_b16 v[154:155], v229 offset:47104
s_waitcnt lgkmcnt(6)
v_mfma_f32_16x16x32_bf16 v[56:59], v[140:143], v[176:179], v[56:59]
ds_read_b64_tr_b16 v[156:157], v230 offset:45056
v_mfma_f32_16x16x32_bf16 v[60:63], v[140:143], v[180:183], v[60:63]
ds_read_b64_tr_b16 v[158:159], v230 offset:47104
s_waitcnt lgkmcnt(6)
v_mfma_f32_16x16x32_bf16 v[32:35], v[144:147], v[184:187], v[32:35]
s_waitcnt vmcnt(6)
s_barrier
ds_read_b64_tr_b16 v[128:129], v227 offset:49152
v_mfma_f32_16x16x32_bf16 v[36:39], v[144:147], v[188:191], v[36:39]
ds_read_b64_tr_b16 v[130:131], v227 offset:51200
s_waitcnt lgkmcnt(6)
v_mfma_f32_16x16x32_bf16 v[40:43], v[148:151], v[184:187], v[40:43]
ds_read_b64_tr_b16 v[132:133], v228 offset:49152
v_mfma_f32_16x16x32_bf16 v[44:47], v[148:151], v[188:191], v[44:47]
ds_read_b64_tr_b16 v[134:135], v228 offset:51200
s_waitcnt lgkmcnt(6)
v_mfma_f32_16x16x32_bf16 v[48:51], v[152:155], v[184:187], v[48:51]
ds_read_b64_tr_b16 v[136:137], v229 offset:49152
v_mfma_f32_16x16x32_bf16 v[52:55], v[152:155], v[188:191], v[52:55]
ds_read_b64_tr_b16 v[138:139], v229 offset:51200
s_waitcnt lgkmcnt(6)
v_mfma_f32_16x16x32_bf16 v[56:59], v[156:159], v[184:187], v[56:59]
ds_read_b64_tr_b16 v[140:141], v230 offset:49152
v_mfma_f32_16x16x32_bf16 v[60:63], v[156:159], v[188:191], v[60:63]
ds_read_b64_tr_b16 v[142:143], v230 offset:51200
s_waitcnt lgkmcnt(6)
v_mfma_f32_16x16x32_bf16 v[32:35], v[128:131], v[192:195], v[32:35]
s_waitcnt vmcnt(4)
s_barrier
ds_read_b64_tr_b16 v[144:145], v227 offset:53248
v_mfma_f32_16x16x32_bf16 v[36:39], v[128:131], v[196:199], v[36:39]
ds_read_b64_tr_b16 v[146:147], v227 offset:55296
s_waitcnt lgkmcnt(6)
v_mfma_f32_16x16x32_bf16 v[40:43], v[132:135], v[192:195], v[40:43]
ds_read_b64_tr_b16 v[148:149], v228 offset:53248
v_mfma_f32_16x16x32_bf16 v[44:47], v[132:135], v[196:199], v[44:47]
ds_read_b64_tr_b16 v[150:151], v228 offset:55296
s_waitcnt lgkmcnt(6)
v_mfma_f32_16x16x32_bf16 v[48:51], v[136:139], v[192:195], v[48:51]
ds_read_b64_tr_b16 v[152:153], v229 offset:53248
v_mfma_f32_16x16x32_bf16 v[52:55], v[136:139], v[196:199], v[52:55]
ds_read_b64_tr_b16 v[154:155], v229 offset:55296
s_waitcnt lgkmcnt(6)
v_mfma_f32_16x16x32_bf16 v[56:59], v[140:143], v[192:195], v[56:59]
ds_read_b64_tr_b16 v[156:157], v230 offset:53248
v_mfma_f32_16x16x32_bf16 v[60:63], v[140:143], v[196:199], v[60:63]
ds_read_b64_tr_b16 v[158:159], v230 offset:55296
s_waitcnt lgkmcnt(6)
v_mfma_f32_16x16x32_bf16 v[32:35], v[144:147], v[200:203], v[32:35]
s_waitcnt vmcnt(2)
s_barrier
ds_read_b64_tr_b16 v[128:129], v227 offset:57344
v_mfma_f32_16x16x32_bf16 v[36:39], v[144:147], v[204:207], v[36:39]
ds_read_b64_tr_b16 v[130:131], v227 offset:59392
s_waitcnt lgkmcnt(6)
v_mfma_f32_16x16x32_bf16 v[40:43], v[148:151], v[200:203], v[40:43]
ds_read_b64_tr_b16 v[132:133], v228 offset:57344
v_mfma_f32_16x16x32_bf16 v[44:47], v[148:151], v[204:207], v[44:47]
ds_read_b64_tr_b16 v[134:135], v228 offset:59392
s_waitcnt lgkmcnt(6)
v_mfma_f32_16x16x32_bf16 v[48:51], v[152:155], v[200:203], v[48:51]
ds_read_b64_tr_b16 v[136:137], v229 offset:57344
v_mfma_f32_16x16x32_bf16 v[52:55], v[152:155], v[204:207], v[52:55]
ds_read_b64_tr_b16 v[138:139], v229 offset:59392
s_waitcnt lgkmcnt(6)
v_mfma_f32_16x16x32_bf16 v[56:59], v[156:159], v[200:203], v[56:59]
ds_read_b64_tr_b16 v[140:141], v230 offset:57344
v_mfma_f32_16x16x32_bf16 v[60:63], v[156:159], v[204:207], v[60:63]
ds_read_b64_tr_b16 v[142:143], v230 offset:59392
s_waitcnt lgkmcnt(6)
v_mfma_f32_16x16x32_bf16 v[32:35], v[128:131], v[208:211], v[32:35]
s_waitcnt vmcnt(0)
s_barrier
ds_read_b64_tr_b16 v[144:145], v227 offset:61440
v_mfma_f32_16x16x32_bf16 v[36:39], v[128:131], v[212:215], v[36:39]
ds_read_b64_tr_b16 v[146:147], v227 offset:63488
s_waitcnt lgkmcnt(6)
v_mfma_f32_16x16x32_bf16 v[40:43], v[132:135], v[208:211], v[40:43]
ds_read_b64_tr_b16 v[148:149], v228 offset:61440
v_mfma_f32_16x16x32_bf16 v[44:47], v[132:135], v[212:215], v[44:47]
ds_read_b64_tr_b16 v[150:151], v228 offset:63488
s_waitcnt lgkmcnt(6)
v_mfma_f32_16x16x32_bf16 v[48:51], v[136:139], v[208:211], v[48:51]
ds_read_b64_tr_b16 v[152:153], v229 offset:61440
v_mfma_f32_16x16x32_bf16 v[52:55], v[136:139], v[212:215], v[52:55]
ds_read_b64_tr_b16 v[154:155], v229 offset:63488
s_waitcnt lgkmcnt(6)
v_mfma_f32_16x16x32_bf16 v[56:59], v[140:143], v[208:211], v[56:59]
ds_read_b64_tr_b16 v[156:157], v230 offset:61440
v_mfma_f32_16x16x32_bf16 v[60:63], v[140:143], v[212:215], v[60:63]
ds_read_b64_tr_b16 v[158:159], v230 offset:63488
s_waitcnt lgkmcnt(6)
v_mfma_f32_16x16x32_bf16 v[32:35], v[144:147], v[216:219], v[32:35]
v_mfma_f32_16x16x32_bf16 v[36:39], v[144:147], v[220:223], v[36:39]
s_waitcnt lgkmcnt(4)
v_mfma_f32_16x16x32_bf16 v[40:43], v[148:151], v[216:219], v[40:43]
v_mfma_f32_16x16x32_bf16 v[44:47], v[148:151], v[220:223], v[44:47]
s_waitcnt lgkmcnt(2)
v_mfma_f32_16x16x32_bf16 v[48:51], v[152:155], v[216:219], v[48:51]
v_mfma_f32_16x16x32_bf16 v[52:55], v[152:155], v[220:223], v[52:55]
s_waitcnt lgkmcnt(0)
v_mfma_f32_16x16x32_bf16 v[56:59], v[156:159], v[216:219], v[56:59]
v_mfma_f32_16x16x32_bf16 v[60:63], v[156:159], v[220:223], v[60:63]
s_nop 7
v_pk_fma_f32 v[96:97], v[32:33], v[64:65], v[96:97]
v_pk_fma_f32 v[98:99], v[34:35], v[66:67], v[98:99]
v_cvt_pk_bf16_f32 v2, v96, v97
v_cvt_pk_bf16_f32 v3, v98, v99
buffer_store_dwordx2 v[2:3], v25, s[32:35], 0 offen offset:0
v_pk_fma_f32 v[100:101], v[36:37], v[68:69], v[100:101]
v_pk_fma_f32 v[102:103], v[38:39], v[70:71], v[102:103]
v_cvt_pk_bf16_f32 v4, v100, v101
v_cvt_pk_bf16_f32 v5, v102, v103
buffer_store_dwordx2 v[4:5], v26, s[32:35], 0 offen offset:0
v_pk_fma_f32 v[104:105], v[40:41], v[72:73], v[104:105]
v_pk_fma_f32 v[106:107], v[42:43], v[74:75], v[106:107]
v_cvt_pk_bf16_f32 v2, v104, v105
v_cvt_pk_bf16_f32 v3, v106, v107
buffer_store_dwordx2 v[2:3], v25, s[32:35], 0 offen offset:32
v_pk_fma_f32 v[108:109], v[44:45], v[76:77], v[108:109]
v_pk_fma_f32 v[110:111], v[46:47], v[78:79], v[110:111]
v_cvt_pk_bf16_f32 v4, v108, v109
v_cvt_pk_bf16_f32 v5, v110, v111
buffer_store_dwordx2 v[4:5], v26, s[32:35], 0 offen offset:32
v_pk_fma_f32 v[112:113], v[48:49], v[80:81], v[112:113]
v_pk_fma_f32 v[114:115], v[50:51], v[82:83], v[114:115]
v_cvt_pk_bf16_f32 v2, v112, v113
v_cvt_pk_bf16_f32 v3, v114, v115
buffer_store_dwordx2 v[2:3], v25, s[32:35], 0 offen offset:64
v_pk_fma_f32 v[116:117], v[52:53], v[84:85], v[116:117]
v_pk_fma_f32 v[118:119], v[54:55], v[86:87], v[118:119]
v_cvt_pk_bf16_f32 v4, v116, v117
v_cvt_pk_bf16_f32 v5, v118, v119
buffer_store_dwordx2 v[4:5], v26, s[32:35], 0 offen offset:64
v_pk_fma_f32 v[120:121], v[56:57], v[88:89], v[120:121]
v_pk_fma_f32 v[122:123], v[58:59], v[90:91], v[122:123]
v_cvt_pk_bf16_f32 v2, v120, v121
v_cvt_pk_bf16_f32 v3, v122, v123
buffer_store_dwordx2 v[2:3], v25, s[32:35], 0 offen offset:96
v_pk_fma_f32 v[124:125], v[60:61], v[92:93], v[124:125]
v_pk_fma_f32 v[126:127], v[62:63], v[94:95], v[126:127]
v_cvt_pk_bf16_f32 v4, v124, v125
v_cvt_pk_bf16_f32 v5, v126, v127
buffer_store_dwordx2 v[4:5], v26, s[32:35], 0 offen offset:96
L_mid_kernel_end:
s_endpgm
.section .rodata,"a"
.p2align 6
.amdhsa_kernel mid_kernel
.amdhsa_next_free_vgpr 256
.amdhsa_next_free_sgpr 102
.amdhsa_accum_offset 256
.amdhsa_group_segment_fixed_size 0
.amdhsa_kernarg_size 88
.amdhsa_user_sgpr_count 2
.amdhsa_user_sgpr_kernarg_segment_ptr 1
.amdhsa_system_sgpr_workgroup_id_x 1
.amdhsa_float_denorm_mode_32 3
.end_amdhsa_kernel
.text
```
